```python
import torch

def _softmax(x, axis=-1):
    return torch.softmax(x, dim=axis)
def _gelu(x):
    return torch.nn.functional.gelu(x, approximate="tanh")
def _silu(x):
    return torch.nn.functional.silu(x)
def _sigmoid(x):
    return torch.sigmoid(x)
def _layernorm(x, axis=-1, eps=1e-5):
    m = x.mean(dim=axis, keepdim=True)
    v = x.var(dim=axis, keepdim=True, unbiased=False)
    return (x - m) / torch.sqrt(v + eps)
def _scatter_add(tgt, idx, src, axis=0):
    return tgt.clone().index_add_(axis, idx, src)
def _segment_sum(src, seg, n):
    out = torch.zeros((n,) + src.shape[1:], dtype=src.dtype)
    return out.index_add_(0, seg, src)
def _pad(x, pw):
    flat = tuple(v for pair in reversed(pw) for v in pair)
    return torch.nn.functional.pad(x, flat)

kernel_name = 'interleave_layers__sliding_local_dilated__dense_activation_relu__prompt'

def setup_inputs():

    _w = (lambda a: (lambda t: t.to(torch.bfloat16) if t.is_floating_point() else t)(torch.as_tensor(a)))
    def _A_setup():
        B, S, D = 1, 2048, 512
        return {
            "x": _w((lambda *s: torch.randn(*s, dtype=torch.bfloat16) * 0.05)(B, S, D)),
            "wqkv": _w((lambda *s: torch.randn(*s, dtype=torch.bfloat16) * 0.05)(D, 3 * D)),
            "wo": _w((lambda *s: torch.randn(*s, dtype=torch.bfloat16) * 0.05)(D, D)),
        }
    _A_in = _A_setup()

    def _B_setup():
        B, S, D, Dff = 1, 2048, 512, 1376
        return {
            "x": _w((lambda *s: torch.randn(*s, dtype=torch.bfloat16) * 0.05)(B, S, D)),
            "w1": _w((lambda *s: torch.randn(*s, dtype=torch.bfloat16) * 0.05)(D, Dff)),
            "w2": _w((lambda *s: torch.randn(*s, dtype=torch.bfloat16) * 0.05)(Dff, D)),
        }
    _B_in = _B_setup()

    return {
        "A_x": _A_in["x"],
        "A_wqkv": _A_in["wqkv"],
        "A_wo": _A_in["wo"],
        "B_x": _B_in["x"],
        "B_w1": _B_in["w1"],
        "B_w2": _B_in["w2"],
    }

def reference(A_x, A_wqkv, A_wo, B_x, B_w1, B_w2):
    def _A_ref(x, wqkv, wo):
        B, S, D = x.shape
        H = 32; Dh = D // H
        W, dil = 8, 2
        qkv = (lambda x, *d: x.permute(*d))((x @ wqkv).reshape(B, S, 3, H, Dh), 2, 0, 3, 1, 4)
        q, k, v = qkv[0], qkv[1], qkv[2]
        scale = Dh ** -0.5
        pos = torch.arange(S)
        off = torch.arange(W) * dil
        idx = pos[:, None] - off[None, :]
        mask = idx >= 0
        idx_c = torch.where(mask, idx, 0).reshape(-1)
        kg = k[:, :, idx_c, :].reshape(B, H, S, W, Dh)
        vg = v[:, :, idx_c, :].reshape(B, H, S, W, Dh)
        logits = torch.einsum("bhsd,bhswd->bhsw", q, kg) * scale
        logits = torch.where(mask[None, None, :, :], logits, -1e9)
        attn = _softmax(logits, axis=-1)
        o = torch.einsum("bhsw,bhswd->bhsd", attn, vg)
        return (lambda x, *d: x.permute(*d))(o, 0, 2, 1, 3).reshape(B, S, D) @ wo

    def _B_ref(x, w1, w2):
        h = torch.einsum("bsd,df->bsf", x, w1)
        zero = torch.zeros_like(h)
        h = torch.maximum(h, zero)
        return torch.einsum("bsf,fd->bsd", h, w2)

    x = A_x
    x = x + _A_ref(_layernorm(x, axis=-1), A_wqkv, A_wo)
    x = x + _B_ref(_layernorm(x, axis=-1), B_w1, B_w2)
    x = x + _A_ref(_layernorm(x, axis=-1), A_wqkv, A_wo)
    x = x + _B_ref(_layernorm(x, axis=-1), B_w1, B_w2)
    return x
```

```asm
; @launch grid=(256,1,1) block=(256,1,1) lds=163840
.amdgcn_target "amdgcn-amd-amdhsa--gfx950"
.text
.p2align 12
.globl interleave_layers__sliding_local_dilated__dense_activation_relu__prompt_kernel
.p2align 8
.type interleave_layers__sliding_local_dilated__dense_activation_relu__prompt_kernel,@function
interleave_layers__sliding_local_dilated__dense_activation_relu__prompt_kernel:
    s_cmp_ge_u32 s2, 256
    s_cbranch_scc1 L_exit
    s_load_dwordx2 s[24:25], s[0:1], 0
    s_load_dwordx2 s[28:29], s[0:1], 8
    s_load_dwordx2 s[36:37], s[0:1], 64
    s_getpc_b64 s[6:7]
    s_lshr_b32 s50, s2, 3
    v_lshrrev_b32 v4, 4, v0
    s_lshl_b32 s5, s50, 11
    v_lshl_add_u32 v4, v4, 7, s5
    v_min_u32 v4, 0xa080, v4
    global_load_dword v5, v4, s[6:7]
    s_and_b32 s4, s2, 7
    s_lshl_b32 s4, s4, 5
    s_add_u32 s13, s4, s50
    s_lshl_b32 s15, s13, 13
    s_add_u32 s19, s15, 4096
    v_lshlrev_b32 v208, 4, v0
    s_mov_b32 s27, 0x20000
    s_lshl_b32 s26, s27, 4
    s_mov_b32 s31, s27
    s_mul_i32 s30, s27, 12
    v_min_u32 v6, 47, v0
    v_lshlrev_b32 v6, 7, v6
    v_lshlrev_b32 v7, 3, v6
    s_mul_i32 s4, s2, 6144
    s_mul_i32 s5, s50, 49152
    v_lshrrev_b32 v4, 6, v0
    v_and_b32 v225, 63, v0
    v_readfirstlane_b32 s48, v4
    s_waitcnt lgkmcnt(0)
    buffer_load_dwordx4 v[200:203], v208, s[24:27], s15 offen
    buffer_load_dwordx4 v[204:207], v208, s[24:27], s19 offen
    buffer_load_dword v5, v7, s[28:31], s5 offen offset:384
    s_lshl_b32 s3, s48, 8
    s_add_u32 s3, s3, s2
    s_cmp_ge_u32 s3, 128
    s_cselect_b32 s4, 40, 16
    s_cmp_ge_u32 s3, 472
    s_cselect_b32 s4, 32, s4
    s_load_dwordx2 s[32:33], s[0:1], s4
    s_lshr_b32 s49, s13, 4
    s_and_b32 s50, s50, 15
    s_mov_b32 s35, 0x20000
    s_cmp_ge_u32 s3, 472
    s_cbranch_scc1 Lw1_f_1
    s_cmp_ge_u32 s3, 128
    s_cselect_b32 s16, 43, 16
    s_cselect_b32 s17, 128, 0
    s_lshl_b32 s34, s16, 15
    s_sub_u32 s3, s3, s17
    s_and_b32 s6, s3, 7
    s_lshr_b32 s7, s3, 3
    s_lshl_b32 s20, s7, 15
    s_lshl_b32 s21, s6, 7
    s_add_u32 s20, s20, s21
    s_mul_i32 s21, s6, s16
    s_add_u32 s21, s21, s7
    s_add_u32 s21, s21, s17
    s_lshl_b32 s21, s21, 12
    s_mov_b32 s22, 1024
    s_mov_b32 s23, 0
    s_branch Lpp_f_2
Lw1_f_1:
    s_mov_b32 s34, 0x158000
    s_sub_u32 s3, s3, 472
    s_and_b32 s7, s3, 15
    s_lshr_b32 s6, s3, 4
    s_mul_i32 s20, s7, 88064
    s_lshl_b32 s21, s6, 7
    s_add_u32 s20, s20, s21
    s_lshl_b32 s21, s6, 5
    s_add_u32 s21, s21, s7
    s_lshl_b32 s21, s21, 11
    s_add_u32 s21, s21, 0x200000
    s_mov_b32 s22, 2752
    s_cmp_ge_u32 s3, 352
    s_cselect_b32 s23, 2, 1
    s_cselect_b32 s20, 0x80000000, s20
Lpp_f_2:
    v_lshrrev_b32 v6, 3, v225
    v_and_b32 v7, 7, v225
    v_mul_lo_u32 v8, s22, v6
    v_lshl_add_u32 v8, v7, 4, v8
    s_lshl_b32 s4, s22, 3
    s_sub_u32 s4, s4, 1024
    s_lshl_b32 s5, s48, 12
    s_add_u32 m0, s5, 0x20000
    s_waitcnt lgkmcnt(0)
    buffer_load_dwordx4 v8, s[32:35], s20 offen nt lds
    s_add_u32 s20, s20, s4
    buffer_load_dwordx4 v8, s[32:35], s20 offen offset:1024 nt lds
    s_add_u32 s20, s20, s4
    buffer_load_dwordx4 v8, s[32:35], s20 offen offset:2048 nt lds
    s_add_u32 s20, s20, s4
    buffer_load_dwordx4 v8, s[32:35], s20 offen offset:3072 nt lds
    s_mov_b32 s38, 0xd00000
    s_mov_b32 s39, 0x20000
    s_lshl_b32 s58, s49, 8
    s_add_u32 s58, s58, 0x3a0000
    s_lshl_b32 s55, s50, 2
    s_add_u32 s55, s55, s58
    s_lshl_b32 s57, s13, 2
    s_add_u32 s57, s57, 0x3a8000
    s_add_u32 s5, s55, 352
    s_cmp_ge_u32 s50, 8
    s_cselect_b32 s5, s5, s55
    v_mov_b32 v6, s55
    v_writelane_b32 v6, s57, 1
    v_writelane_b32 v6, s5, 2
    v_mov_b32 v4, 0
    s_cmp_eq_u32 s48, 3
    s_cselect_b32 s4, 0, 0x80000000
    s_mov_b64 exec, 7
    buffer_store_dword v4, v6, s[36:39], s4 offen sc0 sc1
    s_mov_b64 exec, -1
    s_load_dwordx2 s[40:41], s[0:1], 48
    s_load_dwordx2 s[44:45], s[0:1], 56
    s_and_b32 s51, s2, 3
    v_lshrrev_b32 v2, 4, v225
    v_and_b32 v6, 2, v2
    v_and_b32 v7, 3, v225
    v_xor_b32 v6, v6, v7
    v_lshrrev_b32 v4, 2, v225
    v_mul_u32_u24 v9, 3072, v4
    v_lshl_add_u32 v9, v6, 4, v9
    s_mul_i32 s10, s48, 98304
    s_lshl_b32 s6, s50, 6
    s_add_u32 s10, s10, s6
    s_mul_i32 s11, s48, 6144
    s_mul_i32 s9, s51, 393216
    s_add_u32 s9, s9, s10
    s_add_u32 m0, s11, 0x0
    s_nop 0
    s_nop 0
    buffer_load_dwordx4 v9, s[28:31], s9 offen lds
    buffer_load_dwordx4 v9, s[28:31], s9 offen offset:1024 lds
    buffer_load_dwordx4 v9, s[28:31], s9 offen offset:2048 lds
    s_add_u32 s9, s9, 49152
    s_add_u32 m0, s11, 0xc00
    s_nop 0
    buffer_load_dwordx4 v9, s[28:31], s9 offen lds
    buffer_load_dwordx4 v9, s[28:31], s9 offen offset:1024 lds
    buffer_load_dwordx4 v9, s[28:31], s9 offen offset:2048 lds
    s_branch L_body
    .p2align 12
L_body:
    v_lshlrev_b32 v3, 4, v225
    v_and_b32 v7, 3, v225
    v_lshrrev_b32 v4, 2, v225
    s_lshl_b32 s63, s48, 13
    s_add_u32 s63, s63, 0x18000
    s_add_u32 s52, s51, 1
    s_and_b32 s52, s52, 3
    s_add_u32 s53, s51, 2
    s_and_b32 s53, s53, 3
    s_add_u32 s54, s51, 3
    s_and_b32 s54, s54, 3
    s_mov_b32 s42, 0x200000
    s_mov_b32 s43, 0x20000
    s_mov_b32 s46, 0x100
    s_mov_b32 s47, 0x20000
    s_mov_b32 s14, 0x20000
    s_and_b32 s60, s50, 7
    s_lshl_b32 s59, s49, 3
    s_lshr_b32 s3, s50, 3
    s_lshl_b32 s3, s3, 2
    s_add_u32 s61, s59, s3
    s_lshl_b32 s3, s48, 1
    s_add_u32 s59, s59, s3
    s_mul_i32 s62, s50, 3
    s_lshl_b32 s3, s50, 1
    s_add_u32 s3, s3, 11
    s_min_u32 s62, s62, s3
    s_lshl_b32 s12, s59, 14
    v_and_b32 v1, 15, v0
    v_lshrrev_b32 v10, 1, v2
    v_mul_u32_u24 v10, 3, v10
    v_and_b32 v6, 1, v2
    v_lshlrev_b32 v6, 1, v6
    v_xor_b32 v6, v6, v10
    v_xor_b32 v6, v6, v7
    v_lshlrev_b32 v10, 10, v4
    v_lshl_add_u32 v10, v6, 4, v10
    v_and_b32 v7, 3, v225
    v_bfe_u32 v4, v225, 2, 2
    v_and_b32 v6, 1, v2
    v_mul_u32_u24 v6, 544, v6
    v_lshl_add_u32 v6, v4, 6, v6
    v_lshl_add_u32 v6, v7, 3, v6
    v_lshrrev_b32 v11, 1, v2
    v_mul_u32_u24 v11, 3072, v11
    v_add_u32 v11, v11, v6
    v_xor_b32 v12, 32, v11
    v_add_u32 v13, 49152, v11
    v_add_u32 v14, 49152, v12
    v_lshrrev_b32 v16, 1, v4
    v_mul_u32_u24 v16, 3, v16
    v_and_b32 v6, 1, v4
    v_lshlrev_b32 v6, 1, v6
    v_xor_b32 v6, v6, v16
    v_xor_b32 v6, v6, v2
    v_lshlrev_b32 v16, 6, v1
    v_lshl_add_u32 v16, v6, 4, v16
    v_add_u32 v15, s63, v16
    v_add_u32 v16, 0x24000, v16
    v_and_b32 v4, 1, v1
    v_cmp_eq_u32 s[64:65], 1, v4
    v_lshl_add_u32 v6, v2, 2, v4
    v_cmp_le_u32 s[66:67], v6, v1
    v_add_u32_e64 v6, 2, v6
    v_cmp_le_u32 s[68:69], v6, v1
    v_mov_b32 v7, 0x0c0c0c0c
    v_mov_b32 v4, 0x0c0c0100
    v_mov_b32 v6, 0x01000c0c
    v_cndmask_b32 v4, v4, v6, s[64:65]
    v_cndmask_b32 v18, v4, v7, s[66:67]
    v_cndmask_b32 v20, v7, v4, s[66:67]
    v_mov_b32 v4, 0x0c0c0302
    v_mov_b32 v6, 0x03020c0c
    v_cndmask_b32 v4, v4, v6, s[64:65]
    v_cndmask_b32 v19, v4, v7, s[68:69]
    v_cndmask_b32 v21, v7, v4, s[68:69]
    s_cmp_eq_u32 s59, 0
    s_cselect_b32 s4, 0xf149f2ca, 0
    v_mov_b32 v22, 0x3f803f80
    v_mov_b32 v26, s4
    v_mov_b32 v23, 0x3f803f80
    v_mov_b32 v27, s4
    v_mov_b32 v24, 0x3f803f80
    v_mov_b32 v28, s4
    v_mov_b32 v25, 0x3f803f80
    v_mov_b32 v29, s4
    v_lshlrev_b32 v17, 2, v1
    s_lshr_b32 s4, s60, 1
    s_lshl_b32 s4, s4, 8
    s_and_b32 s5, s60, 1
    s_lshl_b32 s5, s5, 3
    s_add_u32 s4, s4, s5
    v_lshrrev_b32 v4, 1, v2
    v_lshl_add_u32 v4, v4, 2, s4
    v_lshl_add_u32 v30, v1, 4, v4
    v_lshlrev_b32 v224, 3, v225
    v_lshlrev_b32 v4, 3, v2
    v_xor_b32 v40, v4, v224
    s_lshl_b32 s4, s48, 11
    s_add_u32 s4, s4, 0x20000
    v_add_u32 v40, s4, v40
    v_lshrrev_b32 v4, 2, v1
    v_xor_b32 v4, v4, v2
    v_lshlrev_b32 v4, 3, v4
    v_lshl_add_u32 v4, v1, 5, v4
    s_add_u32 s4, s4, 1024
    v_add_u32 v31, s4, v4
    s_lshl_b32 s4, s48, 10
    s_add_u32 s4, s4, 0x22400
    v_add_u32 v41, s4, v224
    s_and_b32 s4, s48, 1
    s_lshl_b32 s4, s4, 9
    s_add_u32 s5, s4, 0x22400
    s_add_u32 s4, s4, 0x20000
    v_add_u32 v4, s4, v4
    v_add_u32 v6, s5, v224
    s_cmp_lt_u32 s48, 2
    s_cselect_b64 vcc, -1, 0
    v_cndmask_b32 v32, v4, v6, vcc
    s_and_b32 s4, s48, 1
    s_lshl_b32 s4, s4, 5
    v_xor_b32 v33, s4, v11
    s_lshr_b32 s4, s48, 1
    s_mul_i32 s5, s4, 12288
    v_add_u32 v44, s5, v33
    s_lshl_b32 s4, s4, 10
    s_add_u32 s4, s4, 1024
    v_add_u32 v33, s4, v33
    v_add_u32 v34, 49152, v33
    v_lshlrev_b32 v35, 4, v2
    v_add_u32 v35, 0x18000, v35
    s_lshl_b32 s4, s48, 6
    s_add_u32 s4, s4, 128
    v_add_u32 v45, s4, v35
    s_lshr_b32 s4, s48, 1
    s_mul_i32 s4, s4, 6
    s_and_b32 s5, s48, 1
    s_add_u32 s4, s4, s5
    s_lshl_b32 s4, s4, 6
    v_add_u32 v46, s4, v35
    s_xor_b32 s4, s48, 1
    s_lshl_b32 s4, s4, 12
    s_add_u32 s4, s4, 0x20000
    v_add_u32 v36, s4, v3
    s_xor_b32 s4, s48, 2
    s_lshl_b32 s4, s4, 12
    s_add_u32 s4, s4, 0x20000
    v_add_u32 v37, s4, v3
    s_xor_b32 s4, s48, 3
    s_lshl_b32 s4, s4, 12
    s_add_u32 s4, s4, 0x20000
    v_add_u32 v38, s4, v3
    s_lshl_b32 s4, s48, 12
    s_add_u32 s4, s4, 0x20000
    v_add_u32 v39, s4, v3
    s_lshl_b32 s70, s62, 15
    s_lshl_b32 s4, s48, 10
    s_add_u32 s70, s70, s4
    s_add_u32 s70, s70, 0x200000
    s_cmp_lt_u32 s50, 11
    s_cselect_b32 s19, s70, 0x80000000
    s_lshr_b32 s4, s48, 1
    s_mul_i32 s4, s4, 6144
    s_and_b32 s5, s48, 1
    s_lshl_b32 s5, s5, 10
    s_add_u32 s71, s4, s5
    s_lshl_b32 s72, s60, 16
    s_lshl_b32 s4, s48, 14
    s_add_u32 s72, s72, s4
    s_mul_i32 s73, s60, 43
    s_mul_i32 s4, s48, 11
    s_add_u32 s73, s73, s4
    s_lshl_b32 s73, s73, 12
    s_add_u32 s73, s73, 0x80000
    s_add_u32 s4, s73, 40960
    s_cmp_eq_u32 s48, 3
    s_cselect_b32 s74, 0x80000000, s4
    s_lshl_b32 s4, s50, 2
    s_add_u32 s4, s4, s48
    s_lshl_b32 s4, s4, 8
    s_add_u32 s4, s4, 1024
    v_lshrrev_b32 v47, 5, v225
    v_lshl_add_u32 v47, v47, 7, s4
    v_lshrrev_b32 v6, 3, v225
    v_and_b32 v7, 7, v225
    v_lshlrev_b32 v8, 10, v6
    v_lshl_add_u32 v8, v7, 4, v8
    s_waitcnt lgkmcnt(0)
    s_lshl_b32 s4, s13, 2
    s_add_u32 s4, s4, s48
    s_lshl_b32 s4, s4, 7
    s_add_u32 s4, s4, 0x380000
    v_mov_b32 v6, s4
    s_add_u32 s5, s49, 1
    s_lshl_b32 s5, s5, 8
    s_add_u32 s5, s5, s50
    s_lshl_b32 s5, s5, 7
    s_add_u32 s5, s5, 0xb63c00
    s_lshr_b32 s7, s50, 3
    s_add_u32 s7, s7, s48
    s_cmp_eq_u32 s7, 4
    s_cselect_b32 s4, s5, s4
    v_writelane_b32 v6, s4, 1
    s_mov_b64 exec, 3
    buffer_load_dword v5, v6, s[36:39], 0 offen
    s_mov_b64 exec, -1
    s_lshl_b32 s22, s13, 3
    s_add_u32 s22, s22, s48
    s_lshl_b32 s22, s22, 3
    s_add_u32 s22, s22, 0x360000
    s_lshl_b32 s6, s49, 17
    s_sub_u32 s6, s6, 16384
    s_lshl_b32 s5, s48, 6
    s_add_u32 s6, s6, s5
    s_cmp_eq_u32 s49, 0
    s_cselect_b32 s13, 0x80000000, s6
    s_waitcnt vmcnt(13)
    v_lshlrev_b32 v208, 16, v200
    v_and_b32 v209, 0xffff0000, v200
    v_lshlrev_b32 v210, 16, v201
    v_and_b32 v211, 0xffff0000, v201
    v_lshlrev_b32 v212, 16, v202
    v_and_b32 v213, 0xffff0000, v202
    v_lshlrev_b32 v214, 16, v203
    v_and_b32 v215, 0xffff0000, v203
    v_add_f32 v216, v208, v209
    v_mul_f32 v217, v208, v208
    v_fmac_f32 v217, v209, v209
    v_add_f32 v216, v216, v210
    v_fmac_f32 v217, v210, v210
    v_add_f32 v216, v216, v211
    v_fmac_f32 v217, v211, v211
    v_add_f32 v216, v216, v212
    v_fmac_f32 v217, v212, v212
    v_add_f32 v216, v216, v213
    v_fmac_f32 v217, v213, v213
    v_add_f32 v216, v216, v214
    v_fmac_f32 v217, v214, v214
    v_add_f32 v216, v216, v215
    v_fmac_f32 v217, v215, v215
    v_lshlrev_b32 v208, 16, v204
    v_and_b32 v209, 0xffff0000, v204
    v_lshlrev_b32 v210, 16, v205
    v_and_b32 v211, 0xffff0000, v205
    v_lshlrev_b32 v212, 16, v206
    v_and_b32 v213, 0xffff0000, v206
    v_lshlrev_b32 v214, 16, v207
    v_and_b32 v215, 0xffff0000, v207
    v_add_f32 v218, v208, v209
    v_mul_f32 v219, v208, v208
    v_fmac_f32 v219, v209, v209
    v_add_f32 v218, v218, v210
    v_fmac_f32 v219, v210, v210
    v_add_f32 v218, v218, v211
    v_fmac_f32 v219, v211, v211
    v_add_f32 v218, v218, v212
    v_fmac_f32 v219, v212, v212
    v_add_f32 v218, v218, v213
    v_fmac_f32 v219, v213, v213
    v_add_f32 v218, v218, v214
    v_fmac_f32 v219, v214, v214
    v_add_f32 v218, v218, v215
    v_fmac_f32_e64 v219, v215, v215
    v_add_f32_dpp v216, v216, v216 quad_perm:[1,0,3,2] row_mask:0xf bank_mask:0xf
    v_add_f32_dpp v217, v217, v217 quad_perm:[1,0,3,2] row_mask:0xf bank_mask:0xf
    v_add_f32_dpp v218, v218, v218 quad_perm:[1,0,3,2] row_mask:0xf bank_mask:0xf
    v_add_f32_dpp v219, v219, v219 quad_perm:[1,0,3,2] row_mask:0xf bank_mask:0xf
    v_add_f32_dpp v216, v216, v216 quad_perm:[2,3,0,1] row_mask:0xf bank_mask:0xf
    v_add_f32_dpp v217, v217, v217 quad_perm:[2,3,0,1] row_mask:0xf bank_mask:0xf
    v_add_f32_dpp v218, v218, v218 quad_perm:[2,3,0,1] row_mask:0xf bank_mask:0xf
    v_add_f32_dpp v219, v219, v219 quad_perm:[2,3,0,1] row_mask:0xf bank_mask:0xf
    v_add_f32_dpp v216, v216, v216 row_half_mirror row_mask:0xf bank_mask:0xf
    v_add_f32_dpp v217, v217, v217 row_half_mirror row_mask:0xf bank_mask:0xf
    v_add_f32_dpp v218, v218, v218 row_half_mirror row_mask:0xf bank_mask:0xf
    v_add_f32_dpp v219, v219, v219 row_half_mirror row_mask:0xf bank_mask:0xf
    v_add_f32_dpp v216, v216, v216 row_mirror row_mask:0xf bank_mask:0xf
    v_add_f32_dpp v217, v217, v217 row_mirror row_mask:0xf bank_mask:0xf
    v_add_f32_dpp v218, v218, v218 row_mirror row_mask:0xf bank_mask:0xf
    v_add_f32_dpp v219, v219, v219 row_mirror row_mask:0xf bank_mask:0xf
    s_nop 0
    v_permlane32_swap_b32 v216, v218
    v_permlane32_swap_b32 v217, v219
    v_add_f32 v216, v216, v218
    v_add_f32 v217, v217, v219
    v_mov_b32 v218, v216
    v_mov_b32 v219, v217
    s_nop 0
    v_permlane16_swap_b32 v216, v218
    v_permlane16_swap_b32 v217, v219
    v_add_f32 v216, v216, v218
    v_add_f32 v217, v217, v219
    v_mul_f32 v216, 0xbb000000, v216
    v_mul_f32 v217, 0x3b000000, v217
    v_fma_f32 v217, -v216, v216, v217
    v_max_f32 v217, 0, v217
    v_add_f32 v217, 0x3727c5ac, v217
    v_rsq_f32 v217, v217
    v_bfe_u32 v6, v225, 2, 2
    v_and_b32 v7, 3, v225
    s_lshl_b32 s4, s48, 12
    s_add_u32 s4, s4, 0x20000
    s_waitcnt vmcnt(8)
    s_cmp_ge_u32 s23, 1
    s_cbranch_scc1 LB_f_3
    v_lshl_add_u32 v6, v2, 2, v6
    v_lshlrev_b32 v6, 7, v6
    v_lshl_add_u32 v6, v7, 4, v6
    v_add_u32_e64 v6, s4, v6
    ds_read_b64_tr_b16 v[48:49], v6 offset:0
    ds_read_b64_tr_b16 v[50:51], v6 offset:2048
    ds_read_b64_tr_b16 v[52:53], v6 offset:8
    ds_read_b64_tr_b16 v[54:55], v6 offset:2056
    ds_read_b64_tr_b16 v[56:57], v6 offset:64
    ds_read_b64_tr_b16 v[58:59], v6 offset:2112
    ds_read_b64_tr_b16 v[60:61], v6 offset:72
    ds_read_b64_tr_b16 v[62:63], v6 offset:2120
    s_add_u32 s20, s21, 2048
    s_branch Lst_f_4
LB_f_3:
    v_lshl_add_u32 v6, v2, 3, v6
    v_lshlrev_b32 v6, 7, v6
    v_lshl_add_u32 v6, v7, 3, v6
    v_add_u32_e64 v6, s4, v6
    ds_read_b64_tr_b16 v[48:49], v6 offset:0
    ds_read_b64_tr_b16 v[50:51], v6 offset:512
    ds_read_b64_tr_b16 v[52:53], v6 offset:32
    ds_read_b64_tr_b16 v[54:55], v6 offset:544
    ds_read_b64_tr_b16 v[56:57], v6 offset:64
    ds_read_b64_tr_b16 v[58:59], v6 offset:576
    ds_read_b64_tr_b16 v[60:61], v6 offset:96
    ds_read_b64_tr_b16 v[62:63], v6 offset:608
    s_cmp_eq_u32 s23, 2
    s_cselect_b32 s21, 0x80000000, s21
    s_add_u32 s20, s21, 32768
Lst_f_4:
    s_lshl_b32 s8, s51, 8
    s_add_u32 s8, s8, s12
    s_add_u32 m0, s63, 0x0
    s_nop 0
    buffer_load_dwordx4 v10, s[24:27], s8 offen lds
    s_add_u32 m0, s63, 0x3c0
    s_nop 0
    buffer_load_dwordx4 v10, s[24:27], s8 offen offset:64 lds
    s_add_u32 m0, s63, 0x780
    s_nop 0
    buffer_load_dwordx4 v10, s[24:27], s8 offen offset:128 lds
    s_add_u32 m0, s63, 0xb40
    s_nop 0
    buffer_load_dwordx4 v10, s[24:27], s8 offen offset:192 lds
    s_add_u32 s8, s8, 16384
    s_add_u32 m0, s63, 0x1000
    s_nop 0
    buffer_load_dwordx4 v10, s[24:27], s8 offen lds
    s_add_u32 m0, s63, 0x13c0
    s_nop 0
    buffer_load_dwordx4 v10, s[24:27], s8 offen offset:64 lds
    s_add_u32 m0, s63, 0x1780
    s_nop 0
    buffer_load_dwordx4 v10, s[24:27], s8 offen offset:128 lds
    s_add_u32 m0, s63, 0x1b40
    s_nop 0
    buffer_load_dwordx4 v10, s[24:27], s8 offen offset:192 lds
    s_lshl_b32 s4, s51, 8
    s_add_u32 s4, s4, s13
    s_lshl_b32 s5, s48, 10
    s_add_u32 m0, s5, 0x24000
    s_nop 0
    buffer_load_dwordx4 v10, s[24:27], s4 offen lds
    s_getreg_b32 s4, hwreg(HW_REG_XCC_ID, 0, 4)
    s_mul_i32 s5, s4, s4
    s_lshl_b32 s5, s5, 16
    s_lshl_b32 s4, s4, 8
    s_add_u32 s4, s4, s5
    s_add_u32 s56, s4, 1
    v_mov_b32 v6, s56
    v_and_b32 v4, 32, v225
    s_lshl_b32 s4, s49, 4
    s_cmp_eq_u32 s48, 3
    s_cselect_b32 s4, s4, 0x80000000
    s_waitcnt vmcnt(16)
    s_mov_b64 exec, 1
    buffer_atomic_add v6, off, s[44:47], s4 sc1
    s_mov_b32 exec_hi, 1
    buffer_store_dwordx2 v[216:217], v4, s[36:39], s22 offen sc0 sc1
    s_mov_b64 exec, -1
    s_waitcnt lgkmcnt(0)
    s_nop 0
    buffer_store_dwordx4 v[48:51], v3, s[36:39], s21 offen sc0 sc1
    buffer_store_dwordx4 v[52:55], v3, s[36:39], s21 offen offset:1024 sc0 sc1
    buffer_store_dwordx4 v[56:59], v3, s[36:39], s20 offen sc0 sc1
    buffer_store_dwordx4 v[60:63], v3, s[36:39], s20 offen offset:1024 sc0 sc1
    s_mul_i32 s9, s52, 393216
    s_add_u32 s9, s9, s10
    s_add_u32 m0, s11, 0x6000
    s_nop 0
    buffer_load_dwordx4 v9, s[28:31], s9 offen lds
    buffer_load_dwordx4 v9, s[28:31], s9 offen offset:1024 lds
    buffer_load_dwordx4 v9, s[28:31], s9 offen offset:2048 lds
    s_add_u32 s9, s9, 49152
    s_add_u32 m0, s11, 0x6c00
    s_nop 0
    buffer_load_dwordx4 v9, s[28:31], s9 offen lds
    buffer_load_dwordx4 v9, s[28:31], s9 offen offset:1024 lds
    buffer_load_dwordx4 v9, s[28:31], s9 offen offset:2048 lds
    v_lshlrev_b32 v6, 4, v1
    s_waitcnt vmcnt(12)
    s_barrier
    ds_read_b64_tr_b16 v[116:117], v11 offset:0
    ds_read_b64_tr_b16 v[118:119], v11 offset:256
    ds_read_b128 v[164:167], v15 offset:0
    ds_read_b128 v[168:171], v15 offset:4096
    ds_read_b64_tr_b16 v[120:121], v12 offset:0
    ds_read_b64_tr_b16 v[122:123], v12 offset:256
    ds_read_b64_tr_b16 v[124:125], v11 offset:1024
    ds_read_b64_tr_b16 v[126:127], v11 offset:1280
    ds_read_b64_tr_b16 v[128:129], v12 offset:1024
    ds_read_b64_tr_b16 v[130:131], v12 offset:1280
    ds_read_b64_tr_b16 v[132:133], v11 offset:2048
    ds_read_b64_tr_b16 v[134:135], v11 offset:2304
    ds_read_b64_tr_b16 v[136:137], v12 offset:2048
    ds_read_b64_tr_b16 v[138:139], v12 offset:2304
    s_waitcnt lgkmcnt(6)
    v_mfma_f32_16x16x32_bf16 v[64:67], v[116:119], v[164:167], 0
    s_nop 0
    ds_read_b64_tr_b16 v[140:141], v11 offset:6144
    ds_read_b128 v[172:175], v15 offset:1024
    v_mfma_f32_16x16x32_bf16 v[88:91], v[116:119], v[168:171], 0
    s_nop 0
    ds_read_b64_tr_b16 v[142:143], v11 offset:6400
    ds_read_b128 v[176:179], v15 offset:5120
    v_mfma_f32_16x16x32_bf16 v[68:71], v[120:123], v[164:167], 0
    s_nop 0
    ds_read_b64_tr_b16 v[144:145], v12 offset:6144
    ds_read_b128 v[180:183], v15 offset:2048
    v_mfma_f32_16x16x32_bf16 v[92:95], v[120:123], v[168:171], 0
    s_nop 0
    ds_read_b64_tr_b16 v[146:147], v12 offset:6400
    ds_read_b128 v[184:187], v15 offset:6144
    v_mfma_f32_16x16x32_bf16 v[72:75], v[124:127], v[164:167], 0
    s_nop 0
    ds_read_b64_tr_b16 v[148:149], v11 offset:7168
    ds_read_b128 v[188:191], v15 offset:3072
    v_mfma_f32_16x16x32_bf16 v[96:99], v[124:127], v[168:171], 0
    s_waitcnt lgkmcnt(10)
    ds_read_b64_tr_b16 v[150:151], v11 offset:7424
    ds_read_b128 v[192:195], v15 offset:7168
    v_mfma_f32_16x16x32_bf16 v[76:79], v[128:131], v[164:167], 0
    s_nop 0
    ds_read_b64_tr_b16 v[152:153], v12 offset:7168
    ds_read_b64_tr_b16 a[240:241], v33 offset:0
    v_mfma_f32_16x16x32_bf16 v[100:103], v[128:131], v[168:171], 0
    s_lshl_b32 s8, s52, 8
    ds_read_b64_tr_b16 v[154:155], v12 offset:7424
    ds_read_b64_tr_b16 a[242:243], v33 offset:256
    v_mfma_f32_16x16x32_bf16 v[80:83], v[132:135], v[164:167], 0
    s_add_u32 s8, s8, s12
    ds_read_b64_tr_b16 v[156:157], v11 offset:8192
    ds_read_b128 a[244:247], v16 offset:0
    v_mfma_f32_16x16x32_bf16 v[104:107], v[132:135], v[168:171], 0
    s_add_u32 m0, s63, 0x0
    ds_read_b64_tr_b16 v[158:159], v11 offset:8448
    v_mfma_f32_16x16x32_bf16 v[84:87], v[136:139], v[164:167], 0
    s_waitcnt lgkmcnt(7)
    ds_read_b64_tr_b16 v[160:161], v12 offset:8192
    buffer_load_dwordx4 v10, s[24:27], s8 offen lds
    v_mfma_f32_16x16x32_bf16 v[108:111], v[136:139], v[168:171], 0
    ds_read_b64_tr_b16 v[162:163], v12 offset:8448
    v_mfma_f32_16x16x32_bf16 v[64:67], v[140:143], v[172:175], v[64:67]
    s_nop 0
    ds_read_b64_tr_b16 v[116:117], v11 offset:12288
    ds_read_b64_tr_b16 a[248:249], v33 offset:6144
    v_mfma_f32_16x16x32_bf16 v[88:91], v[140:143], v[176:179], v[88:91]
    s_nop 0
    ds_read_b64_tr_b16 v[118:119], v11 offset:12544
    ds_read_b64_tr_b16 a[250:251], v33 offset:6400
    v_mfma_f32_16x16x32_bf16 v[68:71], v[144:147], v[172:175], v[68:71]
    s_add_u32 m0, s63, 0x3c0
    ds_read_b128 a[252:255], v16 offset:1024
    buffer_load_dwordx4 v10, s[24:27], s8 offen offset:64 lds
    v_mfma_f32_16x16x32_bf16 v[92:95], v[144:147], v[176:179], v[92:95]
    s_waitcnt lgkmcnt(8)
    ds_read_b64_tr_b16 v[120:121], v12 offset:12288
    v_mfma_f32_16x16x32_bf16 v[112:115], a[240:243], a[244:247], 0
    s_nop 0
    s_add_u32 m0, s63, 0x780
    ds_read_b64_tr_b16 v[122:123], v12 offset:12544
    buffer_load_dwordx4 v10, s[24:27], s8 offen offset:128 lds
    v_mfma_f32_16x16x32_bf16 v[246:249], a[240:243], v[22:25], 0
    v_mfma_f32_16x16x32_bf16 v[72:75], v[148:151], v[172:175], v[72:75]
    s_nop 0
    ds_read_b64_tr_b16 v[124:125], v11 offset:13312
    ds_read_b64_tr_b16 v[212:213], v33 offset:12288
    v_mfma_f32_16x16x32_bf16 v[96:99], v[148:151], v[176:179], v[96:99]
    s_waitcnt lgkmcnt(9)
    ds_read_b64_tr_b16 v[126:127], v11 offset:13568
    ds_read_b64_tr_b16 v[214:215], v33 offset:12544
    v_mfma_f32_16x16x32_bf16 v[76:79], v[152:155], v[172:175], v[76:79]
    s_add_u32 m0, s63, 0xb40
    ds_read_b128 v[216:219], v16 offset:2048
    buffer_load_dwordx4 v10, s[24:27], s8 offen offset:192 lds
    v_mfma_f32_16x16x32_bf16 v[100:103], v[152:155], v[176:179], v[100:103]
    s_waitcnt lgkmcnt(7)
    ds_read_b64_tr_b16 v[128:129], v12 offset:13312
    v_mfma_f32_16x16x32_bf16 v[112:115], a[248:251], a[252:255], v[112:115]
    s_add_u32 s8, s8, 16384
    s_add_u32 m0, s63, 0x1000
    ds_read_b64_tr_b16 v[130:131], v12 offset:13568
    buffer_load_dwordx4 v10, s[24:27], s8 offen lds
    v_mfma_f32_16x16x32_bf16 v[246:249], a[248:251], v[22:25], v[246:249]
    v_mfma_f32_16x16x32_bf16 v[80:83], v[156:159], v[172:175], v[80:83]
    s_nop 0
    ds_read_b64_tr_b16 v[132:133], v11 offset:14336
    ds_read_b64_tr_b16 v[220:221], v33 offset:18432
    v_mfma_f32_16x16x32_bf16 v[104:107], v[156:159], v[176:179], v[104:107]
    s_nop 0
    ds_read_b64_tr_b16 v[134:135], v11 offset:14592
    ds_read_b64_tr_b16 v[222:223], v33 offset:18688
    v_mfma_f32_16x16x32_bf16 v[84:87], v[160:163], v[172:175], v[84:87]
    s_nop 0
    s_add_u32 m0, s63, 0x13c0
    ds_read_b128 v[224:227], v16 offset:3072
    buffer_load_dwordx4 v10, s[24:27], s8 offen offset:64 lds
    v_mfma_f32_16x16x32_bf16 v[108:111], v[160:163], v[176:179], v[108:111]
    s_waitcnt lgkmcnt(7)
    ds_read_b64_tr_b16 v[136:137], v12 offset:14336
    v_mfma_f32_16x16x32_bf16 v[112:115], v[212:215], v[216:219], v[112:115]
    s_add_u32 m0, s63, 0x1780
    ds_read_b64_tr_b16 v[138:139], v12 offset:14592
    ds_read_b64_tr_b16 v[196:197], v44 offset:0
    v_mfma_f32_16x16x32_bf16 v[246:249], v[212:215], v[22:25], v[246:249]
    buffer_load_dwordx4 v10, s[24:27], s8 offen offset:128 lds
    v_mfma_f32_16x16x32_bf16 v[64:67], v[116:119], v[180:183], v[64:67]
    s_nop 0
    ds_read_b64_tr_b16 v[140:141], v11 offset:18432
    ds_read_b64_tr_b16 v[198:199], v44 offset:256
    v_mfma_f32_16x16x32_bf16 v[88:91], v[116:119], v[184:187], v[88:91]
    s_nop 0
    ds_read_b64_tr_b16 v[142:143], v11 offset:18688
    ds_read_b64_tr_b16 v[200:201], v44 offset:6144
    v_mfma_f32_16x16x32_bf16 v[68:71], v[120:123], v[180:183], v[68:71]
    s_add_u32 m0, s63, 0x1b40
    ds_read_b64_tr_b16 v[144:145], v12 offset:18432
    ds_read_b64_tr_b16 v[202:203], v44 offset:6400
    v_mfma_f32_16x16x32_bf16 v[92:95], v[120:123], v[184:187], v[92:95]
    s_waitcnt lgkmcnt(9)
    buffer_load_dwordx4 v10, s[24:27], s8 offen offset:192 lds
    v_mfma_f32_16x16x32_bf16 v[112:115], v[220:223], v[224:227], v[112:115]
    s_lshl_b32 s4, s52, 8
    s_add_u32 s4, s4, s13
    s_lshl_b32 s5, s48, 10
    ds_read_b64_tr_b16 v[146:147], v12 offset:18688
    v_mfma_f32_16x16x32_bf16 v[246:249], v[220:223], v[22:25], v[246:249]
    s_add_u32 m0, s5, 0x25000
    ds_read_b64_tr_b16 v[148:149], v11 offset:19456
    s_nop 0
    buffer_load_dwordx4 v10, s[24:27], s4 offen lds
    v_mfma_f32_16x16x32_bf16 v[72:75], v[124:127], v[180:183], v[72:75]
    s_mul_i32 s9, s53, 393216
    s_add_u32 s9, s9, s10
    s_add_u32 m0, s11, 0xc000
    ds_read_b64_tr_b16 v[150:151], v11 offset:19712
    v_mfma_f32_16x16x32_bf16 v[96:99], v[124:127], v[184:187], v[96:99]
    s_waitcnt lgkmcnt(7)
    v_mfma_f32_16x16x32_bf16 v[250:253], v[196:199], v[22:25], 0
    ds_read_b64_tr_b16 v[152:153], v12 offset:19456
    buffer_load_dwordx4 v9, s[28:31], s9 offen lds
    v_mfma_f32_16x16x32_bf16 v[76:79], v[128:131], v[180:183], v[76:79]
    s_waitcnt lgkmcnt(4)
    ds_read_b64_tr_b16 v[154:155], v12 offset:19712
    v_mfma_f32_16x16x32_bf16 v[250:253], v[200:203], v[22:25], v[250:253]
    ds_read_b64_tr_b16 v[156:157], v11 offset:20480
    v_mfma_f32_16x16x32_bf16 v[100:103], v[128:131], v[184:187], v[100:103]
    v_mfma_f32_16x16x32_bf16 v[80:83], v[132:135], v[180:183], v[80:83]
    ds_read_b64_tr_b16 v[158:159], v11 offset:20736
    buffer_load_dwordx4 v9, s[28:31], s9 offen offset:1024 lds
    v_mfma_f32_16x16x32_bf16 v[104:107], v[132:135], v[184:187], v[104:107]
    ds_read_b64_tr_b16 v[160:161], v12 offset:20480
    v_mfma_f32_16x16x32_bf16 v[84:87], v[136:139], v[180:183], v[84:87]
    ds_read_b64_tr_b16 v[162:163], v12 offset:20736
    v_mfma_f32_16x16x32_bf16 v[108:111], v[136:139], v[184:187], v[108:111]
    s_waitcnt lgkmcnt(6)
    buffer_load_dwordx4 v9, s[28:31], s9 offen offset:2048 lds
    v_mfma_f32_16x16x32_bf16 v[64:67], v[140:143], v[188:191], v[64:67]
    s_nop 0
    v_mfma_f32_16x16x32_bf16 v[88:91], v[140:143], v[192:195], v[88:91]
    s_add_u32 s9, s9, 49152
    v_mfma_f32_16x16x32_bf16 v[68:71], v[144:147], v[188:191], v[68:71]
    s_add_u32 m0, s11, 0xcc00
    s_nop 0
    buffer_load_dwordx4 v9, s[28:31], s9 offen lds
    v_mfma_f32_16x16x32_bf16 v[92:95], v[144:147], v[192:195], v[92:95]
    v_mfma_f32_16x16x32_bf16 v[72:75], v[148:151], v[188:191], v[72:75]
    v_mfma_f32_16x16x32_bf16 v[96:99], v[148:151], v[192:195], v[96:99]
    s_waitcnt lgkmcnt(0)
    buffer_load_dwordx4 v9, s[28:31], s9 offen offset:1024 lds
    v_mfma_f32_16x16x32_bf16 v[76:79], v[152:155], v[188:191], v[76:79]
    v_mfma_f32_16x16x32_bf16 v[100:103], v[152:155], v[192:195], v[100:103]
    v_mfma_f32_16x16x32_bf16 v[80:83], v[156:159], v[188:191], v[80:83]
    buffer_load_dwordx4 v9, s[28:31], s9 offen offset:2048 lds
    v_mfma_f32_16x16x32_bf16 v[104:107], v[156:159], v[192:195], v[104:107]
    v_mfma_f32_16x16x32_bf16 v[84:87], v[160:163], v[188:191], v[84:87]
    s_nop 0
    v_mfma_f32_16x16x32_bf16 v[108:111], v[160:163], v[192:195], v[108:111]
    s_waitcnt vmcnt(6)
    s_barrier
    ds_read_b64_tr_b16 v[116:117], v11 offset:24576
    ds_read_b64_tr_b16 v[118:119], v11 offset:24832
    ds_read_b128 v[164:167], v15 offset:0
    ds_read_b128 v[168:171], v15 offset:4096
    ds_read_b64_tr_b16 v[120:121], v12 offset:24576
    ds_read_b64_tr_b16 v[122:123], v12 offset:24832
    ds_read_b64_tr_b16 v[124:125], v11 offset:25600
    ds_read_b64_tr_b16 v[126:127], v11 offset:25856
    ds_read_b64_tr_b16 v[128:129], v12 offset:25600
    ds_read_b64_tr_b16 v[130:131], v12 offset:25856
    ds_read_b64_tr_b16 v[132:133], v11 offset:26624
    ds_read_b64_tr_b16 v[134:135], v11 offset:26880
    ds_read_b64_tr_b16 v[136:137], v12 offset:26624
    ds_read_b64_tr_b16 v[138:139], v12 offset:26880
    s_cmp_lg_u32 s48, 0
    s_cbranch_scc1 La_f_5
    v_mov_b32 v4, 1
    s_mov_b64 exec, 1
    buffer_store_dword v4, off, s[36:39], s57 sc0 sc1
    s_mov_b64 exec, -1
La_f_5:
    s_waitcnt lgkmcnt(6)
    v_mfma_f32_16x16x32_bf16 v[64:67], v[116:119], v[164:167], v[64:67]
    s_nop 0
    ds_read_b64_tr_b16 v[140:141], v11 offset:30720
    ds_read_b128 v[172:175], v15 offset:1024
    v_mfma_f32_16x16x32_bf16 v[88:91], v[116:119], v[168:171], v[88:91]
    s_nop 0
    ds_read_b64_tr_b16 v[142:143], v11 offset:30976
    ds_read_b128 v[176:179], v15 offset:5120
    v_mfma_f32_16x16x32_bf16 v[68:71], v[120:123], v[164:167], v[68:71]
    s_nop 0
    ds_read_b64_tr_b16 v[144:145], v12 offset:30720
    ds_read_b128 v[180:183], v15 offset:2048
    v_mfma_f32_16x16x32_bf16 v[92:95], v[120:123], v[168:171], v[92:95]
    s_nop 0
    ds_read_b64_tr_b16 v[146:147], v12 offset:30976
    ds_read_b128 v[184:187], v15 offset:6144
    v_mfma_f32_16x16x32_bf16 v[72:75], v[124:127], v[164:167], v[72:75]
    s_nop 0
    ds_read_b64_tr_b16 v[148:149], v11 offset:31744
    ds_read_b128 v[188:191], v15 offset:3072
    v_mfma_f32_16x16x32_bf16 v[96:99], v[124:127], v[168:171], v[96:99]
    s_waitcnt lgkmcnt(10)
    ds_read_b64_tr_b16 v[150:151], v11 offset:32000
    ds_read_b128 v[192:195], v15 offset:7168
    v_mfma_f32_16x16x32_bf16 v[76:79], v[128:131], v[164:167], v[76:79]
    s_nop 0
    ds_read_b64_tr_b16 v[152:153], v12 offset:31744
    ds_read_b64_tr_b16 a[240:241], v33 offset:24576
    v_mfma_f32_16x16x32_bf16 v[100:103], v[128:131], v[168:171], v[100:103]
    s_lshl_b32 s8, s53, 8
    ds_read_b64_tr_b16 v[154:155], v12 offset:32000
    ds_read_b64_tr_b16 a[242:243], v33 offset:24832
    v_mfma_f32_16x16x32_bf16 v[80:83], v[132:135], v[164:167], v[80:83]
    s_add_u32 s8, s8, s12
    ds_read_b64_tr_b16 v[156:157], v11 offset:32768
    ds_read_b128 a[244:247], v16 offset:4096
    v_mfma_f32_16x16x32_bf16 v[104:107], v[132:135], v[168:171], v[104:107]
    s_add_u32 m0, s63, 0x0
    ds_read_b64_tr_b16 v[158:159], v11 offset:33024
    v_mfma_f32_16x16x32_bf16 v[84:87], v[136:139], v[164:167], v[84:87]
    s_waitcnt lgkmcnt(7)
    ds_read_b64_tr_b16 v[160:161], v12 offset:32768
    buffer_load_dwordx4 v10, s[24:27], s8 offen lds
    v_mfma_f32_16x16x32_bf16 v[108:111], v[136:139], v[168:171], v[108:111]
    ds_read_b64_tr_b16 v[162:163], v12 offset:33024
    v_mfma_f32_16x16x32_bf16 v[64:67], v[140:143], v[172:175], v[64:67]
    s_nop 0
    ds_read_b64_tr_b16 v[116:117], v11 offset:36864
    ds_read_b64_tr_b16 a[248:249], v33 offset:30720
    v_mfma_f32_16x16x32_bf16 v[88:91], v[140:143], v[176:179], v[88:91]
    s_nop 0
    ds_read_b64_tr_b16 v[118:119], v11 offset:37120
    ds_read_b64_tr_b16 a[250:251], v33 offset:30976
    v_mfma_f32_16x16x32_bf16 v[68:71], v[144:147], v[172:175], v[68:71]
    s_add_u32 m0, s63, 0x3c0
    ds_read_b128 a[252:255], v16 offset:5120
    buffer_load_dwordx4 v10, s[24:27], s8 offen offset:64 lds
    v_mfma_f32_16x16x32_bf16 v[92:95], v[144:147], v[176:179], v[92:95]
    s_waitcnt lgkmcnt(8)
    ds_read_b64_tr_b16 v[120:121], v12 offset:36864
    v_mfma_f32_16x16x32_bf16 v[112:115], a[240:243], a[244:247], v[112:115]
    s_add_u32 m0, s63, 0x780
    ds_read_b64_tr_b16 v[122:123], v12 offset:37120
    buffer_load_dwordx4 v10, s[24:27], s8 offen offset:128 lds
    v_mfma_f32_16x16x32_bf16 v[246:249], a[240:243], v[22:25], v[246:249]
    v_mfma_f32_16x16x32_bf16 v[72:75], v[148:151], v[172:175], v[72:75]
    s_nop 0
    ds_read_b64_tr_b16 v[124:125], v11 offset:37888
    ds_read_b64_tr_b16 v[212:213], v33 offset:36864
    v_mfma_f32_16x16x32_bf16 v[96:99], v[148:151], v[176:179], v[96:99]
    s_waitcnt lgkmcnt(9)
    ds_read_b64_tr_b16 v[126:127], v11 offset:38144
    ds_read_b64_tr_b16 v[214:215], v33 offset:37120
    v_mfma_f32_16x16x32_bf16 v[76:79], v[152:155], v[172:175], v[76:79]
    s_add_u32 m0, s63, 0xb40
    ds_read_b128 v[216:219], v16 offset:6144
    buffer_load_dwordx4 v10, s[24:27], s8 offen offset:192 lds
    v_mfma_f32_16x16x32_bf16 v[100:103], v[152:155], v[176:179], v[100:103]
    s_waitcnt lgkmcnt(7)
    ds_read_b64_tr_b16 v[128:129], v12 offset:37888
    v_mfma_f32_16x16x32_bf16 v[112:115], a[248:251], a[252:255], v[112:115]
    s_add_u32 s8, s8, 16384
    s_add_u32 m0, s63, 0x1000
    ds_read_b64_tr_b16 v[130:131], v12 offset:38144
    buffer_load_dwordx4 v10, s[24:27], s8 offen lds
    v_mfma_f32_16x16x32_bf16 v[246:249], a[248:251], v[22:25], v[246:249]
    v_mfma_f32_16x16x32_bf16 v[80:83], v[156:159], v[172:175], v[80:83]
    s_nop 0
    ds_read_b64_tr_b16 v[132:133], v11 offset:38912
    ds_read_b64_tr_b16 v[220:221], v33 offset:43008
    v_mfma_f32_16x16x32_bf16 v[104:107], v[156:159], v[176:179], v[104:107]
    s_nop 0
    ds_read_b64_tr_b16 v[134:135], v11 offset:39168
    ds_read_b64_tr_b16 v[222:223], v33 offset:43264
    v_mfma_f32_16x16x32_bf16 v[84:87], v[160:163], v[172:175], v[84:87]
    s_add_u32 m0, s63, 0x13c0
    ds_read_b128 v[224:227], v16 offset:7168
    buffer_load_dwordx4 v10, s[24:27], s8 offen offset:64 lds
    v_mfma_f32_16x16x32_bf16 v[108:111], v[160:163], v[176:179], v[108:111]
    s_waitcnt lgkmcnt(7)
    ds_read_b64_tr_b16 v[136:137], v12 offset:38912
    v_mfma_f32_16x16x32_bf16 v[112:115], v[212:215], v[216:219], v[112:115]
    s_add_u32 m0, s63, 0x1780
    ds_read_b64_tr_b16 v[138:139], v12 offset:39168
    ds_read_b64_tr_b16 v[196:197], v44 offset:24576
    v_mfma_f32_16x16x32_bf16 v[246:249], v[212:215], v[22:25], v[246:249]
    buffer_load_dwordx4 v10, s[24:27], s8 offen offset:128 lds
    v_mfma_f32_16x16x32_bf16 v[64:67], v[116:119], v[180:183], v[64:67]
    s_nop 0
    ds_read_b64_tr_b16 v[140:141], v11 offset:43008
    ds_read_b64_tr_b16 v[198:199], v44 offset:24832
    v_mfma_f32_16x16x32_bf16 v[88:91], v[116:119], v[184:187], v[88:91]
    s_nop 0
    ds_read_b64_tr_b16 v[142:143], v11 offset:43264
    ds_read_b64_tr_b16 v[200:201], v44 offset:30720
    v_mfma_f32_16x16x32_bf16 v[68:71], v[120:123], v[180:183], v[68:71]
    s_add_u32 m0, s63, 0x1b40
    ds_read_b64_tr_b16 v[144:145], v12 offset:43008
    ds_read_b64_tr_b16 v[202:203], v44 offset:30976
    v_mfma_f32_16x16x32_bf16 v[92:95], v[120:123], v[184:187], v[92:95]
    s_waitcnt lgkmcnt(9)
    buffer_load_dwordx4 v10, s[24:27], s8 offen offset:192 lds
    v_mfma_f32_16x16x32_bf16 v[112:115], v[220:223], v[224:227], v[112:115]
    s_lshl_b32 s4, s53, 8
    s_add_u32 s4, s4, s13
    s_lshl_b32 s5, s48, 10
    s_add_u32 m0, s5, 0x26000
    ds_read_b64_tr_b16 v[146:147], v12 offset:43264
    buffer_load_dwordx4 v10, s[24:27], s4 offen lds
    v_mfma_f32_16x16x32_bf16 v[246:249], v[220:223], v[22:25], v[246:249]
    s_cmp_eq_u32 s48, 0
    ds_read_b64_tr_b16 v[148:149], v11 offset:44032
    v_mfma_f32_16x16x32_bf16 v[72:75], v[124:127], v[180:183], v[72:75]
    s_cselect_b32 s4, 0, 0x80000000
    ds_read_b64_tr_b16 v[150:151], v11 offset:44288
    v_mfma_f32_16x16x32_bf16 v[96:99], v[124:127], v[184:187], v[96:99]
    s_waitcnt lgkmcnt(7)
    buffer_load_dword v5, v6, s[44:47], s4 offen sc1
    v_mfma_f32_16x16x32_bf16 v[250:253], v[196:199], v[22:25], v[250:253]
    s_nop 0
    ds_read_b64_tr_b16 v[152:153], v12 offset:44032
    v_mfma_f32_16x16x32_bf16 v[76:79], v[128:131], v[180:183], v[76:79]
    s_waitcnt lgkmcnt(4)
    ds_read_b64_tr_b16 v[154:155], v12 offset:44288
    v_mfma_f32_16x16x32_bf16 v[250:253], v[200:203], v[22:25], v[250:253]
    s_mul_i32 s9, s54, 393216
    s_add_u32 s9, s9, s10
    s_add_u32 m0, s11, 0x12000
    ds_read_b64_tr_b16 v[156:157], v11 offset:45056
    buffer_load_dwordx4 v9, s[28:31], s9 offen lds
    v_mfma_f32_16x16x32_bf16 v[100:103], v[128:131], v[184:187], v[100:103]
    v_mfma_f32_16x16x32_bf16 v[80:83], v[132:135], v[180:183], v[80:83]
    ds_read_b64_tr_b16 v[158:159], v11 offset:45312
    v_mfma_f32_16x16x32_bf16 v[104:107], v[132:135], v[184:187], v[104:107]
    ds_read_b64_tr_b16 v[160:161], v12 offset:45056
    buffer_load_dwordx4 v9, s[28:31], s9 offen offset:1024 lds
    v_mfma_f32_16x16x32_bf16 v[84:87], v[136:139], v[180:183], v[84:87]
    ds_read_b64_tr_b16 v[162:163], v12 offset:45312
    v_mfma_f32_16x16x32_bf16 v[108:111], v[136:139], v[184:187], v[108:111]
    s_waitcnt lgkmcnt(6)
    v_mfma_f32_16x16x32_bf16 v[64:67], v[140:143], v[188:191], v[64:67]
    buffer_load_dwordx4 v9, s[28:31], s9 offen offset:2048 lds
    v_mfma_f32_16x16x32_bf16 v[88:91], v[140:143], v[192:195], v[88:91]
    v_mfma_f32_16x16x32_bf16 v[68:71], v[144:147], v[188:191], v[68:71]
    s_add_u32 s9, s9, 49152
    v_mfma_f32_16x16x32_bf16 v[92:95], v[144:147], v[192:195], v[92:95]
    s_add_u32 m0, s11, 0x12c00
    s_nop 0
    buffer_load_dwordx4 v9, s[28:31], s9 offen lds
    v_mfma_f32_16x16x32_bf16 v[72:75], v[148:151], v[188:191], v[72:75]
    v_mfma_f32_16x16x32_bf16 v[96:99], v[148:151], v[192:195], v[96:99]
    s_waitcnt lgkmcnt(0)
    v_mfma_f32_16x16x32_bf16 v[76:79], v[152:155], v[188:191], v[76:79]
    buffer_load_dwordx4 v9, s[28:31], s9 offen offset:1024 lds
    v_mfma_f32_16x16x32_bf16 v[100:103], v[152:155], v[192:195], v[100:103]
    v_mfma_f32_16x16x32_bf16 v[80:83], v[156:159], v[188:191], v[80:83]
    v_mfma_f32_16x16x32_bf16 v[104:107], v[156:159], v[192:195], v[104:107]
    buffer_load_dwordx4 v9, s[28:31], s9 offen offset:2048 lds
    v_mfma_f32_16x16x32_bf16 v[84:87], v[160:163], v[188:191], v[84:87]
    v_mfma_f32_16x16x32_bf16 v[108:111], v[160:163], v[192:195], v[108:111]
    s_lshl_b32 s4, s50, 2
    s_add_u32 s4, s4, s48
    s_lshr_b32 s5, s4, 3
    s_lshl_b32 s6, s49, 3
    s_add_u32 s5, s5, s6
    s_mul_i32 s5, s5, 44032
    s_add_u32 s5, s5, 0x600000
    s_lshl_b32 s6, s49, 6
    s_add_u32 s6, s6, s4
    s_lshl_b32 s6, s6, 11
    s_add_u32 s6, s6, 0xfffff800
    s_and_b32 s4, s4, 7
    s_mul_i32 s7, s4, 3456
    s_add_u32 s7, s7, s5
    s_add_u32 s7, s7, 12288
    s_lshl_b32 s4, s4, 11
    s_add_u32 s5, s5, s4
    v_mov_b32 v9, s7
    v_mov_b32 v4, s6
    v_cmp_eq_u32 vcc, 1, v2
    s_nop 1
    v_cndmask_b32 v9, v9, v4, vcc
    v_mov_b32 v4, s5
    v_cmp_eq_u32 vcc, 0, v2
    s_nop 1
    v_cndmask_b32 v9, v9, v4, vcc
    v_lshl_add_u32 v9, v3, 3, v9
    s_cmp_lg_u32 s48, 0
    s_cbranch_scc1 Li_f_8
    s_waitcnt vmcnt(6)
Lg_f_6:
    v_and_b32 v4, 0xff, v5
    v_cmp_ne_u32 vcc, 16, v4
    s_cbranch_vccz Lh_f_7
    s_sleep 8
    buffer_load_dword v5, v6, s[44:47], 0 offen sc1
    s_waitcnt vmcnt(0)
    s_sub_u32 s14, s14, 1
    s_cbranch_scc1 L_end_f
    s_branch Lg_f_6
Lh_f_7:
    v_add_u32 v4, 0x23a00, v17
    ds_write_b32 v4, v5
    s_waitcnt lgkmcnt(0)
Li_f_8:
    s_waitcnt vmcnt(7)
    s_barrier
    ds_read_b64_tr_b16 v[116:117], v13 offset:0
    ds_read_b64_tr_b16 v[118:119], v13 offset:256
    ds_read_b128 v[164:167], v15 offset:0
    ds_read_b128 v[168:171], v15 offset:4096
    ds_read_b64_tr_b16 v[120:121], v14 offset:0
    ds_read_b64_tr_b16 v[122:123], v14 offset:256
    ds_read_b64_tr_b16 v[124:125], v13 offset:1024
    ds_read_b64_tr_b16 v[126:127], v13 offset:1280
    ds_read_b64_tr_b16 v[128:129], v14 offset:1024
    ds_read_b64_tr_b16 v[130:131], v14 offset:1280
    ds_read_b64_tr_b16 v[132:133], v13 offset:2048
    ds_read_b64_tr_b16 v[134:135], v13 offset:2304
    ds_read_b64_tr_b16 v[136:137], v14 offset:2048
    ds_read_b64_tr_b16 v[138:139], v14 offset:2304
    v_add_u32 v44, 49152, v44
    s_waitcnt lgkmcnt(6)
    v_mfma_f32_16x16x32_bf16 v[64:67], v[116:119], v[164:167], v[64:67]
    s_nop 0
    ds_read_b64_tr_b16 v[140:141], v13 offset:6144
    ds_read_b128 v[172:175], v15 offset:1024
    v_mfma_f32_16x16x32_bf16 v[88:91], v[116:119], v[168:171], v[88:91]
    s_nop 0
    ds_read_b64_tr_b16 v[142:143], v13 offset:6400
    ds_read_b128 v[176:179], v15 offset:5120
    v_mfma_f32_16x16x32_bf16 v[68:71], v[120:123], v[164:167], v[68:71]
    s_nop 0
    ds_read_b64_tr_b16 v[144:145], v14 offset:6144
    ds_read_b128 v[180:183], v15 offset:2048
    v_mfma_f32_16x16x32_bf16 v[92:95], v[120:123], v[168:171], v[92:95]
    s_nop 0
    ds_read_b64_tr_b16 v[146:147], v14 offset:6400
    ds_read_b128 v[184:187], v15 offset:6144
    v_mfma_f32_16x16x32_bf16 v[72:75], v[124:127], v[164:167], v[72:75]
    s_nop 0
    ds_read_b64_tr_b16 v[148:149], v13 offset:7168
    ds_read_b128 v[188:191], v15 offset:3072
    v_mfma_f32_16x16x32_bf16 v[96:99], v[124:127], v[168:171], v[96:99]
    s_waitcnt lgkmcnt(10)
    s_nop 0
    ds_read_b64_tr_b16 v[150:151], v13 offset:7424
    ds_read_b128 v[192:195], v15 offset:7168
    v_mfma_f32_16x16x32_bf16 v[76:79], v[128:131], v[164:167], v[76:79]
    s_nop 0
    ds_read_b64_tr_b16 v[152:153], v14 offset:7168
    ds_read_b64_tr_b16 a[240:241], v34 offset:0
    v_mfma_f32_16x16x32_bf16 v[100:103], v[128:131], v[168:171], v[100:103]
    s_lshl_b32 s8, s54, 8
    ds_read_b64_tr_b16 v[154:155], v14 offset:7424
    ds_read_b64_tr_b16 a[242:243], v34 offset:256
    v_mfma_f32_16x16x32_bf16 v[80:83], v[132:135], v[164:167], v[80:83]
    s_add_u32 s8, s8, s12
    ds_read_b64_tr_b16 v[156:157], v13 offset:8192
    ds_read_b128 a[244:247], v16 offset:8192
    v_mfma_f32_16x16x32_bf16 v[104:107], v[132:135], v[168:171], v[104:107]
    s_add_u32 m0, s63, 0x0
    ds_read_b64_tr_b16 v[158:159], v13 offset:8448
    v_mfma_f32_16x16x32_bf16 v[84:87], v[136:139], v[164:167], v[84:87]
    s_waitcnt lgkmcnt(7)
    ds_read_b64_tr_b16 v[160:161], v14 offset:8192
    buffer_load_dwordx4 v10, s[24:27], s8 offen lds
    v_mfma_f32_16x16x32_bf16 v[108:111], v[136:139], v[168:171], v[108:111]
    ds_read_b64_tr_b16 v[162:163], v14 offset:8448
    v_mfma_f32_16x16x32_bf16 v[64:67], v[140:143], v[172:175], v[64:67]
    s_nop 0
    ds_read_b64_tr_b16 v[116:117], v13 offset:12288
    ds_read_b64_tr_b16 a[248:249], v34 offset:6144
    v_mfma_f32_16x16x32_bf16 v[88:91], v[140:143], v[176:179], v[88:91]
    s_nop 0
    ds_read_b64_tr_b16 v[118:119], v13 offset:12544
    ds_read_b64_tr_b16 a[250:251], v34 offset:6400
    v_mfma_f32_16x16x32_bf16 v[68:71], v[144:147], v[172:175], v[68:71]
    s_add_u32 m0, s63, 0x3c0
    ds_read_b128 a[252:255], v16 offset:9216
    buffer_load_dwordx4 v10, s[24:27], s8 offen offset:64 lds
    s_nop 0
    v_mfma_f32_16x16x32_bf16 v[92:95], v[144:147], v[176:179], v[92:95]
    s_waitcnt lgkmcnt(8)
    s_add_u32 m0, s63, 0x780
    ds_read_b64_tr_b16 v[120:121], v14 offset:12288
    buffer_load_dwordx4 v10, s[24:27], s8 offen offset:128 lds
    v_mfma_f32_16x16x32_bf16 v[112:115], a[240:243], a[244:247], v[112:115]
    ds_read_b64_tr_b16 v[122:123], v14 offset:12544
    v_mfma_f32_16x16x32_bf16 v[246:249], a[240:243], v[22:25], v[246:249]
    s_add_u32 m0, s63, 0xb40
    s_nop 0
    buffer_load_dwordx4 v10, s[24:27], s8 offen offset:192 lds
    v_mfma_f32_16x16x32_bf16 v[72:75], v[148:151], v[172:175], v[72:75]
    s_add_u32 s8, s8, 16384
    ds_read_b64_tr_b16 v[124:125], v13 offset:13312
    ds_read_b64_tr_b16 v[212:213], v34 offset:12288
    v_mfma_f32_16x16x32_bf16 v[96:99], v[148:151], v[176:179], v[96:99]
    s_waitcnt lgkmcnt(9)
    ds_read_b64_tr_b16 v[126:127], v13 offset:13568
    ds_read_b64_tr_b16 v[214:215], v34 offset:12544
    v_mfma_f32_16x16x32_bf16 v[76:79], v[152:155], v[172:175], v[76:79]
    s_add_u32 m0, s63, 0x1000
    ds_read_b128 v[216:219], v16 offset:10240
    buffer_load_dwordx4 v10, s[24:27], s8 offen lds
    v_mfma_f32_16x16x32_bf16 v[100:103], v[152:155], v[176:179], v[100:103]
    s_waitcnt lgkmcnt(7)
    ds_read_b64_tr_b16 v[128:129], v14 offset:13312
    v_mfma_f32_16x16x32_bf16 v[112:115], a[248:251], a[252:255], v[112:115]
    ds_read_b64_tr_b16 v[130:131], v14 offset:13568
    v_mfma_f32_16x16x32_bf16 v[246:249], a[248:251], v[22:25], v[246:249]
    s_add_u32 m0, s63, 0x13c0
    s_nop 0
    buffer_load_dwordx4 v10, s[24:27], s8 offen offset:64 lds
    v_mfma_f32_16x16x32_bf16 v[80:83], v[156:159], v[172:175], v[80:83]
    s_nop 0
    ds_read_b64_tr_b16 v[132:133], v13 offset:14336
    ds_read_b64_tr_b16 v[220:221], v34 offset:18432
    v_mfma_f32_16x16x32_bf16 v[104:107], v[156:159], v[176:179], v[104:107]
    s_nop 0
    ds_read_b64_tr_b16 v[134:135], v13 offset:14592
    ds_read_b64_tr_b16 v[222:223], v34 offset:18688
    v_mfma_f32_16x16x32_bf16 v[84:87], v[160:163], v[172:175], v[84:87]
    s_add_u32 m0, s63, 0x1780
    ds_read_b128 v[224:227], v16 offset:11264
    buffer_load_dwordx4 v10, s[24:27], s8 offen offset:128 lds
    v_mfma_f32_16x16x32_bf16 v[108:111], v[160:163], v[176:179], v[108:111]
    s_waitcnt lgkmcnt(7)
    ds_read_b64_tr_b16 v[136:137], v14 offset:14336
    v_mfma_f32_16x16x32_bf16 v[112:115], v[212:215], v[216:219], v[112:115]
    s_add_u32 m0, s63, 0x1b40
    ds_read_b64_tr_b16 v[138:139], v14 offset:14592
    ds_read_b64_tr_b16 v[196:197], v44 offset:0
    v_mfma_f32_16x16x32_bf16 v[246:249], v[212:215], v[22:25], v[246:249]
    buffer_load_dwordx4 v10, s[24:27], s8 offen offset:192 lds
    v_mfma_f32_16x16x32_bf16 v[64:67], v[116:119], v[180:183], v[64:67]
    s_lshl_b32 s4, s54, 8
    s_add_u32 s4, s4, s13
    ds_read_b64_tr_b16 v[140:141], v13 offset:18432
    ds_read_b64_tr_b16 v[198:199], v44 offset:256
    v_mfma_f32_16x16x32_bf16 v[88:91], v[116:119], v[184:187], v[88:91]
    s_lshl_b32 s5, s48, 10
    ds_read_b64_tr_b16 v[142:143], v13 offset:18688
    ds_read_b64_tr_b16 v[200:201], v44 offset:6144
    v_mfma_f32_16x16x32_bf16 v[68:71], v[120:123], v[180:183], v[68:71]
    s_add_u32 m0, s5, 0x27000
    ds_read_b64_tr_b16 v[144:145], v14 offset:18432
    ds_read_b64_tr_b16 v[202:203], v44 offset:6400
    v_mfma_f32_16x16x32_bf16 v[92:95], v[120:123], v[184:187], v[92:95]
    s_waitcnt lgkmcnt(9)
    buffer_load_dwordx4 v10, s[24:27], s4 offen lds
    buffer_load_dword v228, v17, s[36:39], s58 offen sc1
    s_mov_b32 s4, 0x3a8000
    s_cmp_eq_u32 s48, 0
    s_cselect_b32 s4, s4, 0x80000000
    buffer_load_dwordx4 v[228:231], v3, s[36:39], s4 offen sc1
    v_mfma_f32_16x16x32_bf16 v[112:115], v[220:223], v[224:227], v[112:115]
    s_add_u32 s4, s61, s48
    s_lshl_b32 s4, s4, 14
    s_lshl_b32 s5, s60, 7
    s_add_u32 s4, s4, s5
    s_add_u32 s5, s4, 8192
    ds_read_b64_tr_b16 v[146:147], v14 offset:18688
    v_mfma_f32_16x16x32_bf16 v[246:249], v[220:223], v[22:25], v[246:249]
    s_lshl_b32 s6, s48, 11
    ds_read_b64_tr_b16 v[148:149], v13 offset:19456
    v_mfma_f32_16x16x32_bf16 v[72:75], v[124:127], v[180:183], v[72:75]
    s_add_u32 m0, s6, 0x20000
    ds_read_b64_tr_b16 v[150:151], v13 offset:19712
    buffer_load_dwordx4 v8, s[24:27], s4 offen lds
    s_add_u32 m0, s6, 0x20400
    s_nop 0
    buffer_load_dwordx4 v8, s[24:27], s5 offen lds
    v_mfma_f32_16x16x32_bf16 v[96:99], v[124:127], v[184:187], v[96:99]
    s_waitcnt lgkmcnt(7)
    v_mfma_f32_16x16x32_bf16 v[250:253], v[196:199], v[22:25], v[250:253]
    ds_read_b64_tr_b16 v[152:153], v14 offset:19456
    s_mov_b32 exec_lo, 0xffff
    s_mov_b32 exec_hi, 0x0
    buffer_load_dword v10, v9, s[36:39], 0 offen
    s_mov_b64 exec, -1
    v_mfma_f32_16x16x32_bf16 v[76:79], v[128:131], v[180:183], v[76:79]
    s_waitcnt lgkmcnt(4)
    ds_read_b64_tr_b16 v[154:155], v14 offset:19712
    v_mfma_f32_16x16x32_bf16 v[250:253], v[200:203], v[22:25], v[250:253]
    ds_read_b64_tr_b16 v[156:157], v13 offset:20480
    v_mfma_f32_16x16x32_bf16 v[100:103], v[128:131], v[184:187], v[100:103]
    s_mov_b32 exec_lo, 0xffff0000
    s_mov_b32 exec_hi, 0x0
    buffer_load_dword v10, v9, s[40:43], 0 offen
    s_mov_b64 exec, -1
    v_mfma_f32_16x16x32_bf16 v[80:83], v[132:135], v[180:183], v[80:83]
    ds_read_b64_tr_b16 v[158:159], v13 offset:20736
    v_mfma_f32_16x16x32_bf16 v[104:107], v[132:135], v[184:187], v[104:107]
    ds_read_b64_tr_b16 v[160:161], v14 offset:20480
    v_mfma_f32_16x16x32_bf16 v[84:87], v[136:139], v[180:183], v[84:87]
    ds_read_b64_tr_b16 v[162:163], v14 offset:20736
    v_mfma_f32_16x16x32_bf16 v[108:111], v[136:139], v[184:187], v[108:111]
    s_waitcnt lgkmcnt(6)
    v_mfma_f32_16x16x32_bf16 v[64:67], v[140:143], v[188:191], v[64:67]
    v_mfma_f32_16x16x32_bf16 v[88:91], v[140:143], v[192:195], v[88:91]
    v_mfma_f32_16x16x32_bf16 v[68:71], v[144:147], v[188:191], v[68:71]
    v_mfma_f32_16x16x32_bf16 v[92:95], v[144:147], v[192:195], v[92:95]
    v_mfma_f32_16x16x32_bf16 v[72:75], v[148:151], v[188:191], v[72:75]
    v_mfma_f32_16x16x32_bf16 v[96:99], v[148:151], v[192:195], v[96:99]
    s_waitcnt lgkmcnt(0)
    v_mfma_f32_16x16x32_bf16 v[76:79], v[152:155], v[188:191], v[76:79]
    v_mfma_f32_16x16x32_bf16 v[100:103], v[152:155], v[192:195], v[100:103]
    v_mfma_f32_16x16x32_bf16 v[80:83], v[156:159], v[188:191], v[80:83]
    v_mfma_f32_16x16x32_bf16 v[104:107], v[156:159], v[192:195], v[104:107]
    v_mfma_f32_16x16x32_bf16 v[84:87], v[160:163], v[188:191], v[84:87]
    v_mfma_f32_16x16x32_bf16 v[108:111], v[160:163], v[192:195], v[108:111]
    v_lshlrev_b32 v4, 7, v1
    v_lshl_add_u32 v4, v2, 4, v4
    s_lshl_b32 s4, s48, 11
    s_add_u32 s4, s4, 0x20000
    v_add_u32 v4, s4, v4
    s_lshl_b32 s4, s49, 2
    s_add_u32 s4, s4, 0x23a00
    v_mov_b32 v7, s4
    v_lshlrev_b32 v6, 3, v1
    s_lshl_b32 s6, s59, 7
    s_add_u32 s6, s6, 0x360000
    s_lshl_b32 s7, s49, 10
    s_add_u32 s7, s7, 0x35ff80
    s_cmp_eq_u32 s49, 0
    s_cselect_b32 s7, 0x80000000, s7
    s_cmp_lg_u32 s48, 0
    s_cbranch_scc1 Li_f_10
    s_waitcnt vmcnt(4)
Lg_f_9:
    v_and_b32 v228, v228, v229
    v_and_b32 v230, v230, v231
    v_and_b32 v228, v228, v230
    v_cmp_ne_u32 vcc, 1, v228
    s_cbranch_vccz Li_f_10
    s_sleep 4
    s_mov_b32 s4, 0x3a8000
    buffer_load_dwordx4 v[228:231], v3, s[36:39], s4 offen sc1
    s_waitcnt vmcnt(0)
    s_sub_u32 s14, s14, 1
    s_cbranch_scc1 L_end_f
    s_branch Lg_f_9
Li_f_10:
    s_cmp_lg_u32 s48, 1
    s_cbranch_scc1 Lnw_1_1_f
    s_mov_b64 exec, 0
    s_branch Lpg_3000
Lret_1_1_f:
    s_mov_b64 exec, -1
Lnw_1_1_f:
    s_cmp_lg_u32 s48, 2
    s_cbranch_scc1 Lnw_1_2_f
    s_mov_b64 exec, 0
    s_branch Lret_1_2_f
Lret_1_2_f:
    s_mov_b64 exec, -1
Lnw_1_2_f:
    s_waitcnt vmcnt(2)
    s_barrier
    s_nop 0
    buffer_load_dwordx2 v[240:241], v6, s[36:39], s6 offen sc1
    buffer_load_dwordx2 v[242:243], v6, s[36:39], s6 offen offset:128 sc1
    buffer_load_dwordx2 v[244:245], v6, s[36:39], s7 offen sc1
    ds_read_b64_tr_b16 v[116:117], v13 offset:24576
    ds_read_b64_tr_b16 v[118:119], v13 offset:24832
    ds_read_b128 v[164:167], v15 offset:0
    ds_read_b128 v[168:171], v15 offset:4096
    ds_read_b64_tr_b16 v[120:121], v14 offset:24576
    ds_read_b64_tr_b16 v[122:123], v14 offset:24832
    ds_read_b64_tr_b16 v[124:125], v13 offset:25600
    ds_read_b64_tr_b16 v[126:127], v13 offset:25856
    ds_read_b64_tr_b16 v[128:129], v14 offset:25600
    ds_read_b64_tr_b16 v[130:131], v14 offset:25856
    ds_read_b64_tr_b16 v[132:133], v13 offset:26624
    ds_read_b64_tr_b16 v[134:135], v13 offset:26880
    ds_read_b64_tr_b16 v[136:137], v14 offset:26624
    ds_read_b64_tr_b16 v[138:139], v14 offset:26880
    s_waitcnt lgkmcnt(6)
    s_nop 0
    v_mfma_f32_16x16x32_bf16 v[64:67], v[116:119], v[164:167], v[64:67]
    s_nop 0
    ds_read_b64_tr_b16 v[140:141], v13 offset:30720
    ds_read_b128 v[172:175], v15 offset:1024
    v_mfma_f32_16x16x32_bf16 v[88:91], v[116:119], v[168:171], v[88:91]
    s_nop 0
    ds_read_b64_tr_b16 v[142:143], v13 offset:30976
    ds_read_b128 v[176:179], v15 offset:5120
    v_mfma_f32_16x16x32_bf16 v[68:71], v[120:123], v[164:167], v[68:71]
    s_nop 0
    ds_read_b64_tr_b16 v[144:145], v14 offset:30720
    ds_read_b128 v[180:183], v15 offset:2048
    v_mfma_f32_16x16x32_bf16 v[92:95], v[120:123], v[168:171], v[92:95]
    s_nop 0
    ds_read_b64_tr_b16 v[146:147], v14 offset:30976
    ds_read_b128 v[184:187], v15 offset:6144
    v_mfma_f32_16x16x32_bf16 v[72:75], v[124:127], v[164:167], v[72:75]
    s_nop 0
    ds_read_b64_tr_b16 v[148:149], v13 offset:31744
    ds_read_b128 v[188:191], v15 offset:3072
    v_mfma_f32_16x16x32_bf16 v[96:99], v[124:127], v[168:171], v[96:99]
    s_waitcnt lgkmcnt(10)
    ds_read_b64_tr_b16 v[150:151], v13 offset:32000
    ds_read_b128 v[192:195], v15 offset:7168
    v_mfma_f32_16x16x32_bf16 v[76:79], v[128:131], v[164:167], v[76:79]
    s_nop 0
    ds_read_b64_tr_b16 v[152:153], v14 offset:31744
    ds_read_b64_tr_b16 a[240:241], v34 offset:24576
    v_mfma_f32_16x16x32_bf16 v[100:103], v[128:131], v[168:171], v[100:103]
    s_nop 0
    ds_read_b64_tr_b16 v[154:155], v14 offset:32000
    ds_read_b64_tr_b16 a[242:243], v34 offset:24832
    v_mfma_f32_16x16x32_bf16 v[80:83], v[132:135], v[164:167], v[80:83]
    s_nop 0
    ds_read_b64_tr_b16 v[156:157], v13 offset:32768
    ds_read_b128 a[244:247], v16 offset:12288
    s_nop 0
    v_mfma_f32_16x16x32_bf16 v[104:107], v[132:135], v[168:171], v[104:107]
    ds_read_b64_tr_b16 v[158:159], v13 offset:33024
    buffer_load_dwordx4 a[0:3], v3, s[36:39], s72 offen sc1
    v_mfma_f32_16x16x32_bf16 v[84:87], v[136:139], v[164:167], v[84:87]
    ds_read_b64_tr_b16 v[160:161], v14 offset:32768
    buffer_load_dwordx4 a[4:7], v3, s[36:39], s72 offen offset:1024 sc1
    v_mfma_f32_16x16x32_bf16 v[108:111], v[136:139], v[168:171], v[108:111]
    s_waitcnt lgkmcnt(9)
    ds_read_b64_tr_b16 v[162:163], v14 offset:33024
    buffer_load_dwordx4 a[8:11], v3, s[36:39], s72 offen offset:2048 sc1
    v_mfma_f32_16x16x32_bf16 v[64:67], v[140:143], v[172:175], v[64:67]
    s_nop 0
    ds_read_b64_tr_b16 v[116:117], v13 offset:36864
    ds_read_b64_tr_b16 a[248:249], v34 offset:30720
    v_mfma_f32_16x16x32_bf16 v[88:91], v[140:143], v[176:179], v[88:91]
    s_nop 0
    ds_read_b64_tr_b16 v[118:119], v13 offset:37120
    ds_read_b64_tr_b16 a[250:251], v34 offset:30976
    v_mfma_f32_16x16x32_bf16 v[68:71], v[144:147], v[172:175], v[68:71]
    s_add_u32 s75, s72, 0x1000
    ds_read_b128 a[252:255], v16 offset:13312
    buffer_load_dwordx4 a[12:15], v3, s[36:39], s72 offen offset:3072 sc1
    v_mfma_f32_16x16x32_bf16 v[92:95], v[144:147], v[176:179], v[92:95]
    s_waitcnt lgkmcnt(8)
    ds_read_b64_tr_b16 v[120:121], v14 offset:36864
    buffer_load_dwordx4 a[16:19], v3, s[36:39], s75 offen sc1
    v_mfma_f32_16x16x32_bf16 v[112:115], a[240:243], a[244:247], v[112:115]
    ds_read_b64_tr_b16 v[122:123], v14 offset:37120
    v_mfma_f32_16x16x32_bf16 v[246:249], a[240:243], v[22:25], v[246:249]
    v_mfma_f32_16x16x32_bf16 v[72:75], v[148:151], v[172:175], v[72:75]
    s_nop 0
    ds_read_b64_tr_b16 v[124:125], v13 offset:37888
    ds_read_b64_tr_b16 v[212:213], v34 offset:36864
    v_mfma_f32_16x16x32_bf16 v[96:99], v[148:151], v[176:179], v[96:99]
    s_waitcnt lgkmcnt(9)
    ds_read_b64_tr_b16 v[126:127], v13 offset:38144
    ds_read_b64_tr_b16 v[214:215], v34 offset:37120
    v_mfma_f32_16x16x32_bf16 v[76:79], v[152:155], v[172:175], v[76:79]
    ds_read_b128 v[216:219], v16 offset:14336
    buffer_load_dwordx4 a[20:23], v3, s[36:39], s75 offen offset:1024 sc1
    v_mfma_f32_16x16x32_bf16 v[100:103], v[152:155], v[176:179], v[100:103]
    s_waitcnt lgkmcnt(7)
    ds_read_b64_tr_b16 v[128:129], v14 offset:37888
    v_mfma_f32_16x16x32_bf16 v[112:115], a[248:251], a[252:255], v[112:115]
    ds_read_b64_tr_b16 v[130:131], v14 offset:38144
    buffer_load_dwordx4 a[24:27], v3, s[36:39], s75 offen offset:2048 sc1
    v_mfma_f32_16x16x32_bf16 v[246:249], a[248:251], v[22:25], v[246:249]
    v_mfma_f32_16x16x32_bf16 v[80:83], v[156:159], v[172:175], v[80:83]
    s_nop 0
    ds_read_b64_tr_b16 v[132:133], v13 offset:38912
    ds_read_b64_tr_b16 v[220:221], v34 offset:43008
    v_mfma_f32_16x16x32_bf16 v[104:107], v[156:159], v[176:179], v[104:107]
    s_nop 0
    ds_read_b64_tr_b16 v[134:135], v13 offset:39168
    ds_read_b64_tr_b16 v[222:223], v34 offset:43264
    v_mfma_f32_16x16x32_bf16 v[84:87], v[160:163], v[172:175], v[84:87]
    ds_read_b128 v[224:227], v16 offset:15360
    buffer_load_dwordx4 a[28:31], v3, s[36:39], s75 offen offset:3072 sc1
    v_mfma_f32_16x16x32_bf16 v[108:111], v[160:163], v[176:179], v[108:111]
    s_waitcnt lgkmcnt(7)
    ds_read_b64_tr_b16 v[136:137], v14 offset:38912
    v_mfma_f32_16x16x32_bf16 v[112:115], v[212:215], v[216:219], v[112:115]
    s_add_u32 s75, s72, 0x2000
    ds_read_b64_tr_b16 v[138:139], v14 offset:39168
    ds_read_b64_tr_b16 v[196:197], v44 offset:24576
    v_mfma_f32_16x16x32_bf16 v[246:249], v[212:215], v[22:25], v[246:249]
    s_nop 0
    buffer_load_dwordx4 a[32:35], v3, s[36:39], s75 offen sc1
    v_mfma_f32_16x16x32_bf16 v[64:67], v[116:119], v[180:183], v[64:67]
    s_nop 0
    ds_read_b64_tr_b16 v[140:141], v13 offset:43008
    ds_read_b64_tr_b16 v[198:199], v44 offset:24832
    v_mfma_f32_16x16x32_bf16 v[88:91], v[116:119], v[184:187], v[88:91]
    s_nop 0
    ds_read_b64_tr_b16 v[142:143], v13 offset:43264
    ds_read_b64_tr_b16 v[200:201], v44 offset:30720
    v_mfma_f32_16x16x32_bf16 v[68:71], v[120:123], v[180:183], v[68:71]
    s_nop 0
    ds_read_b64_tr_b16 v[144:145], v14 offset:43008
    ds_read_b64_tr_b16 v[202:203], v44 offset:30976
    v_mfma_f32_16x16x32_bf16 v[92:95], v[120:123], v[184:187], v[92:95]
    s_waitcnt lgkmcnt(9)
    buffer_load_dwordx4 a[36:39], v3, s[36:39], s75 offen offset:1024 sc1
    v_mfma_f32_16x16x32_bf16 v[112:115], v[220:223], v[224:227], v[112:115]
    ds_read_b64_tr_b16 v[146:147], v14 offset:43264
    v_mfma_f32_16x16x32_bf16 v[246:249], v[220:223], v[22:25], v[246:249]
    ds_read_b64_tr_b16 v[148:149], v13 offset:44032
    v_mfma_f32_16x16x32_bf16 v[72:75], v[124:127], v[180:183], v[72:75]
    s_nop 0
    ds_read_b64_tr_b16 v[150:151], v13 offset:44288
    ds_read_b32 v5, v7
    v_mfma_f32_16x16x32_bf16 v[96:99], v[124:127], v[184:187], v[96:99]
    s_waitcnt lgkmcnt(8)
    buffer_load_dwordx4 a[40:43], v3, s[36:39], s75 offen offset:2048 sc1
    v_mfma_f32_16x16x32_bf16 v[250:253], v[196:199], v[22:25], v[250:253]
    ds_read_b64_tr_b16 v[152:153], v14 offset:44032
    ds_read_b128 v[204:207], v4
    v_mfma_f32_16x16x32_bf16 v[76:79], v[128:131], v[180:183], v[76:79]
    s_waitcnt lgkmcnt(6)
    ds_read_b64_tr_b16 v[154:155], v14 offset:44288
    v_mfma_f32_16x16x32_bf16 v[250:253], v[200:203], v[22:25], v[250:253]
    s_nop 0
    ds_read_b64_tr_b16 v[156:157], v13 offset:45056
    ds_read_b128 v[208:211], v4 offset:64
    v_mfma_f32_16x16x32_bf16 v[100:103], v[128:131], v[184:187], v[100:103]
    s_nop 0
Lpg_3000:
    s_cbranch_execz Lret_1_1_f
    s_nop 0
    buffer_load_dwordx4 a[44:47], v3, s[36:39], s75 offen offset:3072 sc1
    v_mfma_f32_16x16x32_bf16 v[80:83], v[132:135], v[180:183], v[80:83]
    ds_read_b64_tr_b16 v[158:159], v13 offset:45312
    v_mfma_f32_16x16x32_bf16 v[104:107], v[132:135], v[184:187], v[104:107]
    s_add_u32 s75, s72, 0x3000
    ds_read_b64_tr_b16 v[160:161], v14 offset:45056
    buffer_load_dwordx4 a[48:51], v3, s[36:39], s75 offen sc1
    v_mfma_f32_16x16x32_bf16 v[84:87], v[136:139], v[180:183], v[84:87]
    ds_read_b64_tr_b16 v[162:163], v14 offset:45312
    s_mov_b32 exec_lo, 0x00010001
    s_mov_b32 exec_hi, 0x00010001
    ds_write_b128 v45, v[246:249] offset:47104
    ds_write_b128 v46, v[250:253] offset:47104
    s_mov_b64 exec, -1
    v_mfma_f32_16x16x32_bf16 v[108:111], v[136:139], v[184:187], v[108:111]
    s_waitcnt lgkmcnt(11)
    v_mfma_f32_16x16x32_bf16 v[64:67], v[140:143], v[188:191], v[64:67]
    v_mfma_f32_16x16x32_bf16 v[88:91], v[140:143], v[192:195], v[88:91]
    s_waitcnt lgkmcnt(0)
    s_barrier
    ds_read_b128 v[124:127], v35 offset:47232
    buffer_load_dwordx4 a[52:55], v3, s[36:39], s75 offen offset:1024 sc1
    v_mfma_f32_16x16x32_bf16 v[68:71], v[144:147], v[188:191], v[68:71]
    ds_read_b128 v[128:131], v35 offset:47296
    v_mfma_f32_16x16x32_bf16 v[92:95], v[144:147], v[192:195], v[92:95]
    ds_read_b128 v[132:135], v35 offset:47360
    v_mfma_f32_16x16x32_bf16 v[72:75], v[148:151], v[188:191], v[72:75]
    ds_read_b128 v[136:139], v35 offset:47424
    buffer_load_dwordx4 a[56:59], v3, s[36:39], s75 offen offset:2048 sc1
    v_mfma_f32_16x16x32_bf16 v[96:99], v[148:151], v[192:195], v[96:99]
    ds_read_b128 v[116:119], v35 offset:47104
    v_mfma_f32_16x16x32_bf16 v[76:79], v[152:155], v[188:191], v[76:79]
    ds_read_b128 v[120:123], v35 offset:47168
    v_mfma_f32_16x16x32_bf16 v[100:103], v[152:155], v[192:195], v[100:103]
    ds_read_b128 v[196:199], v35 offset:47488
    v_mfma_f32_16x16x32_bf16 v[80:83], v[156:159], v[188:191], v[80:83]
    ds_read_b128 v[200:203], v35 offset:47552
    buffer_load_dwordx4 a[60:63], v3, s[36:39], s75 offen offset:3072 sc1
    v_mfma_f32_16x16x32_bf16 v[104:107], v[156:159], v[192:195], v[104:107]
    v_mfma_f32_16x16x32_bf16 v[84:87], v[160:163], v[188:191], v[84:87]
    s_nop 0
    v_mfma_f32_16x16x32_bf16 v[108:111], v[160:163], v[192:195], v[108:111]
    s_waitcnt vmcnt(16) lgkmcnt(0)
    v_readfirstlane_b32 s6, v5
    s_lshl_b32 s4, s56, 4
    s_cmp_eq_u32 s4, s6
    s_cbranch_scc0 L_fork_s
L_fork_f:
    s_getpc_b64 s[6:7]
    s_nop 0
    global_load_dword v7, v47, s[6:7]
    v_pk_fma_f32 v[96:97], v[124:125], v[242:243], v[96:97] op_sel:[0,0,0] op_sel_hi:[1,0,1]
    v_pk_fma_f32 v[98:99], v[126:127], v[242:243], v[98:99] op_sel:[0,0,0] op_sel_hi:[1,0,1]
    v_pk_mul_f32 v[96:97], v[96:97], v[242:243] op_sel:[0,1] op_sel_hi:[1,1]
    v_pk_mul_f32 v[98:99], v[98:99], v[242:243] op_sel:[0,1] op_sel_hi:[1,1]
    v_cvt_pk_bf16_f32 v168, v96, v97
    v_cvt_pk_bf16_f32 v169, v98, v99
    v_pk_fma_f32 v[100:101], v[128:129], v[242:243], v[100:101] op_sel:[0,0,0] op_sel_hi:[1,0,1]
    v_pk_fma_f32 v[102:103], v[130:131], v[242:243], v[102:103] op_sel:[0,0,0] op_sel_hi:[1,0,1]
    ds_write_b64 v41, v[168:169] offset:1024
    v_pk_mul_f32 v[100:101], v[100:101], v[242:243] op_sel:[0,1] op_sel_hi:[1,1]
    v_pk_mul_f32 v[102:103], v[102:103], v[242:243] op_sel:[0,1] op_sel_hi:[1,1]
    v_cvt_pk_bf16_f32 v170, v100, v101
    v_cvt_pk_bf16_f32 v171, v102, v103
    v_pk_fma_f32 v[112:113], v[246:247], v[244:245], v[112:113] op_sel:[0,0,0] op_sel_hi:[1,0,1]
    v_pk_fma_f32 v[114:115], v[248:249], v[244:245], v[114:115] op_sel:[0,0,0] op_sel_hi:[1,0,1]
    ds_write_b64 v41, v[170:171] offset:1536
    v_pk_mul_f32 v[112:113], v[112:113], v[244:245] op_sel:[0,1] op_sel_hi:[1,1]
    v_pk_mul_f32 v[114:115], v[114:115], v[244:245] op_sel:[0,1] op_sel_hi:[1,1]
    v_cvt_pk_bf16_f32 v188, v112, v113
    v_cvt_pk_bf16_f32 v189, v114, v115
    v_pk_fma_f32 v[80:81], v[132:133], v[240:241], v[80:81] op_sel:[0,0,0] op_sel_hi:[1,0,1]
    s_add_u32 m0, s71, 0x18800
    s_add_u32 s75, s70, 0x0
    s_nop 0
    buffer_load_dwordx4 v3, s[36:39], s75 offen sc1 lds
    v_pk_fma_f32 v[82:83], v[134:135], v[240:241], v[82:83] op_sel:[0,0,0] op_sel_hi:[1,0,1]
    ds_write_b64 v32, v[188:189]
    v_pk_mul_f32 v[80:81], v[80:81], v[240:241] op_sel:[0,1] op_sel_hi:[1,1]
    v_pk_mul_f32 v[82:83], v[82:83], v[240:241] op_sel:[0,1] op_sel_hi:[1,1]
    v_cvt_pk_bf16_f32 v180, v80, v81
    v_cvt_pk_bf16_f32 v181, v82, v83
    v_pk_fma_f32 v[84:85], v[136:137], v[240:241], v[84:85] op_sel:[0,0,0] op_sel_hi:[1,0,1]
    v_pk_fma_f32 v[86:87], v[138:139], v[240:241], v[86:87] op_sel:[0,0,0] op_sel_hi:[1,0,1]
    ds_write_b64 v31, v[180:181] offset:0
    v_pk_mul_f32 v[84:85], v[84:85], v[240:241] op_sel:[0,1] op_sel_hi:[1,1]
    v_pk_mul_f32 v[86:87], v[86:87], v[240:241] op_sel:[0,1] op_sel_hi:[1,1]
    v_cvt_pk_bf16_f32 v182, v84, v85
    v_cvt_pk_bf16_f32 v183, v86, v87
    v_pk_fma_f32 v[104:105], v[132:133], v[242:243], v[104:105] op_sel:[0,0,0] op_sel_hi:[1,0,1]
    v_pk_fma_f32 v[106:107], v[134:135], v[242:243], v[106:107] op_sel:[0,0,0] op_sel_hi:[1,0,1]
    ds_write_b64 v31, v[182:183] offset:512
    v_pk_mul_f32 v[104:105], v[104:105], v[242:243] op_sel:[0,1] op_sel_hi:[1,1]
    v_pk_mul_f32 v[106:107], v[106:107], v[242:243] op_sel:[0,1] op_sel_hi:[1,1]
    v_cvt_pk_bf16_f32 v184, v104, v105
    v_cvt_pk_bf16_f32 v185, v106, v107
    v_pk_fma_f32 v[108:109], v[136:137], v[242:243], v[108:109] op_sel:[0,0,0] op_sel_hi:[1,0,1]
    s_add_u32 m0, s71, 0x19000
    s_add_u32 s75, s70, 0x8000
    buffer_load_dwordx4 v3, s[36:39], s75 offen sc1 lds
    v_pk_fma_f32 v[110:111], v[138:139], v[242:243], v[110:111] op_sel:[0,0,0] op_sel_hi:[1,0,1]
    ds_write_b64 v31, v[184:185] offset:1024
    v_pk_mul_f32 v[108:109], v[108:109], v[242:243] op_sel:[0,1] op_sel_hi:[1,1]
    v_pk_mul_f32 v[110:111], v[110:111], v[242:243] op_sel:[0,1] op_sel_hi:[1,1]
    v_cvt_pk_bf16_f32 v186, v108, v109
    v_cvt_pk_bf16_f32 v187, v110, v111
    v_pk_fma_f32 v[72:73], v[124:125], v[240:241], v[72:73] op_sel:[0,0,0] op_sel_hi:[1,0,1]
    v_pk_fma_f32 v[74:75], v[126:127], v[240:241], v[74:75] op_sel:[0,0,0] op_sel_hi:[1,0,1]
    ds_write_b64 v31, v[186:187] offset:1536
    v_pk_mul_f32 v[72:73], v[72:73], v[240:241] op_sel:[0,1] op_sel_hi:[1,1]
    v_pk_mul_f32 v[74:75], v[74:75], v[240:241] op_sel:[0,1] op_sel_hi:[1,1]
    v_cvt_pk_bf16_f32 v164, v72, v73
    v_cvt_pk_bf16_f32 v165, v74, v75
    v_pk_fma_f32 v[76:77], v[128:129], v[240:241], v[76:77] op_sel:[0,0,0] op_sel_hi:[1,0,1]
    v_pk_fma_f32 v[78:79], v[130:131], v[240:241], v[78:79] op_sel:[0,0,0] op_sel_hi:[1,0,1]
    v_pk_mul_f32 v[76:77], v[76:77], v[240:241] op_sel:[0,1] op_sel_hi:[1,1]
    v_pk_mul_f32 v[78:79], v[78:79], v[240:241] op_sel:[0,1] op_sel_hi:[1,1]
    v_cvt_pk_bf16_f32 v166, v76, v77
    v_cvt_pk_bf16_f32 v167, v78, v79
    v_pk_add_f32 v[116:117], v[116:117], v[196:197]
    v_pk_add_f32 v[118:119], v[118:119], v[198:199]
    s_add_u32 m0, s71, 0x19800
    s_add_u32 s75, s19, 0x10000
    buffer_load_dwordx4 v3, s[36:39], s75 offen sc1 lds
    v_pk_add_f32 v[120:121], v[120:121], v[200:201]
    v_pk_add_f32 v[122:123], v[122:123], v[202:203]
    v_pk_fma_f32 v[88:89], v[116:117], v[242:243], v[88:89] op_sel:[0,0,0] op_sel_hi:[1,0,1]
    v_pk_fma_f32 v[90:91], v[118:119], v[242:243], v[90:91] op_sel:[0,0,0] op_sel_hi:[1,0,1]
    v_cvt_pk_bf16_f32 v176, v88, v89
    v_cvt_pk_bf16_f32 v177, v90, v91
    v_pk_fma_f32 v[92:93], v[120:121], v[242:243], v[92:93] op_sel:[0,0,0] op_sel_hi:[1,0,1]
    v_pk_fma_f32 v[94:95], v[122:123], v[242:243], v[94:95] op_sel:[0,0,0] op_sel_hi:[1,0,1]
    v_cvt_pk_bf16_f32 v178, v92, v93
    v_cvt_pk_bf16_f32 v179, v94, v95
    v_pk_fma_f32 v[64:65], v[116:117], v[240:241], v[64:65] op_sel:[0,0,0] op_sel_hi:[1,0,1]
    v_pk_fma_f32 v[66:67], v[118:119], v[240:241], v[66:67] op_sel:[0,0,0] op_sel_hi:[1,0,1]
    v_cvt_pk_bf16_f32 v172, v64, v65
    v_cvt_pk_bf16_f32 v173, v66, v67
    v_pk_fma_f32 v[68:69], v[120:121], v[240:241], v[68:69] op_sel:[0,0,0] op_sel_hi:[1,0,1]
    v_pk_fma_f32 v[70:71], v[122:123], v[240:241], v[70:71] op_sel:[0,0,0] op_sel_hi:[1,0,1]
    v_cvt_pk_bf16_f32 v174, v68, v69
    v_cvt_pk_bf16_f32 v175, v70, v71
    s_waitcnt lgkmcnt(0)
    s_barrier
    ds_read_b64 v[224:225], v41 offset:0
    ds_read_b64 v[226:227], v41 offset:512
    s_add_u32 m0, s71, 0x1b800
    s_add_u32 s75, s70, 0x1000
    buffer_load_dwordx4 v3, s[36:39], s75 offen sc1 lds
    v_mfma_f32_16x16x16_bf16 v[64:67], v[164:165], v[176:177], 0
    s_mul_i32 s4, s59, 43
    ds_read_b64_tr_b16 v[212:213], v40 offset:0
    v_mfma_f32_16x16x16_bf16 v[68:71], v[168:169], v[176:177], 0
    s_add_u32 s4, s4, s50
    ds_read_b64_tr_b16 v[214:215], v40 offset:1024
    v_mfma_f32_16x16x16_bf16 v[72:75], v[166:167], v[178:179], 0
    s_lshl_b32 s4, s4, 10
    ds_read_b64_tr_b16 v[216:217], v40 offset:2048
    v_mfma_f32_16x16x16_bf16 v[76:79], v[170:171], v[178:179], 0
    s_add_u32 s4, s4, 0x600000
    ds_read_b64_tr_b16 v[218:219], v40 offset:512
    v_mfma_f32_16x16x16_bf16 v[84:87], v[164:165], v[172:173], 0
    s_add_u32 s5, s4, 44032
    ds_read_b64_tr_b16 v[220:221], v40 offset:1536
    v_mfma_f32_16x16x16_bf16 v[92:95], v[166:167], v[174:175], 0
    s_add_u32 m0, s71, 0x1c000
    s_add_u32 s75, s70, 0x9000
    buffer_load_dwordx4 v3, s[36:39], s75 offen sc1 lds
    ds_read_b64_tr_b16 v[222:223], v40 offset:2560
    s_waitcnt lgkmcnt(6)
    v_mfma_f32_16x16x16_bf16 v[80:83], v[224:225], v[172:173], v[26:29]
    v_mul_f32 v241, 0x3eb8aa3b, v241
    v_mfma_f32_16x16x16_bf16 v[88:91], v[226:227], v[174:175], v[26:29]
    v_mul_f32 v243, 0x3eb8aa3b, v243
    v_cndmask_b32 v142, v68, v69, s[64:65]
    v_cndmask_b32 v146, v76, v77, s[64:65]
    v_cndmask_b32 v150, v84, v85, s[64:65]
    v_cndmask_b32 v154, v92, v93, s[64:65]
    v_cndmask_b32 v143, v70, v71, s[64:65]
    v_cndmask_b32 v147, v78, v79, s[64:65]
    v_cndmask_b32 v151, v86, v87, s[64:65]
    v_cndmask_b32 v155, v94, v95, s[64:65]
    v_cndmask_b32 v140, v64, v65, s[64:65]
    v_cndmask_b32 v144, v72, v73, s[64:65]
    v_cndmask_b32 v148, v80, v81, s[64:65]
    s_add_u32 m0, s71, 0x1c800
    s_add_u32 s75, s19, 0x11000
    buffer_load_dwordx4 v3, s[36:39], s75 offen sc1 lds
    v_cndmask_b32 v152, v88, v89, s[64:65]
    v_cndmask_b32 v141, v66, v67, s[64:65]
    v_cndmask_b32 v145, v74, v75, s[64:65]
    v_cndmask_b32 v149, v82, v83, s[64:65]
    v_cndmask_b32 v153, v90, v91, s[64:65]
    v_cndmask_b32 v140, v140, v142, s[66:67]
    v_cndmask_b32 v144, v144, v146, s[66:67]
    v_cndmask_b32 v148, v148, v150, s[66:67]
    v_cndmask_b32 v152, v152, v154, s[66:67]
    v_cndmask_b32 v141, v141, v143, s[68:69]
    v_cndmask_b32 v145, v145, v147, s[68:69]
    v_cndmask_b32 v149, v149, v151, s[68:69]
    v_cndmask_b32 v153, v153, v155, s[68:69]
    v_pk_mul_f32 v[140:141], v[140:141], v[242:243] op_sel:[0,1] op_sel_hi:[1,1]
    v_pk_mul_f32 v[144:145], v[144:145], v[242:243] op_sel:[0,1] op_sel_hi:[1,1]
    v_pk_mul_f32 v[148:149], v[148:149], v[240:241] op_sel:[0,1] op_sel_hi:[1,1]
    v_pk_mul_f32 v[152:153], v[152:153], v[240:241] op_sel:[0,1] op_sel_hi:[1,1]
    v_max_f32 v158, v140, v141
    v_max_f32 v159, v144, v145
    v_max_f32 v156, v148, v149
    v_max_f32 v157, v152, v153
    buffer_load_dwordx4 a[64:67], v3, s[36:39], s73 offen sc1
    v_permlane32_swap_b32 v158, v159
    v_permlane32_swap_b32 v156, v157
    v_max_f32 v158, v158, v159
    v_max_f32 v156, v156, v157
    v_mov_b32 v159, v158
    v_mov_b32 v157, v156
    s_nop 0
    v_permlane16_swap_b32 v158, v159
    v_permlane16_swap_b32 v156, v157
    v_max_f32 v158, v158, v159
    v_max_f32 v156, v156, v157
    v_mov_b32 v159, v158
    v_mov_b32 v157, v156
    s_nop 0
    v_permlane32_swap_b32 v158, v159
    v_permlane32_swap_b32 v156, v157
    v_pk_add_f32 v[140:141], v[140:141], v[158:159] op_sel:[0,0] op_sel_hi:[1,0] neg_lo:[0,1] neg_hi:[0,1]
    v_pk_add_f32 v[144:145], v[144:145], v[158:159] op_sel:[0,1] op_sel_hi:[1,1] neg_lo:[0,1] neg_hi:[0,1]
    v_pk_add_f32 v[148:149], v[148:149], v[156:157] op_sel:[0,0] op_sel_hi:[1,0] neg_lo:[0,1] neg_hi:[0,1]
    v_pk_add_f32 v[152:153], v[152:153], v[156:157] op_sel:[0,1] op_sel_hi:[1,1] neg_lo:[0,1] neg_hi:[0,1]
    v_exp_f32 v140, v140
    v_exp_f32 v144, v144
    buffer_load_dwordx4 a[68:71], v3, s[36:39], s73 offen offset:1024 sc1
    v_exp_f32 v148, v148
    v_exp_f32 v152, v152
    v_exp_f32 v141, v141
    v_exp_f32 v145, v145
    v_exp_f32 v149, v149
    v_exp_f32_e64 v153, v153
    v_cvt_pk_bf16_f32 v140, v140, v141
    v_cvt_pk_bf16_f32 v144, v144, v145
    v_cvt_pk_bf16_f32 v148, v148, v149
    v_cvt_pk_bf16_f32 v152, v152, v153
    s_waitcnt lgkmcnt(0)
    v_perm_b32 v96, v140, v140, v18
    v_perm_b32 v97, v140, v140, v19
    v_perm_b32 v98, v140, v140, v20
    v_perm_b32 v99, v140, v140, v21
    v_perm_b32 v100, v144, v144, v18
    v_perm_b32 v101, v144, v144, v19
    v_mfma_f32_16x16x32_bf16 v[68:71], v[22:25], v[96:99], 0
    v_perm_b32 v102, v144, v144, v20
    v_perm_b32 v103, v144, v144, v21
    v_mfma_f32_16x16x32_bf16 v[64:67], v[214:217], v[96:99], 0
    v_perm_b32 v104, v148, v148, v18
    v_perm_b32 v105, v148, v148, v19
    v_mfma_f32_16x16x32_bf16 v[76:79], v[22:25], v[100:103], 0
    v_perm_b32 v106, v148, v148, v20
    v_perm_b32 v107, v148, v148, v21
    v_mfma_f32_16x16x32_bf16 v[72:75], v[220:223], v[100:103], 0
    v_perm_b32 v108, v152, v152, v18
    v_perm_b32 v109, v152, v152, v19
    v_mfma_f32_16x16x32_bf16 v[84:87], v[22:25], v[104:107], 0
    v_perm_b32 v110, v152, v152, v20
    v_perm_b32 v111, v152, v152, v21
    v_mfma_f32_16x16x32_bf16 v[80:83], v[212:215], v[104:107], 0
    v_rcp_f32 v68, v68
    v_mfma_f32_16x16x32_bf16 v[92:95], v[22:25], v[108:111], 0
    v_rcp_f32 v76, v76
    v_mfma_f32_16x16x32_bf16 v[88:91], v[218:221], v[108:111], 0
    v_pk_mul_f32 v[64:65], v[64:65], v[68:69] op_sel:[0,0] op_sel_hi:[1,0]
    v_pk_mul_f32 v[66:67], v[66:67], v[68:69] op_sel:[0,0] op_sel_hi:[1,0]
    v_cvt_pk_bf16_f32 v168, v64, v65
    v_cvt_pk_bf16_f32 v169, v66, v67
    v_pk_mul_f32 v[72:73], v[72:73], v[76:77] op_sel:[0,0] op_sel_hi:[1,0]
    v_pk_mul_f32 v[74:75], v[74:75], v[76:77] op_sel:[0,0] op_sel_hi:[1,0]
    v_cvt_pk_bf16_f32 v170, v72, v73
    v_cvt_pk_bf16_f32 v171, v74, v75
    v_rcp_f32 v84, v84
    v_rcp_f32 v92, v92
    v_pk_mul_f32 v[80:81], v[80:81], v[84:85] op_sel:[0,0] op_sel_hi:[1,0]
    v_pk_mul_f32 v[82:83], v[82:83], v[84:85] op_sel:[0,0] op_sel_hi:[1,0]
    v_cvt_pk_bf16_f32 v164, v80, v81
    v_cvt_pk_bf16_f32 v165, v82, v83
    v_pk_mul_f32 v[88:89], v[88:89], v[92:93] op_sel:[0,0] op_sel_hi:[1,0]
    v_pk_mul_f32 v[90:91], v[90:91], v[92:93] op_sel:[0,0] op_sel_hi:[1,0]
    v_cvt_pk_bf16_f32 v166, v88, v89
    v_cvt_pk_bf16_f32 v167, v90, v91
    buffer_store_dwordx4 v[168:171], v3, s[36:39], s5 offen
    buffer_store_dwordx4 v[164:167], v3, s[36:39], s4 offen
    v_lshlrev_b32 v48, 16, v204
    v_and_b32 v49, 0xffff0000, v204
    v_lshlrev_b32 v50, 16, v205
    v_and_b32 v51, 0xffff0000, v205
    v_lshlrev_b32 v52, 16, v206
    v_and_b32 v53, 0xffff0000, v206
    v_lshlrev_b32 v54, 16, v207
    v_and_b32 v55, 0xffff0000, v207
    v_lshlrev_b32 v56, 16, v208
    v_and_b32 v57, 0xffff0000, v208
    v_lshlrev_b32 v58, 16, v209
    v_and_b32 v59, 0xffff0000, v209
    v_lshlrev_b32 v60, 16, v210
    v_and_b32 v61, 0xffff0000, v210
    v_lshlrev_b32 v62, 16, v211
    v_and_b32 v63, 0xffff0000, v211
    buffer_load_dwordx4 a[72:75], v3, s[36:39], s73 offen offset:2048 sc1
    buffer_load_dwordx4 a[76:79], v3, s[36:39], s73 offen offset:3072 sc1
    s_add_u32 s75, s73, 0x1000
    buffer_load_dwordx4 a[80:83], v3, s[36:39], s75 offen sc1
    buffer_load_dwordx4 a[84:87], v3, s[36:39], s75 offen offset:1024 sc1
    v_mov_b32 v4, 1
    s_cmp_lg_u32 s48, 0
    s_mov_b64 exec, 1
    s_waitcnt vmcnt(4)
    s_barrier
    s_cbranch_scc1 Lq_f_13
    buffer_store_dword v4, off, s[36:39], s55
Lq_f_13:
    s_mov_b64 exec, -1
    s_nop 0
    buffer_load_dwordx4 a[88:91], v3, s[36:39], s75 offen offset:2048 sc1
    buffer_load_dwordx4 a[92:95], v3, s[36:39], s75 offen offset:3072 sc1
    s_add_u32 s75, s73, 0x2000
    buffer_load_dwordx4 a[96:99], v3, s[36:39], s75 offen sc1
    buffer_load_dwordx4 a[100:103], v3, s[36:39], s75 offen offset:1024 sc1
    buffer_load_dwordx4 a[104:107], v3, s[36:39], s75 offen offset:2048 sc1
    buffer_load_dwordx4 a[108:111], v3, s[36:39], s75 offen offset:3072 sc1
    s_add_u32 s75, s73, 0x3000
    buffer_load_dwordx4 a[112:115], v3, s[36:39], s75 offen sc1
    buffer_load_dwordx4 a[116:119], v3, s[36:39], s75 offen offset:1024 sc1
    s_mov_b32 exec_lo, 0x00010001
    s_mov_b32 exec_hi, 0x00010001
    ds_write_b128 v35, v[116:119] offset:0
    ds_write_b128 v35, v[120:123] offset:64
    ds_write_b128 v35, v[124:127] offset:128
    ds_write_b128 v35, v[128:131] offset:192
    ds_write_b128 v35, v[132:135] offset:256
    ds_write_b128 v35, v[136:139] offset:320
    s_mov_b64 exec, -1
    s_mul_i32 s4, s48, 4096
    s_add_u32 s4, s4, 0x600000
    s_xor_b32 s5, s48, 0
    s_add_u32 s5, s5, s61
    s_mul_i32 s5, s5, 44032
    s_add_u32 s10, s5, s4
    s_xor_b32 s5, s48, 1
    s_add_u32 s5, s5, s61
    s_mul_i32 s5, s5, 44032
    s_add_u32 s11, s5, s4
    s_xor_b32 s5, s48, 2
    s_add_u32 s5, s5, s61
    s_mul_i32 s5, s5, 44032
    s_add_u32 s12, s5, s4
    s_xor_b32 s5, s48, 3
    s_add_u32 s5, s5, s61
    s_mul_i32 s5, s5, 44032
    s_add_u32 s13, s5, s4
    s_cmp_lg_u32 s48, 1
    s_cbranch_scc1 Lnw_2_1_f
    s_mov_b64 exec, 0
    s_branch Lpg_4000
Lret_2_1_f:
    s_mov_b64 exec, -1
Lnw_2_1_f:
    s_cmp_lg_u32 s48, 2
    s_cbranch_scc1 Lnw_2_2_f
    s_mov_b64 exec, 0
    s_branch Lret_2_2_f
Lret_2_2_f:
    s_mov_b64 exec, -1
Lnw_2_2_f:
    s_cmp_lg_u32 s48, 0
    s_cbranch_scc1 Ln_f_11
    buffer_load_dword v4, v17, s[36:39], s58 offen sc1
    s_nop 15
Lp_f_12:
    buffer_load_dword v5, v17, s[36:39], s58 offen sc1
    s_waitcnt vmcnt(1)
    v_cmp_gt_u32 vcc, 1, v4
    s_cbranch_vccz Ln_f_11
    buffer_load_dword v4, v17, s[36:39], s58 offen sc1
    s_waitcnt vmcnt(1)
    v_cmp_gt_u32 vcc, 1, v5
    s_cbranch_vccz Ln_f_11
    s_sub_u32 s14, s14, 1
    s_cbranch_scc1 L_end_f
    s_branch Lp_f_12
Ln_f_11:
    s_barrier
    buffer_load_dwordx4 v[64:67], v3, s[36:39], s13 offen sc1
    s_barrier
    buffer_load_dwordx4 v[68:71], v3, s[36:39], s13 offen offset:1024 sc1
    s_barrier
    buffer_load_dwordx4 v[72:75], v3, s[36:39], s13 offen offset:2048 sc1
    s_barrier
    buffer_load_dwordx4 v[76:79], v3, s[36:39], s13 offen offset:3072 sc1
    s_barrier
    buffer_load_dwordx4 v[80:83], v3, s[36:39], s12 offen sc1
    s_barrier
    buffer_load_dwordx4 v[84:87], v3, s[36:39], s12 offen offset:1024 sc1
    s_waitcnt vmcnt(5)
    v_mfma_f32_16x16x32_bf16 v[144:147], a[0:3], v[64:67], 0
    buffer_load_dwordx4 v[88:91], v3, s[36:39], s12 offen offset:2048 sc1
    v_mfma_f32_16x16x32_bf16 v[148:151], a[4:7], v[64:67], 0
    v_mfma_f32_16x16x32_bf16 v[152:155], a[8:11], v[64:67], 0
    buffer_load_dwordx4 v[92:95], v3, s[36:39], s12 offen offset:3072 sc1
    v_mfma_f32_16x16x32_bf16 v[156:159], a[12:15], v[64:67], 0
    s_waitcnt vmcnt(6)
    v_mfma_f32_16x16x32_bf16 v[144:147], a[16:19], v[68:71], v[144:147]
    buffer_load_dwordx4 v[96:99], v3, s[36:39], s11 offen sc1
    v_mfma_f32_16x16x32_bf16 v[148:151], a[20:23], v[68:71], v[148:151]
    v_mfma_f32_16x16x32_bf16 v[152:155], a[24:27], v[68:71], v[152:155]
    v_mfma_f32_16x16x32_bf16 v[156:159], a[28:31], v[68:71], v[156:159]
    s_waitcnt vmcnt(6)
    v_mfma_f32_16x16x32_bf16 v[144:147], a[32:35], v[72:75], v[144:147]
    buffer_load_dwordx4 v[100:103], v3, s[36:39], s11 offen offset:1024 sc1
    v_mfma_f32_16x16x32_bf16 v[148:151], a[36:39], v[72:75], v[148:151]
    v_mfma_f32_16x16x32_bf16 v[152:155], a[40:43], v[72:75], v[152:155]
    v_mfma_f32_16x16x32_bf16 v[156:159], a[44:47], v[72:75], v[156:159]
    s_waitcnt vmcnt(6)
    v_mfma_f32_16x16x32_bf16 v[144:147], a[48:51], v[76:79], v[144:147]
    buffer_load_dwordx4 v[104:107], v3, s[36:39], s11 offen offset:2048 sc1
    v_mfma_f32_16x16x32_bf16 v[148:151], a[52:55], v[76:79], v[148:151]
    v_mfma_f32_16x16x32_bf16 v[152:155], a[56:59], v[76:79], v[152:155]
    v_mfma_f32_16x16x32_bf16 v[156:159], a[60:63], v[76:79], v[156:159]
    s_waitcnt vmcnt(6)
    v_mfma_f32_16x16x32_bf16 v[128:131], a[0:3], v[80:83], 0
    buffer_load_dwordx4 v[108:111], v3, s[36:39], s11 offen offset:3072 sc1
    v_mfma_f32_16x16x32_bf16 v[132:135], a[4:7], v[80:83], 0
    ds_write_b128 v38, v[144:147] offset:0
    v_mfma_f32_16x16x32_bf16 v[136:139], a[8:11], v[80:83], 0
    v_mfma_f32_16x16x32_bf16 v[140:143], a[12:15], v[80:83], 0
    s_waitcnt vmcnt(6)
    v_mfma_f32_16x16x32_bf16 v[128:131], a[16:19], v[84:87], v[128:131]
    buffer_load_dwordx4 v[112:115], v3, s[36:39], s10 offen sc1
    ds_write_b128 v38, v[148:151] offset:1024
    v_mfma_f32_16x16x32_bf16 v[132:135], a[20:23], v[84:87], v[132:135]
    v_mfma_f32_16x16x32_bf16 v[136:139], a[24:27], v[84:87], v[136:139]
    v_mfma_f32_16x16x32_bf16 v[140:143], a[28:31], v[84:87], v[140:143]
    s_waitcnt vmcnt(6)
    ds_write_b128 v38, v[152:155] offset:2048
    v_mfma_f32_16x16x32_bf16 v[128:131], a[32:35], v[88:91], v[128:131]
    buffer_load_dwordx4 v[116:119], v3, s[36:39], s10 offen offset:1024 sc1
    v_mfma_f32_16x16x32_bf16 v[132:135], a[36:39], v[88:91], v[132:135]
    v_mfma_f32_16x16x32_bf16 v[136:139], a[40:43], v[88:91], v[136:139]
    s_nop 0
    ds_write_b128 v38, v[156:159] offset:3072
    v_mfma_f32_16x16x32_bf16 v[140:143], a[44:47], v[88:91], v[140:143]
    s_waitcnt vmcnt(6)
    v_mfma_f32_16x16x32_bf16 v[128:131], a[48:51], v[92:95], v[128:131]
    buffer_load_dwordx4 v[120:123], v3, s[36:39], s10 offen offset:2048 sc1
    v_mfma_f32_16x16x32_bf16 v[132:135], a[52:55], v[92:95], v[132:135]
    v_mfma_f32_16x16x32_bf16 v[136:139], a[56:59], v[92:95], v[136:139]
    v_mfma_f32_16x16x32_bf16 v[140:143], a[60:63], v[92:95], v[140:143]
    s_waitcnt lgkmcnt(0)
    s_barrier
    s_waitcnt vmcnt(6)
    ds_read_b128 v[192:195], v39 offset:0
    v_mfma_f32_16x16x32_bf16 v[144:147], a[0:3], v[96:99], 0
    buffer_load_dwordx4 v[124:127], v3, s[36:39], s10 offen offset:3072 sc1
    ds_read_b128 v[196:199], v39 offset:1024
    ds_read_b128 v[200:203], v39 offset:2048
    v_mfma_f32_16x16x32_bf16 v[148:151], a[4:7], v[96:99], 0
    s_nop 0
    ds_read_b128 v[204:207], v39 offset:3072
    ds_write_b128 v37, v[128:131] offset:16384
    v_mfma_f32_16x16x32_bf16 v[152:155], a[8:11], v[96:99], 0
    v_mfma_f32_16x16x32_bf16 v[156:159], a[12:15], v[96:99], 0
    s_waitcnt vmcnt(6)
    v_mfma_f32_16x16x32_bf16 v[144:147], a[16:19], v[100:103], v[144:147]
    ds_write_b128 v37, v[132:135] offset:17408
    s_mov_b32 exec_lo, 0x0
    s_mov_b32 exec_hi, 0x3fff
    buffer_load_dword v10, v9, s[36:39], 0 offen
    s_mov_b64 exec, -1
    v_mfma_f32_16x16x32_bf16 v[148:151], a[20:23], v[100:103], v[148:151]
    v_mfma_f32_16x16x32_bf16 v[152:155], a[24:27], v[100:103], v[152:155]
    v_mfma_f32_16x16x32_bf16 v[156:159], a[28:31], v[100:103], v[156:159]
    s_waitcnt vmcnt(6)
    ds_write_b128 v37, v[136:139] offset:18432
    v_mfma_f32_16x16x32_bf16 v[144:147], a[32:35], v[104:107], v[144:147]
    s_mov_b32 exec_lo, 0x0
    s_mov_b32 exec_hi, 0x7ffc000
    buffer_load_dword v10, v9, s[36:39], 0 offen
    s_mov_b64 exec, -1
    v_mfma_f32_16x16x32_bf16 v[148:151], a[36:39], v[104:107], v[148:151]
    v_mfma_f32_16x16x32_bf16 v[152:155], a[40:43], v[104:107], v[152:155]
    ds_write_b128 v37, v[140:143] offset:19456
    v_mfma_f32_16x16x32_bf16 v[156:159], a[44:47], v[104:107], v[156:159]
    s_waitcnt vmcnt(6)
    v_mfma_f32_16x16x32_bf16 v[144:147], a[48:51], v[108:111], v[144:147]
    v_mfma_f32_16x16x32_bf16 v[148:151], a[52:55], v[108:111], v[148:151]
    buffer_load_dwordx4 a[120:123], v3, s[36:39], s75 offen offset:2048 sc1
    v_mfma_f32_16x16x32_bf16 v[152:155], a[56:59], v[108:111], v[152:155]
    v_mfma_f32_16x16x32_bf16 v[156:159], a[60:63], v[108:111], v[156:159]
    s_waitcnt lgkmcnt(0)
    s_barrier
    s_waitcnt vmcnt(6)
    ds_read_b128 v[160:163], v39 offset:16384
    v_mfma_f32_16x16x32_bf16 v[128:131], a[0:3], v[112:115], 0
    s_nop 0
    ds_read_b128 v[164:167], v39 offset:17408
    ds_read_b128 v[168:171], v39 offset:18432
    v_mfma_f32_16x16x32_bf16 v[132:135], a[4:7], v[112:115], 0
    s_nop 0
    ds_read_b128 v[172:175], v39 offset:19456
    ds_write_b128 v36, v[144:147] offset:0
    v_mfma_f32_16x16x32_bf16 v[136:139], a[8:11], v[112:115], 0
    buffer_load_dwordx4 a[124:127], v3, s[36:39], s75 offen offset:3072 sc1
    v_mfma_f32_16x16x32_bf16 v[140:143], a[12:15], v[112:115], 0
    s_waitcnt vmcnt(6)
    ds_write_b128 v36, v[148:151] offset:1024
    v_mfma_f32_16x16x32_bf16 v[128:131], a[16:19], v[116:119], v[128:131]
    v_mfma_f32_16x16x32_bf16 v[132:135], a[20:23], v[116:119], v[132:135]
    ds_write_b128 v36, v[152:155] offset:2048
    v_mfma_f32_16x16x32_bf16 v[136:139], a[24:27], v[116:119], v[136:139]
    s_add_u32 s75, s73, 0x4000
    buffer_load_dwordx4 a[128:131], v3, s[36:39], s75 offen sc1
    v_mfma_f32_16x16x32_bf16 v[140:143], a[28:31], v[116:119], v[140:143]
    s_waitcnt vmcnt(6)
    ds_write_b128 v36, v[156:159] offset:3072
    v_mfma_f32_16x16x32_bf16 v[128:131], a[32:35], v[120:123], v[128:131]
    s_add_u32 s6, s61, s48
    s_lshl_b32 s4, s6, 14
    s_lshl_b32 s5, s60, 11
    v_mfma_f32_16x16x32_bf16 v[132:135], a[36:39], v[120:123], v[132:135]
    s_add_u32 s4, s4, s5
    v_mfma_f32_16x16x32_bf16 v[136:139], a[40:43], v[120:123], v[136:139]
    s_add_u32 s4, s4, 0x0
    v_mfma_f32_16x16x32_bf16 v[140:143], a[44:47], v[120:123], v[140:143]
    s_waitcnt vmcnt(5)
    buffer_load_dwordx4 a[132:135], v3, s[36:39], s75 offen offset:1024 sc1
    v_mfma_f32_16x16x32_bf16 v[128:131], a[48:51], v[124:127], v[128:131]
    s_waitcnt lgkmcnt(0)
    s_barrier
    ds_read_b128 v[176:179], v39 offset:0
    v_mfma_f32_16x16x32_bf16 v[132:135], a[52:55], v[124:127], v[132:135]
    s_lshl_b32 s6, s6, 10
    ds_read_b128 v[180:183], v39 offset:1024
    ds_read_b128 v[184:187], v39 offset:2048
    v_mfma_f32_16x16x32_bf16 v[136:139], a[56:59], v[124:127], v[136:139]
    s_add_u32 s6, s6, 0x380000
    ds_read_b128 v[188:191], v39 offset:3072
    v_mfma_f32_16x16x32_bf16 v[140:143], a[60:63], v[124:127], v[140:143]
    s_nop 0
    v_pk_add_f32 v[48:49], v[48:49], v[192:193]
    v_pk_add_f32 v[50:51], v[50:51], v[194:195]
    v_pk_add_f32 v[52:53], v[52:53], v[196:197]
    v_pk_add_f32 v[54:55], v[54:55], v[198:199]
    v_pk_add_f32 v[56:57], v[56:57], v[200:201]
    v_pk_add_f32 v[58:59], v[58:59], v[202:203]
    v_pk_add_f32 v[60:61], v[60:61], v[204:205]
    v_pk_add_f32 v[62:63], v[62:63], v[206:207]
    v_pk_add_f32 v[48:49], v[48:49], v[160:161]
    v_pk_add_f32 v[50:51], v[50:51], v[162:163]
    v_pk_add_f32 v[52:53], v[52:53], v[164:165]
    v_pk_add_f32 v[54:55], v[54:55], v[166:167]
    v_pk_add_f32 v[56:57], v[56:57], v[168:169]
    v_pk_add_f32 v[58:59], v[58:59], v[170:171]
    v_pk_add_f32 v[60:61], v[60:61], v[172:173]
    v_pk_add_f32 v[62:63], v[62:63], v[174:175]
    v_pk_add_f32 v[48:49], v[48:49], v[128:129]
    v_pk_add_f32 v[50:51], v[50:51], v[130:131]
    v_pk_add_f32 v[52:53], v[52:53], v[132:133]
    v_pk_add_f32 v[54:55], v[54:55], v[134:135]
    v_pk_add_f32 v[56:57], v[56:57], v[136:137]
    v_pk_add_f32 v[58:59], v[58:59], v[138:139]
    v_pk_add_f32 v[60:61], v[60:61], v[140:141]
    v_pk_add_f32 v[62:63], v[62:63], v[142:143]
    s_waitcnt lgkmcnt(0)
    s_nop 0
    v_pk_add_f32 v[48:49], v[48:49], v[176:177]
    v_pk_add_f32 v[50:51], v[50:51], v[178:179]
    v_pk_add_f32 v[52:53], v[52:53], v[180:181]
    v_pk_add_f32 v[54:55], v[54:55], v[182:183]
    v_cvt_pk_bf16_f32 v208, v48, v49
    v_cvt_pk_bf16_f32 v209, v50, v51
    v_cvt_pk_bf16_f32 v210, v52, v53
    v_cvt_pk_bf16_f32 v211, v54, v55
    buffer_store_dwordx4 v[208:211], v3, s[40:43], s4 offen
    v_pk_add_f32 v[56:57], v[56:57], v[184:185]
    v_pk_add_f32 v[58:59], v[58:59], v[186:187]
    v_pk_add_f32 v[60:61], v[60:61], v[188:189]
    v_pk_add_f32 v[62:63], v[62:63], v[190:191]
    v_cvt_pk_bf16_f32 v212, v56, v57
    v_cvt_pk_bf16_f32 v213, v58, v59
    v_cvt_pk_bf16_f32 v214, v60, v61
    v_cvt_pk_bf16_f32 v215, v62, v63
    buffer_store_dwordx4 v[212:215], v3, s[40:43], s4 offen offset:1024
    v_pk_add_f32 v[216:217], v[48:49], v[50:51]
    v_pk_mul_f32 v[218:219], v[48:49], v[48:49]
    v_pk_fma_f32 v[218:219], v[50:51], v[50:51], v[218:219]
Lpg_4000:
    s_cbranch_execz Lret_2_1_f
    s_nop 0
    v_pk_add_f32 v[216:217], v[216:217], v[52:53]
    v_pk_fma_f32 v[218:219], v[52:53], v[52:53], v[218:219]
    v_pk_add_f32 v[216:217], v[216:217], v[54:55]
    v_pk_fma_f32 v[218:219], v[54:55], v[54:55], v[218:219]
    v_pk_add_f32 v[216:217], v[216:217], v[56:57]
    v_pk_fma_f32 v[218:219], v[56:57], v[56:57], v[218:219]
    v_pk_add_f32 v[216:217], v[216:217], v[58:59]
    v_pk_fma_f32 v[218:219], v[58:59], v[58:59], v[218:219]
    v_pk_add_f32 v[216:217], v[216:217], v[60:61]
    v_pk_fma_f32 v[218:219], v[60:61], v[60:61], v[218:219]
    v_pk_add_f32 v[216:217], v[216:217], v[62:63]
    v_pk_fma_f32 v[218:219], v[62:63], v[62:63], v[218:219]
    v_add_f32 v216, v216, v217
    v_add_f32 v217, v218, v219
    s_nop 1
    v_permlane32_swap_b32 v216, v217
    v_add_f32 v216, v216, v217
    v_mov_b32 v217, v216
    s_nop 1
    v_permlane16_swap_b32 v216, v217
    v_add_f32 v216, v216, v217
    s_mov_b32 exec_lo, 0xffff
    s_mov_b32 exec_hi, 0xffff
    buffer_store_dword v216, v30, s[36:39], s6 offen
    s_mov_b64 exec, -1
    v_mov_b32 v4, 2
    s_cmp_lg_u32 s48, 0
    s_mov_b64 exec, 1
    s_waitcnt vmcnt(0)
    s_barrier
    s_cbranch_scc1 Lq_f_16
    buffer_store_dword v4, off, s[36:39], s55
Lq_f_16:
    s_mov_b64 exec, -1
    s_nop 0
    s_add_u32 m0, s71, 0x1e800
    s_add_u32 s75, s70, 0x2000
    buffer_load_dwordx4 v3, s[36:39], s75 offen sc1 lds
    s_add_u32 m0, s71, 0x1f000
    s_add_u32 s75, s70, 0xa000
    buffer_load_dwordx4 v3, s[36:39], s75 offen sc1 lds
    s_add_u32 m0, s71, 0x1f800
    s_add_u32 s75, s19, 0x12000
    buffer_load_dwordx4 v3, s[36:39], s75 offen sc1 lds
    s_lshl_b32 s12, s59, 14
    s_add_u32 s12, s12, 0x0
    s_lshl_b32 s11, s59, 10
    s_add_u32 s11, s11, 0x380000
    s_add_u32 s10, s61, s48
    s_lshl_b32 s10, s10, 10
    s_add_u32 s10, s10, 0x380000
    s_add_u32 s16, s12, 0x4000
    s_mul_i32 s20, s59, 43
    s_add_u32 s20, s20, s62
    s_lshl_b32 s20, s20, 10
    s_add_u32 s20, s20, 0x600000
    s_add_u32 s21, s20, 44032
    s_cmp_lt_u32 s50, 11
    s_cselect_b32 s22, s20, 0x80000000
    s_cselect_b32 s23, s21, 0x80000000
    v_add_u32 v240, 0x18800, v3
    s_lshl_b32 s4, s48, 10
    s_add_u32 s4, s4, 2048
    v_add_u32 v250, s4, v240
    v_add_u32 v251, s71, v240
    ds_read_b128 v[112:115], v240 offset:0
    ds_read_b128 v[116:119], v240 offset:1024
    ds_read_b128 v[120:123], v240 offset:2048
    ds_read_b128 v[124:127], v240 offset:3072
    ds_read_b128 v[128:131], v240 offset:4096
    ds_read_b128 v[132:135], v240 offset:5120
    s_cmp_lg_u32 s48, 1
    s_cbranch_scc1 Lnw_3_1_f
    s_mov_b64 exec, 0
    s_branch Lpg_5000
Lret_3_1_f:
    s_mov_b64 exec, -1
Lnw_3_1_f:
    s_cmp_lg_u32 s48, 2
    s_cbranch_scc1 Lnw_3_2_f
    s_mov_b64 exec, 0
    s_branch Lret_3_2_f
Lret_3_2_f:
    s_mov_b64 exec, -1
Lnw_3_2_f:
    s_cmp_lg_u32 s48, 0
    s_cbranch_scc1 Ln_f_14
    buffer_load_dword v4, v17, s[36:39], s58 offen sc1
    s_nop 15
Lp_f_15:
    s_nop 0
    buffer_load_dword v5, v17, s[36:39], s58 offen sc1
    s_waitcnt vmcnt(1)
    v_cmp_gt_u32 vcc, 2, v4
    s_cbranch_vccz Ln_f_14
    buffer_load_dword v4, v17, s[36:39], s58 offen sc1
    s_waitcnt vmcnt(1)
    v_cmp_gt_u32 vcc, 2, v5
    s_cbranch_vccz Ln_f_14
    s_sub_u32 s14, s14, 1
    s_cbranch_scc1 L_end_f
    s_branch Lp_f_15
Ln_f_14:
    s_barrier
    buffer_load_dwordx4 v[160:163], v3, s[40:43], s12 offen sc1
    buffer_load_dwordx4 v[164:167], v3, s[40:43], s16 offen sc1
    buffer_load_dwordx4 v[168:171], v3, s[40:43], s12 offen offset:1024 sc1
    buffer_load_dwordx4 v[172:175], v3, s[40:43], s16 offen offset:1024 sc1
    buffer_load_dwordx4 v[176:179], v3, s[40:43], s12 offen offset:2048 sc1
    buffer_load_dwordx4 v[180:183], v3, s[40:43], s16 offen offset:2048 sc1
    s_waitcnt vmcnt(4) lgkmcnt(3)
    v_mfma_f32_16x16x32_bf16 v[64:67], v[112:115], v[160:163], 0
    s_add_u32 m0, s71, 0x21800
    s_add_u32 s75, s70, 0x3000
    ds_read_b128 v[136:139], v240 offset:6144
    buffer_load_dwordx4 v3, s[36:39], s75 offen sc1 lds
    v_mfma_f32_16x16x32_bf16 v[88:91], v[112:115], v[164:167], 0
    ds_read_b128 a[240:243], v250 offset:0
    v_mfma_f32_16x16x32_bf16 v[68:71], v[116:119], v[160:163], 0
    ds_read_b128 v[140:143], v240 offset:7168
    buffer_load_dwordx4 v[184:187], v3, s[40:43], s12 offen offset:3072 sc1
    v_mfma_f32_16x16x32_bf16 v[92:95], v[116:119], v[164:167], 0
    s_add_u32 m0, s71, 0x22000
    v_mfma_f32_16x16x32_bf16 v[72:75], v[120:123], v[160:163], 0
    s_add_u32 s75, s70, 0xb000
    ds_read_b128 v[144:147], v240 offset:8192
    buffer_load_dwordx4 v3, s[36:39], s75 offen sc1 lds
    v_mfma_f32_16x16x32_bf16 v[96:99], v[120:123], v[164:167], 0
    s_waitcnt lgkmcnt(4)
    v_mfma_f32_16x16x32_bf16 v[76:79], v[124:127], v[160:163], 0
    ds_read_b128 v[148:151], v240 offset:9216
    buffer_load_dwordx4 v[188:191], v3, s[40:43], s16 offen offset:3072 sc1
    v_mfma_f32_16x16x32_bf16 v[100:103], v[124:127], v[164:167], 0
    s_add_u32 m0, s71, 0x22800
    v_mfma_f32_16x16x32_bf16 v[80:83], v[128:131], v[160:163], 0
    s_add_u32 s75, s19, 0x13000
    ds_read_b128 v[152:155], v240 offset:10240
    buffer_load_dwordx4 v3, s[36:39], s75 offen sc1 lds
    v_mfma_f32_16x16x32_bf16 v[104:107], v[128:131], v[164:167], 0
    s_waitcnt lgkmcnt(4)
    v_mfma_f32_16x16x32_bf16 v[242:245], a[240:243], v[22:25], 0
    buffer_load_dwordx4 v[224:227], v3, s[36:39], s11 offen sc1
    v_mfma_f32_16x16x32_bf16 v[84:87], v[132:135], v[160:163], 0
    s_add_u32 m0, s71, 0x24800
    ds_read_b128 v[156:159], v240 offset:11264
    v_mfma_f32_16x16x32_bf16 v[108:111], v[132:135], v[164:167], 0
    s_waitcnt vmcnt(8) lgkmcnt(3)
    v_mfma_f32_16x16x32_bf16 v[64:67], v[136:139], v[168:171], v[64:67]
    s_add_u32 s75, s70, 0x4000
    ds_read_b128 v[112:115], v240 offset:12288
    buffer_load_dwordx4 v3, s[36:39], s75 offen sc1 lds
    v_mfma_f32_16x16x32_bf16 v[88:91], v[136:139], v[172:175], v[88:91]
    ds_read_b128 a[244:247], v250 offset:6144
    v_mfma_f32_16x16x32_bf16 v[68:71], v[140:143], v[168:171], v[68:71]
    s_nop 0
    ds_read_b128 v[116:119], v240 offset:13312
    ds_read_b128 a[248:251], v251 offset:0
    v_mfma_f32_16x16x32_bf16 v[92:95], v[140:143], v[172:175], v[92:95]
    s_add_u32 s17, s12, 0x1000
    buffer_load_dwordx4 v[192:195], v3, s[40:43], s17 offen sc1
    v_mfma_f32_16x16x32_bf16 v[72:75], v[144:147], v[168:171], v[72:75]
    s_add_u32 m0, s71, 0x25000
    s_add_u32 s75, s70, 0xc000
    s_nop 0
    ds_read_b128 v[120:123], v240 offset:14336
    v_mfma_f32_16x16x32_bf16 v[96:99], v[144:147], v[172:175], v[96:99]
    s_waitcnt lgkmcnt(5)
    buffer_load_dwordx4 v3, s[36:39], s75 offen sc1 lds
    v_mfma_f32_16x16x32_bf16 v[76:79], v[148:151], v[168:171], v[76:79]
    ds_read_b128 v[124:127], v240 offset:15360
    v_mfma_f32_16x16x32_bf16 v[100:103], v[148:151], v[172:175], v[100:103]
    v_mfma_f32_16x16x32_bf16 v[80:83], v[152:155], v[168:171], v[80:83]
    s_add_u32 s18, s12, 0x5000
    ds_read_b128 v[128:131], v240 offset:16384
    buffer_load_dwordx4 v[196:199], v3, s[40:43], s18 offen sc1
    v_mfma_f32_16x16x32_bf16 v[104:107], v[152:155], v[172:175], v[104:107]
    s_waitcnt lgkmcnt(5)
    v_mfma_f32_16x16x32_bf16 v[242:245], a[244:247], v[22:25], v[242:245]
    s_waitcnt lgkmcnt(3)
    v_mfma_f32_16x16x32_bf16 v[246:249], a[248:251], v[22:25], 0
    buffer_load_dwordx4 v[228:231], v3, s[36:39], s11 offen offset:1024 sc1
    v_mfma_f32_16x16x32_bf16 v[84:87], v[156:159], v[168:171], v[84:87]
    s_add_u32 m0, s71, 0x25800
    ds_read_b128 v[132:135], v240 offset:17408
    v_mfma_f32_16x16x32_bf16 v[108:111], v[156:159], v[172:175], v[108:111]
    s_waitcnt vmcnt(11) lgkmcnt(3)
    v_mfma_f32_16x16x32_bf16 v[64:67], v[112:115], v[176:179], v[64:67]
    s_add_u32 s75, s19, 0x14000
    ds_read_b128 v[136:139], v240 offset:18432
    buffer_load_dwordx4 v3, s[36:39], s75 offen sc1 lds
    v_mfma_f32_16x16x32_bf16 v[88:91], v[112:115], v[180:183], v[88:91]
    ds_read_b128 a[252:255], v250 offset:12288
    v_mfma_f32_16x16x32_bf16 v[68:71], v[116:119], v[176:179], v[68:71]
    ds_read_b128 v[140:143], v240 offset:19456
    v_mfma_f32_16x16x32_bf16 v[92:95], v[116:119], v[180:183], v[92:95]
    v_mfma_f32_16x16x32_bf16 v[72:75], v[120:123], v[176:179], v[72:75]
    ds_read_b128 v[144:147], v240 offset:20480
    buffer_load_dwordx4 v[200:203], v3, s[40:43], s17 offen offset:1024 sc1
    v_mfma_f32_16x16x32_bf16 v[96:99], v[120:123], v[180:183], v[96:99]
    s_waitcnt lgkmcnt(4)
    v_mfma_f32_16x16x32_bf16 v[76:79], v[124:127], v[176:179], v[76:79]
    ds_read_b128 v[148:151], v240 offset:21504
    v_mfma_f32_16x16x32_bf16 v[100:103], v[124:127], v[180:183], v[100:103]
    v_mfma_f32_16x16x32_bf16 v[80:83], v[128:131], v[176:179], v[80:83]
    ds_read_b128 v[152:155], v240 offset:22528
    buffer_load_dwordx4 v[204:207], v3, s[40:43], s18 offen offset:1024 sc1
    v_mfma_f32_16x16x32_bf16 v[104:107], v[128:131], v[180:183], v[104:107]
    s_waitcnt lgkmcnt(4)
    v_mfma_f32_16x16x32_bf16 v[242:245], a[252:255], v[22:25], v[242:245]
    s_add_u32 m0, s71, 0x18800
    v_mfma_f32_16x16x32_bf16 v[84:87], v[132:135], v[176:179], v[84:87]
    s_add_u32 s75, s70, 0x5000
    ds_read_b128 v[156:159], v240 offset:23552
    v_mfma_f32_16x16x32_bf16 v[108:111], v[132:135], v[180:183], v[108:111]
    s_waitcnt vmcnt(10) lgkmcnt(3)
    v_mfma_f32_16x16x32_bf16 v[64:67], v[136:139], v[184:187], v[64:67]
    s_barrier
    ds_read_b128 v[112:115], v240 offset:24576
    buffer_load_dwordx4 v3, s[36:39], s75 offen sc1 lds
    v_mfma_f32_16x16x32_bf16 v[88:91], v[136:139], v[188:191], v[88:91]
    ds_read_b128 a[240:243], v250 offset:18432
    v_mfma_f32_16x16x32_bf16 v[68:71], v[140:143], v[184:187], v[68:71]
    s_nop 0
    ds_read_b128 v[116:119], v240 offset:25600
    ds_read_b128 a[244:247], v251 offset:12288
    v_mfma_f32_16x16x32_bf16 v[92:95], v[140:143], v[188:191], v[92:95]
    buffer_load_dwordx4 v[208:211], v3, s[40:43], s17 offen offset:2048 sc1
    v_mfma_f32_16x16x32_bf16 v[72:75], v[144:147], v[184:187], v[72:75]
    ds_read_b128 v[120:123], v240 offset:26624
    v_mfma_f32_16x16x32_bf16 v[96:99], v[144:147], v[188:191], v[96:99]
    s_waitcnt lgkmcnt(5)
    v_mfma_f32_16x16x32_bf16 v[76:79], v[148:151], v[184:187], v[76:79]
    s_add_u32 m0, s71, 0x19000
    ds_read_b128 v[124:127], v240 offset:27648
    v_mfma_f32_16x16x32_bf16 v[100:103], v[148:151], v[188:191], v[100:103]
    s_add_u32 s75, s70, 0xd000
    buffer_load_dwordx4 v3, s[36:39], s75 offen sc1 lds
    v_mfma_f32_16x16x32_bf16 v[80:83], v[152:155], v[184:187], v[80:83]
    ds_read_b128 v[128:131], v240 offset:28672
    v_mfma_f32_16x16x32_bf16 v[104:107], v[152:155], v[188:191], v[104:107]
    s_waitcnt lgkmcnt(5)
    v_mfma_f32_16x16x32_bf16 v[242:245], a[240:243], v[22:25], v[242:245]
    s_waitcnt lgkmcnt(3)
    buffer_load_dwordx4 v[212:215], v3, s[40:43], s18 offen offset:2048 sc1
    v_mfma_f32_16x16x32_bf16 v[246:249], a[244:247], v[22:25], v[246:249]
    s_add_u32 m0, s71, 0x19800
    v_mfma_f32_16x16x32_bf16 v[84:87], v[156:159], v[184:187], v[84:87]
    s_add_u32 s75, s19, 0x15000
    ds_read_b128 v[132:135], v240 offset:29696
    v_mfma_f32_16x16x32_bf16 v[108:111], v[156:159], v[188:191], v[108:111]
    s_waitcnt vmcnt(8) lgkmcnt(3)
    v_mfma_f32_16x16x32_bf16 v[64:67], v[112:115], v[192:195], v[64:67]
    s_waitcnt vmcnt(7)
    ds_read_b128 v[136:139], v240 offset:30720
    buffer_load_dwordx4 v3, s[36:39], s75 offen sc1 lds
    v_mfma_f32_16x16x32_bf16 v[88:91], v[112:115], v[196:199], v[88:91]
    s_nop 0
    ds_read_b128 a[248:251], v250 offset:24576
    v_add_f32 v224, v224, v226
    v_mfma_f32_16x16x32_bf16 v[68:71], v[116:119], v[192:195], v[68:71]
    s_nop 0
    ds_read_b128 v[140:143], v240 offset:31744
    v_add_f32 v228, v228, v230
    v_mfma_f32_16x16x32_bf16 v[92:95], v[116:119], v[196:199], v[92:95]
    v_add_f32 v225, v225, v227
    v_mfma_f32_16x16x32_bf16 v[72:75], v[120:123], v[192:195], v[72:75]
    ds_read_b128 v[144:147], v240 offset:32768
    buffer_load_dwordx4 v[216:219], v3, s[40:43], s17 offen offset:3072 sc1
    v_mfma_f32_16x16x32_bf16 v[96:99], v[120:123], v[196:199], v[96:99]
    s_waitcnt lgkmcnt(4)
    v_add_f32 v229, v229, v231
    v_mfma_f32_16x16x32_bf16 v[76:79], v[124:127], v[192:195], v[76:79]
    ds_read_b128 v[148:151], v240 offset:33792
    v_mfma_f32_16x16x32_bf16 v[100:103], v[124:127], v[196:199], v[100:103]
    v_permlane32_swap_b32 v224, v225
    v_mfma_f32_16x16x32_bf16 v[80:83], v[128:131], v[192:195], v[80:83]
    ds_read_b128 v[152:155], v240 offset:34816
    buffer_load_dwordx4 v[220:223], v3, s[40:43], s18 offen offset:3072 sc1
    v_mfma_f32_16x16x32_bf16 v[104:107], v[128:131], v[196:199], v[104:107]
    s_waitcnt lgkmcnt(4)
    v_permlane32_swap_b32 v228, v229
    v_mfma_f32_16x16x32_bf16 v[242:245], a[248:251], v[22:25], v[242:245]
    s_add_u32 m0, s71, 0x1b800
    v_add_f32 v224, v224, v225
    v_add_f32 v228, v228, v229
    v_mfma_f32_16x16x32_bf16 v[84:87], v[132:135], v[192:195], v[84:87]
    s_add_u32 s75, s70, 0x6000
    ds_read_b128 v[156:159], v240 offset:35840
    v_mov_b32 v225, v224
    v_mfma_f32_16x16x32_bf16 v[108:111], v[132:135], v[196:199], v[108:111]
    s_waitcnt vmcnt(7) lgkmcnt(3)
    v_mov_b32 v229, v228
    v_mfma_f32_16x16x32_bf16 v[64:67], v[136:139], v[200:203], v[64:67]
    s_barrier
    ds_read_b128 v[112:115], v240 offset:36864
    buffer_load_dwordx4 v3, s[36:39], s75 offen sc1 lds
    v_mfma_f32_16x16x32_bf16 v[88:91], v[136:139], v[204:207], v[88:91]
    ds_read_b128 a[252:255], v250 offset:30720
    v_mfma_f32_16x16x32_bf16 v[68:71], v[140:143], v[200:203], v[68:71]
    s_nop 0
    ds_read_b128 v[116:119], v240 offset:37888
    ds_read_b128 a[240:243], v251 offset:24576
    v_mfma_f32_16x16x32_bf16 v[92:95], v[140:143], v[204:207], v[92:95]
    s_add_u32 s16, s12, 0x2000
    buffer_load_dwordx4 v[160:163], v3, s[40:43], s16 offen sc1
    v_mfma_f32_16x16x32_bf16 v[72:75], v[144:147], v[200:203], v[72:75]
    s_nop 0
    ds_read_b128 v[120:123], v240 offset:38912
    v_mfma_f32_16x16x32_bf16 v[96:99], v[144:147], v[204:207], v[96:99]
    s_waitcnt lgkmcnt(5)
    v_permlane16_swap_b32 v224, v225
    v_mfma_f32_16x16x32_bf16 v[76:79], v[148:151], v[200:203], v[76:79]
    s_add_u32 m0, s71, 0x1c000
    ds_read_b128 v[124:127], v240 offset:39936
    v_mfma_f32_16x16x32_bf16 v[100:103], v[148:151], v[204:207], v[100:103]
    s_add_u32 s75, s70, 0xe000
    buffer_load_dwordx4 v3, s[36:39], s75 offen sc1 lds
    v_mfma_f32_16x16x32_bf16 v[80:83], v[152:155], v[200:203], v[80:83]
    s_add_u32 s17, s12, 0x6000
    ds_read_b128 v[128:131], v240 offset:40960
    v_mfma_f32_16x16x32_bf16 v[104:107], v[152:155], v[204:207], v[104:107]
    s_waitcnt lgkmcnt(5)
    v_permlane16_swap_b32 v228, v229
    v_mfma_f32_16x16x32_bf16 v[242:245], a[252:255], v[22:25], v[242:245]
    s_waitcnt lgkmcnt(3)
    buffer_load_dwordx4 v[164:167], v3, s[40:43], s17 offen sc1
    v_add_f32 v224, v224, v225
    v_mfma_f32_16x16x32_bf16 v[246:249], a[240:243], v[22:25], v[246:249]
    v_add_f32 v228, v228, v229
    v_mov_b32 v225, v224
    v_mfma_f32_16x16x32_bf16 v[84:87], v[156:159], v[200:203], v[84:87]
    s_add_u32 m0, s71, 0x1c800
    ds_read_b128 v[132:135], v240 offset:41984
    v_mov_b32 v229, v228
    v_mfma_f32_16x16x32_bf16 v[108:111], v[156:159], v[204:207], v[108:111]
    s_waitcnt vmcnt(7) lgkmcnt(3)
    v_permlane32_swap_b32 v224, v225
    v_permlane32_swap_b32 v228, v229
    v_mul_f32 v236, 0xbb000000, v224
    v_mul_f32 v238, 0xbb000000, v228
    v_mfma_f32_16x16x32_bf16 v[64:67], v[112:115], v[208:211], v[64:67]
    s_add_u32 s75, s19, 0x16000
    ds_read_b128 v[136:139], v240 offset:43008
    buffer_load_dwordx4 v3, s[36:39], s75 offen sc1 lds
    v_mfma_f32_16x16x32_bf16 v[88:91], v[112:115], v[212:215], v[88:91]
    ds_read_b128 a[244:247], v250 offset:36864
    v_mfma_f32_16x16x32_bf16 v[68:71], v[116:119], v[208:211], v[68:71]
    ds_read_b128 v[140:143], v240 offset:44032
    v_mfma_f32_16x16x32_bf16 v[92:95], v[116:119], v[212:215], v[92:95]
    v_mfma_f32_16x16x32_bf16 v[72:75], v[120:123], v[208:211], v[72:75]
    ds_read_b128 v[144:147], v240 offset:45056
    buffer_load_dwordx4 v[168:171], v3, s[40:43], s16 offen offset:1024 sc1
    v_mfma_f32_16x16x32_bf16 v[96:99], v[120:123], v[212:215], v[96:99]
    s_waitcnt lgkmcnt(4)
    v_mfma_f32_16x16x32_bf16 v[76:79], v[124:127], v[208:211], v[76:79]
    ds_read_b128 v[148:151], v240 offset:46080
    v_mfma_f32_16x16x32_bf16 v[100:103], v[124:127], v[212:215], v[100:103]
    v_mfma_f32_16x16x32_bf16 v[80:83], v[128:131], v[208:211], v[80:83]
    ds_read_b128 v[152:155], v240 offset:47104
    buffer_load_dwordx4 v[172:175], v3, s[40:43], s17 offen offset:1024 sc1
    v_mfma_f32_16x16x32_bf16 v[104:107], v[128:131], v[212:215], v[104:107]
    s_waitcnt lgkmcnt(4)
    v_mfma_f32_16x16x32_bf16 v[242:245], a[244:247], v[22:25], v[242:245]
    s_add_u32 m0, s71, 0x1e800
    v_mfma_f32_16x16x32_bf16 v[84:87], v[132:135], v[208:211], v[84:87]
    s_add_u32 s75, s70, 0x7000
    ds_read_b128 v[156:159], v240 offset:48128
    v_mfma_f32_16x16x32_bf16 v[108:111], v[132:135], v[212:215], v[108:111]
    s_waitcnt vmcnt(7) lgkmcnt(3)
    v_mfma_f32_16x16x32_bf16 v[64:67], v[136:139], v[216:219], v[64:67]
    s_barrier
    ds_read_b128 v[112:115], v240 offset:49152
    buffer_load_dwordx4 v3, s[36:39], s75 offen sc1 lds
    v_mfma_f32_16x16x32_bf16 v[88:91], v[136:139], v[220:223], v[88:91]
    ds_read_b128 a[248:251], v250 offset:43008
    v_mfma_f32_16x16x32_bf16 v[68:71], v[140:143], v[216:219], v[68:71]
    s_nop 0
    ds_read_b128 v[116:119], v240 offset:50176
    ds_read_b128 a[252:255], v251 offset:36864
    v_mfma_f32_16x16x32_bf16 v[92:95], v[140:143], v[220:223], v[92:95]
    s_nop 0
    s_add_u32 m0, s71, 0x1f000
    buffer_load_dwordx4 v[176:179], v3, s[40:43], s16 offen offset:2048 sc1
    v_mfma_f32_16x16x32_bf16 v[72:75], v[144:147], v[216:219], v[72:75]
    s_add_u32 s75, s70, 0xf000
    ds_read_b128 v[120:123], v240 offset:51200
    v_mfma_f32_16x16x32_bf16 v[96:99], v[144:147], v[220:223], v[96:99]
    s_waitcnt lgkmcnt(5)
    buffer_load_dwordx4 v3, s[36:39], s75 offen sc1 lds
    v_mfma_f32_16x16x32_bf16 v[76:79], v[148:151], v[216:219], v[76:79]
    ds_read_b128 v[124:127], v240 offset:52224
    v_mfma_f32_16x16x32_bf16 v[100:103], v[148:151], v[220:223], v[100:103]
    v_mfma_f32_16x16x32_bf16 v[80:83], v[152:155], v[216:219], v[80:83]
    s_add_u32 m0, s71, 0x1f800
    ds_read_b128 v[128:131], v240 offset:53248
    buffer_load_dwordx4 v[180:183], v3, s[40:43], s17 offen offset:2048 sc1
    v_mfma_f32_16x16x32_bf16 v[104:107], v[152:155], v[220:223], v[104:107]
    s_waitcnt lgkmcnt(5)
    v_mfma_f32_16x16x32_bf16 v[242:245], a[248:251], v[22:25], v[242:245]
    s_waitcnt lgkmcnt(3)
    v_mfma_f32_16x16x32_bf16 v[246:249], a[252:255], v[22:25], v[246:249]
    s_add_u32 s75, s19, 0x17000
    buffer_load_dwordx4 v3, s[36:39], s75 offen sc1 lds
    v_mfma_f32_16x16x32_bf16 v[84:87], v[156:159], v[216:219], v[84:87]
    ds_read_b128 v[132:135], v240 offset:54272
    v_mfma_f32_16x16x32_bf16 v[108:111], v[156:159], v[220:223], v[108:111]
    s_waitcnt vmcnt(8) lgkmcnt(3)
    v_mfma_f32_16x16x32_bf16 v[64:67], v[112:115], v[160:163], v[64:67]
    ds_read_b128 v[136:139], v240 offset:55296
    buffer_load_dwordx4 v[184:187], v3, s[40:43], s16 offen offset:3072 sc1
    v_mfma_f32_16x16x32_bf16 v[88:91], v[112:115], v[164:167], v[88:91]
    ds_read_b128 a[240:243], v250 offset:49152
    v_mfma_f32_16x16x32_bf16 v[68:71], v[116:119], v[160:163], v[68:71]
    ds_read_b128 v[140:143], v240 offset:56320
    buffer_load_dwordx4 v[188:191], v3, s[40:43], s17 offen offset:3072 sc1
    v_mfma_f32_16x16x32_bf16 v[92:95], v[116:119], v[164:167], v[92:95]
    v_mfma_f32_16x16x32_bf16 v[72:75], v[120:123], v[160:163], v[72:75]
    s_add_u32 s18, s12, 0x3000
    ds_read_b128 v[144:147], v240 offset:57344
    v_mfma_f32_16x16x32_bf16 v[96:99], v[120:123], v[164:167], v[96:99]
    s_waitcnt lgkmcnt(4)
    buffer_load_dwordx4 v[192:195], v3, s[40:43], s18 offen sc1
    v_mfma_f32_16x16x32_bf16 v[76:79], v[124:127], v[160:163], v[76:79]
    ds_read_b128 v[148:151], v240 offset:58368
    v_mfma_f32_16x16x32_bf16 v[100:103], v[124:127], v[164:167], v[100:103]
    s_add_u32 s16, s12, 0x7000
    buffer_load_dwordx4 v[196:199], v3, s[40:43], s16 offen sc1
    v_mfma_f32_16x16x32_bf16 v[80:83], v[128:131], v[160:163], v[80:83]
    ds_read_b128 v[152:155], v240 offset:59392
    v_mfma_f32_16x16x32_bf16 v[104:107], v[128:131], v[164:167], v[104:107]
    s_waitcnt lgkmcnt(4)
    v_mfma_f32_16x16x32_bf16 v[242:245], a[240:243], v[22:25], v[242:245]
    buffer_load_dwordx4 v[200:203], v3, s[40:43], s18 offen offset:1024 sc1
    v_mfma_f32_16x16x32_bf16 v[84:87], v[132:135], v[160:163], v[84:87]
    ds_read_b128 v[156:159], v240 offset:60416
    v_mfma_f32_16x16x32_bf16 v[108:111], v[132:135], v[164:167], v[108:111]
    s_waitcnt vmcnt(10) lgkmcnt(3)
    v_mfma_f32_16x16x32_bf16 v[64:67], v[136:139], v[168:171], v[64:67]
    s_barrier
    ds_read_b128 v[112:115], v240 offset:2048
    buffer_load_dwordx4 v[204:207], v3, s[40:43], s16 offen offset:1024 sc1
    v_mfma_f32_16x16x32_bf16 v[88:91], v[136:139], v[172:175], v[88:91]
    ds_read_b128 a[244:247], v250 offset:55296
    v_mfma_f32_16x16x32_bf16 v[68:71], v[140:143], v[168:171], v[68:71]
    s_nop 0
    ds_read_b128 v[116:119], v240 offset:3072
    ds_read_b128 a[248:251], v251 offset:49152
    v_mfma_f32_16x16x32_bf16 v[92:95], v[140:143], v[172:175], v[92:95]
    s_nop 0
    buffer_load_dwordx4 v[208:211], v3, s[40:43], s18 offen offset:2048 sc1
    v_mfma_f32_16x16x32_bf16 v[72:75], v[144:147], v[168:171], v[72:75]
    ds_read_b128 v[120:123], v240 offset:8192
    v_mfma_f32_16x16x32_bf16 v[96:99], v[144:147], v[172:175], v[96:99]
    s_waitcnt lgkmcnt(5)
    buffer_load_dwordx4 v[212:215], v3, s[40:43], s16 offen offset:2048 sc1
    v_mfma_f32_16x16x32_bf16 v[76:79], v[148:151], v[168:171], v[76:79]
    ds_read_b128 v[124:127], v240 offset:9216
    v_mfma_f32_16x16x32_bf16 v[100:103], v[148:151], v[172:175], v[100:103]
    v_mfma_f32_16x16x32_bf16 v[80:83], v[152:155], v[168:171], v[80:83]
    ds_read_b128 v[128:131], v240 offset:14336
    buffer_load_dwordx4 v[216:219], v3, s[40:43], s18 offen offset:3072 sc1
    v_mfma_f32_16x16x32_bf16 v[104:107], v[152:155], v[172:175], v[104:107]
    s_waitcnt lgkmcnt(5)
    ds_read_b128 a[252:255], v250 offset:0
    v_mfma_f32_16x16x32_bf16 v[242:245], a[244:247], v[22:25], v[242:245]
    s_waitcnt lgkmcnt(4)
    v_mfma_f32_16x16x32_bf16 v[246:249], a[248:251], v[22:25], v[246:249]
    buffer_load_dwordx4 v[220:223], v3, s[40:43], s16 offen offset:3072 sc1
    v_mfma_f32_16x16x32_bf16 v[84:87], v[156:159], v[168:171], v[84:87]
    s_nop 0
    ds_read_b128 v[132:135], v240 offset:15360
    ds_read_b128 a[240:243], v250 offset:6144
    v_mfma_f32_16x16x32_bf16 v[108:111], v[156:159], v[172:175], v[108:111]
    s_waitcnt vmcnt(11) lgkmcnt(5)
    v_mfma_f32_16x16x32_bf16 v[72:75], v[112:115], v[176:179], v[72:75]
    s_waitcnt vmcnt(10)
    s_barrier
    ds_read_b128 v[136:139], v240 offset:20480
    buffer_load_dwordx4 v[232:235], v3, s[36:39], s10 offen sc1
    v_mfma_f32_16x16x32_bf16 v[96:99], v[112:115], v[180:183], v[96:99]
    ds_read_b128 a[244:247], v251 offset:0
    v_mfma_f32_16x16x32_bf16 v[76:79], v[116:119], v[176:179], v[76:79]
    s_nop 0
    ds_read_b128 v[140:143], v240 offset:21504
    v_mfma_f32_16x16x32_bf16 v[100:103], v[116:119], v[180:183], v[100:103]
    s_waitcnt lgkmcnt(5)
    s_getpc_b64 s[6:7]
    global_load_dword v7, v47, s[6:7]
    v_mfma_f32_16x16x32_bf16 v[242:245], a[252:255], v[22:25], v[242:245]
    s_waitcnt vmcnt(10)
    ds_read_b128 a[248:251], v250 offset:12288
    v_mfma_f32_16x16x32_bf16 v[72:75], v[120:123], v[184:187], v[72:75]
    s_add_u32 s75, s73, 0x4000
    ds_read_b128 v[144:147], v240 offset:26624
    v_mfma_f32_16x16x32_bf16 v[96:99], v[120:123], v[188:191], v[96:99]
    s_waitcnt lgkmcnt(5)
    buffer_load_dwordx4 a[136:139], v3, s[36:39], s75 offen offset:2048 sc1
    v_mfma_f32_16x16x32_bf16 v[242:245], a[240:243], v[22:25], v[242:245]
    ds_read_b128 a[252:255], v250 offset:18432
    v_mfma_f32_16x16x32_bf16 v[76:79], v[124:127], v[184:187], v[76:79]
    ds_read_b128 v[148:151], v240 offset:27648
    v_mfma_f32_16x16x32_bf16 v[100:103], v[124:127], v[188:191], v[100:103]
    s_waitcnt lgkmcnt(5)
    v_mfma_f32_16x16x32_bf16 v[246:249], a[244:247], v[22:25], v[246:249]
    s_waitcnt vmcnt(9)
    ds_read_b128 a[240:243], v251 offset:12288
    buffer_load_dwordx4 a[140:143], v3, s[36:39], s75 offen offset:3072 sc1
    v_mfma_f32_16x16x32_bf16 v[72:75], v[128:131], v[192:195], v[72:75]
    ds_read_b128 v[152:155], v240 offset:32768
    v_mfma_f32_16x16x32_bf16 v[96:99], v[128:131], v[196:199], v[96:99]
    s_waitcnt lgkmcnt(5)
    v_mfma_f32_16x16x32_bf16 v[242:245], a[248:251], v[22:25], v[242:245]
    s_add_u32 s75, s73, 0x5000
    ds_read_b128 a[244:247], v250 offset:24576
    buffer_load_dwordx4 a[144:147], v3, s[36:39], s75 offen sc1
    v_mfma_f32_16x16x32_bf16 v[76:79], v[132:135], v[192:195], v[76:79]
    s_nop 0
    ds_read_b128 v[156:159], v240 offset:33792
    v_mfma_f32_16x16x32_bf16 v[100:103], v[132:135], v[196:199], v[100:103]
    s_waitcnt lgkmcnt(5)
    v_mfma_f32_16x16x32_bf16 v[242:245], a[252:255], v[22:25], v[242:245]
    s_waitcnt vmcnt(9)
    ds_read_b128 a[248:251], v250 offset:30720
    v_mfma_f32_16x16x32_bf16 v[72:75], v[136:139], v[200:203], v[72:75]
    ds_read_b128 v[112:115], v240 offset:4096
    buffer_load_dwordx4 a[148:151], v3, s[36:39], s75 offen offset:1024 sc1
    v_mfma_f32_16x16x32_bf16 v[96:99], v[136:139], v[204:207], v[96:99]
    s_waitcnt lgkmcnt(5)
    v_mfma_f32_16x16x32_bf16 v[246:249], a[240:243], v[22:25], v[246:249]
    ds_read_b128 a[252:255], v251 offset:24576
    v_mfma_f32_16x16x32_bf16 v[76:79], v[140:143], v[200:203], v[76:79]
    ds_read_b128 v[116:119], v240 offset:5120
    v_mfma_f32_16x16x32_bf16 v[100:103], v[140:143], v[204:207], v[100:103]
    s_waitcnt lgkmcnt(5)
    v_mfma_f32_16x16x32_bf16 v[242:245], a[244:247], v[22:25], v[242:245]
    s_waitcnt vmcnt(8)
    buffer_load_dwordx4 a[152:155], v3, s[36:39], s75 offen offset:2048 sc1
    v_mfma_f32_16x16x32_bf16 v[72:75], v[144:147], v[208:211], v[72:75]
    ds_read_b128 v[120:123], v240 offset:10240
    v_mfma_f32_16x16x32_bf16 v[96:99], v[144:147], v[212:215], v[96:99]
    s_waitcnt lgkmcnt(4)
    v_mfma_f32_16x16x32_bf16 v[242:245], a[248:251], v[22:25], v[242:245]
    v_mfma_f32_16x16x32_bf16 v[76:79], v[148:151], v[208:211], v[76:79]
    ds_read_b128 v[124:127], v240 offset:11264
    v_mfma_f32_16x16x32_bf16 v[100:103], v[148:151], v[212:215], v[100:103]
    s_waitcnt lgkmcnt(3)
    buffer_load_dwordx4 a[156:159], v3, s[36:39], s75 offen offset:3072 sc1
    v_mfma_f32_16x16x32_bf16 v[246:249], a[252:255], v[22:25], v[246:249]
    s_waitcnt vmcnt(8)
    v_mfma_f32_16x16x32_bf16 v[72:75], v[152:155], v[216:219], v[72:75]
    ds_read_b128 v[128:131], v240 offset:16384
    v_mfma_f32_16x16x32_bf16 v[96:99], v[152:155], v[220:223], v[96:99]
    v_mfma_f32_16x16x32_bf16 v[76:79], v[156:159], v[216:219], v[76:79]
    s_nop 0
    ds_read_b128 v[132:135], v240 offset:17408
    v_mfma_f32_16x16x32_bf16 v[100:103], v[156:159], v[220:223], v[100:103]
    s_waitcnt lgkmcnt(3)
    s_mov_b32 exec_lo, 0x00010001
    s_mov_b32 exec_hi, 0x00010001
    ds_write_b128 v45, v[242:245] offset:512
    ds_write_b128 v46, v[246:249] offset:512
    s_mov_b64 exec, -1
    v_mfma_f32_16x16x32_bf16 v[80:83], v[112:115], v[176:179], v[80:83]
    s_add_u32 s75, s73, 0x6000
    ds_read_b128 v[136:139], v240 offset:22528
    buffer_load_dwordx4 a[160:163], v3, s[36:39], s75 offen sc1
    v_mfma_f32_16x16x32_bf16 v[104:107], v[112:115], v[180:183], v[104:107]
    v_mfma_f32_16x16x32_bf16 v[84:87], v[116:119], v[176:179], v[84:87]
    s_waitcnt lgkmcnt(1)
    s_barrier
    ds_read_b128 v[140:143], v240 offset:23552
    ds_read_b128 v[160:163], v35 offset:640
    v_mfma_f32_16x16x32_bf16 v[108:111], v[116:119], v[180:183], v[108:111]
    ds_read_b128 v[164:167], v35 offset:704
    v_mfma_f32_16x16x32_bf16 v[80:83], v[120:123], v[184:187], v[80:83]
    ds_read_b128 v[144:147], v240 offset:28672
    buffer_load_dwordx4 a[164:167], v3, s[36:39], s75 offen offset:1024 sc1
    v_mfma_f32_16x16x32_bf16 v[104:107], v[120:123], v[188:191], v[104:107]
    ds_read_b128 v[168:171], v35 offset:768
    ds_read_b128 v[172:175], v35 offset:832
    v_mfma_f32_16x16x32_bf16 v[84:87], v[124:127], v[184:187], v[84:87]
    ds_read_b128 v[148:151], v240 offset:29696
    v_mfma_f32_16x16x32_bf16 v[108:111], v[124:127], v[188:191], v[108:111]
    v_mfma_f32_16x16x32_bf16 v[80:83], v[128:131], v[192:195], v[80:83]
    ds_read_b128 v[152:155], v240 offset:34816
    buffer_load_dwordx4 a[168:171], v3, s[36:39], s75 offen offset:2048 sc1
    v_mfma_f32_16x16x32_bf16 v[104:107], v[128:131], v[196:199], v[104:107]
    s_waitcnt lgkmcnt(2)
    v_fmac_f32 v72, v160, v236
    v_fmac_f32 v73, v161, v236
    v_mfma_f32_16x16x32_bf16 v[84:87], v[132:135], v[192:195], v[84:87]
    s_nop 0
    ds_read_b128 v[156:159], v240 offset:35840
    v_fmac_f32 v74, v162, v236
    v_mfma_f32_16x16x32_bf16 v[108:111], v[132:135], v[196:199], v[108:111]
Lpg_5000:
    s_cbranch_execz Lret_3_1_f
    s_nop 0
    v_fmac_f32 v75, v163, v236
    v_fmac_f32 v76, v164, v236
    v_mfma_f32_16x16x32_bf16 v[80:83], v[136:139], v[200:203], v[80:83]
    ds_read_b128 v[112:115], v240 offset:0
    buffer_load_dwordx4 a[172:175], v3, s[36:39], s75 offen offset:3072 sc1
    v_mfma_f32_16x16x32_bf16 v[104:107], v[136:139], v[204:207], v[104:107]
    v_fmac_f32 v77, v165, v236
    v_fmac_f32 v78, v166, v236
    v_mfma_f32_16x16x32_bf16 v[84:87], v[140:143], v[200:203], v[84:87]
    s_nop 0
    ds_read_b128 v[116:119], v240 offset:1024
    v_fmac_f32 v79, v167, v236
    v_mfma_f32_16x16x32_bf16 v[108:111], v[140:143], v[204:207], v[108:111]
    v_cvt_pk_bf16_f32 v72, v72, v73
    v_cvt_pk_bf16_f32 v73, v74, v75
    v_mfma_f32_16x16x32_bf16 v[80:83], v[144:147], v[208:211], v[80:83]
    s_add_u32 s75, s73, 0x7000
    ds_read_b128 v[120:123], v240 offset:6144
    buffer_load_dwordx4 a[176:179], v3, s[36:39], s75 offen sc1
    v_mfma_f32_16x16x32_bf16 v[104:107], v[144:147], v[212:215], v[104:107]
    s_waitcnt lgkmcnt(3)
    v_cvt_pk_bf16_f32 v74, v76, v77
    v_cvt_pk_bf16_f32 v75, v78, v79
    v_mfma_f32_16x16x32_bf16 v[84:87], v[148:151], v[208:211], v[84:87]
    s_nop 0
    ds_read_b128 v[124:127], v240 offset:7168
    v_pk_max_i16 v72, v72, 0
    v_mfma_f32_16x16x32_bf16 v[108:111], v[148:151], v[212:215], v[108:111]
    v_pk_max_i16 v73, v73, 0
    v_pk_max_i16 v74, v74, 0
    v_mfma_f32_16x16x32_bf16 v[80:83], v[152:155], v[216:219], v[80:83]
    ds_read_b128 v[128:131], v240 offset:12288
    buffer_load_dwordx4 a[180:183], v3, s[36:39], s75 offen offset:1024 sc1
    v_mfma_f32_16x16x32_bf16 v[104:107], v[152:155], v[220:223], v[104:107]
    v_pk_max_i16 v75, v75, 0
    buffer_store_dwordx4 v[72:75], v3, s[36:39], s20 offen offset:1024
    v_mfma_f32_16x16x32_bf16 v[84:87], v[156:159], v[216:219], v[84:87]
    s_nop 0
    ds_read_b128 v[132:135], v240 offset:13312
    v_fmac_f32 v96, v160, v238
    v_mfma_f32_16x16x32_bf16 v[108:111], v[156:159], v[220:223], v[108:111]
    s_waitcnt lgkmcnt(3)
    v_fmac_f32 v97, v161, v238
    v_fmac_f32 v98, v162, v238
    v_mfma_f32_16x16x32_bf16 v[64:67], v[112:115], v[176:179], v[64:67]
    ds_read_b128 v[136:139], v240 offset:18432
    buffer_load_dwordx4 a[184:187], v3, s[36:39], s75 offen offset:2048 sc1
    v_mfma_f32_16x16x32_bf16 v[88:91], v[112:115], v[180:183], v[88:91]
    v_fmac_f32 v99, v163, v238
    v_fmac_f32 v100, v164, v238
    v_mfma_f32_16x16x32_bf16 v[68:71], v[116:119], v[176:179], v[68:71]
    ds_read_b128 v[140:143], v240 offset:19456
    v_fmac_f32 v101, v165, v238
    v_fmac_f32 v102, v166, v238
    v_fmac_f32 v103, v167, v238
    v_cvt_pk_bf16_f32 v96, v96, v97
    v_cvt_pk_bf16_f32 v97, v98, v99
    v_cvt_pk_bf16_f32 v98, v100, v101
    v_cvt_pk_bf16_f32 v99, v102, v103
    v_pk_max_i16 v96, v96, 0
    v_pk_max_i16 v97, v97, 0
    v_pk_max_i16 v98, v98, 0
    v_pk_max_i16 v99, v99, 0
    buffer_store_dwordx4 v[96:99], v3, s[36:39], s21 offen offset:1024
    v_mfma_f32_16x16x32_bf16 v[92:95], v[116:119], v[180:183], v[92:95]
    v_mfma_f32_16x16x32_bf16 v[64:67], v[120:123], v[184:187], v[64:67]
    ds_read_b128 v[144:147], v240 offset:24576
    buffer_load_dwordx4 a[188:191], v3, s[36:39], s75 offen offset:3072 sc1
    v_mfma_f32_16x16x32_bf16 v[88:91], v[120:123], v[188:191], v[88:91]
    s_waitcnt lgkmcnt(3)
    v_fmac_f32 v80, v168, v236
    v_fmac_f32 v81, v169, v236
    v_mfma_f32_16x16x32_bf16 v[68:71], v[124:127], v[184:187], v[68:71]
    s_nop 0
    ds_read_b128 v[148:151], v240 offset:25600
    v_fmac_f32 v82, v170, v236
    v_mfma_f32_16x16x32_bf16 v[92:95], v[124:127], v[188:191], v[92:95]
    v_fmac_f32 v83, v171, v236
    v_fmac_f32 v84, v172, v236
    v_mfma_f32_16x16x32_bf16 v[64:67], v[128:131], v[192:195], v[64:67]
    s_add_u32 s75, s73, 0x8000
    ds_read_b128 v[152:155], v240 offset:30720
    buffer_load_dwordx4 a[192:195], v3, s[36:39], s75 offen sc1
    v_mfma_f32_16x16x32_bf16 v[88:91], v[128:131], v[196:199], v[88:91]
    v_fmac_f32 v85, v173, v236
    v_fmac_f32 v86, v174, v236
    v_mfma_f32_16x16x32_bf16 v[68:71], v[132:135], v[192:195], v[68:71]
    s_nop 0
    ds_read_b128 v[156:159], v240 offset:31744
    v_fmac_f32 v87, v175, v236
    v_mfma_f32_16x16x32_bf16 v[92:95], v[132:135], v[196:199], v[92:95]
    s_waitcnt lgkmcnt(3)
    v_cvt_pk_bf16_f32 v80, v80, v81
    v_cvt_pk_bf16_f32 v81, v82, v83
    v_mfma_f32_16x16x32_bf16 v[64:67], v[136:139], v[200:203], v[64:67]
    ds_read_b128 v[160:163], v35 offset:512
    v_cvt_pk_bf16_f32 v82, v84, v85
    v_cvt_pk_bf16_f32 v83, v86, v87
    v_mfma_f32_16x16x32_bf16 v[88:91], v[136:139], v[204:207], v[88:91]
    ds_read_b128 v[164:167], v35 offset:576
    v_pk_max_i16 v80, v80, 0
    v_pk_max_i16 v81, v81, 0
    v_mfma_f32_16x16x32_bf16 v[68:71], v[140:143], v[200:203], v[68:71]
    ds_read_b128 v[242:245], v35 offset:896
    v_pk_max_i16 v82, v82, 0
    v_pk_max_i16 v83, v83, 0
    v_mfma_f32_16x16x32_bf16 v[92:95], v[140:143], v[204:207], v[92:95]
    ds_read_b128 v[246:249], v35 offset:960
    buffer_store_dwordx4 v[80:83], v3, s[36:39], s22 offen offset:2048
    v_fmac_f32_e64 v104, v168, v238
    v_mfma_f32_16x16x32_bf16 v[64:67], v[144:147], v[208:211], v[64:67]
    v_fmac_f32 v105, v169, v238
    v_fmac_f32 v106, v170, v238
    v_mfma_f32_16x16x32_bf16 v[88:91], v[144:147], v[212:215], v[88:91]
    s_waitcnt lgkmcnt(4)
    v_fmac_f32 v107, v171, v238
    v_fmac_f32 v108, v172, v238
    v_mfma_f32_16x16x32_bf16 v[68:71], v[148:151], v[208:211], v[68:71]
    v_fmac_f32 v109, v173, v238
    v_fmac_f32 v110, v174, v238
    v_mfma_f32_16x16x32_bf16 v[92:95], v[148:151], v[212:215], v[92:95]
    v_fmac_f32 v111, v175, v238
    v_cvt_pk_bf16_f32 v104, v104, v105
    v_mfma_f32_16x16x32_bf16 v[64:67], v[152:155], v[216:219], v[64:67]
    v_cvt_pk_bf16_f32 v105, v106, v107
    v_cvt_pk_bf16_f32 v106, v108, v109
    v_mfma_f32_16x16x32_bf16 v[88:91], v[152:155], v[220:223], v[88:91]
    v_cvt_pk_bf16_f32 v107, v110, v111
    v_pk_max_i16 v104, v104, 0
    v_mfma_f32_16x16x32_bf16 v[68:71], v[156:159], v[216:219], v[68:71]
    v_pk_max_i16 v105, v105, 0
    v_pk_max_i16 v106, v106, 0
    v_mfma_f32_16x16x32_bf16 v[92:95], v[156:159], v[220:223], v[92:95]
    s_nop 0
    v_pk_max_i16 v107, v107, 0
    buffer_store_dwordx4 v[104:107], v3, s[36:39], s23 offen offset:2048
    s_waitcnt lgkmcnt(0)
    v_pk_add_f32 v[160:161], v[160:161], v[242:243]
    v_pk_add_f32 v[162:163], v[162:163], v[244:245]
    v_pk_add_f32 v[164:165], v[164:165], v[246:247]
    v_pk_add_f32 v[166:167], v[166:167], v[248:249]
    v_pk_fma_f32 v[64:65], v[160:161], v[236:237], v[64:65] op_sel:[0,0,0] op_sel_hi:[1,0,1]
    v_pk_fma_f32 v[68:69], v[164:165], v[236:237], v[68:69] op_sel:[0,0,0] op_sel_hi:[1,0,1]
    v_pk_fma_f32 v[66:67], v[162:163], v[236:237], v[66:67] op_sel:[0,0,0] op_sel_hi:[1,0,1]
    v_pk_fma_f32 v[70:71], v[166:167], v[236:237], v[70:71] op_sel:[0,0,0] op_sel_hi:[1,0,1]
    v_cvt_pk_bf16_f32 v64, v64, v65
    v_cvt_pk_bf16_f32 v68, v68, v69
    v_cvt_pk_bf16_f32 v65, v66, v67
    v_cvt_pk_bf16_f32 v69, v70, v71
    v_pk_max_i16 v64, v64, 0
    v_pk_max_i16 v65, v65, 0
    v_pk_max_i16 v66, v68, 0
    v_pk_max_i16 v67, v69, 0
    v_pk_fma_f32 v[88:89], v[160:161], v[238:239], v[88:89] op_sel:[0,0,0] op_sel_hi:[1,0,1]
    v_pk_fma_f32 v[92:93], v[164:165], v[238:239], v[92:93] op_sel:[0,0,0] op_sel_hi:[1,0,1]
    v_pk_fma_f32 v[90:91], v[162:163], v[238:239], v[90:91] op_sel:[0,0,0] op_sel_hi:[1,0,1]
    v_pk_fma_f32 v[94:95], v[166:167], v[238:239], v[94:95] op_sel:[0,0,0] op_sel_hi:[1,0,1]
    v_cvt_pk_bf16_f32 v88, v88, v89
    v_cvt_pk_bf16_f32 v92, v92, v93
    v_cvt_pk_bf16_f32 v89, v90, v91
    v_cvt_pk_bf16_f32 v93, v94, v95
    v_pk_max_i16 v88, v88, 0
    v_pk_max_i16 v89, v89, 0
    v_pk_max_i16 v90, v92, 0
    v_pk_max_i16 v91, v93, 0
    buffer_store_dwordx4 v[64:67], v3, s[36:39], s20 offen
    buffer_store_dwordx4 v[88:91], v3, s[36:39], s21 offen
    buffer_load_dwordx4 a[196:199], v3, s[36:39], s75 offen offset:1024 sc1
    buffer_load_dwordx4 a[200:203], v3, s[36:39], s75 offen offset:2048 sc1
    buffer_load_dwordx4 a[204:207], v3, s[36:39], s75 offen offset:3072 sc1
    s_add_u32 s75, s73, 0x9000
    buffer_load_dwordx4 a[208:211], v3, s[36:39], s75 offen sc1
    buffer_load_dwordx4 a[212:215], v3, s[36:39], s75 offen offset:1024 sc1
    buffer_load_dwordx4 a[216:219], v3, s[36:39], s75 offen offset:2048 sc1
    buffer_load_dwordx4 a[220:223], v3, s[36:39], s75 offen offset:3072 sc1
    buffer_load_dwordx4 a[224:227], v3, s[36:39], s74 offen sc1
    v_mov_b32 v4, 3
    s_cmp_lg_u32 s48, 0
    s_mov_b64 exec, 1
    s_waitcnt vmcnt(8)
    s_barrier
    s_cbranch_scc1 Lq_f_19
    buffer_store_dword v4, off, s[36:39], s55
Lq_f_19:
    s_mov_b64 exec, -1
    s_nop 0
    buffer_load_dwordx4 a[228:231], v3, s[36:39], s74 offen offset:1024 sc1
    buffer_load_dwordx4 a[232:235], v3, s[36:39], s74 offen offset:2048 sc1
    buffer_load_dwordx4 a[236:239], v3, s[36:39], s74 offen offset:3072 sc1
    s_mov_b32 exec_lo, 0x00010001
    s_mov_b32 exec_hi, 0x00010001
    ds_write_b128 v35, v[160:163] offset:512
    ds_write_b128 v35, v[164:167] offset:576
    s_mov_b64 exec, -1
    v_add_f32 v232, v232, v234
    v_add_f32 v233, v233, v235
    s_nop 1
    v_permlane32_swap_b32 v232, v233
    v_add_f32 v232, v232, v233
    v_mov_b32 v233, v232
    s_nop 1
    v_permlane16_swap_b32 v232, v233
    v_add_f32 v232, v232, v233
    v_mov_b32 v233, v232
    s_nop 1
    v_permlane32_swap_b32 v232, v233
    v_mul_f32 v42, 0xbb000000, v232
    v_mul_f32 v233, 0x3b000000, v233
    v_fma_f32 v233, -v42, v42, v233
    v_max_f32 v233, 0, v233
    v_add_f32 v233, 0x3727c5ac, v233
    v_rsq_f32 v43, v233
    s_mul_i32 s4, s48, 11264
    s_add_u32 s4, s4, 0x600000
    s_xor_b32 s5, s48, 0
    s_add_u32 s5, s5, s61
    s_mul_i32 s5, s5, 44032
    s_add_u32 s10, s5, s4
    s_xor_b32 s5, s48, 1
    s_add_u32 s5, s5, s61
    s_mul_i32 s5, s5, 44032
    s_add_u32 s11, s5, s4
    s_xor_b32 s5, s48, 2
    s_add_u32 s5, s5, s61
    s_mul_i32 s5, s5, 44032
    s_add_u32 s12, s5, s4
    s_xor_b32 s5, s48, 3
    s_add_u32 s5, s5, s61
    s_mul_i32 s5, s5, 44032
    s_add_u32 s13, s5, s4
    s_cmp_lg_u32 s48, 1
    s_cbranch_scc1 Lnw_4_1_f
    s_mov_b64 exec, 0
    s_branch Lpg_6000
Lret_4_1_f:
    s_mov_b64 exec, -1
Lnw_4_1_f:
    s_cmp_lg_u32 s48, 2
    s_cbranch_scc1 Lnw_4_2_f
    s_mov_b64 exec, 0
    s_branch Lret_4_2_f
Lret_4_2_f:
    s_mov_b64 exec, -1
Lnw_4_2_f:
    s_cmp_lg_u32 s48, 0
    s_cbranch_scc1 Ln_f_17
    buffer_load_dword v4, v17, s[36:39], s58 offen sc1
    s_nop 15
Lp_f_18:
    buffer_load_dword v5, v17, s[36:39], s58 offen sc1
    s_waitcnt vmcnt(1)
    v_cmp_gt_u32 vcc, 3, v4
    s_cbranch_vccz Ln_f_17
    buffer_load_dword v4, v17, s[36:39], s58 offen sc1
    s_waitcnt vmcnt(1)
    v_cmp_gt_u32 vcc, 3, v5
    s_cbranch_vccz Ln_f_17
    s_sub_u32 s14, s14, 1
    s_cbranch_scc1 L_end_f
    s_branch Lp_f_18
Ln_f_17:
    s_barrier
    buffer_load_dwordx4 v[64:67], v3, s[36:39], s13 offen sc1
    s_barrier
    buffer_load_dwordx4 v[68:71], v3, s[36:39], s13 offen offset:1024 sc1
    s_barrier
    buffer_load_dwordx4 v[72:75], v3, s[36:39], s13 offen offset:2048 sc1
    s_barrier
    buffer_load_dwordx4 v[76:79], v3, s[36:39], s13 offen offset:3072 sc1
    s_barrier
    s_add_u32 s17, s13, 0x1000
    buffer_load_dwordx4 v[80:83], v3, s[36:39], s17 offen sc1
    s_barrier
    buffer_load_dwordx4 v[84:87], v3, s[36:39], s17 offen offset:1024 sc1
    s_waitcnt vmcnt(5)
    v_mfma_f32_16x16x32_bf16 v[144:147], a[64:67], v[64:67], 0
    buffer_load_dwordx4 v[88:91], v3, s[36:39], s17 offen offset:2048 sc1
    v_mfma_f32_16x16x32_bf16 v[148:151], a[68:71], v[64:67], 0
    v_mfma_f32_16x16x32_bf16 v[152:155], a[72:75], v[64:67], 0
    s_nop 0
    buffer_load_dwordx4 v[92:95], v3, s[36:39], s17 offen offset:3072 sc1
    v_mfma_f32_16x16x32_bf16 v[156:159], a[76:79], v[64:67], 0
    s_waitcnt vmcnt(6)
    v_mfma_f32_16x16x32_bf16 v[144:147], a[80:83], v[68:71], v[144:147]
    s_add_u32 s18, s13, 0x2000
    buffer_load_dwordx4 v[96:99], v3, s[36:39], s18 offen sc1
    v_mfma_f32_16x16x32_bf16 v[148:151], a[84:87], v[68:71], v[148:151]
    v_mfma_f32_16x16x32_bf16 v[152:155], a[88:91], v[68:71], v[152:155]
    v_mfma_f32_16x16x32_bf16 v[156:159], a[92:95], v[68:71], v[156:159]
    s_waitcnt vmcnt(6)
    v_mfma_f32_16x16x32_bf16 v[144:147], a[96:99], v[72:75], v[144:147]
    buffer_load_dwordx4 v[100:103], v3, s[36:39], s18 offen offset:1024 sc1
    v_mfma_f32_16x16x32_bf16 v[148:151], a[100:103], v[72:75], v[148:151]
    s_add_u32 s4, s13, 10240
    v_mfma_f32_16x16x32_bf16 v[152:155], a[104:107], v[72:75], v[152:155]
    s_cmp_eq_u32 s48, 3
    v_mfma_f32_16x16x32_bf16 v[156:159], a[108:111], v[72:75], v[156:159]
    s_waitcnt vmcnt(6)
    v_mfma_f32_16x16x32_bf16 v[144:147], a[112:115], v[76:79], v[144:147]
    s_cselect_b32 s4, 0x80000000, s4
    buffer_load_dwordx4 v[104:107], v3, s[36:39], s4 offen sc1
    v_mfma_f32_16x16x32_bf16 v[148:151], a[116:119], v[76:79], v[148:151]
    v_mfma_f32_16x16x32_bf16 v[152:155], a[120:123], v[76:79], v[152:155]
    v_mfma_f32_16x16x32_bf16 v[156:159], a[124:127], v[76:79], v[156:159]
    s_waitcnt vmcnt(6)
    v_mfma_f32_16x16x32_bf16 v[144:147], a[128:131], v[80:83], v[144:147]
    buffer_load_dwordx4 v[108:111], v3, s[36:39], s12 offen sc1
    v_mfma_f32_16x16x32_bf16 v[148:151], a[132:135], v[80:83], v[148:151]
    v_mfma_f32_16x16x32_bf16 v[152:155], a[136:139], v[80:83], v[152:155]
    v_mfma_f32_16x16x32_bf16 v[156:159], a[140:143], v[80:83], v[156:159]
    s_waitcnt vmcnt(6)
    v_mfma_f32_16x16x32_bf16 v[144:147], a[144:147], v[84:87], v[144:147]
    buffer_load_dwordx4 v[112:115], v3, s[36:39], s12 offen offset:1024 sc1
    v_mfma_f32_16x16x32_bf16 v[148:151], a[148:151], v[84:87], v[148:151]
    v_mfma_f32_16x16x32_bf16 v[152:155], a[152:155], v[84:87], v[152:155]
    v_mfma_f32_16x16x32_bf16 v[156:159], a[156:159], v[84:87], v[156:159]
    s_waitcnt vmcnt(6)
    v_mfma_f32_16x16x32_bf16 v[144:147], a[160:163], v[88:91], v[144:147]
    buffer_load_dwordx4 v[116:119], v3, s[36:39], s12 offen offset:2048 sc1
    v_mfma_f32_16x16x32_bf16 v[148:151], a[164:167], v[88:91], v[148:151]
    v_mfma_f32_16x16x32_bf16 v[152:155], a[168:171], v[88:91], v[152:155]
    v_mfma_f32_16x16x32_bf16 v[156:159], a[172:175], v[88:91], v[156:159]
    s_waitcnt vmcnt(6)
    v_mfma_f32_16x16x32_bf16 v[144:147], a[176:179], v[92:95], v[144:147]
    buffer_load_dwordx4 v[120:123], v3, s[36:39], s12 offen offset:3072 sc1
    v_mfma_f32_16x16x32_bf16 v[148:151], a[180:183], v[92:95], v[148:151]
    v_mfma_f32_16x16x32_bf16 v[152:155], a[184:187], v[92:95], v[152:155]
    v_mfma_f32_16x16x32_bf16 v[156:159], a[188:191], v[92:95], v[156:159]
    s_waitcnt vmcnt(6)
    v_mfma_f32_16x16x32_bf16 v[144:147], a[192:195], v[96:99], v[144:147]
    s_add_u32 s16, s12, 0x1000
    buffer_load_dwordx4 v[124:127], v3, s[36:39], s16 offen sc1
    v_mfma_f32_16x16x32_bf16 v[148:151], a[196:199], v[96:99], v[148:151]
    v_mfma_f32_16x16x32_bf16 v[152:155], a[200:203], v[96:99], v[152:155]
    v_mfma_f32_16x16x32_bf16 v[156:159], a[204:207], v[96:99], v[156:159]
    s_waitcnt vmcnt(6)
    v_mfma_f32_16x16x32_bf16 v[144:147], a[208:211], v[100:103], v[144:147]
    buffer_load_dwordx4 v[64:67], v3, s[36:39], s16 offen offset:1024 sc1
    v_mfma_f32_16x16x32_bf16 v[148:151], a[212:215], v[100:103], v[148:151]
    v_mfma_f32_16x16x32_bf16 v[152:155], a[216:219], v[100:103], v[152:155]
    v_mfma_f32_16x16x32_bf16 v[156:159], a[220:223], v[100:103], v[156:159]
    s_waitcnt vmcnt(6)
    v_mfma_f32_16x16x32_bf16 v[144:147], a[224:227], v[104:107], v[144:147]
    buffer_load_dwordx4 v[68:71], v3, s[36:39], s16 offen offset:2048 sc1
    v_mfma_f32_16x16x32_bf16 v[148:151], a[228:231], v[104:107], v[148:151]
    v_mfma_f32_16x16x32_bf16 v[152:155], a[232:235], v[104:107], v[152:155]
    v_mfma_f32_16x16x32_bf16 v[156:159], a[236:239], v[104:107], v[156:159]
    s_waitcnt vmcnt(6)
    v_mfma_f32_16x16x32_bf16 v[128:131], a[64:67], v[108:111], 0
    buffer_load_dwordx4 v[72:75], v3, s[36:39], s16 offen offset:3072 sc1
    v_mfma_f32_16x16x32_bf16 v[132:135], a[68:71], v[108:111], 0
    s_nop 0
    ds_write_b128 v38, v[144:147] offset:0
    v_mfma_f32_16x16x32_bf16 v[136:139], a[72:75], v[108:111], 0
    v_mfma_f32_16x16x32_bf16 v[140:143], a[76:79], v[108:111], 0
    s_waitcnt vmcnt(6)
    v_mfma_f32_16x16x32_bf16 v[128:131], a[80:83], v[112:115], v[128:131]
    s_add_u32 s17, s12, 0x2000
    buffer_load_dwordx4 v[76:79], v3, s[36:39], s17 offen sc1
    v_mfma_f32_16x16x32_bf16 v[132:135], a[84:87], v[112:115], v[132:135]
    ds_write_b128 v38, v[148:151] offset:1024
    v_mfma_f32_16x16x32_bf16 v[136:139], a[88:91], v[112:115], v[136:139]
    v_mfma_f32_16x16x32_bf16 v[140:143], a[92:95], v[112:115], v[140:143]
    s_waitcnt vmcnt(6)
    v_mfma_f32_16x16x32_bf16 v[128:131], a[96:99], v[116:119], v[128:131]
    buffer_load_dwordx4 v[80:83], v3, s[36:39], s17 offen offset:1024 sc1
    v_mfma_f32_16x16x32_bf16 v[132:135], a[100:103], v[116:119], v[132:135]
    s_add_u32 s4, s12, 10240
    ds_write_b128 v38, v[152:155] offset:2048
    v_mfma_f32_16x16x32_bf16 v[136:139], a[104:107], v[116:119], v[136:139]
    s_cmp_eq_u32 s48, 3
    v_mfma_f32_16x16x32_bf16 v[140:143], a[108:111], v[116:119], v[140:143]
    s_waitcnt vmcnt(6)
    v_mfma_f32_16x16x32_bf16 v[128:131], a[112:115], v[120:123], v[128:131]
    s_cselect_b32 s4, 0x80000000, s4
    buffer_load_dwordx4 v[84:87], v3, s[36:39], s4 offen sc1
    v_mfma_f32_16x16x32_bf16 v[132:135], a[116:119], v[120:123], v[132:135]
    ds_write_b128 v38, v[156:159] offset:3072
    v_mfma_f32_16x16x32_bf16 v[136:139], a[120:123], v[120:123], v[136:139]
    v_mfma_f32_16x16x32_bf16 v[140:143], a[124:127], v[120:123], v[140:143]
    s_waitcnt vmcnt(6)
    v_mfma_f32_16x16x32_bf16 v[128:131], a[128:131], v[124:127], v[128:131]
    buffer_load_dwordx4 v[88:91], v3, s[36:39], s11 offen sc1
    v_mfma_f32_16x16x32_bf16 v[132:135], a[132:135], v[124:127], v[132:135]
    v_mfma_f32_16x16x32_bf16 v[136:139], a[136:139], v[124:127], v[136:139]
    v_mfma_f32_16x16x32_bf16 v[140:143], a[140:143], v[124:127], v[140:143]
    s_waitcnt lgkmcnt(0)
    s_barrier
    s_waitcnt vmcnt(6)
    ds_read_b128 v[192:195], v39 offset:0
    v_mfma_f32_16x16x32_bf16 v[128:131], a[144:147], v[64:67], v[128:131]
    buffer_load_dwordx4 v[92:95], v3, s[36:39], s11 offen offset:1024 sc1
    ds_read_b128 v[196:199], v39 offset:1024
    v_mfma_f32_16x16x32_bf16 v[132:135], a[148:151], v[64:67], v[132:135]
    ds_read_b128 v[200:203], v39 offset:2048
    v_mfma_f32_16x16x32_bf16 v[136:139], a[152:155], v[64:67], v[136:139]
    ds_read_b128 v[204:207], v39 offset:3072
    v_mfma_f32_16x16x32_bf16 v[140:143], a[156:159], v[64:67], v[140:143]
    s_waitcnt vmcnt(6)
    v_mfma_f32_16x16x32_bf16 v[128:131], a[160:163], v[68:71], v[128:131]
    buffer_load_dwordx4 v[96:99], v3, s[36:39], s11 offen offset:2048 sc1
    v_mfma_f32_16x16x32_bf16 v[132:135], a[164:167], v[68:71], v[132:135]
    v_mfma_f32_16x16x32_bf16 v[136:139], a[168:171], v[68:71], v[136:139]
    v_mfma_f32_16x16x32_bf16 v[140:143], a[172:175], v[68:71], v[140:143]
    s_waitcnt vmcnt(6)
    v_mfma_f32_16x16x32_bf16 v[128:131], a[176:179], v[72:75], v[128:131]
    buffer_load_dwordx4 v[100:103], v3, s[36:39], s11 offen offset:3072 sc1
    v_mfma_f32_16x16x32_bf16 v[132:135], a[180:183], v[72:75], v[132:135]
    v_mfma_f32_16x16x32_bf16 v[136:139], a[184:187], v[72:75], v[136:139]
    s_waitcnt lgkmcnt(0)
    v_fmac_f32 v48, v43, v192
    v_fmac_f32 v49, v43, v193
    v_mfma_f32_16x16x32_bf16 v[140:143], a[188:191], v[72:75], v[140:143]
    s_waitcnt vmcnt(6)
    v_fmac_f32 v50, v43, v194
    v_mfma_f32_16x16x32_bf16 v[128:131], a[192:195], v[76:79], v[128:131]
    s_add_u32 s18, s11, 0x1000
    buffer_load_dwordx4 v[104:107], v3, s[36:39], s18 offen sc1
    v_fmac_f32 v51, v43, v195
    v_mfma_f32_16x16x32_bf16 v[132:135], a[196:199], v[76:79], v[132:135]
    v_fmac_f32 v52, v43, v196
    v_mfma_f32_16x16x32_bf16 v[136:139], a[200:203], v[76:79], v[136:139]
    v_fmac_f32 v53, v43, v197
    v_mfma_f32_16x16x32_bf16 v[140:143], a[204:207], v[76:79], v[140:143]
    s_waitcnt vmcnt(6)
    v_fmac_f32 v54, v43, v198
    v_mfma_f32_16x16x32_bf16 v[128:131], a[208:211], v[80:83], v[128:131]
    buffer_load_dwordx4 v[108:111], v3, s[36:39], s18 offen offset:1024 sc1
    v_fmac_f32 v55, v43, v199
    v_mfma_f32_16x16x32_bf16 v[132:135], a[212:215], v[80:83], v[132:135]
    v_fmac_f32 v56, v43, v200
    v_fmac_f32 v57, v43, v201
    v_mfma_f32_16x16x32_bf16 v[136:139], a[216:219], v[80:83], v[136:139]
    v_fmac_f32 v58, v43, v202
    v_mfma_f32_16x16x32_bf16 v[140:143], a[220:223], v[80:83], v[140:143]
    s_waitcnt vmcnt(6)
    v_fmac_f32 v59, v43, v203
    v_mfma_f32_16x16x32_bf16 v[128:131], a[224:227], v[84:87], v[128:131]
    buffer_load_dwordx4 v[112:115], v3, s[36:39], s18 offen offset:2048 sc1
    v_fmac_f32 v60, v43, v204
    v_mfma_f32_16x16x32_bf16 v[132:135], a[228:231], v[84:87], v[132:135]
    v_fmac_f32 v61, v43, v205
    v_mfma_f32_16x16x32_bf16 v[136:139], a[232:235], v[84:87], v[136:139]
    v_fmac_f32 v62, v43, v206
    v_mfma_f32_16x16x32_bf16 v[140:143], a[236:239], v[84:87], v[140:143]
    s_waitcnt vmcnt(6)
    v_fmac_f32 v63, v43, v207
    v_mfma_f32_16x16x32_bf16 v[144:147], a[64:67], v[88:91], 0
    buffer_load_dwordx4 v[116:119], v3, s[36:39], s18 offen offset:3072 sc1
    v_mfma_f32_16x16x32_bf16 v[148:151], a[68:71], v[88:91], 0
    ds_write_b128 v37, v[128:131] offset:16384
    v_mfma_f32_16x16x32_bf16 v[152:155], a[72:75], v[88:91], 0
    v_mfma_f32_16x16x32_bf16 v[156:159], a[76:79], v[88:91], 0
    s_waitcnt vmcnt(6)
    v_mfma_f32_16x16x32_bf16 v[144:147], a[80:83], v[92:95], v[144:147]
    s_add_u32 s16, s11, 0x2000
    buffer_load_dwordx4 v[120:123], v3, s[36:39], s16 offen sc1
    v_mfma_f32_16x16x32_bf16 v[148:151], a[84:87], v[92:95], v[148:151]
    ds_write_b128 v37, v[132:135] offset:17408
    v_mfma_f32_16x16x32_bf16 v[152:155], a[88:91], v[92:95], v[152:155]
    v_mfma_f32_16x16x32_bf16 v[156:159], a[92:95], v[92:95], v[156:159]
    s_waitcnt vmcnt(6)
    v_mfma_f32_16x16x32_bf16 v[144:147], a[96:99], v[96:99], v[144:147]
    buffer_load_dwordx4 v[124:127], v3, s[36:39], s16 offen offset:1024 sc1
    v_mfma_f32_16x16x32_bf16 v[148:151], a[100:103], v[96:99], v[148:151]
    s_nop 0
    s_add_u32 s4, s11, 10240
    ds_write_b128 v37, v[136:139] offset:18432
    v_mfma_f32_16x16x32_bf16 v[152:155], a[104:107], v[96:99], v[152:155]
    s_cmp_eq_u32 s48, 3
    v_mfma_f32_16x16x32_bf16 v[156:159], a[108:111], v[96:99], v[156:159]
    s_waitcnt vmcnt(6)
    v_mfma_f32_16x16x32_bf16 v[144:147], a[112:115], v[100:103], v[144:147]
    s_cselect_b32 s4, 0x80000000, s4
    buffer_load_dwordx4 v[64:67], v3, s[36:39], s4 offen sc1
    v_mfma_f32_16x16x32_bf16 v[148:151], a[116:119], v[100:103], v[148:151]
    ds_write_b128 v37, v[140:143] offset:19456
    v_mfma_f32_16x16x32_bf16 v[152:155], a[120:123], v[100:103], v[152:155]
    v_mfma_f32_16x16x32_bf16 v[156:159], a[124:127], v[100:103], v[156:159]
    s_waitcnt vmcnt(6)
    v_mfma_f32_16x16x32_bf16 v[144:147], a[128:131], v[104:107], v[144:147]
    buffer_load_dwordx4 v[68:71], v3, s[36:39], s10 offen sc1
    v_mfma_f32_16x16x32_bf16 v[148:151], a[132:135], v[104:107], v[148:151]
    v_mfma_f32_16x16x32_bf16 v[152:155], a[136:139], v[104:107], v[152:155]
    v_mfma_f32_16x16x32_bf16 v[156:159], a[140:143], v[104:107], v[156:159]
    s_waitcnt lgkmcnt(0)
    s_barrier
    s_waitcnt vmcnt(6)
    ds_read_b128 v[160:163], v39 offset:16384
    v_mfma_f32_16x16x32_bf16 v[144:147], a[144:147], v[108:111], v[144:147]
    buffer_load_dwordx4 v[72:75], v3, s[36:39], s10 offen offset:1024 sc1
    ds_read_b128 v[164:167], v39 offset:17408
    v_mfma_f32_16x16x32_bf16 v[148:151], a[148:151], v[108:111], v[148:151]
    ds_read_b128 v[168:171], v39 offset:18432
    v_mfma_f32_16x16x32_bf16 v[152:155], a[152:155], v[108:111], v[152:155]
    ds_read_b128 v[172:175], v39 offset:19456
    v_mfma_f32_16x16x32_bf16 v[156:159], a[156:159], v[108:111], v[156:159]
    s_waitcnt vmcnt(6)
    v_mfma_f32_16x16x32_bf16 v[144:147], a[160:163], v[112:115], v[144:147]
    buffer_load_dwordx4 v[76:79], v3, s[36:39], s10 offen offset:2048 sc1
    v_mfma_f32_16x16x32_bf16 v[148:151], a[164:167], v[112:115], v[148:151]
    s_nop 0
    v_mfma_f32_16x16x32_bf16 v[152:155], a[168:171], v[112:115], v[152:155]
    v_mfma_f32_16x16x32_bf16 v[156:159], a[172:175], v[112:115], v[156:159]
    s_waitcnt vmcnt(6)
    v_mfma_f32_16x16x32_bf16 v[144:147], a[176:179], v[116:119], v[144:147]
    buffer_load_dwordx4 v[80:83], v3, s[36:39], s10 offen offset:3072 sc1
    v_mfma_f32_16x16x32_bf16 v[148:151], a[180:183], v[116:119], v[148:151]
    v_mfma_f32_16x16x32_bf16 v[152:155], a[184:187], v[116:119], v[152:155]
    s_waitcnt lgkmcnt(0)
    v_fmac_f32 v48, v43, v160
    v_fmac_f32 v49, v43, v161
    v_mfma_f32_16x16x32_bf16 v[156:159], a[188:191], v[116:119], v[156:159]
    s_waitcnt vmcnt(6)
    v_fmac_f32 v50, v43, v162
    v_mfma_f32_16x16x32_bf16 v[144:147], a[192:195], v[120:123], v[144:147]
    s_add_u32 s17, s10, 0x1000
    buffer_load_dwordx4 v[84:87], v3, s[36:39], s17 offen sc1
    v_fmac_f32 v51, v43, v163
    v_mfma_f32_16x16x32_bf16 v[148:151], a[196:199], v[120:123], v[148:151]
    v_fmac_f32 v52, v43, v164
    v_mfma_f32_16x16x32_bf16 v[152:155], a[200:203], v[120:123], v[152:155]
    v_fmac_f32 v53, v43, v165
    v_mfma_f32_16x16x32_bf16 v[156:159], a[204:207], v[120:123], v[156:159]
    s_waitcnt vmcnt(6)
    v_fmac_f32 v54, v43, v166
    v_mfma_f32_16x16x32_bf16 v[144:147], a[208:211], v[124:127], v[144:147]
    buffer_load_dwordx4 v[88:91], v3, s[36:39], s17 offen offset:1024 sc1
    v_fmac_f32 v55, v43, v167
    v_mfma_f32_16x16x32_bf16 v[148:151], a[212:215], v[124:127], v[148:151]
    v_fmac_f32 v56, v43, v168
    v_fmac_f32 v57, v43, v169
    v_mfma_f32_16x16x32_bf16 v[152:155], a[216:219], v[124:127], v[152:155]
    v_fmac_f32 v58, v43, v170
    v_mfma_f32_16x16x32_bf16 v[156:159], a[220:223], v[124:127], v[156:159]
    s_waitcnt vmcnt(6)
    v_fmac_f32 v59, v43, v171
    v_mfma_f32_16x16x32_bf16 v[144:147], a[224:227], v[64:67], v[144:147]
    buffer_load_dwordx4 v[92:95], v3, s[36:39], s17 offen offset:2048 sc1
    v_fmac_f32 v60, v43, v172
    v_mfma_f32_16x16x32_bf16 v[148:151], a[228:231], v[64:67], v[148:151]
    v_fmac_f32 v61, v43, v173
    v_mfma_f32_16x16x32_bf16 v[152:155], a[232:235], v[64:67], v[152:155]
    v_fmac_f32 v62, v43, v174
    v_mfma_f32_16x16x32_bf16 v[156:159], a[236:239], v[64:67], v[156:159]
    s_waitcnt vmcnt(6)
    v_fmac_f32 v63, v43, v175
    v_mfma_f32_16x16x32_bf16 v[128:131], a[64:67], v[68:71], 0
    buffer_load_dwordx4 v[96:99], v3, s[36:39], s17 offen offset:3072 sc1
    v_mfma_f32_16x16x32_bf16 v[132:135], a[68:71], v[68:71], 0
    ds_write_b128 v36, v[144:147] offset:0
    v_mfma_f32_16x16x32_bf16 v[136:139], a[72:75], v[68:71], 0
    v_mfma_f32_16x16x32_bf16 v[140:143], a[76:79], v[68:71], 0
    s_waitcnt vmcnt(6)
    v_mfma_f32_16x16x32_bf16 v[128:131], a[80:83], v[72:75], v[128:131]
    s_add_u32 s18, s10, 0x2000
    buffer_load_dwordx4 v[100:103], v3, s[36:39], s18 offen sc1
    v_mfma_f32_16x16x32_bf16 v[132:135], a[84:87], v[72:75], v[132:135]
    ds_write_b128 v36, v[148:151] offset:1024
    v_mfma_f32_16x16x32_bf16 v[136:139], a[88:91], v[72:75], v[136:139]
    v_mfma_f32_16x16x32_bf16 v[140:143], a[92:95], v[72:75], v[140:143]
    s_waitcnt vmcnt(6)
    v_mfma_f32_16x16x32_bf16 v[128:131], a[96:99], v[76:79], v[128:131]
    buffer_load_dwordx4 v[104:107], v3, s[36:39], s18 offen offset:1024 sc1
    v_mfma_f32_16x16x32_bf16 v[132:135], a[100:103], v[76:79], v[132:135]
    s_add_u32 s4, s10, 10240
    ds_write_b128 v36, v[152:155] offset:2048
    v_mfma_f32_16x16x32_bf16 v[136:139], a[104:107], v[76:79], v[136:139]
    s_cmp_eq_u32 s48, 3
    v_mfma_f32_16x16x32_bf16 v[140:143], a[108:111], v[76:79], v[140:143]
    s_waitcnt vmcnt(6)
    v_mfma_f32_16x16x32_bf16 v[128:131], a[112:115], v[80:83], v[128:131]
    s_cselect_b32 s4, 0x80000000, s4
    buffer_load_dwordx4 v[108:111], v3, s[36:39], s4 offen sc1
    v_mfma_f32_16x16x32_bf16 v[132:135], a[116:119], v[80:83], v[132:135]
    ds_write_b128 v36, v[156:159] offset:3072
    v_mfma_f32_16x16x32_bf16 v[136:139], a[120:123], v[80:83], v[136:139]
    s_nop 0
    v_mfma_f32_16x16x32_bf16 v[140:143], a[124:127], v[80:83], v[140:143]
    s_waitcnt vmcnt(6)
    v_mfma_f32_16x16x32_bf16 v[128:131], a[128:131], v[84:87], v[128:131]
    v_mfma_f32_16x16x32_bf16 v[132:135], a[132:135], v[84:87], v[132:135]
    v_mfma_f32_16x16x32_bf16 v[136:139], a[136:139], v[84:87], v[136:139]
    v_mfma_f32_16x16x32_bf16 v[140:143], a[140:143], v[84:87], v[140:143]
    s_waitcnt lgkmcnt(0)
    s_barrier
    s_waitcnt vmcnt(5)
    ds_read_b128 v[176:179], v39 offset:0
    v_mfma_f32_16x16x32_bf16 v[128:131], a[144:147], v[88:91], v[128:131]
    ds_read_b128 v[180:183], v39 offset:1024
    v_mfma_f32_16x16x32_bf16 v[132:135], a[148:151], v[88:91], v[132:135]
    ds_read_b128 v[184:187], v39 offset:2048
    v_mfma_f32_16x16x32_bf16 v[136:139], a[152:155], v[88:91], v[136:139]
    ds_read_b128 v[188:191], v39 offset:3072
    v_mfma_f32_16x16x32_bf16 v[140:143], a[156:159], v[88:91], v[140:143]
    s_waitcnt vmcnt(4)
    v_mfma_f32_16x16x32_bf16 v[128:131], a[160:163], v[92:95], v[128:131]
    v_mfma_f32_16x16x32_bf16 v[132:135], a[164:167], v[92:95], v[132:135]
    v_mfma_f32_16x16x32_bf16 v[136:139], a[168:171], v[92:95], v[136:139]
    v_mfma_f32_16x16x32_bf16 v[140:143], a[172:175], v[92:95], v[140:143]
    s_waitcnt vmcnt(3)
    v_mfma_f32_16x16x32_bf16 v[128:131], a[176:179], v[96:99], v[128:131]
    v_mfma_f32_16x16x32_bf16 v[132:135], a[180:183], v[96:99], v[132:135]
    v_mfma_f32_16x16x32_bf16 v[136:139], a[184:187], v[96:99], v[136:139]
    s_waitcnt lgkmcnt(0)
    v_fmac_f32 v48, v43, v176
    v_fmac_f32 v49, v43, v177
    v_mfma_f32_16x16x32_bf16 v[140:143], a[188:191], v[96:99], v[140:143]
    s_waitcnt vmcnt(2)
    v_fmac_f32 v50, v43, v178
    v_mfma_f32_16x16x32_bf16 v[128:131], a[192:195], v[100:103], v[128:131]
    v_fmac_f32 v51, v43, v179
    v_mfma_f32_16x16x32_bf16 v[132:135], a[196:199], v[100:103], v[132:135]
    v_fmac_f32 v52, v43, v180
    v_mfma_f32_16x16x32_bf16 v[136:139], a[200:203], v[100:103], v[136:139]
    s_add_u32 s6, s61, s48
    v_fmac_f32 v53, v43, v181
    v_mfma_f32_16x16x32_bf16 v[140:143], a[204:207], v[100:103], v[140:143]
    s_waitcnt vmcnt(1)
    v_fmac_f32 v54, v43, v182
Lpg_6000:
    s_cbranch_execz Lret_4_1_f
    s_nop 0
    v_mfma_f32_16x16x32_bf16 v[128:131], a[208:211], v[104:107], v[128:131]
    s_lshl_b32 s4, s6, 14
    v_fmac_f32 v55, v43, v183
    v_mfma_f32_16x16x32_bf16 v[132:135], a[212:215], v[104:107], v[132:135]
    s_lshl_b32 s5, s60, 11
    v_fmac_f32 v56, v43, v184
    v_fmac_f32 v57, v43, v185
    v_mfma_f32_16x16x32_bf16 v[136:139], a[216:219], v[104:107], v[136:139]
    s_add_u32 s4, s4, s5
    v_fmac_f32 v58, v43, v186
    v_mfma_f32_16x16x32_bf16 v[140:143], a[220:223], v[104:107], v[140:143]
    s_waitcnt vmcnt(0)
    v_fmac_f32 v59, v43, v187
    v_mfma_f32_16x16x32_bf16 v[128:131], a[224:227], v[108:111], v[128:131]
    s_add_u32 s4, s4, 0x0
    v_fmac_f32 v60, v43, v188
    v_mfma_f32_16x16x32_bf16 v[132:135], a[228:231], v[108:111], v[132:135]
    s_lshl_b32 s6, s6, 10
    v_fmac_f32 v61, v43, v189
    v_mfma_f32_16x16x32_bf16 v[136:139], a[232:235], v[108:111], v[136:139]
    s_add_u32 s6, s6, 0x380000
    v_fmac_f32 v62, v43, v190
    v_mfma_f32_16x16x32_bf16 v[140:143], a[236:239], v[108:111], v[140:143]
    v_fmac_f32_e64 v63, v43, v191
    v_pk_fma_f32 v[48:49], v[128:129], v[42:43], v[48:49] op_sel:[0,1,0] op_sel_hi:[1,1,1]
    v_pk_fma_f32 v[50:51], v[130:131], v[42:43], v[50:51] op_sel:[0,1,0] op_sel_hi:[1,1,1]
    v_pk_fma_f32 v[52:53], v[132:133], v[42:43], v[52:53] op_sel:[0,1,0] op_sel_hi:[1,1,1]
    v_pk_fma_f32 v[54:55], v[134:135], v[42:43], v[54:55] op_sel:[0,1,0] op_sel_hi:[1,1,1]
    v_cvt_pk_bf16_f32 v208, v48, v49
    v_cvt_pk_bf16_f32 v209, v50, v51
    v_cvt_pk_bf16_f32 v210, v52, v53
    v_cvt_pk_bf16_f32 v211, v54, v55
    buffer_store_dwordx4 v[208:211], v3, s[40:43], s4 offen
    v_pk_fma_f32 v[56:57], v[136:137], v[42:43], v[56:57] op_sel:[0,1,0] op_sel_hi:[1,1,1]
    v_pk_fma_f32 v[58:59], v[138:139], v[42:43], v[58:59] op_sel:[0,1,0] op_sel_hi:[1,1,1]
    v_pk_fma_f32 v[60:61], v[140:141], v[42:43], v[60:61] op_sel:[0,1,0] op_sel_hi:[1,1,1]
    v_pk_fma_f32 v[62:63], v[142:143], v[42:43], v[62:63] op_sel:[0,1,0] op_sel_hi:[1,1,1]
    v_cvt_pk_bf16_f32 v212, v56, v57
    v_cvt_pk_bf16_f32 v213, v58, v59
    v_cvt_pk_bf16_f32 v214, v60, v61
    v_cvt_pk_bf16_f32 v215, v62, v63
    buffer_store_dwordx4 v[212:215], v3, s[40:43], s4 offen offset:1024
    v_pk_add_f32 v[216:217], v[48:49], v[50:51]
    v_pk_mul_f32 v[218:219], v[48:49], v[48:49]
    v_pk_fma_f32 v[218:219], v[50:51], v[50:51], v[218:219]
    v_pk_add_f32 v[216:217], v[216:217], v[52:53]
    v_pk_fma_f32 v[218:219], v[52:53], v[52:53], v[218:219]
    v_pk_add_f32 v[216:217], v[216:217], v[54:55]
    v_pk_fma_f32 v[218:219], v[54:55], v[54:55], v[218:219]
    v_pk_add_f32 v[216:217], v[216:217], v[56:57]
    v_pk_fma_f32 v[218:219], v[56:57], v[56:57], v[218:219]
    v_pk_add_f32 v[216:217], v[216:217], v[58:59]
    v_pk_fma_f32 v[218:219], v[58:59], v[58:59], v[218:219]
    v_pk_add_f32 v[216:217], v[216:217], v[60:61]
    v_pk_fma_f32 v[218:219], v[60:61], v[60:61], v[218:219]
    v_pk_add_f32 v[216:217], v[216:217], v[62:63]
    v_pk_fma_f32 v[218:219], v[62:63], v[62:63], v[218:219]
    v_add_f32 v216, v216, v217
    v_add_f32 v217, v218, v219
    s_nop 1
    v_permlane32_swap_b32 v216, v217
    v_add_f32 v216, v216, v217
    v_mov_b32 v217, v216
    s_nop 1
    v_permlane16_swap_b32 v216, v217
    v_add_f32 v216, v216, v217
    s_mov_b32 exec_lo, 0xffff
    s_mov_b32 exec_hi, 0xffff
    buffer_store_dword v216, v30, s[36:39], s6 offen
    s_lshr_b32 s7, s50, 3
    s_add_u32 s7, s7, s48
    s_cmp_lg_u32 s7, 4
    s_cbranch_scc1 Lhl_f_20
    s_add_u32 s6, s49, 1
    s_lshl_b32 s6, s6, 15
    s_add_u32 s6, s6, 0xb60000
    s_add_u32 s4, s6, s5
    s_add_u32 s6, s6, 16384
    buffer_store_dword v216, v30, s[36:39], s6 offen sc0 sc1
    s_mov_b64 exec, -1
    buffer_store_dwordx4 v[208:211], v3, s[36:39], s4 offen sc0 sc1
    buffer_store_dwordx4 v[212:215], v3, s[36:39], s4 offen offset:1024 sc0 sc1
    s_waitcnt vmcnt(3)
    s_branch Lhj_f_21
Lhl_f_20:
    s_waitcnt vmcnt(0)
Lhj_f_21:
    s_mov_b64 exec, -1
    v_mov_b32 v4, 4
    s_cmp_lg_u32 s48, 0
    s_mov_b64 exec, 1
    s_barrier
    s_cbranch_scc1 Lq_f_24
    buffer_store_dword v4, off, s[36:39], s55
Lq_f_24:
    s_mov_b64 exec, -1
    s_lshl_b32 s12, s59, 14
    s_add_u32 s12, s12, 0x0
    s_lshl_b32 s8, s51, 12
    s_add_u32 s8, s8, s12
    s_nop 0
    s_add_u32 s9, s8, 16384
    ds_read_b64_tr_b16 v[116:117], v11 offset:0
    ds_read_b64_tr_b16 v[118:119], v11 offset:256
    ds_read_b64_tr_b16 v[120:121], v12 offset:0
    ds_read_b64_tr_b16 v[122:123], v12 offset:256
    ds_read_b64_tr_b16 v[124:125], v11 offset:1024
    ds_read_b64_tr_b16 v[126:127], v11 offset:1280
    ds_read_b64_tr_b16 v[128:129], v12 offset:1024
    ds_read_b64_tr_b16 v[130:131], v12 offset:1280
    ds_read_b64_tr_b16 v[132:133], v11 offset:2048
    ds_read_b64_tr_b16 v[134:135], v11 offset:2304
    ds_read_b64_tr_b16 v[136:137], v12 offset:2048
    ds_read_b64_tr_b16 v[138:139], v12 offset:2304
    s_lshl_b32 s11, s59, 10
    s_add_u32 s11, s11, 0x380000
    s_lshl_b32 s4, s49, 15
    s_add_u32 s4, s4, 0xb60000
    s_add_u32 s10, s4, 16384
    s_add_u32 s5, s48, s51
    s_and_b32 s5, s5, 3
    s_lshl_b32 s5, s5, 12
    s_add_u32 s4, s4, s5
    s_cmp_eq_u32 s49, 0
    s_nop 0
    s_cselect_b32 s13, 0x80000000, s4
    s_cselect_b32 s10, 0x80000000, s10
    s_lshl_b32 s5, s48, 12
    s_add_u32 s63, s5, 0x23000
    v_add_u32 v16, 0x24000, v3
    v_and_b32 v6, 28, v17
    s_cmp_lg_u32 s48, 3
    s_cbranch_scc1 Lhf_f_25
    s_cmp_lt_u32 s50, 8
    s_cbranch_scc1 Lhf_f_25
    v_mov_b32 v4, 1
    s_add_u32 s4, s55, 352
    s_mov_b64 exec, 1
    s_waitcnt vmcnt(0)
    buffer_store_dword v4, off, s[36:39], s4 sc0 sc1
    s_mov_b64 exec, -1
Lhf_f_25:
    s_cmp_lg_u32 s48, 1
    s_cbranch_scc1 Lnw_5_1_f
    s_mov_b64 exec, 0
    s_branch Lpg_7000
Lret_5_1_f:
    s_mov_b64 exec, -1
Lnw_5_1_f:
    s_cmp_lg_u32 s48, 2
    s_cbranch_scc1 Lnw_5_2_f
    s_mov_b64 exec, 0
    s_branch Lret_5_2_f
Lret_5_2_f:
    s_mov_b64 exec, -1
Lnw_5_2_f:
    s_cmp_lg_u32 s48, 0
    s_cbranch_scc1 Ln_f_22
    buffer_load_dword v4, v17, s[36:39], s58 offen sc1
    s_nop 15
Lp_f_23:
    buffer_load_dword v5, v17, s[36:39], s58 offen sc1
    s_waitcnt vmcnt(1)
    v_cmp_gt_u32 vcc, 4, v4
    s_cbranch_vccz Ln_f_22
    buffer_load_dword v4, v17, s[36:39], s58 offen sc1
    s_waitcnt vmcnt(1)
    v_cmp_gt_u32 vcc, 4, v5
    s_cbranch_vccz Ln_f_22
    s_sub_u32 s14, s14, 1
    s_cbranch_scc1 L_end_f
    s_branch Lp_f_23
Ln_f_22:
    s_barrier
    buffer_load_dwordx4 v[164:167], v3, s[40:43], s8 offen sc1
    s_barrier
    buffer_load_dwordx4 v[168:171], v3, s[40:43], s9 offen sc1
    s_barrier
    buffer_load_dwordx4 v[172:175], v3, s[40:43], s8 offen offset:1024 sc1
    buffer_load_dwordx4 v[176:179], v3, s[40:43], s9 offen offset:1024 sc1
    buffer_load_dwordx4 v[180:183], v3, s[40:43], s8 offen offset:2048 sc1
    s_nop 0
    buffer_load_dwordx4 v[184:187], v3, s[40:43], s9 offen offset:2048 sc1
    s_waitcnt vmcnt(4) lgkmcnt(6)
    v_mfma_f32_16x16x32_bf16 v[64:67], v[116:119], v[164:167], 0
    ds_read_b64_tr_b16 v[140:141], v11 offset:6144
    buffer_load_dwordx4 v[188:191], v3, s[40:43], s8 offen offset:3072 sc1
    v_mfma_f32_16x16x32_bf16 v[88:91], v[116:119], v[168:171], 0
    ds_read_b64_tr_b16 v[142:143], v11 offset:6400
    v_mfma_f32_16x16x32_bf16 v[68:71], v[120:123], v[164:167], 0
    ds_read_b64_tr_b16 v[144:145], v12 offset:6144
    v_mfma_f32_16x16x32_bf16 v[92:95], v[120:123], v[168:171], 0
    ds_read_b64_tr_b16 v[146:147], v12 offset:6400
    v_mfma_f32_16x16x32_bf16 v[72:75], v[124:127], v[164:167], 0
    ds_read_b64_tr_b16 v[148:149], v11 offset:7168
    buffer_load_dwordx4 v[192:195], v3, s[40:43], s9 offen offset:3072 sc1
    v_mfma_f32_16x16x32_bf16 v[96:99], v[124:127], v[168:171], 0
    s_waitcnt lgkmcnt(5)
    ds_read_b64_tr_b16 v[150:151], v11 offset:7424
    v_mfma_f32_16x16x32_bf16 v[76:79], v[128:131], v[164:167], 0
    ds_read_b64_tr_b16 v[152:153], v12 offset:7168
    v_mfma_f32_16x16x32_bf16 v[100:103], v[128:131], v[168:171], 0
    ds_read_b64_tr_b16 v[154:155], v12 offset:7424
    v_mfma_f32_16x16x32_bf16 v[80:83], v[132:135], v[164:167], 0
    ds_read_b64_tr_b16 v[156:157], v11 offset:8192
    buffer_load_dwordx4 v[228:231], v3, s[36:39], s11 offen sc1
    v_mfma_f32_16x16x32_bf16 v[104:107], v[132:135], v[168:171], 0
    s_lshl_b32 s8, s52, 12
    ds_read_b64_tr_b16 v[158:159], v11 offset:8448
    v_mfma_f32_16x16x32_bf16 v[84:87], v[136:139], v[164:167], 0
    s_add_u32 s8, s8, s12
    ds_read_b64_tr_b16 v[160:161], v12 offset:8192
    v_mfma_f32_16x16x32_bf16 v[108:111], v[136:139], v[168:171], 0
    s_waitcnt vmcnt(5) lgkmcnt(5)
    ds_read_b64_tr_b16 v[162:163], v12 offset:8448
    v_mfma_f32_16x16x32_bf16 v[64:67], v[140:143], v[172:175], v[64:67]
    s_nop 0
    s_add_u32 s9, s8, 16384
    ds_read_b64_tr_b16 v[116:117], v11 offset:12288
    buffer_load_dwordx4 v[196:199], v3, s[40:43], s8 offen sc1
    v_mfma_f32_16x16x32_bf16 v[88:91], v[140:143], v[176:179], v[88:91]
    ds_read_b64_tr_b16 v[118:119], v11 offset:12544
    v_mfma_f32_16x16x32_bf16 v[68:71], v[144:147], v[172:175], v[68:71]
    ds_read_b64_tr_b16 v[120:121], v12 offset:12288
    v_mfma_f32_16x16x32_bf16 v[92:95], v[144:147], v[176:179], v[92:95]
    ds_read_b64_tr_b16 v[122:123], v12 offset:12544
    v_mfma_f32_16x16x32_bf16 v[72:75], v[148:151], v[172:175], v[72:75]
    ds_read_b64_tr_b16 v[124:125], v11 offset:13312
    buffer_load_dwordx4 v[200:203], v3, s[40:43], s9 offen sc1
    v_mfma_f32_16x16x32_bf16 v[96:99], v[148:151], v[176:179], v[96:99]
    s_waitcnt lgkmcnt(5)
    ds_read_b64_tr_b16 v[126:127], v11 offset:13568
    v_mfma_f32_16x16x32_bf16 v[76:79], v[152:155], v[172:175], v[76:79]
    ds_read_b64_tr_b16 v[128:129], v12 offset:13312
    v_mfma_f32_16x16x32_bf16 v[100:103], v[152:155], v[176:179], v[100:103]
    ds_read_b64_tr_b16 v[130:131], v12 offset:13568
    v_mfma_f32_16x16x32_bf16 v[80:83], v[156:159], v[172:175], v[80:83]
    ds_read_b64_tr_b16 v[132:133], v11 offset:14336
    buffer_load_dwordx4 v[232:235], v3, s[36:39], s11 offen offset:1024 sc1
    v_mfma_f32_16x16x32_bf16 v[104:107], v[156:159], v[176:179], v[104:107]
    ds_read_b64_tr_b16 v[134:135], v11 offset:14592
    v_mfma_f32_16x16x32_bf16 v[84:87], v[160:163], v[172:175], v[84:87]
    ds_read_b64_tr_b16 v[136:137], v12 offset:14336
    v_mfma_f32_16x16x32_bf16 v[108:111], v[160:163], v[176:179], v[108:111]
    s_waitcnt vmcnt(6) lgkmcnt(5)
    ds_read_b64_tr_b16 v[138:139], v12 offset:14592
    v_mfma_f32_16x16x32_bf16 v[64:67], v[116:119], v[180:183], v[64:67]
    ds_read_b64_tr_b16 v[140:141], v11 offset:18432
    buffer_load_dwordx4 v[204:207], v3, s[40:43], s8 offen offset:1024 sc1
    v_mfma_f32_16x16x32_bf16 v[88:91], v[116:119], v[184:187], v[88:91]
    ds_read_b64_tr_b16 v[142:143], v11 offset:18688
    v_mfma_f32_16x16x32_bf16 v[68:71], v[120:123], v[180:183], v[68:71]
    ds_read_b64_tr_b16 v[144:145], v12 offset:18432
    v_mfma_f32_16x16x32_bf16 v[92:95], v[120:123], v[184:187], v[92:95]
    ds_read_b64_tr_b16 v[146:147], v12 offset:18688
    v_mfma_f32_16x16x32_bf16 v[72:75], v[124:127], v[180:183], v[72:75]
    ds_read_b64_tr_b16 v[148:149], v11 offset:19456
    buffer_load_dwordx4 v[208:211], v3, s[40:43], s9 offen offset:1024 sc1
    v_mfma_f32_16x16x32_bf16 v[96:99], v[124:127], v[184:187], v[96:99]
    s_waitcnt lgkmcnt(5)
    ds_read_b64_tr_b16 v[150:151], v11 offset:19712
    v_mfma_f32_16x16x32_bf16 v[76:79], v[128:131], v[180:183], v[76:79]
    ds_read_b64_tr_b16 v[152:153], v12 offset:19456
    v_mfma_f32_16x16x32_bf16 v[100:103], v[128:131], v[184:187], v[100:103]
    ds_read_b64_tr_b16 v[154:155], v12 offset:19712
    v_mfma_f32_16x16x32_bf16 v[80:83], v[132:135], v[180:183], v[80:83]
    ds_read_b64_tr_b16 v[156:157], v11 offset:20480
    buffer_load_dwordx4 v[164:167], v3, s[40:43], s8 offen offset:2048 sc1
    v_mfma_f32_16x16x32_bf16 v[104:107], v[132:135], v[184:187], v[104:107]
    ds_read_b64_tr_b16 v[158:159], v11 offset:20736
    v_mfma_f32_16x16x32_bf16 v[84:87], v[136:139], v[180:183], v[84:87]
    ds_read_b64_tr_b16 v[160:161], v12 offset:20480
    v_mfma_f32_16x16x32_bf16 v[108:111], v[136:139], v[184:187], v[108:111]
    s_waitcnt vmcnt(7) lgkmcnt(5)
    ds_read_b64_tr_b16 v[162:163], v12 offset:20736
    v_mfma_f32_16x16x32_bf16 v[64:67], v[140:143], v[188:191], v[64:67]
    ds_read_b64_tr_b16 v[116:117], v11 offset:24576
    buffer_load_dword v5, v6, s[36:39], s58 offen offset:128 sc1
    v_mfma_f32_16x16x32_bf16 v[88:91], v[140:143], v[192:195], v[88:91]
    ds_read_b64_tr_b16 v[118:119], v11 offset:24832
    v_mfma_f32_16x16x32_bf16 v[68:71], v[144:147], v[188:191], v[68:71]
    ds_read_b64_tr_b16 v[120:121], v12 offset:24576
    v_mfma_f32_16x16x32_bf16 v[92:95], v[144:147], v[192:195], v[92:95]
    ds_read_b64_tr_b16 v[122:123], v12 offset:24832
    buffer_load_dwordx4 v[168:171], v3, s[40:43], s9 offen offset:2048 sc1
    v_mfma_f32_16x16x32_bf16 v[72:75], v[148:151], v[188:191], v[72:75]
    ds_read_b64_tr_b16 v[124:125], v11 offset:25600
    v_mfma_f32_16x16x32_bf16 v[96:99], v[148:151], v[192:195], v[96:99]
    s_waitcnt lgkmcnt(5)
    ds_read_b64_tr_b16 v[126:127], v11 offset:25856
    v_mfma_f32_16x16x32_bf16 v[76:79], v[152:155], v[188:191], v[76:79]
    ds_read_b64_tr_b16 v[128:129], v12 offset:25600
    buffer_load_dwordx4 v[172:175], v3, s[40:43], s8 offen offset:3072 sc1
    v_mfma_f32_16x16x32_bf16 v[100:103], v[152:155], v[192:195], v[100:103]
    ds_read_b64_tr_b16 v[130:131], v12 offset:25856
    v_mfma_f32_16x16x32_bf16 v[80:83], v[156:159], v[188:191], v[80:83]
    s_lshl_b32 s8, s53, 12
    ds_read_b64_tr_b16 v[132:133], v11 offset:26624
    v_mfma_f32_16x16x32_bf16 v[104:107], v[156:159], v[192:195], v[104:107]
    s_add_u32 s8, s8, s12
    ds_read_b64_tr_b16 v[134:135], v11 offset:26880
    buffer_load_dwordx4 v[176:179], v3, s[40:43], s9 offen offset:3072 sc1
    v_mfma_f32_16x16x32_bf16 v[84:87], v[160:163], v[188:191], v[84:87]
    s_add_u32 s9, s8, 16384
    ds_read_b64_tr_b16 v[136:137], v12 offset:26624
    v_mfma_f32_16x16x32_bf16 v[108:111], v[160:163], v[192:195], v[108:111]
    s_waitcnt vmcnt(8) lgkmcnt(5)
    ds_read_b64_tr_b16 v[138:139], v12 offset:26880
    v_mfma_f32_16x16x32_bf16 v[64:67], v[116:119], v[196:199], v[64:67]
    s_waitcnt vmcnt(7)
    ds_read_b64_tr_b16 v[140:141], v11 offset:30720
    buffer_load_dwordx4 v[180:183], v3, s[40:43], s8 offen sc1
    v_mfma_f32_16x16x32_bf16 v[88:91], v[116:119], v[200:203], v[88:91]
    s_nop 0
    ds_read_b64_tr_b16 v[142:143], v11 offset:30976
    v_add_f32 v228, v228, v230
    v_mfma_f32_16x16x32_bf16 v[68:71], v[120:123], v[196:199], v[68:71]
    s_nop 0
    ds_read_b64_tr_b16 v[144:145], v12 offset:30720
    v_add_f32 v232, v232, v234
    v_mfma_f32_16x16x32_bf16 v[92:95], v[120:123], v[200:203], v[92:95]
    s_nop 0
    ds_read_b64_tr_b16 v[146:147], v12 offset:30976
    v_add_f32 v229, v229, v231
    v_mfma_f32_16x16x32_bf16 v[72:75], v[124:127], v[196:199], v[72:75]
    ds_read_b64_tr_b16 v[148:149], v11 offset:31744
    buffer_load_dwordx4 v[184:187], v3, s[40:43], s9 offen sc1
    v_mfma_f32_16x16x32_bf16 v[96:99], v[124:127], v[200:203], v[96:99]
    s_waitcnt lgkmcnt(5)
    ds_read_b64_tr_b16 v[150:151], v11 offset:32000
    v_add_f32 v233, v233, v235
    v_mfma_f32_16x16x32_bf16 v[76:79], v[128:131], v[196:199], v[76:79]
    ds_read_b64_tr_b16 v[152:153], v12 offset:31744
    v_mfma_f32_16x16x32_bf16 v[100:103], v[128:131], v[200:203], v[100:103]
    s_nop 0
    ds_read_b64_tr_b16 v[154:155], v12 offset:32000
    v_permlane32_swap_b32 v228, v229
    v_mfma_f32_16x16x32_bf16 v[80:83], v[132:135], v[196:199], v[80:83]
    ds_read_b64_tr_b16 v[156:157], v11 offset:32768
    buffer_load_dwordx4 v[188:191], v3, s[40:43], s8 offen offset:1024 sc1
    v_mfma_f32_16x16x32_bf16 v[104:107], v[132:135], v[200:203], v[104:107]
    s_nop 0
    ds_read_b64_tr_b16 v[158:159], v11 offset:33024
    v_permlane32_swap_b32 v232, v233
    v_mfma_f32_16x16x32_bf16 v[84:87], v[136:139], v[196:199], v[84:87]
    s_nop 0
    ds_read_b64_tr_b16 v[160:161], v12 offset:32768
    v_add_f32 v228, v228, v229
    v_mfma_f32_16x16x32_bf16 v[108:111], v[136:139], v[200:203], v[108:111]
    s_waitcnt vmcnt(8) lgkmcnt(5)
    ds_read_b64_tr_b16 v[162:163], v12 offset:33024
    v_mfma_f32_16x16x32_bf16 v[64:67], v[140:143], v[204:207], v[64:67]
    ds_read_b64_tr_b16 v[116:117], v11 offset:36864
    buffer_load_dwordx4 v[192:195], v3, s[40:43], s9 offen offset:1024 sc1
    v_mfma_f32_16x16x32_bf16 v[88:91], v[140:143], v[208:211], v[88:91]
    s_nop 0
    ds_read_b64_tr_b16 v[118:119], v11 offset:37120
    v_add_f32 v232, v232, v233
    v_mfma_f32_16x16x32_bf16 v[68:71], v[144:147], v[204:207], v[68:71]
    s_nop 0
    ds_read_b64_tr_b16 v[120:121], v12 offset:36864
    v_mov_b32 v229, v228
    v_mfma_f32_16x16x32_bf16 v[92:95], v[144:147], v[208:211], v[92:95]
    ds_read_b64_tr_b16 v[122:123], v12 offset:37120
    v_mfma_f32_16x16x32_bf16 v[72:75], v[148:151], v[204:207], v[72:75]
    ds_read_b64_tr_b16 v[124:125], v11 offset:37888
    buffer_load_dwordx4 v[196:199], v3, s[40:43], s8 offen offset:2048 sc1
    v_mfma_f32_16x16x32_bf16 v[96:99], v[148:151], v[208:211], v[96:99]
    s_waitcnt lgkmcnt(5)
    ds_read_b64_tr_b16 v[126:127], v11 offset:38144
    v_mov_b32 v233, v232
    v_mfma_f32_16x16x32_bf16 v[76:79], v[152:155], v[204:207], v[76:79]
    s_nop 0
    ds_read_b64_tr_b16 v[128:129], v12 offset:37888
    v_permlane16_swap_b32 v228, v229
    v_mfma_f32_16x16x32_bf16 v[100:103], v[152:155], v[208:211], v[100:103]
    s_nop 0
    ds_read_b64_tr_b16 v[130:131], v12 offset:38144
    v_permlane16_swap_b32 v232, v233
    v_mfma_f32_16x16x32_bf16 v[80:83], v[156:159], v[204:207], v[80:83]
    ds_read_b64_tr_b16 v[132:133], v11 offset:38912
    buffer_load_dwordx4 v[200:203], v3, s[40:43], s9 offen offset:2048 sc1
    v_mfma_f32_16x16x32_bf16 v[104:107], v[156:159], v[208:211], v[104:107]
    s_nop 0
    ds_read_b64_tr_b16 v[134:135], v11 offset:39168
    v_add_f32 v228, v228, v229
    v_mfma_f32_16x16x32_bf16 v[84:87], v[160:163], v[204:207], v[84:87]
    ds_read_b64_tr_b16 v[136:137], v12 offset:38912
    v_mfma_f32_16x16x32_bf16 v[108:111], v[160:163], v[208:211], v[108:111]
    s_waitcnt vmcnt(8) lgkmcnt(5)
    ds_read_b64_tr_b16 v[138:139], v12 offset:39168
    v_add_f32 v232, v232, v233
    v_mfma_f32_16x16x32_bf16 v[64:67], v[116:119], v[164:167], v[64:67]
    s_cmp_eq_u32 s49, 0
    s_cbranch_scc1 Lh_f_27
Lg_f_26:
    v_cmp_ne_u32 vcc, 1, v5
    s_cbranch_vccz Lh_f_27
    buffer_load_dword v5, v6, s[36:39], s58 offen offset:128 sc1
    s_waitcnt vmcnt(0)
    s_sub_u32 s14, s14, 1
    s_cbranch_scc1 L_end_f
    s_branch Lg_f_26
Lh_f_27:
    ds_read_b64_tr_b16 v[140:141], v11 offset:43008
    s_add_u32 m0, s63, 0x1000
    s_nop 0
    buffer_load_dwordx4 v3, s[36:39], s13 offen sc1 lds
    v_mfma_f32_16x16x32_bf16 v[88:91], v[116:119], v[168:171], v[88:91]
    s_nop 0
    ds_read_b64_tr_b16 v[142:143], v11 offset:43264
    v_mov_b32 v229, v228
    v_mfma_f32_16x16x32_bf16 v[68:71], v[120:123], v[164:167], v[68:71]
    ds_read_b64_tr_b16 v[144:145], v12 offset:43008
    v_mfma_f32_16x16x32_bf16 v[92:95], v[120:123], v[168:171], v[92:95]
    s_nop 0
    ds_read_b64_tr_b16 v[146:147], v12 offset:43264
    v_mov_b32 v233, v232
    v_mfma_f32_16x16x32_bf16 v[72:75], v[124:127], v[164:167], v[72:75]
    ds_read_b64_tr_b16 v[148:149], v11 offset:44032
    buffer_load_dwordx4 v3, s[36:39], s13 offen offset:1024 sc1 lds
    v_mfma_f32_16x16x32_bf16 v[96:99], v[124:127], v[168:171], v[96:99]
    s_waitcnt lgkmcnt(5)
    ds_read_b64_tr_b16 v[150:151], v11 offset:44288
    v_permlane32_swap_b32 v228, v229
    v_mfma_f32_16x16x32_bf16 v[76:79], v[128:131], v[164:167], v[76:79]
    s_nop 0
    ds_read_b64_tr_b16 v[152:153], v12 offset:44032
    v_permlane32_swap_b32 v232, v233
    v_mfma_f32_16x16x32_bf16 v[100:103], v[128:131], v[168:171], v[100:103]
    ds_read_b64_tr_b16 v[154:155], v12 offset:44288
    v_mfma_f32_16x16x32_bf16 v[80:83], v[132:135], v[164:167], v[80:83]
    ds_read_b64_tr_b16 v[156:157], v11 offset:45056
    buffer_load_dwordx4 v3, s[36:39], s13 offen offset:2048 sc1 lds
    v_mfma_f32_16x16x32_bf16 v[104:107], v[132:135], v[168:171], v[104:107]
    s_nop 0
    ds_read_b64_tr_b16 v[158:159], v11 offset:45312
    v_mul_f32 v240, 0xbb000000, v228
    v_mfma_f32_16x16x32_bf16 v[84:87], v[136:139], v[164:167], v[84:87]
    s_nop 0
    ds_read_b64_tr_b16 v[160:161], v12 offset:45056
    v_mul_f32 v242, 0xbb000000, v232
    v_mfma_f32_16x16x32_bf16 v[108:111], v[136:139], v[168:171], v[108:111]
    s_waitcnt vmcnt(9) lgkmcnt(5)
    ds_read_b64_tr_b16 v[162:163], v12 offset:45312
    ds_read_b128 v[246:249], v35 offset:0
    v_mfma_f32_16x16x32_bf16 v[64:67], v[140:143], v[172:175], v[64:67]
    ds_read_b64_tr_b16 v[116:117], v13 offset:0
    buffer_load_dwordx4 v3, s[36:39], s13 offen offset:3072 sc1 lds
    v_mfma_f32_16x16x32_bf16 v[88:91], v[140:143], v[176:179], v[88:91]
    ds_read_b64_tr_b16 v[118:119], v13 offset:256
    v_mfma_f32_16x16x32_bf16 v[68:71], v[144:147], v[172:175], v[68:71]
    ds_read_b64_tr_b16 v[120:121], v14 offset:0
    v_mfma_f32_16x16x32_bf16 v[92:95], v[144:147], v[176:179], v[92:95]
    ds_read_b64_tr_b16 v[122:123], v14 offset:256
    v_mfma_f32_16x16x32_bf16 v[72:75], v[148:151], v[172:175], v[72:75]
    s_waitcnt lgkmcnt(4)
    ds_read_b64_tr_b16 v[124:125], v13 offset:1024
    buffer_load_dwordx4 v[236:239], v3, s[36:39], s10 offen sc1
    v_mfma_f32_16x16x32_bf16 v[96:99], v[148:151], v[176:179], v[96:99]
    ds_read_b64_tr_b16 v[126:127], v13 offset:1280
    v_fmac_f32 v64, v246, v240
    v_mfma_f32_16x16x32_bf16 v[76:79], v[152:155], v[172:175], v[76:79]
    s_nop 0
    ds_read_b64_tr_b16 v[128:129], v14 offset:1024
    v_fmac_f32 v65, v247, v240
    v_mfma_f32_16x16x32_bf16 v[100:103], v[152:155], v[176:179], v[100:103]
    s_nop 0
    ds_read_b64_tr_b16 v[130:131], v14 offset:1280
    v_fmac_f32_e64 v66, v248, v240
    v_mfma_f32_16x16x32_bf16 v[80:83], v[156:159], v[172:175], v[80:83]
    ds_read_b64_tr_b16 v[132:133], v13 offset:2048
    buffer_load_dwordx4 v[204:207], v3, s[40:43], s8 offen offset:3072 sc1
    v_mfma_f32_16x16x32_bf16 v[104:107], v[156:159], v[176:179], v[104:107]
    s_nop 0
    ds_read_b64_tr_b16 v[134:135], v13 offset:2304
    v_fmac_f32 v67, v249, v240
    v_mfma_f32_16x16x32_bf16 v[84:87], v[160:163], v[172:175], v[84:87]
    ds_read_b64_tr_b16 v[136:137], v14 offset:2048
    v_fmac_f32 v88, v246, v242
    v_fmac_f32 v89, v247, v242
    v_fmac_f32 v90, v248, v242
    v_fmac_f32 v91, v249, v242
    v_mfma_f32_16x16x32_bf16 v[108:111], v[160:163], v[176:179], v[108:111]
    s_waitcnt vmcnt(10) lgkmcnt(5)
    ds_read_b64_tr_b16 v[138:139], v14 offset:2304
    ds_read_b128 v[250:253], v35 offset:64
    v_mfma_f32_16x16x32_bf16 v[64:67], v[116:119], v[180:183], v[64:67]
    ds_read_b64_tr_b16 v[140:141], v13 offset:6144
    buffer_load_dwordx4 v[208:211], v3, s[40:43], s9 offen offset:3072 sc1
    v_mfma_f32_16x16x32_bf16 v[88:91], v[116:119], v[184:187], v[88:91]
    ds_read_b64_tr_b16 v[142:143], v13 offset:6400
    v_mfma_f32_16x16x32_bf16 v[68:71], v[120:123], v[180:183], v[68:71]
    s_lshl_b32 s8, s54, 12
    ds_read_b64_tr_b16 v[144:145], v14 offset:6144
    v_mfma_f32_16x16x32_bf16 v[92:95], v[120:123], v[184:187], v[92:95]
    s_add_u32 s8, s8, s12
    ds_read_b64_tr_b16 v[146:147], v14 offset:6400
    v_mfma_f32_16x16x32_bf16 v[72:75], v[124:127], v[180:183], v[72:75]
    s_add_u32 s9, s8, 16384
    ds_read_b64_tr_b16 v[148:149], v13 offset:7168
    buffer_load_dwordx4 v[164:167], v3, s[40:43], s8 offen sc1
    v_mfma_f32_16x16x32_bf16 v[96:99], v[124:127], v[184:187], v[96:99]
    s_waitcnt lgkmcnt(6)
    ds_read_b64_tr_b16 v[150:151], v13 offset:7424
    v_mfma_f32_16x16x32_bf16 v[76:79], v[128:131], v[180:183], v[76:79]
    s_waitcnt lgkmcnt(6)
    ds_read_b64_tr_b16 v[152:153], v14 offset:7168
    v_fmac_f32 v68, v250, v240
    v_mfma_f32_16x16x32_bf16 v[100:103], v[128:131], v[184:187], v[100:103]
    s_nop 0
    ds_read_b64_tr_b16 v[154:155], v14 offset:7424
    v_fmac_f32_e64 v69, v251, v240
    v_mfma_f32_16x16x32_bf16 v[80:83], v[132:135], v[180:183], v[80:83]
    ds_read_b64_tr_b16 v[156:157], v13 offset:8192
    buffer_load_dwordx4 v[168:171], v3, s[40:43], s9 offen sc1
    v_mfma_f32_16x16x32_bf16 v[104:107], v[132:135], v[184:187], v[104:107]
    s_nop 0
    ds_read_b64_tr_b16 v[158:159], v13 offset:8448
    v_fmac_f32 v70, v252, v240
    v_mfma_f32_16x16x32_bf16 v[84:87], v[136:139], v[180:183], v[84:87]
    s_nop 0
    ds_read_b64_tr_b16 v[160:161], v14 offset:8192
    v_fmac_f32 v71, v253, v240
    v_mfma_f32_16x16x32_bf16 v[108:111], v[136:139], v[184:187], v[108:111]
    s_waitcnt vmcnt(11) lgkmcnt(5)
    ds_read_b64_tr_b16 v[162:163], v14 offset:8448
    v_fmac_f32 v92, v250, v242
    v_fmac_f32 v93, v251, v242
    v_mfma_f32_16x16x32_bf16 v[64:67], v[140:143], v[188:191], v[64:67]
    ds_read_b64_tr_b16 v[116:117], v13 offset:12288
    buffer_load_dwordx4 v[172:175], v3, s[40:43], s8 offen offset:1024 sc1
    v_fmac_f32 v94, v252, v242
    v_fmac_f32 v95, v253, v242
    v_mfma_f32_16x16x32_bf16 v[88:91], v[140:143], v[192:195], v[88:91]
    s_nop 0
    ds_read_b64_tr_b16 v[118:119], v13 offset:12544
    ds_read_b128 v[246:249], v35 offset:128
    v_mfma_f32_16x16x32_bf16 v[68:71], v[144:147], v[188:191], v[68:71]
    ds_read_b64_tr_b16 v[120:121], v14 offset:12288
    v_mfma_f32_16x16x32_bf16 v[92:95], v[144:147], v[192:195], v[92:95]
    ds_read_b64_tr_b16 v[122:123], v14 offset:12544
    v_mfma_f32_16x16x32_bf16 v[72:75], v[148:151], v[188:191], v[72:75]
    ds_read_b64_tr_b16 v[124:125], v13 offset:13312
    buffer_load_dwordx4 v[176:179], v3, s[40:43], s9 offen offset:1024 sc1
    v_mfma_f32_16x16x32_bf16 v[96:99], v[148:151], v[192:195], v[96:99]
    s_waitcnt lgkmcnt(6)
    ds_read_b64_tr_b16 v[126:127], v13 offset:13568
    v_mfma_f32_16x16x32_bf16 v[76:79], v[152:155], v[188:191], v[76:79]
    s_nop 0
    ds_read_b64_tr_b16 v[128:129], v14 offset:13312
    v_mfma_f32_16x16x32_bf16 v[100:103], v[152:155], v[192:195], v[100:103]
    ds_read_b64_tr_b16 v[130:131], v14 offset:13568
    v_mfma_f32_16x16x32_bf16 v[80:83], v[156:159], v[188:191], v[80:83]
    s_waitcnt lgkmcnt(6)
    ds_read_b64_tr_b16 v[132:133], v13 offset:14336
    buffer_load_dwordx4 v[180:183], v3, s[40:43], s8 offen offset:2048 sc1
    v_mfma_f32_16x16x32_bf16 v[104:107], v[156:159], v[192:195], v[104:107]
    s_nop 0
    ds_read_b64_tr_b16 v[134:135], v13 offset:14592
    v_fmac_f32 v72, v246, v240
    v_mfma_f32_16x16x32_bf16 v[84:87], v[160:163], v[188:191], v[84:87]
    s_nop 0
    ds_read_b64_tr_b16 v[136:137], v14 offset:14336
    v_fmac_f32 v73, v247, v240
    v_mfma_f32_16x16x32_bf16 v[108:111], v[160:163], v[192:195], v[108:111]
    s_waitcnt vmcnt(12) lgkmcnt(5)
    ds_read_b64_tr_b16 v[138:139], v14 offset:14592
    v_fmac_f32 v74, v248, v240
    v_mfma_f32_16x16x32_bf16 v[64:67], v[116:119], v[196:199], v[64:67]
    ds_read_b64_tr_b16 v[140:141], v13 offset:18432
    buffer_load_dwordx4 v[184:187], v3, s[40:43], s9 offen offset:2048 sc1
    v_mfma_f32_16x16x32_bf16 v[88:91], v[116:119], v[200:203], v[88:91]
    ds_read_b64_tr_b16 v[142:143], v13 offset:18688
    v_fmac_f32 v75, v249, v240
    v_fmac_f32 v96, v246, v242
    v_mfma_f32_16x16x32_bf16 v[68:71], v[120:123], v[196:199], v[68:71]
    s_waitcnt vmcnt(9)
    s_barrier
    ds_read_b64_tr_b16 v[144:145], v14 offset:18432
    ds_read_b64_tr_b16 a[240:241], v33 offset:0
    v_fmac_f32 v97, v247, v242
    v_fmac_f32 v98, v248, v242
    v_fmac_f32_e64 v99, v249, v242
    v_mfma_f32_16x16x32_bf16 v[92:95], v[120:123], v[200:203], v[92:95]
    ds_read_b64_tr_b16 v[146:147], v14 offset:18688
    ds_read_b64_tr_b16 a[242:243], v33 offset:256
    ds_read_b128 v[250:253], v35 offset:192
    v_mfma_f32_16x16x32_bf16 v[72:75], v[124:127], v[196:199], v[72:75]
    s_nop 0
    ds_read_b64_tr_b16 v[148:149], v13 offset:19456
    ds_read_b128 a[244:247], v16 offset:0
    v_mfma_f32_16x16x32_bf16 v[96:99], v[124:127], v[200:203], v[96:99]
    s_waitcnt lgkmcnt(9)
    ds_read_b64_tr_b16 v[150:151], v13 offset:19712
    buffer_load_dwordx4 v[188:191], v3, s[40:43], s8 offen offset:3072 sc1
    v_mfma_f32_16x16x32_bf16 v[76:79], v[128:131], v[196:199], v[76:79]
    s_nop 0
    ds_read_b64_tr_b16 v[152:153], v14 offset:19456
    ds_read_b64_tr_b16 a[248:249], v33 offset:6144
    v_mfma_f32_16x16x32_bf16 v[100:103], v[128:131], v[200:203], v[100:103]
    s_nop 0
    ds_read_b64_tr_b16 v[154:155], v14 offset:19712
    ds_read_b64_tr_b16 a[250:251], v33 offset:6400
    v_mfma_f32_16x16x32_bf16 v[80:83], v[132:135], v[196:199], v[80:83]
    s_nop 0
    ds_read_b64_tr_b16 v[156:157], v13 offset:20480
    ds_read_b128 a[252:255], v16 offset:1024
    v_mfma_f32_16x16x32_bf16 v[104:107], v[132:135], v[200:203], v[104:107]
    ds_read_b64_tr_b16 v[158:159], v13 offset:20736
    buffer_load_dwordx4 v[192:195], v3, s[40:43], s9 offen offset:3072 sc1
    v_mfma_f32_16x16x32_bf16 v[84:87], v[136:139], v[196:199], v[84:87]
    s_waitcnt lgkmcnt(10)
    ds_read_b64_tr_b16 v[160:161], v14 offset:20480
    v_fmac_f32 v76, v250, v240
    v_mfma_f32_16x16x32_bf16 v[108:111], v[136:139], v[200:203], v[108:111]
    s_waitcnt lgkmcnt(9)
    ds_read_b64_tr_b16 v[162:163], v14 offset:20736
    ds_read_b64_tr_b16 v[212:213], v33 offset:12288
    v_mfma_f32_16x16x32_bf16 v[112:115], a[240:243], a[244:247], 0
    s_waitcnt vmcnt(8) lgkmcnt(10)
    ds_read_b64_tr_b16 v[214:215], v33 offset:12544
    v_fmac_f32 v77, v251, v240
    v_mfma_f32_16x16x32_bf16 v[64:67], v[140:143], v[204:207], v[64:67]
    s_nop 0
    ds_read_b64_tr_b16 v[116:117], v13 offset:24576
    ds_read_b128 v[216:219], v16 offset:2048
Lpg_7000:
    s_cbranch_execz Lret_5_1_f
    s_nop 0
    v_mfma_f32_16x16x32_bf16 v[88:91], v[140:143], v[208:211], v[88:91]
    s_nop 0
    ds_read_b64_tr_b16 v[118:119], v13 offset:24832
    v_fmac_f32 v78, v252, v240
    v_mfma_f32_16x16x32_bf16 v[68:71], v[144:147], v[204:207], v[68:71]
    s_waitcnt lgkmcnt(8)
    ds_read_b64_tr_b16 v[120:121], v14 offset:24576
    v_fmac_f32 v79, v253, v240
    v_mfma_f32_16x16x32_bf16 v[112:115], a[248:251], a[252:255], v[112:115]
    s_nop 0
    ds_read_b64_tr_b16 v[122:123], v14 offset:24832
    ds_read_b64_tr_b16 v[220:221], v33 offset:18432
    v_mfma_f32_16x16x32_bf16 v[92:95], v[144:147], v[208:211], v[92:95]
    ds_read_b64_tr_b16 v[222:223], v33 offset:18688
    v_fmac_f32 v100, v250, v242
    v_fmac_f32 v101, v251, v242
    v_mfma_f32_16x16x32_bf16 v[72:75], v[148:151], v[204:207], v[72:75]
    ds_read_b64_tr_b16 v[124:125], v13 offset:25600
    ds_read_b128 v[224:227], v16 offset:3072
    v_fmac_f32 v102, v252, v242
    v_fmac_f32 v103, v253, v242
    v_mfma_f32_16x16x32_bf16 v[96:99], v[148:151], v[208:211], v[96:99]
    s_waitcnt lgkmcnt(11)
    ds_read_b64_tr_b16 v[126:127], v13 offset:25856
    s_getpc_b64 s[6:7]
    global_load_dword v7, v47, s[6:7]
    v_mfma_f32_16x16x32_bf16 v[76:79], v[152:155], v[204:207], v[76:79]
    s_waitcnt lgkmcnt(8)
    ds_read_b64_tr_b16 v[128:129], v14 offset:25600
    ds_read_b128 v[246:249], v35 offset:256
    v_mfma_f32_16x16x32_bf16 v[112:115], v[212:215], v[216:219], v[112:115]
    s_nop 0
    ds_read_b64_tr_b16 v[130:131], v14 offset:25856
    ds_read_b64_tr_b16 a[240:241], v33 offset:24576
    v_mfma_f32_16x16x32_bf16 v[100:103], v[152:155], v[208:211], v[100:103]
    ds_read_b64_tr_b16 a[242:243], v33 offset:24832
    v_mfma_f32_16x16x32_bf16 v[80:83], v[156:159], v[204:207], v[80:83]
    s_nop 0
    ds_read_b64_tr_b16 v[132:133], v13 offset:26624
    ds_read_b128 a[244:247], v16 offset:4096
    v_mfma_f32_16x16x32_bf16 v[104:107], v[156:159], v[208:211], v[104:107]
    ds_read_b64_tr_b16 v[134:135], v13 offset:26880
    v_mfma_f32_16x16x32_bf16 v[84:87], v[160:163], v[204:207], v[84:87]
    s_waitcnt lgkmcnt(9)
    ds_read_b64_tr_b16 v[136:137], v14 offset:26624
    v_mfma_f32_16x16x32_bf16 v[112:115], v[220:223], v[224:227], v[112:115]
    s_nop 0
    ds_read_b64_tr_b16 v[138:139], v14 offset:26880
    ds_read_b64_tr_b16 a[248:249], v33 offset:30720
    v_mfma_f32_16x16x32_bf16 v[108:111], v[160:163], v[208:211], v[108:111]
    s_waitcnt lgkmcnt(9)
    s_waitcnt vmcnt(7)
    ds_read_b64_tr_b16 a[250:251], v33 offset:30976
    v_fmac_f32 v80, v246, v240
    v_mfma_f32_16x16x32_bf16 v[64:67], v[116:119], v[164:167], v[64:67]
    s_nop 0
    ds_read_b64_tr_b16 v[140:141], v13 offset:30720
    ds_read_b128 a[252:255], v16 offset:5120
    v_mfma_f32_16x16x32_bf16 v[88:91], v[116:119], v[168:171], v[88:91]
    s_nop 0
    ds_read_b64_tr_b16 v[142:143], v13 offset:30976
    v_fmac_f32 v81, v247, v240
    v_mfma_f32_16x16x32_bf16 v[68:71], v[120:123], v[164:167], v[68:71]
    s_waitcnt lgkmcnt(8)
    ds_read_b64_tr_b16 v[144:145], v14 offset:30720
    v_fmac_f32 v82, v248, v240
    v_mfma_f32_16x16x32_bf16 v[112:115], a[240:243], a[244:247], v[112:115]
    s_nop 0
    ds_read_b64_tr_b16 v[146:147], v14 offset:30976
    ds_read_b64_tr_b16 v[212:213], v33 offset:36864
    v_mfma_f32_16x16x32_bf16 v[92:95], v[120:123], v[168:171], v[92:95]
    s_nop 0
    ds_read_b64_tr_b16 v[214:215], v33 offset:37120
    v_fmac_f32 v83, v249, v240
    v_mfma_f32_16x16x32_bf16 v[72:75], v[124:127], v[164:167], v[72:75]
    s_nop 0
    ds_read_b64_tr_b16 v[148:149], v13 offset:31744
    ds_read_b128 v[216:219], v16 offset:6144
    v_mfma_f32_16x16x32_bf16 v[96:99], v[124:127], v[168:171], v[96:99]
    s_waitcnt lgkmcnt(11)
    ds_read_b64_tr_b16 v[150:151], v13 offset:32000
    v_fmac_f32 v104, v246, v242
    v_mfma_f32_16x16x32_bf16 v[76:79], v[128:131], v[164:167], v[76:79]
    s_waitcnt lgkmcnt(8)
    ds_read_b64_tr_b16 v[152:153], v14 offset:31744
    v_fmac_f32 v105, v247, v242
    v_fmac_f32 v106, v248, v242
    v_mfma_f32_16x16x32_bf16 v[112:115], a[248:251], a[252:255], v[112:115]
    ds_read_b64_tr_b16 v[154:155], v14 offset:32000
    ds_read_b64_tr_b16 v[220:221], v33 offset:43008
    v_fmac_f32 v107, v249, v242
    v_mfma_f32_16x16x32_bf16 v[100:103], v[128:131], v[168:171], v[100:103]
    s_nop 0
    ds_read_b64_tr_b16 v[222:223], v33 offset:43264
    ds_read_b128 v[250:253], v35 offset:320
    v_mfma_f32_16x16x32_bf16 v[80:83], v[132:135], v[164:167], v[80:83]
    s_nop 0
    ds_read_b64_tr_b16 v[156:157], v13 offset:32768
    ds_read_b128 v[224:227], v16 offset:7168
    v_mfma_f32_16x16x32_bf16 v[104:107], v[132:135], v[168:171], v[104:107]
    ds_read_b64_tr_b16 v[158:159], v13 offset:33024
    v_mfma_f32_16x16x32_bf16 v[84:87], v[136:139], v[164:167], v[84:87]
    s_waitcnt lgkmcnt(9)
    ds_read_b64_tr_b16 v[160:161], v14 offset:32768
    v_mfma_f32_16x16x32_bf16 v[112:115], v[212:215], v[216:219], v[112:115]
    s_nop 0
    ds_read_b64_tr_b16 v[162:163], v14 offset:33024
    ds_read_b64_tr_b16 a[240:241], v34 offset:0
    v_mfma_f32_16x16x32_bf16 v[108:111], v[136:139], v[168:171], v[108:111]
    s_waitcnt vmcnt(5) lgkmcnt(11)
    ds_read_b64_tr_b16 a[242:243], v34 offset:256
    v_mfma_f32_16x16x32_bf16 v[64:67], v[140:143], v[172:175], v[64:67]
    s_nop 0
    ds_read_b64_tr_b16 v[116:117], v13 offset:36864
    ds_read_b128 a[244:247], v16 offset:8192
    v_mfma_f32_16x16x32_bf16 v[88:91], v[140:143], v[176:179], v[88:91]
    s_waitcnt lgkmcnt(9)
    ds_read_b64_tr_b16 v[118:119], v13 offset:37120
    v_fmac_f32 v84, v250, v240
    v_mfma_f32_16x16x32_bf16 v[68:71], v[144:147], v[172:175], v[68:71]
    s_waitcnt lgkmcnt(8)
    ds_read_b64_tr_b16 v[120:121], v14 offset:36864
    v_fmac_f32 v85, v251, v240
    v_mfma_f32_16x16x32_bf16 v[112:115], v[220:223], v[224:227], v[112:115]
    s_nop 0
    ds_read_b64_tr_b16 v[122:123], v14 offset:37120
    ds_read_b64_tr_b16 a[248:249], v34 offset:6144
    v_mfma_f32_16x16x32_bf16 v[92:95], v[144:147], v[176:179], v[92:95]
    s_nop 0
    ds_read_b64_tr_b16 a[250:251], v34 offset:6400
    v_fmac_f32 v86, v252, v240
    v_mfma_f32_16x16x32_bf16 v[72:75], v[148:151], v[172:175], v[72:75]
    s_nop 0
    ds_read_b64_tr_b16 v[124:125], v13 offset:37888
    ds_read_b128 a[252:255], v16 offset:9216
    v_mfma_f32_16x16x32_bf16 v[96:99], v[148:151], v[176:179], v[96:99]
    s_waitcnt lgkmcnt(11)
    ds_read_b64_tr_b16 v[126:127], v13 offset:38144
    v_fmac_f32 v87, v253, v240
    v_mfma_f32_16x16x32_bf16 v[76:79], v[152:155], v[172:175], v[76:79]
    s_waitcnt lgkmcnt(8)
    ds_read_b64_tr_b16 v[128:129], v14 offset:37888
    v_fmac_f32 v108, v250, v242
    v_mfma_f32_16x16x32_bf16 v[112:115], a[240:243], a[244:247], v[112:115]
    s_nop 0
    ds_read_b64_tr_b16 v[130:131], v14 offset:38144
    ds_read_b64_tr_b16 v[212:213], v34 offset:12288
    v_mfma_f32_16x16x32_bf16 v[100:103], v[152:155], v[176:179], v[100:103]
    ds_read_b64_tr_b16 v[214:215], v34 offset:12544
    v_fmac_f32 v109, v251, v242
    v_fmac_f32 v110, v252, v242
    v_mfma_f32_16x16x32_bf16 v[80:83], v[156:159], v[172:175], v[80:83]
    ds_read_b64_tr_b16 v[132:133], v13 offset:38912
    ds_read_b128 v[216:219], v16 offset:10240
    v_fmac_f32 v111, v253, v242
    v_mfma_f32_16x16x32_bf16 v[104:107], v[156:159], v[176:179], v[104:107]
    s_nop 0
    ds_read_b64_tr_b16 v[134:135], v13 offset:39168
    v_mul_f32 v229, 0x3b000000, v229
    v_mfma_f32_16x16x32_bf16 v[84:87], v[160:163], v[172:175], v[84:87]
    s_waitcnt lgkmcnt(8)
    ds_read_b64_tr_b16 v[136:137], v14 offset:38912
    v_mul_f32 v233, 0x3b000000, v233
    v_mfma_f32_16x16x32_bf16 v[112:115], a[248:251], a[252:255], v[112:115]
    s_nop 0
    ds_read_b64_tr_b16 v[138:139], v14 offset:39168
    ds_read_b64_tr_b16 v[220:221], v34 offset:18432
    v_mfma_f32_16x16x32_bf16 v[108:111], v[160:163], v[176:179], v[108:111]
    s_waitcnt vmcnt(3) lgkmcnt(10)
    ds_read_b64_tr_b16 v[222:223], v34 offset:18688
    v_fma_f32 v229, -v240, v240, v229
    v_mfma_f32_16x16x32_bf16 v[64:67], v[116:119], v[180:183], v[64:67]
    s_nop 0
    ds_read_b64_tr_b16 v[140:141], v13 offset:43008
    ds_read_b128 v[224:227], v16 offset:11264
    v_mfma_f32_16x16x32_bf16 v[88:91], v[116:119], v[184:187], v[88:91]
    s_nop 0
    ds_read_b64_tr_b16 v[142:143], v13 offset:43264
    v_fma_f32 v233, -v242, v242, v233
    v_mfma_f32_16x16x32_bf16 v[68:71], v[120:123], v[180:183], v[68:71]
    s_waitcnt lgkmcnt(8)
    ds_read_b64_tr_b16 v[144:145], v14 offset:43008
    v_max_f32 v229, 0, v229
    v_mfma_f32_16x16x32_bf16 v[112:115], v[212:215], v[216:219], v[112:115]
    s_nop 0
    ds_read_b64_tr_b16 v[146:147], v14 offset:43264
    ds_read_b64_tr_b16 a[240:241], v34 offset:24576
    v_mfma_f32_16x16x32_bf16 v[92:95], v[120:123], v[184:187], v[92:95]
    s_nop 0
    ds_read_b64_tr_b16 a[242:243], v34 offset:24832
    v_max_f32 v233, 0, v233
    v_mfma_f32_16x16x32_bf16 v[72:75], v[124:127], v[180:183], v[72:75]
    s_nop 0
    ds_read_b64_tr_b16 v[148:149], v13 offset:44032
    ds_read_b128 a[244:247], v16 offset:12288
    v_mfma_f32_16x16x32_bf16 v[96:99], v[124:127], v[184:187], v[96:99]
    s_waitcnt lgkmcnt(11)
    ds_read_b64_tr_b16 v[150:151], v13 offset:44288
    ds_read_b64_tr_b16 a[248:249], v34 offset:30720
    v_mfma_f32_16x16x32_bf16 v[76:79], v[128:131], v[180:183], v[76:79]
    s_waitcnt lgkmcnt(9)
    ds_read_b64_tr_b16 v[152:153], v14 offset:44032
    ds_read_b64_tr_b16 a[250:251], v34 offset:30976
    v_mfma_f32_16x16x32_bf16 v[112:115], v[220:223], v[224:227], v[112:115]
    s_nop 0
    ds_read_b64_tr_b16 v[154:155], v14 offset:44288
    ds_read_b128 a[252:255], v16 offset:13312
    v_mfma_f32_16x16x32_bf16 v[100:103], v[128:131], v[184:187], v[100:103]
    s_nop 0
    ds_read_b64_tr_b16 v[212:213], v34 offset:36864
    v_add_f32 v229, 0x3727c5ac, v229
    v_mfma_f32_16x16x32_bf16 v[80:83], v[132:135], v[180:183], v[80:83]
    s_nop 0
    ds_read_b64_tr_b16 v[156:157], v13 offset:45056
    ds_read_b64_tr_b16 v[214:215], v34 offset:37120
    v_mfma_f32_16x16x32_bf16 v[104:107], v[132:135], v[184:187], v[104:107]
    s_nop 0
    ds_read_b64_tr_b16 v[158:159], v13 offset:45312
    ds_read_b128 v[216:219], v16 offset:14336
    v_mfma_f32_16x16x32_bf16 v[84:87], v[136:139], v[180:183], v[84:87]
    s_waitcnt lgkmcnt(11)
    ds_read_b64_tr_b16 v[160:161], v14 offset:45056
    ds_read_b64_tr_b16 v[220:221], v34 offset:43008
    v_mfma_f32_16x16x32_bf16 v[112:115], a[240:243], a[244:247], v[112:115]
    s_nop 0
    ds_read_b64_tr_b16 v[162:163], v14 offset:45312
    ds_read_b64_tr_b16 v[222:223], v34 offset:43264
    v_mfma_f32_16x16x32_bf16 v[108:111], v[136:139], v[184:187], v[108:111]
    s_waitcnt vmcnt(1) lgkmcnt(14)
    s_nop 0
    ds_read_b128 v[224:227], v16 offset:15360
    v_add_f32 v233, 0x3727c5ac, v233
    v_mfma_f32_16x16x32_bf16 v[64:67], v[140:143], v[188:191], v[64:67]
    s_waitcnt lgkmcnt(10)
    ds_read_b128 v[246:249], v45
    v_rsq_f32 v241, v229
    v_rsq_f32 v243, v233
    v_mfma_f32_16x16x32_bf16 v[112:115], a[248:251], a[252:255], v[112:115]
    v_add_f32 v236, v236, v238
    v_add_f32 v237, v237, v239
    v_mfma_f32_16x16x32_bf16 v[88:91], v[140:143], v[192:195], v[88:91]
    s_nop 0
    v_permlane32_swap_b32 v236, v237
    v_add_f32 v236, v236, v237
    v_mfma_f32_16x16x32_bf16 v[68:71], v[144:147], v[188:191], v[68:71]
    s_waitcnt lgkmcnt(6)
    v_mov_b32 v237, v236
    s_nop 1
    v_permlane16_swap_b32 v236, v237
    v_mfma_f32_16x16x32_bf16 v[112:115], v[212:215], v[216:219], v[112:115]
    v_add_f32 v236, v236, v237
    v_mov_b32 v237, v236
    v_mfma_f32_16x16x32_bf16 v[92:95], v[144:147], v[192:195], v[92:95]
    s_nop 0
    v_permlane32_swap_b32 v236, v237
    v_mul_f32 v244, 0xbb000000, v236
    v_mul_f32 v237, 0x3b000000, v237
    v_fma_f32 v237, -v244, v244, v237
    v_max_f32 v237, 0, v237
    v_add_f32 v237, 0x3727c5ac, v237
    v_rsq_f32 v245, v237
    v_mfma_f32_16x16x32_bf16 v[72:75], v[148:151], v[188:191], v[72:75]
    s_waitcnt lgkmcnt(1)
    s_barrier
    v_mfma_f32_16x16x32_bf16 v[112:115], v[220:223], v[224:227], v[112:115]
    v_mfma_f32_16x16x32_bf16 v[96:99], v[148:151], v[192:195], v[96:99]
    v_mfma_f32_16x16x32_bf16 v[76:79], v[152:155], v[188:191], v[76:79]
    v_mfma_f32_16x16x32_bf16 v[100:103], v[152:155], v[192:195], v[100:103]
    v_mfma_f32_16x16x32_bf16 v[80:83], v[156:159], v[188:191], v[80:83]
    v_mfma_f32_16x16x32_bf16 v[104:107], v[156:159], v[192:195], v[104:107]
    v_mfma_f32_16x16x32_bf16 v[84:87], v[160:163], v[188:191], v[84:87]
    v_mfma_f32_16x16x32_bf16 v[108:111], v[160:163], v[192:195], v[108:111]
    s_waitcnt lgkmcnt(0)
    s_add_u32 m0, s71, 0x0
    s_add_u32 s75, s70, 0x0
    s_nop 0
    buffer_load_dwordx4 v3, s[36:39], s75 offen sc1 lds
    v_pk_mul_f32 v[96:97], v[96:97], v[242:243] op_sel:[0,1] op_sel_hi:[1,1]
    v_pk_mul_f32 v[98:99], v[98:99], v[242:243] op_sel:[0,1] op_sel_hi:[1,1]
    v_cvt_pk_bf16_f32 v168, v96, v97
    v_cvt_pk_bf16_f32 v169, v98, v99
    v_pk_mul_f32 v[100:101], v[100:101], v[242:243] op_sel:[0,1] op_sel_hi:[1,1]
    v_pk_mul_f32 v[102:103], v[102:103], v[242:243] op_sel:[0,1] op_sel_hi:[1,1]
    ds_write_b64 v41, v[168:169] offset:1024
    v_cvt_pk_bf16_f32 v170, v100, v101
    v_cvt_pk_bf16_f32 v171, v102, v103
    v_pk_fma_f32 v[112:113], v[246:247], v[244:245], v[112:113] op_sel:[0,0,0] op_sel_hi:[1,0,1]
    s_add_u32 m0, s71, 0x800
    s_add_u32 s75, s70, 0x8000
    buffer_load_dwordx4 v3, s[36:39], s75 offen sc1 lds
    v_pk_fma_f32 v[114:115], v[248:249], v[244:245], v[114:115] op_sel:[0,0,0] op_sel_hi:[1,0,1]
    ds_write_b64 v41, v[170:171] offset:1536
    v_pk_mul_f32 v[112:113], v[112:113], v[244:245] op_sel:[0,1] op_sel_hi:[1,1]
    v_pk_mul_f32 v[114:115], v[114:115], v[244:245] op_sel:[0,1] op_sel_hi:[1,1]
    v_cvt_pk_bf16_f32 v188, v112, v113
    v_cvt_pk_bf16_f32 v189, v114, v115
    v_pk_mul_f32 v[80:81], v[80:81], v[240:241] op_sel:[0,1] op_sel_hi:[1,1]
    v_pk_mul_f32 v[82:83], v[82:83], v[240:241] op_sel:[0,1] op_sel_hi:[1,1]
    ds_write_b64 v32, v[188:189]
    v_cvt_pk_bf16_f32 v180, v80, v81
    s_add_u32 m0, s71, 0x1000
    s_add_u32 s75, s19, 0x10000
    buffer_load_dwordx4 v3, s[36:39], s75 offen sc1 lds
    v_cvt_pk_bf16_f32 v181, v82, v83
    v_pk_mul_f32 v[84:85], v[84:85], v[240:241] op_sel:[0,1] op_sel_hi:[1,1]
    v_pk_mul_f32 v[86:87], v[86:87], v[240:241] op_sel:[0,1] op_sel_hi:[1,1]
    ds_write_b64 v31, v[180:181] offset:0
    v_cvt_pk_bf16_f32 v182, v84, v85
    v_cvt_pk_bf16_f32 v183, v86, v87
    v_pk_mul_f32 v[104:105], v[104:105], v[242:243] op_sel:[0,1] op_sel_hi:[1,1]
    v_pk_mul_f32 v[106:107], v[106:107], v[242:243] op_sel:[0,1] op_sel_hi:[1,1]
    ds_write_b64 v31, v[182:183] offset:512
    v_cvt_pk_bf16_f32 v184, v104, v105
    s_add_u32 m0, s71, 0x3000
    s_add_u32 s75, s70, 0x1000
    buffer_load_dwordx4 v3, s[36:39], s75 offen sc1 lds
    v_cvt_pk_bf16_f32 v185, v106, v107
    v_pk_mul_f32 v[108:109], v[108:109], v[242:243] op_sel:[0,1] op_sel_hi:[1,1]
    v_pk_mul_f32 v[110:111], v[110:111], v[242:243] op_sel:[0,1] op_sel_hi:[1,1]
    ds_write_b64 v31, v[184:185] offset:1024
    v_cvt_pk_bf16_f32 v186, v108, v109
    v_cvt_pk_bf16_f32 v187, v110, v111
    v_pk_mul_f32 v[72:73], v[72:73], v[240:241] op_sel:[0,1] op_sel_hi:[1,1]
    v_pk_mul_f32 v[74:75], v[74:75], v[240:241] op_sel:[0,1] op_sel_hi:[1,1]
    ds_write_b64 v31, v[186:187] offset:1536
    v_cvt_pk_bf16_f32 v164, v72, v73
    s_add_u32 m0, s71, 0x3800
    s_add_u32 s75, s70, 0x9000
    buffer_load_dwordx4 v3, s[36:39], s75 offen sc1 lds
    v_cvt_pk_bf16_f32 v165, v74, v75
    v_pk_mul_f32 v[76:77], v[76:77], v[240:241] op_sel:[0,1] op_sel_hi:[1,1]
    v_pk_mul_f32 v[78:79], v[78:79], v[240:241] op_sel:[0,1] op_sel_hi:[1,1]
    v_cvt_pk_bf16_f32 v166, v76, v77
    v_cvt_pk_bf16_f32 v167, v78, v79
    v_cvt_pk_bf16_f32 v176, v88, v89
    v_cvt_pk_bf16_f32 v177, v90, v91
    v_cvt_pk_bf16_f32 v178, v92, v93
    v_cvt_pk_bf16_f32 v179, v94, v95
    v_cvt_pk_bf16_f32 v172, v64, v65
    s_add_u32 m0, s71, 0x4000
    s_add_u32 s75, s19, 0x11000
    buffer_load_dwordx4 v3, s[36:39], s75 offen sc1 lds
    v_cvt_pk_bf16_f32 v173, v66, v67
    v_cvt_pk_bf16_f32 v174, v68, v69
    v_cvt_pk_bf16_f32 v175, v70, v71
    s_waitcnt lgkmcnt(0)
    s_barrier
    ds_read_b64 v[224:225], v41 offset:0
    ds_read_b64 v[226:227], v41 offset:512
    v_mfma_f32_16x16x16_bf16 v[64:67], v[164:165], v[176:177], 0
    s_mul_i32 s4, s59, 43
    ds_read_b64_tr_b16 v[212:213], v40 offset:0
    s_add_u32 m0, s71, 0x6000
    s_add_u32 s75, s70, 0x2000
    buffer_load_dwordx4 v3, s[36:39], s75 offen sc1 lds
    v_mfma_f32_16x16x16_bf16 v[68:71], v[168:169], v[176:177], 0
    s_add_u32 s4, s4, s50
    ds_read_b64_tr_b16 v[214:215], v40 offset:1024
    v_mfma_f32_16x16x16_bf16 v[72:75], v[166:167], v[178:179], 0
    s_lshl_b32 s4, s4, 10
    ds_read_b64_tr_b16 v[216:217], v40 offset:2048
    v_mfma_f32_16x16x16_bf16 v[76:79], v[170:171], v[178:179], 0
    s_nop 0
    s_add_u32 s4, s4, 0x600000
    s_add_u32 m0, s71, 0x6800
    s_add_u32 s75, s70, 0xa000
    buffer_load_dwordx4 v3, s[36:39], s75 offen sc1 lds
    ds_read_b64_tr_b16 v[218:219], v40 offset:512
    v_mfma_f32_16x16x16_bf16 v[84:87], v[164:165], v[172:173], 0
    s_add_u32 s5, s4, 44032
    ds_read_b64_tr_b16 v[220:221], v40 offset:1536
    v_mfma_f32_16x16x16_bf16 v[92:95], v[166:167], v[174:175], 0
    ds_read_b64_tr_b16 v[222:223], v40 offset:2560
    s_waitcnt lgkmcnt(6)
    s_add_u32 m0, s71, 0x7000
    s_add_u32 s75, s19, 0x12000
    buffer_load_dwordx4 v3, s[36:39], s75 offen sc1 lds
    v_mfma_f32_16x16x16_bf16 v[80:83], v[224:225], v[172:173], v[26:29]
    v_mul_f32 v241, 0x3eb8aa3b, v241
    v_mfma_f32_16x16x16_bf16 v[88:91], v[226:227], v[174:175], v[26:29]
    s_nop 0
    v_mul_f32 v243, 0x3eb8aa3b, v243
    v_cndmask_b32 v142, v68, v69, s[64:65]
    v_cndmask_b32 v146, v76, v77, s[64:65]
    v_cndmask_b32 v150, v84, v85, s[64:65]
    s_add_u32 m0, s71, 0x9000
    s_add_u32 s75, s70, 0x3000
    buffer_load_dwordx4 v3, s[36:39], s75 offen sc1 lds
    v_cndmask_b32 v154, v92, v93, s[64:65]
    v_cndmask_b32 v143, v70, v71, s[64:65]
    v_cndmask_b32 v147, v78, v79, s[64:65]
    v_cndmask_b32 v151, v86, v87, s[64:65]
    v_cndmask_b32 v155, v94, v95, s[64:65]
    v_cndmask_b32 v140, v64, v65, s[64:65]
    v_cndmask_b32 v144, v72, v73, s[64:65]
    v_cndmask_b32 v148, v80, v81, s[64:65]
    v_cndmask_b32 v152, v88, v89, s[64:65]
    v_cndmask_b32 v141, v66, v67, s[64:65]
    s_add_u32 m0, s71, 0x9800
    s_add_u32 s75, s70, 0xb000
    buffer_load_dwordx4 v3, s[36:39], s75 offen sc1 lds
    v_cndmask_b32 v145, v74, v75, s[64:65]
    v_cndmask_b32 v149, v82, v83, s[64:65]
    v_cndmask_b32 v153, v90, v91, s[64:65]
    v_cndmask_b32 v140, v140, v142, s[66:67]
    v_cndmask_b32 v144, v144, v146, s[66:67]
    v_cndmask_b32 v148, v148, v150, s[66:67]
    v_cndmask_b32 v152, v152, v154, s[66:67]
    v_cndmask_b32 v141, v141, v143, s[68:69]
    v_cndmask_b32 v145, v145, v147, s[68:69]
    v_cndmask_b32 v149, v149, v151, s[68:69]
    s_add_u32 m0, s71, 0xa000
    s_add_u32 s75, s19, 0x13000
    buffer_load_dwordx4 v3, s[36:39], s75 offen sc1 lds
    v_cndmask_b32 v153, v153, v155, s[68:69]
    v_pk_mul_f32 v[140:141], v[140:141], v[242:243] op_sel:[0,1] op_sel_hi:[1,1]
    v_pk_mul_f32 v[144:145], v[144:145], v[242:243] op_sel:[0,1] op_sel_hi:[1,1]
    v_pk_mul_f32 v[148:149], v[148:149], v[240:241] op_sel:[0,1] op_sel_hi:[1,1]
    v_pk_mul_f32 v[152:153], v[152:153], v[240:241] op_sel:[0,1] op_sel_hi:[1,1]
    v_max_f32 v158, v140, v141
    v_max_f32 v159, v144, v145
    v_max_f32 v156, v148, v149
    v_max_f32 v157, v152, v153
    v_permlane32_swap_b32 v158, v159
    s_add_u32 m0, s71, 0xc000
    s_add_u32 s75, s70, 0x4000
    buffer_load_dwordx4 v3, s[36:39], s75 offen sc1 lds
    v_permlane32_swap_b32 v156, v157
    v_max_f32 v158, v158, v159
    v_max_f32 v156, v156, v157
    v_mov_b32 v159, v158
    v_mov_b32 v157, v156
    s_nop 0
    v_permlane16_swap_b32 v158, v159
    v_permlane16_swap_b32 v156, v157
    v_max_f32 v158, v158, v159
    v_max_f32 v156, v156, v157
    v_mov_b32 v159, v158
    s_add_u32 m0, s71, 0xc800
    s_add_u32 s75, s70, 0xc000
    buffer_load_dwordx4 v3, s[36:39], s75 offen sc1 lds
    v_mov_b32 v157, v156
    v_permlane32_swap_b32 v158, v159
    s_nop 0
    v_permlane32_swap_b32 v156, v157
    v_pk_add_f32 v[140:141], v[140:141], v[158:159] op_sel:[0,0] op_sel_hi:[1,0] neg_lo:[0,1] neg_hi:[0,1]
    v_pk_add_f32 v[144:145], v[144:145], v[158:159] op_sel:[0,1] op_sel_hi:[1,1] neg_lo:[0,1] neg_hi:[0,1]
    v_pk_add_f32 v[148:149], v[148:149], v[156:157] op_sel:[0,0] op_sel_hi:[1,0] neg_lo:[0,1] neg_hi:[0,1]
    v_pk_add_f32 v[152:153], v[152:153], v[156:157] op_sel:[0,1] op_sel_hi:[1,1] neg_lo:[0,1] neg_hi:[0,1]
    v_exp_f32 v140, v140
    v_exp_f32 v144, v144
    s_add_u32 m0, s71, 0xd000
    s_add_u32 s75, s19, 0x14000
    buffer_load_dwordx4 v3, s[36:39], s75 offen sc1 lds
    v_exp_f32 v148, v148
    v_exp_f32 v152, v152
    v_exp_f32 v141, v141
    v_exp_f32 v145, v145
    v_exp_f32 v149, v149
    v_exp_f32_e64 v153, v153
    v_cvt_pk_bf16_f32 v140, v140, v141
    v_cvt_pk_bf16_f32 v144, v144, v145
    v_cvt_pk_bf16_f32 v148, v148, v149
    v_cvt_pk_bf16_f32 v152, v152, v153
    s_waitcnt lgkmcnt(0)
    v_perm_b32 v96, v140, v140, v18
    v_perm_b32 v97, v140, v140, v19
    v_perm_b32 v98, v140, v140, v20
    v_perm_b32 v99, v140, v140, v21
    v_perm_b32 v100, v144, v144, v18
    v_perm_b32 v101, v144, v144, v19
    v_mfma_f32_16x16x32_bf16 v[68:71], v[22:25], v[96:99], 0
    v_perm_b32 v102, v144, v144, v20
    v_perm_b32 v103, v144, v144, v21
    v_mfma_f32_16x16x32_bf16 v[64:67], v[214:217], v[96:99], 0
    v_perm_b32 v104, v148, v148, v18
    v_perm_b32 v105, v148, v148, v19
    v_mfma_f32_16x16x32_bf16 v[76:79], v[22:25], v[100:103], 0
    v_perm_b32 v106, v148, v148, v20
    v_perm_b32 v107, v148, v148, v21
    v_mfma_f32_16x16x32_bf16 v[72:75], v[220:223], v[100:103], 0
    v_perm_b32 v108, v152, v152, v18
    v_perm_b32 v109, v152, v152, v19
    v_mfma_f32_16x16x32_bf16 v[84:87], v[22:25], v[104:107], 0
    v_perm_b32 v110, v152, v152, v20
    v_perm_b32 v111, v152, v152, v21
    v_mfma_f32_16x16x32_bf16 v[80:83], v[212:215], v[104:107], 0
    v_rcp_f32 v68, v68
    v_mfma_f32_16x16x32_bf16 v[92:95], v[22:25], v[108:111], 0
    v_rcp_f32 v76, v76
    v_mfma_f32_16x16x32_bf16 v[88:91], v[218:221], v[108:111], 0
    v_pk_mul_f32 v[64:65], v[64:65], v[68:69] op_sel:[0,0] op_sel_hi:[1,0]
    v_pk_mul_f32 v[66:67], v[66:67], v[68:69] op_sel:[0,0] op_sel_hi:[1,0]
    v_cvt_pk_bf16_f32 v168, v64, v65
    v_cvt_pk_bf16_f32 v169, v66, v67
    v_pk_mul_f32 v[72:73], v[72:73], v[76:77] op_sel:[0,0] op_sel_hi:[1,0]
    v_pk_mul_f32 v[74:75], v[74:75], v[76:77] op_sel:[0,0] op_sel_hi:[1,0]
    v_cvt_pk_bf16_f32 v170, v72, v73
    v_cvt_pk_bf16_f32 v171, v74, v75
    v_rcp_f32 v84, v84
    v_rcp_f32 v92, v92
    v_pk_mul_f32 v[80:81], v[80:81], v[84:85] op_sel:[0,0] op_sel_hi:[1,0]
    v_pk_mul_f32 v[82:83], v[82:83], v[84:85] op_sel:[0,0] op_sel_hi:[1,0]
    v_cvt_pk_bf16_f32 v164, v80, v81
    v_cvt_pk_bf16_f32 v165, v82, v83
    v_pk_mul_f32 v[88:89], v[88:89], v[92:93] op_sel:[0,0] op_sel_hi:[1,0]
    v_pk_mul_f32 v[90:91], v[90:91], v[92:93] op_sel:[0,0] op_sel_hi:[1,0]
    v_cvt_pk_bf16_f32 v166, v88, v89
    v_cvt_pk_bf16_f32 v167, v90, v91
    buffer_store_dwordx4 v[168:171], v3, s[36:39], s5 offen
    buffer_store_dwordx4 v[164:167], v3, s[36:39], s4 offen
    s_add_u32 m0, s71, 0xf000
    s_add_u32 s75, s70, 0x7000
    buffer_load_dwordx4 v3, s[36:39], s75 offen sc1 lds
    s_add_u32 m0, s71, 0xf800
    s_add_u32 s75, s70, 0xf000
    buffer_load_dwordx4 v3, s[36:39], s75 offen sc1 lds
    s_add_u32 m0, s71, 0x10000
    s_add_u32 s75, s19, 0x17000
    buffer_load_dwordx4 v3, s[36:39], s75 offen sc1 lds
    v_mov_b32 v4, 5
    s_cmp_lg_u32 s48, 0
    s_mov_b64 exec, 1
    s_waitcnt vmcnt(3)
    s_barrier
    s_cbranch_scc1 Lq_f_30
    buffer_store_dword v4, off, s[36:39], s55
Lq_f_30:
    s_mov_b64 exec, -1
    s_mul_i32 s4, s48, 4096
    s_add_u32 s4, s4, 0x600000
    s_xor_b32 s5, s48, 0
    s_add_u32 s5, s5, s61
    s_mul_i32 s5, s5, 44032
    s_add_u32 s10, s5, s4
    s_xor_b32 s5, s48, 1
    s_add_u32 s5, s5, s61
    s_mul_i32 s5, s5, 44032
    s_add_u32 s11, s5, s4
    s_xor_b32 s5, s48, 2
    s_add_u32 s5, s5, s61
    s_mul_i32 s5, s5, 44032
    s_add_u32 s12, s5, s4
    s_xor_b32 s5, s48, 3
    s_add_u32 s5, s5, s61
    s_mul_i32 s5, s5, 44032
    s_add_u32 s13, s5, s4
    s_cmp_lg_u32 s48, 1
    s_cbranch_scc1 Lnw_6_1_f
    s_mov_b64 exec, 0
    s_branch Lpg_8000
Lret_6_1_f:
    s_mov_b64 exec, -1
Lnw_6_1_f:
    s_cmp_lg_u32 s48, 2
    s_cbranch_scc1 Lnw_6_2_f
    s_mov_b64 exec, 0
    s_branch Lret_6_2_f
Lret_6_2_f:
    s_mov_b64 exec, -1
Lnw_6_2_f:
    s_cmp_lg_u32 s48, 0
    s_cbranch_scc1 Ln_f_28
    buffer_load_dword v4, v17, s[36:39], s58 offen sc1
    s_nop 15
Lp_f_29:
    buffer_load_dword v5, v17, s[36:39], s58 offen sc1
    s_waitcnt vmcnt(1)
    v_cmp_gt_u32 vcc, 5, v4
    s_cbranch_vccz Ln_f_28
    buffer_load_dword v4, v17, s[36:39], s58 offen sc1
    s_waitcnt vmcnt(1)
    v_cmp_gt_u32 vcc, 5, v5
    s_cbranch_vccz Ln_f_28
    s_sub_u32 s14, s14, 1
    s_cbranch_scc1 L_end_f
    s_branch Lp_f_29
Ln_f_28:
    s_barrier
    buffer_load_dwordx4 v[64:67], v3, s[36:39], s13 offen sc1
    s_barrier
    buffer_load_dwordx4 v[68:71], v3, s[36:39], s13 offen offset:1024 sc1
    s_barrier
    buffer_load_dwordx4 v[72:75], v3, s[36:39], s13 offen offset:2048 sc1
    s_barrier
    buffer_load_dwordx4 v[76:79], v3, s[36:39], s13 offen offset:3072 sc1
    s_barrier
    buffer_load_dwordx4 v[80:83], v3, s[36:39], s12 offen sc1
    s_barrier
    buffer_load_dwordx4 v[84:87], v3, s[36:39], s12 offen offset:1024 sc1
    s_waitcnt vmcnt(5)
    v_mfma_f32_16x16x32_bf16 v[144:147], a[0:3], v[64:67], 0
    buffer_load_dwordx4 v[88:91], v3, s[36:39], s12 offen offset:2048 sc1
    v_mfma_f32_16x16x32_bf16 v[148:151], a[4:7], v[64:67], 0
    v_mfma_f32_16x16x32_bf16 v[152:155], a[8:11], v[64:67], 0
    buffer_load_dwordx4 v[92:95], v3, s[36:39], s12 offen offset:3072 sc1
    v_mfma_f32_16x16x32_bf16 v[156:159], a[12:15], v[64:67], 0
    s_waitcnt vmcnt(6)
    v_mfma_f32_16x16x32_bf16 v[144:147], a[16:19], v[68:71], v[144:147]
    buffer_load_dwordx4 v[96:99], v3, s[36:39], s11 offen sc1
    v_mfma_f32_16x16x32_bf16 v[148:151], a[20:23], v[68:71], v[148:151]
    v_mfma_f32_16x16x32_bf16 v[152:155], a[24:27], v[68:71], v[152:155]
    v_mfma_f32_16x16x32_bf16 v[156:159], a[28:31], v[68:71], v[156:159]
    s_waitcnt vmcnt(6)
    v_mfma_f32_16x16x32_bf16 v[144:147], a[32:35], v[72:75], v[144:147]
    buffer_load_dwordx4 v[100:103], v3, s[36:39], s11 offen offset:1024 sc1
    v_mfma_f32_16x16x32_bf16 v[148:151], a[36:39], v[72:75], v[148:151]
    v_mfma_f32_16x16x32_bf16 v[152:155], a[40:43], v[72:75], v[152:155]
    v_mfma_f32_16x16x32_bf16 v[156:159], a[44:47], v[72:75], v[156:159]
    s_waitcnt vmcnt(6)
    v_mfma_f32_16x16x32_bf16 v[144:147], a[48:51], v[76:79], v[144:147]
    buffer_load_dwordx4 v[104:107], v3, s[36:39], s11 offen offset:2048 sc1
    v_mfma_f32_16x16x32_bf16 v[148:151], a[52:55], v[76:79], v[148:151]
    v_mfma_f32_16x16x32_bf16 v[152:155], a[56:59], v[76:79], v[152:155]
    s_nop 0
Lpg_8000:
    s_cbranch_execz Lret_6_1_f
    s_nop 0
    v_mfma_f32_16x16x32_bf16 v[156:159], a[60:63], v[76:79], v[156:159]
    s_waitcnt vmcnt(6)
    v_mfma_f32_16x16x32_bf16 v[128:131], a[0:3], v[80:83], 0
    buffer_load_dwordx4 v[108:111], v3, s[36:39], s11 offen offset:3072 sc1
    v_mfma_f32_16x16x32_bf16 v[132:135], a[4:7], v[80:83], 0
    ds_write_b128 v38, v[144:147] offset:0
    v_mfma_f32_16x16x32_bf16 v[136:139], a[8:11], v[80:83], 0
    v_mfma_f32_16x16x32_bf16 v[140:143], a[12:15], v[80:83], 0
    s_waitcnt vmcnt(6)
    v_mfma_f32_16x16x32_bf16 v[128:131], a[16:19], v[84:87], v[128:131]
    buffer_load_dwordx4 v[112:115], v3, s[36:39], s10 offen sc1
    ds_write_b128 v38, v[148:151] offset:1024
    v_mfma_f32_16x16x32_bf16 v[132:135], a[20:23], v[84:87], v[132:135]
    v_mfma_f32_16x16x32_bf16 v[136:139], a[24:27], v[84:87], v[136:139]
    v_mfma_f32_16x16x32_bf16 v[140:143], a[28:31], v[84:87], v[140:143]
    s_waitcnt vmcnt(6)
    ds_write_b128 v38, v[152:155] offset:2048
    v_mfma_f32_16x16x32_bf16 v[128:131], a[32:35], v[88:91], v[128:131]
    buffer_load_dwordx4 v[116:119], v3, s[36:39], s10 offen offset:1024 sc1
    v_mfma_f32_16x16x32_bf16 v[132:135], a[36:39], v[88:91], v[132:135]
    v_mfma_f32_16x16x32_bf16 v[136:139], a[40:43], v[88:91], v[136:139]
    ds_write_b128 v38, v[156:159] offset:3072
    v_mfma_f32_16x16x32_bf16 v[140:143], a[44:47], v[88:91], v[140:143]
    s_waitcnt vmcnt(6)
    v_mfma_f32_16x16x32_bf16 v[128:131], a[48:51], v[92:95], v[128:131]
    buffer_load_dwordx4 v[120:123], v3, s[36:39], s10 offen offset:2048 sc1
    v_mfma_f32_16x16x32_bf16 v[132:135], a[52:55], v[92:95], v[132:135]
    v_mfma_f32_16x16x32_bf16 v[136:139], a[56:59], v[92:95], v[136:139]
    v_mfma_f32_16x16x32_bf16 v[140:143], a[60:63], v[92:95], v[140:143]
    s_waitcnt lgkmcnt(0)
    s_barrier
    s_waitcnt vmcnt(6)
    ds_read_b128 v[192:195], v39 offset:0
    v_mfma_f32_16x16x32_bf16 v[144:147], a[0:3], v[96:99], 0
    s_nop 0
    buffer_load_dwordx4 v[124:127], v3, s[36:39], s10 offen offset:3072 sc1
    ds_read_b128 v[196:199], v39 offset:1024
    ds_read_b128 v[200:203], v39 offset:2048
    v_mfma_f32_16x16x32_bf16 v[148:151], a[4:7], v[96:99], 0
    s_nop 0
    ds_read_b128 v[204:207], v39 offset:3072
    ds_write_b128 v37, v[128:131] offset:16384
    v_mfma_f32_16x16x32_bf16 v[152:155], a[8:11], v[96:99], 0
    v_mfma_f32_16x16x32_bf16 v[156:159], a[12:15], v[96:99], 0
    s_waitcnt vmcnt(6)
    v_mfma_f32_16x16x32_bf16 v[144:147], a[16:19], v[100:103], v[144:147]
    ds_write_b128 v37, v[132:135] offset:17408
    v_mfma_f32_16x16x32_bf16 v[148:151], a[20:23], v[100:103], v[148:151]
    v_mfma_f32_16x16x32_bf16 v[152:155], a[24:27], v[100:103], v[152:155]
    v_mfma_f32_16x16x32_bf16 v[156:159], a[28:31], v[100:103], v[156:159]
    s_waitcnt vmcnt(5)
    ds_write_b128 v37, v[136:139] offset:18432
    v_mfma_f32_16x16x32_bf16 v[144:147], a[32:35], v[104:107], v[144:147]
    v_mfma_f32_16x16x32_bf16 v[148:151], a[36:39], v[104:107], v[148:151]
    v_mfma_f32_16x16x32_bf16 v[152:155], a[40:43], v[104:107], v[152:155]
    ds_write_b128 v37, v[140:143] offset:19456
    v_mfma_f32_16x16x32_bf16 v[156:159], a[44:47], v[104:107], v[156:159]
    s_waitcnt vmcnt(4)
    v_mfma_f32_16x16x32_bf16 v[144:147], a[48:51], v[108:111], v[144:147]
    v_mfma_f32_16x16x32_bf16 v[148:151], a[52:55], v[108:111], v[148:151]
    v_mfma_f32_16x16x32_bf16 v[152:155], a[56:59], v[108:111], v[152:155]
    v_mfma_f32_16x16x32_bf16 v[156:159], a[60:63], v[108:111], v[156:159]
    s_waitcnt lgkmcnt(0)
    s_barrier
    s_waitcnt vmcnt(3)
    ds_read_b128 v[160:163], v39 offset:16384
    v_mfma_f32_16x16x32_bf16 v[128:131], a[0:3], v[112:115], 0
    s_nop 0
    ds_read_b128 v[164:167], v39 offset:17408
    ds_read_b128 v[168:171], v39 offset:18432
    v_mfma_f32_16x16x32_bf16 v[132:135], a[4:7], v[112:115], 0
    s_nop 0
    ds_read_b128 v[172:175], v39 offset:19456
    ds_write_b128 v36, v[144:147] offset:0
    v_mfma_f32_16x16x32_bf16 v[136:139], a[8:11], v[112:115], 0
    v_mfma_f32_16x16x32_bf16 v[140:143], a[12:15], v[112:115], 0
    s_waitcnt vmcnt(2)
    ds_write_b128 v36, v[148:151] offset:1024
    v_mfma_f32_16x16x32_bf16 v[128:131], a[16:19], v[116:119], v[128:131]
    v_mfma_f32_16x16x32_bf16 v[132:135], a[20:23], v[116:119], v[132:135]
    ds_write_b128 v36, v[152:155] offset:2048
    v_mfma_f32_16x16x32_bf16 v[136:139], a[24:27], v[116:119], v[136:139]
    s_add_u32 s6, s61, s48
    s_lshl_b32 s4, s6, 14
    v_mfma_f32_16x16x32_bf16 v[140:143], a[28:31], v[116:119], v[140:143]
    s_waitcnt vmcnt(1)
    ds_write_b128 v36, v[156:159] offset:3072
    v_mfma_f32_16x16x32_bf16 v[128:131], a[32:35], v[120:123], v[128:131]
    s_lshl_b32 s5, s60, 11
    v_mfma_f32_16x16x32_bf16 v[132:135], a[36:39], v[120:123], v[132:135]
    s_add_u32 s4, s4, s5
    v_mfma_f32_16x16x32_bf16 v[136:139], a[40:43], v[120:123], v[136:139]
    s_add_u32 s4, s4, 0x0
    v_mfma_f32_16x16x32_bf16 v[140:143], a[44:47], v[120:123], v[140:143]
    s_waitcnt vmcnt(0)
    v_mfma_f32_16x16x32_bf16 v[128:131], a[48:51], v[124:127], v[128:131]
    s_waitcnt lgkmcnt(0)
    s_barrier
    ds_read_b128 v[176:179], v39 offset:0
    v_mfma_f32_16x16x32_bf16 v[132:135], a[52:55], v[124:127], v[132:135]
    s_lshl_b32 s6, s6, 10
    ds_read_b128 v[180:183], v39 offset:1024
    ds_read_b128 v[184:187], v39 offset:2048
    v_mfma_f32_16x16x32_bf16 v[136:139], a[56:59], v[124:127], v[136:139]
    s_add_u32 s6, s6, 0x380000
    ds_read_b128 v[188:191], v39 offset:3072
    v_mfma_f32_16x16x32_bf16 v[140:143], a[60:63], v[124:127], v[140:143]
    v_pk_add_f32 v[48:49], v[48:49], v[192:193]
    v_pk_add_f32 v[50:51], v[50:51], v[194:195]
    v_pk_add_f32 v[52:53], v[52:53], v[196:197]
    v_pk_add_f32 v[54:55], v[54:55], v[198:199]
    v_pk_add_f32 v[56:57], v[56:57], v[200:201]
    v_pk_add_f32 v[58:59], v[58:59], v[202:203]
    v_pk_add_f32 v[60:61], v[60:61], v[204:205]
    v_pk_add_f32 v[62:63], v[62:63], v[206:207]
    v_pk_add_f32 v[48:49], v[48:49], v[160:161]
    v_pk_add_f32 v[50:51], v[50:51], v[162:163]
    v_pk_add_f32 v[52:53], v[52:53], v[164:165]
    v_pk_add_f32 v[54:55], v[54:55], v[166:167]
    v_pk_add_f32 v[56:57], v[56:57], v[168:169]
    v_pk_add_f32 v[58:59], v[58:59], v[170:171]
    v_pk_add_f32 v[60:61], v[60:61], v[172:173]
    v_pk_add_f32 v[62:63], v[62:63], v[174:175]
    v_pk_add_f32 v[48:49], v[48:49], v[128:129]
    v_pk_add_f32 v[50:51], v[50:51], v[130:131]
    v_pk_add_f32 v[52:53], v[52:53], v[132:133]
    v_pk_add_f32 v[54:55], v[54:55], v[134:135]
    v_pk_add_f32 v[56:57], v[56:57], v[136:137]
    v_pk_add_f32 v[58:59], v[58:59], v[138:139]
    v_pk_add_f32 v[60:61], v[60:61], v[140:141]
    v_pk_add_f32 v[62:63], v[62:63], v[142:143]
    s_waitcnt lgkmcnt(0)
    s_nop 0
    v_pk_add_f32 v[48:49], v[48:49], v[176:177]
    v_pk_add_f32 v[50:51], v[50:51], v[178:179]
    v_pk_add_f32 v[52:53], v[52:53], v[180:181]
    v_pk_add_f32 v[54:55], v[54:55], v[182:183]
    v_cvt_pk_bf16_f32 v208, v48, v49
    v_cvt_pk_bf16_f32 v209, v50, v51
    v_cvt_pk_bf16_f32 v210, v52, v53
    v_cvt_pk_bf16_f32 v211, v54, v55
    buffer_store_dwordx4 v[208:211], v3, s[40:43], s4 offen nt
    v_pk_add_f32 v[56:57], v[56:57], v[184:185]
    v_pk_add_f32 v[58:59], v[58:59], v[186:187]
    v_pk_add_f32 v[60:61], v[60:61], v[188:189]
    v_pk_add_f32 v[62:63], v[62:63], v[190:191]
    v_cvt_pk_bf16_f32 v212, v56, v57
    v_cvt_pk_bf16_f32 v213, v58, v59
    v_cvt_pk_bf16_f32 v214, v60, v61
    v_cvt_pk_bf16_f32 v215, v62, v63
    buffer_store_dwordx4 v[212:215], v3, s[40:43], s4 offen offset:1024 nt
    v_pk_add_f32 v[216:217], v[48:49], v[50:51]
    v_pk_mul_f32 v[218:219], v[48:49], v[48:49]
    v_pk_fma_f32 v[218:219], v[50:51], v[50:51], v[218:219]
    v_pk_add_f32 v[216:217], v[216:217], v[52:53]
    v_pk_fma_f32 v[218:219], v[52:53], v[52:53], v[218:219]
    v_pk_add_f32 v[216:217], v[216:217], v[54:55]
    v_pk_fma_f32 v[218:219], v[54:55], v[54:55], v[218:219]
    v_pk_add_f32 v[216:217], v[216:217], v[56:57]
    v_pk_fma_f32 v[218:219], v[56:57], v[56:57], v[218:219]
    v_pk_add_f32 v[216:217], v[216:217], v[58:59]
    v_pk_fma_f32 v[218:219], v[58:59], v[58:59], v[218:219]
    v_pk_add_f32 v[216:217], v[216:217], v[60:61]
    v_pk_fma_f32 v[218:219], v[60:61], v[60:61], v[218:219]
    v_pk_add_f32 v[216:217], v[216:217], v[62:63]
    v_pk_fma_f32 v[218:219], v[62:63], v[62:63], v[218:219]
    v_add_f32 v216, v216, v217
    v_add_f32 v217, v218, v219
    s_nop 1
    v_permlane32_swap_b32 v216, v217
    v_add_f32 v216, v216, v217
    v_mov_b32 v217, v216
    s_nop 1
    v_permlane16_swap_b32 v216, v217
    v_add_f32 v216, v216, v217
    s_mov_b32 exec_lo, 0xffff
    s_mov_b32 exec_hi, 0xffff
    buffer_store_dword v216, v30, s[36:39], s6 offen
    s_mov_b64 exec, -1
    v_mov_b32 v4, 6
    s_cmp_lg_u32 s48, 0
    s_mov_b64 exec, 1
    s_waitcnt vmcnt(0)
    s_barrier
    s_cbranch_scc1 Lq_f_33
    buffer_store_dword v4, off, s[36:39], s55
Lq_f_33:
    s_mov_b64 exec, -1
    s_lshl_b32 s12, s59, 14
    s_add_u32 s12, s12, 0x0
    s_lshl_b32 s11, s59, 10
    s_add_u32 s11, s11, 0x380000
    s_add_u32 s10, s61, s48
    s_lshl_b32 s10, s10, 10
    s_add_u32 s10, s10, 0x380000
    s_add_u32 s16, s12, 0x4000
    s_mul_i32 s20, s59, 43
    s_add_u32 s20, s20, s62
    s_lshl_b32 s20, s20, 10
    s_add_u32 s20, s20, 0x600000
    s_add_u32 s21, s20, 44032
    s_cmp_lt_u32 s50, 11
    s_cselect_b32 s22, s20, 0x80000000
    s_cselect_b32 s23, s21, 0x80000000
    v_add_u32 v240, 0x18800, v3
    v_add_u32 v241, 49152, v3
    ds_read_b128 v[112:115], v3 offset:0
    ds_read_b128 v[116:119], v3 offset:1024
    ds_read_b128 v[120:123], v3 offset:2048
    ds_read_b128 v[124:127], v3 offset:3072
    ds_read_b128 v[128:131], v3 offset:4096
    ds_read_b128 v[132:135], v3 offset:5120
    s_cmp_lg_u32 s48, 1
    s_cbranch_scc1 Lnw_7_1_f
    s_mov_b64 exec, 0
    s_branch Lpg_9000
Lret_7_1_f:
    s_mov_b64 exec, -1
Lnw_7_1_f:
    s_cmp_lg_u32 s48, 2
    s_cbranch_scc1 Lnw_7_2_f
    s_mov_b64 exec, 0
    s_branch Lret_7_2_f
Lret_7_2_f:
    s_mov_b64 exec, -1
Lnw_7_2_f:
    s_cmp_lg_u32 s48, 0
    s_cbranch_scc1 Ln_f_31
    buffer_load_dword v4, v17, s[36:39], s58 offen sc1
    s_nop 15
Lp_f_32:
    s_nop 0
    buffer_load_dword v5, v17, s[36:39], s58 offen sc1
    s_waitcnt vmcnt(1)
    v_cmp_gt_u32 vcc, 6, v4
    s_cbranch_vccz Ln_f_31
    buffer_load_dword v4, v17, s[36:39], s58 offen sc1
    s_waitcnt vmcnt(1)
    v_cmp_gt_u32 vcc, 6, v5
    s_cbranch_vccz Ln_f_31
    s_sub_u32 s14, s14, 1
    s_cbranch_scc1 L_end_f
    s_branch Lp_f_32
Ln_f_31:
    s_barrier
    buffer_load_dwordx4 v[160:163], v3, s[40:43], s12 offen sc1
    buffer_load_dwordx4 v[164:167], v3, s[40:43], s16 offen sc1
    buffer_load_dwordx4 v[168:171], v3, s[40:43], s12 offen offset:1024 sc1
    buffer_load_dwordx4 v[172:175], v3, s[40:43], s16 offen offset:1024 sc1
    buffer_load_dwordx4 v[176:179], v3, s[40:43], s12 offen offset:2048 sc1
    buffer_load_dwordx4 v[180:183], v3, s[40:43], s16 offen offset:2048 sc1
    s_waitcnt vmcnt(4) lgkmcnt(3)
    v_mfma_f32_16x16x32_bf16 v[64:67], v[112:115], v[160:163], 0
    ds_read_b128 v[136:139], v3 offset:6144
    buffer_load_dwordx4 v[184:187], v3, s[40:43], s12 offen offset:3072 sc1
    v_mfma_f32_16x16x32_bf16 v[88:91], v[112:115], v[164:167], 0
    v_mfma_f32_16x16x32_bf16 v[68:71], v[116:119], v[160:163], 0
    ds_read_b128 v[140:143], v3 offset:7168
    v_mfma_f32_16x16x32_bf16 v[92:95], v[116:119], v[164:167], 0
    v_mfma_f32_16x16x32_bf16 v[72:75], v[120:123], v[160:163], 0
    ds_read_b128 v[144:147], v3 offset:8192
    buffer_load_dwordx4 v[188:191], v3, s[40:43], s16 offen offset:3072 sc1
    v_mfma_f32_16x16x32_bf16 v[96:99], v[120:123], v[164:167], 0
    s_waitcnt lgkmcnt(3)
    v_mfma_f32_16x16x32_bf16 v[76:79], v[124:127], v[160:163], 0
    ds_read_b128 v[148:151], v3 offset:9216
    v_mfma_f32_16x16x32_bf16 v[100:103], v[124:127], v[164:167], 0
    v_mfma_f32_16x16x32_bf16 v[80:83], v[128:131], v[160:163], 0
    ds_read_b128 v[152:155], v3 offset:10240
    buffer_load_dwordx4 v[224:227], v3, s[36:39], s11 offen sc1
    v_mfma_f32_16x16x32_bf16 v[104:107], v[128:131], v[164:167], 0
    v_mfma_f32_16x16x32_bf16 v[84:87], v[132:135], v[160:163], 0
    ds_read_b128 v[156:159], v3 offset:11264
    v_mfma_f32_16x16x32_bf16 v[108:111], v[132:135], v[164:167], 0
    s_waitcnt vmcnt(5) lgkmcnt(3)
    v_mfma_f32_16x16x32_bf16 v[64:67], v[136:139], v[168:171], v[64:67]
    s_add_u32 s17, s12, 0x1000
    ds_read_b128 v[112:115], v3 offset:12288
    buffer_load_dwordx4 v[192:195], v3, s[40:43], s17 offen sc1
    v_mfma_f32_16x16x32_bf16 v[88:91], v[136:139], v[172:175], v[88:91]
    v_mfma_f32_16x16x32_bf16 v[68:71], v[140:143], v[168:171], v[68:71]
    ds_read_b128 v[116:119], v3 offset:13312
    v_mfma_f32_16x16x32_bf16 v[92:95], v[140:143], v[172:175], v[92:95]
    v_mfma_f32_16x16x32_bf16 v[72:75], v[144:147], v[168:171], v[72:75]
    s_add_u32 s18, s12, 0x5000
    ds_read_b128 v[120:123], v3 offset:14336
    buffer_load_dwordx4 v[196:199], v3, s[40:43], s18 offen sc1
    v_mfma_f32_16x16x32_bf16 v[96:99], v[144:147], v[172:175], v[96:99]
    s_waitcnt lgkmcnt(3)
    v_mfma_f32_16x16x32_bf16 v[76:79], v[148:151], v[168:171], v[76:79]
    ds_read_b128 v[124:127], v3 offset:15360
    v_mfma_f32_16x16x32_bf16 v[100:103], v[148:151], v[172:175], v[100:103]
    v_mfma_f32_16x16x32_bf16 v[80:83], v[152:155], v[168:171], v[80:83]
    ds_read_b128 v[128:131], v3 offset:16384
    buffer_load_dwordx4 v[228:231], v3, s[36:39], s11 offen offset:1024 sc1
    v_mfma_f32_16x16x32_bf16 v[104:107], v[152:155], v[172:175], v[104:107]
    v_mfma_f32_16x16x32_bf16 v[84:87], v[156:159], v[168:171], v[84:87]
    ds_read_b128 v[132:135], v3 offset:17408
    v_mfma_f32_16x16x32_bf16 v[108:111], v[156:159], v[172:175], v[108:111]
    s_waitcnt vmcnt(6) lgkmcnt(3)
    v_mfma_f32_16x16x32_bf16 v[64:67], v[112:115], v[176:179], v[64:67]
    ds_read_b128 v[136:139], v3 offset:18432
    buffer_load_dwordx4 v[200:203], v3, s[40:43], s17 offen offset:1024 sc1
    v_mfma_f32_16x16x32_bf16 v[88:91], v[112:115], v[180:183], v[88:91]
    s_nop 0
    v_mfma_f32_16x16x32_bf16 v[68:71], v[116:119], v[176:179], v[68:71]
    ds_read_b128 v[140:143], v3 offset:19456
    v_mfma_f32_16x16x32_bf16 v[92:95], v[116:119], v[180:183], v[92:95]
    v_mfma_f32_16x16x32_bf16 v[72:75], v[120:123], v[176:179], v[72:75]
    ds_read_b128 v[144:147], v3 offset:20480
    buffer_load_dwordx4 v[204:207], v3, s[40:43], s18 offen offset:1024 sc1
    v_mfma_f32_16x16x32_bf16 v[96:99], v[120:123], v[180:183], v[96:99]
    s_waitcnt lgkmcnt(3)
    v_mfma_f32_16x16x32_bf16 v[76:79], v[124:127], v[176:179], v[76:79]
    ds_read_b128 v[148:151], v3 offset:21504
    v_mfma_f32_16x16x32_bf16 v[100:103], v[124:127], v[180:183], v[100:103]
    v_mfma_f32_16x16x32_bf16 v[80:83], v[128:131], v[176:179], v[80:83]
    ds_read_b128 v[152:155], v3 offset:22528
    buffer_load_dwordx4 v[208:211], v3, s[40:43], s17 offen offset:2048 sc1
    v_mfma_f32_16x16x32_bf16 v[104:107], v[128:131], v[180:183], v[104:107]
    v_mfma_f32_16x16x32_bf16 v[84:87], v[132:135], v[176:179], v[84:87]
    ds_read_b128 v[156:159], v3 offset:23552
    v_mfma_f32_16x16x32_bf16 v[108:111], v[132:135], v[180:183], v[108:111]
    s_waitcnt vmcnt(7) lgkmcnt(3)
    v_mfma_f32_16x16x32_bf16 v[64:67], v[136:139], v[184:187], v[64:67]
    ds_read_b128 v[112:115], v3 offset:24576
    buffer_load_dwordx4 v[212:215], v3, s[40:43], s18 offen offset:2048 sc1
    v_mfma_f32_16x16x32_bf16 v[88:91], v[136:139], v[188:191], v[88:91]
    v_mfma_f32_16x16x32_bf16 v[68:71], v[140:143], v[184:187], v[68:71]
    ds_read_b128 v[116:119], v3 offset:25600
    v_mfma_f32_16x16x32_bf16 v[92:95], v[140:143], v[188:191], v[92:95]
    v_mfma_f32_16x16x32_bf16 v[72:75], v[144:147], v[184:187], v[72:75]
    ds_read_b128 v[120:123], v3 offset:26624
    buffer_load_dwordx4 v[216:219], v3, s[40:43], s17 offen offset:3072 sc1
    v_mfma_f32_16x16x32_bf16 v[96:99], v[144:147], v[188:191], v[96:99]
    s_waitcnt lgkmcnt(3)
    v_mfma_f32_16x16x32_bf16 v[76:79], v[148:151], v[184:187], v[76:79]
    s_nop 0
    ds_read_b128 v[124:127], v3 offset:27648
    v_mfma_f32_16x16x32_bf16 v[100:103], v[148:151], v[188:191], v[100:103]
    v_mfma_f32_16x16x32_bf16 v[80:83], v[152:155], v[184:187], v[80:83]
    ds_read_b128 v[128:131], v3 offset:28672
    buffer_load_dwordx4 v[220:223], v3, s[40:43], s18 offen offset:3072 sc1
    v_mfma_f32_16x16x32_bf16 v[104:107], v[152:155], v[188:191], v[104:107]
    v_mfma_f32_16x16x32_bf16 v[84:87], v[156:159], v[184:187], v[84:87]
    s_add_u32 s16, s12, 0x2000
    ds_read_b128 v[132:135], v3 offset:29696
    v_mfma_f32_16x16x32_bf16 v[108:111], v[156:159], v[188:191], v[108:111]
    s_waitcnt vmcnt(7) lgkmcnt(3)
    v_mfma_f32_16x16x32_bf16 v[64:67], v[112:115], v[192:195], v[64:67]
    s_waitcnt vmcnt(6)
    ds_read_b128 v[136:139], v3 offset:30720
    buffer_load_dwordx4 v[160:163], v3, s[40:43], s16 offen sc1
    v_mfma_f32_16x16x32_bf16 v[88:91], v[112:115], v[196:199], v[88:91]
    v_add_f32 v224, v224, v226
    v_add_f32 v228, v228, v230
    v_mfma_f32_16x16x32_bf16 v[68:71], v[116:119], v[192:195], v[68:71]
    s_nop 0
    ds_read_b128 v[140:143], v3 offset:31744
    v_add_f32 v225, v225, v227
    v_mfma_f32_16x16x32_bf16 v[92:95], v[116:119], v[196:199], v[92:95]
    v_add_f32 v229, v229, v231
    v_mfma_f32_16x16x32_bf16 v[72:75], v[120:123], v[192:195], v[72:75]
    s_add_u32 s17, s12, 0x6000
    ds_read_b128 v[144:147], v3 offset:32768
    buffer_load_dwordx4 v[164:167], v3, s[40:43], s17 offen sc1
    v_mfma_f32_16x16x32_bf16 v[96:99], v[120:123], v[196:199], v[96:99]
    s_waitcnt lgkmcnt(3)
    v_permlane32_swap_b32 v224, v225
    v_mfma_f32_16x16x32_bf16 v[76:79], v[124:127], v[192:195], v[76:79]
    ds_read_b128 v[148:151], v3 offset:33792
    v_mfma_f32_16x16x32_bf16 v[100:103], v[124:127], v[196:199], v[100:103]
    v_permlane32_swap_b32 v228, v229
    v_mfma_f32_16x16x32_bf16 v[80:83], v[128:131], v[192:195], v[80:83]
    ds_read_b128 v[152:155], v3 offset:34816
    buffer_load_dwordx4 v[168:171], v3, s[40:43], s16 offen offset:1024 sc1
    v_mfma_f32_16x16x32_bf16 v[104:107], v[128:131], v[196:199], v[104:107]
    v_add_f32 v224, v224, v225
    v_add_f32 v228, v228, v229
    v_mfma_f32_16x16x32_bf16 v[84:87], v[132:135], v[192:195], v[84:87]
    s_nop 0
    ds_read_b128 v[156:159], v3 offset:35840
    v_mov_b32 v225, v224
    v_mfma_f32_16x16x32_bf16 v[108:111], v[132:135], v[196:199], v[108:111]
    s_waitcnt vmcnt(7) lgkmcnt(3)
    v_mov_b32 v229, v228
    v_mfma_f32_16x16x32_bf16 v[64:67], v[136:139], v[200:203], v[64:67]
    ds_read_b128 v[112:115], v3 offset:36864
    buffer_load_dwordx4 v[172:175], v3, s[40:43], s17 offen offset:1024 sc1
    v_mfma_f32_16x16x32_bf16 v[88:91], v[136:139], v[204:207], v[88:91]
    v_permlane16_swap_b32 v224, v225
    v_mfma_f32_16x16x32_bf16 v[68:71], v[140:143], v[200:203], v[68:71]
    ds_read_b128 v[116:119], v3 offset:37888
    v_mfma_f32_16x16x32_bf16 v[92:95], v[140:143], v[204:207], v[92:95]
    v_permlane16_swap_b32 v228, v229
    v_mfma_f32_16x16x32_bf16 v[72:75], v[144:147], v[200:203], v[72:75]
    ds_read_b128 v[120:123], v3 offset:38912
    buffer_load_dwordx4 v[176:179], v3, s[40:43], s16 offen offset:2048 sc1
    v_mfma_f32_16x16x32_bf16 v[96:99], v[144:147], v[204:207], v[96:99]
    s_waitcnt lgkmcnt(3)
    v_add_f32 v224, v224, v225
    v_add_f32 v228, v228, v229
    v_mfma_f32_16x16x32_bf16 v[76:79], v[148:151], v[200:203], v[76:79]
    s_nop 0
    ds_read_b128 v[124:127], v3 offset:39936
    v_mov_b32 v225, v224
    v_mfma_f32_16x16x32_bf16 v[100:103], v[148:151], v[204:207], v[100:103]
    v_mov_b32 v229, v228
    v_mfma_f32_16x16x32_bf16 v[80:83], v[152:155], v[200:203], v[80:83]
    ds_read_b128 v[128:131], v3 offset:40960
    buffer_load_dwordx4 v[180:183], v3, s[40:43], s17 offen offset:2048 sc1
    v_mfma_f32_16x16x32_bf16 v[104:107], v[152:155], v[204:207], v[104:107]
    v_permlane32_swap_b32 v224, v225
    v_mfma_f32_16x16x32_bf16 v[84:87], v[156:159], v[200:203], v[84:87]
    s_nop 0
    ds_read_b128 v[132:135], v3 offset:41984
    ds_read_b128 v[242:245], v35 offset:512
    v_mfma_f32_16x16x32_bf16 v[108:111], v[156:159], v[204:207], v[108:111]
    s_waitcnt vmcnt(8) lgkmcnt(4)
    v_permlane32_swap_b32 v228, v229
    v_mul_f32 v236, 0xbb000000, v224
    v_mul_f32 v238, 0xbb000000, v228
    v_mfma_f32_16x16x32_bf16 v[64:67], v[112:115], v[208:211], v[64:67]
    ds_read_b128 v[136:139], v3 offset:43008
    buffer_load_dwordx4 v[184:187], v3, s[40:43], s16 offen offset:3072 sc1
    v_mfma_f32_16x16x32_bf16 v[88:91], v[112:115], v[212:215], v[88:91]
    v_mfma_f32_16x16x32_bf16 v[68:71], v[116:119], v[208:211], v[68:71]
    ds_read_b128 v[140:143], v3 offset:44032
    v_mfma_f32_16x16x32_bf16 v[92:95], v[116:119], v[212:215], v[92:95]
    ds_read_b128 v[246:249], v35 offset:704
    v_mfma_f32_16x16x32_bf16 v[72:75], v[120:123], v[208:211], v[72:75]
    s_waitcnt lgkmcnt(3)
    ds_read_b128 v[144:147], v3 offset:45056
    buffer_load_dwordx4 v[188:191], v3, s[40:43], s17 offen offset:3072 sc1
    v_mfma_f32_16x16x32_bf16 v[96:99], v[120:123], v[212:215], v[96:99]
    v_fmac_f32 v64, v242, v236
    v_fmac_f32 v65, v243, v236
    v_mfma_f32_16x16x32_bf16 v[76:79], v[124:127], v[208:211], v[76:79]
    s_nop 0
    ds_read_b128 v[148:151], v3 offset:46080
    v_fmac_f32 v66, v244, v236
    v_mfma_f32_16x16x32_bf16 v[100:103], v[124:127], v[212:215], v[100:103]
    v_fmac_f32 v67, v245, v236
    v_fmac_f32 v88, v242, v238
    v_mfma_f32_16x16x32_bf16 v[80:83], v[128:131], v[208:211], v[80:83]
    s_add_u32 s18, s12, 0x3000
    ds_read_b128 v[152:155], v3 offset:47104
    buffer_load_dwordx4 v[192:195], v3, s[40:43], s18 offen sc1
    v_mfma_f32_16x16x32_bf16 v[104:107], v[128:131], v[212:215], v[104:107]
    v_fmac_f32 v89, v243, v238
    v_fmac_f32 v90, v244, v238
    v_mfma_f32_16x16x32_bf16 v[84:87], v[132:135], v[208:211], v[84:87]
    s_waitcnt lgkmcnt(3)
    ds_read_b128 v[156:159], v3 offset:48128
    v_fmac_f32 v91, v245, v238
    v_mfma_f32_16x16x32_bf16 v[108:111], v[132:135], v[212:215], v[108:111]
    s_waitcnt vmcnt(9) lgkmcnt(3)
    ds_read_b128 v[242:245], v35 offset:576
    v_fmac_f32 v76, v246, v236
    v_mfma_f32_16x16x32_bf16 v[64:67], v[136:139], v[216:219], v[64:67]
    s_add_u32 s16, s12, 0x7000
    ds_read_b128 v[112:115], v241 offset:0
    buffer_load_dwordx4 v[196:199], v3, s[40:43], s16 offen sc1
    v_mfma_f32_16x16x32_bf16 v[88:91], v[136:139], v[220:223], v[88:91]
    v_fmac_f32 v77, v247, v236
    v_fmac_f32 v78, v248, v236
    v_mfma_f32_16x16x32_bf16 v[68:71], v[140:143], v[216:219], v[68:71]
    s_nop 0
    ds_read_b128 v[116:119], v241 offset:1024
    v_fmac_f32 v79, v249, v236
    v_mfma_f32_16x16x32_bf16 v[92:95], v[140:143], v[220:223], v[92:95]
    v_fmac_f32 v100, v246, v238
    v_fmac_f32 v101, v247, v238
    v_fmac_f32 v102, v248, v238
    v_mfma_f32_16x16x32_bf16 v[72:75], v[144:147], v[216:219], v[72:75]
    ds_read_b128 v[120:123], v241 offset:2048
    buffer_load_dwordx4 v[200:203], v3, s[40:43], s18 offen offset:1024 sc1
    v_fmac_f32 v103, v249, v238
    v_mfma_f32_16x16x32_bf16 v[96:99], v[144:147], v[220:223], v[96:99]
    s_waitcnt lgkmcnt(4)
    ds_read_b128 v[246:249], v35 offset:768
    v_mfma_f32_16x16x32_bf16 v[76:79], v[148:151], v[216:219], v[76:79]
    s_waitcnt lgkmcnt(4)
    ds_read_b128 v[124:127], v241 offset:3072
    v_fmac_f32 v68, v242, v236
    v_mfma_f32_16x16x32_bf16 v[100:103], v[148:151], v[220:223], v[100:103]
    v_fmac_f32 v69, v243, v236
    v_fmac_f32 v70, v244, v236
    v_mfma_f32_16x16x32_bf16 v[80:83], v[152:155], v[216:219], v[80:83]
    ds_read_b128 v[128:131], v241 offset:4096
    buffer_load_dwordx4 v[204:207], v3, s[40:43], s16 offen offset:1024 sc1
    v_mfma_f32_16x16x32_bf16 v[104:107], v[152:155], v[220:223], v[104:107]
    v_fmac_f32 v71, v245, v236
    v_fmac_f32 v92, v242, v238
    v_mfma_f32_16x16x32_bf16 v[84:87], v[156:159], v[216:219], v[84:87]
    s_nop 0
    ds_read_b128 v[132:135], v241 offset:5120
    v_fmac_f32 v93, v243, v238
    v_mfma_f32_16x16x32_bf16 v[108:111], v[156:159], v[220:223], v[108:111]
    s_waitcnt vmcnt(10) lgkmcnt(4)
    v_fmac_f32 v94, v244, v238
    v_fmac_f32 v95, v245, v238
    v_mfma_f32_16x16x32_bf16 v[64:67], v[112:115], v[160:163], v[64:67]
    s_waitcnt lgkmcnt(3)
    ds_read_b128 v[136:139], v241 offset:6144
    buffer_load_dwordx4 v[208:211], v3, s[40:43], s18 offen offset:2048 sc1
    v_mfma_f32_16x16x32_bf16 v[88:91], v[112:115], v[164:167], v[88:91]
    s_nop 0
    ds_read_b128 v[242:245], v35 offset:640
    v_fmac_f32 v80, v246, v236
    v_mfma_f32_16x16x32_bf16 v[68:71], v[116:119], v[160:163], v[68:71]
    s_nop 0
    ds_read_b128 v[140:143], v241 offset:7168
    v_fmac_f32 v81, v247, v236
    v_mfma_f32_16x16x32_bf16 v[92:95], v[116:119], v[164:167], v[92:95]
    v_fmac_f32 v82, v248, v236
    v_fmac_f32 v83, v249, v236
    v_mfma_f32_16x16x32_bf16 v[72:75], v[120:123], v[160:163], v[72:75]
    ds_read_b128 v[144:147], v241 offset:8192
    buffer_load_dwordx4 v[212:215], v3, s[40:43], s16 offen offset:2048 sc1
    v_mfma_f32_16x16x32_bf16 v[96:99], v[120:123], v[164:167], v[96:99]
    s_waitcnt lgkmcnt(4)
    v_fmac_f32 v104, v246, v238
    v_fmac_f32 v105, v247, v238
    v_mfma_f32_16x16x32_bf16 v[76:79], v[124:127], v[160:163], v[76:79]
    ds_read_b128 v[148:151], v241 offset:9216
    v_fmac_f32 v106, v248, v238
    v_fmac_f32 v107, v249, v238
    v_mfma_f32_16x16x32_bf16 v[100:103], v[124:127], v[164:167], v[100:103]
    ds_read_b128 v[246:249], v35 offset:832
    v_mfma_f32_16x16x32_bf16 v[80:83], v[128:131], v[160:163], v[80:83]
    s_waitcnt lgkmcnt(4)
    ds_read_b128 v[152:155], v241 offset:10240
    buffer_load_dwordx4 v[216:219], v3, s[40:43], s18 offen offset:3072 sc1
    v_mfma_f32_16x16x32_bf16 v[104:107], v[128:131], v[164:167], v[104:107]
    v_fmac_f32 v72, v242, v236
    v_fmac_f32 v73, v243, v236
    v_mfma_f32_16x16x32_bf16 v[84:87], v[132:135], v[160:163], v[84:87]
    s_nop 0
    ds_read_b128 v[156:159], v241 offset:11264
    v_fmac_f32 v74, v244, v236
    v_mfma_f32_16x16x32_bf16 v[108:111], v[132:135], v[164:167], v[108:111]
    s_waitcnt vmcnt(11) lgkmcnt(4)
    v_fmac_f32 v75, v245, v236
    v_fmac_f32 v96, v242, v238
    v_mfma_f32_16x16x32_bf16 v[64:67], v[136:139], v[168:171], v[64:67]
    ds_read_b128 v[112:115], v240 offset:0
    buffer_load_dwordx4 v[220:223], v3, s[40:43], s16 offen offset:3072 sc1
    v_mfma_f32_16x16x32_bf16 v[88:91], v[136:139], v[172:175], v[88:91]
    v_fmac_f32 v97, v243, v238
    v_fmac_f32 v98, v244, v238
    v_mfma_f32_16x16x32_bf16 v[68:71], v[140:143], v[168:171], v[68:71]
    s_waitcnt lgkmcnt(3)
    ds_read_b128 v[116:119], v240 offset:1024
    v_fmac_f32 v99, v245, v238
    v_mfma_f32_16x16x32_bf16 v[92:95], v[140:143], v[172:175], v[92:95]
    v_fmac_f32 v84, v246, v236
    v_fmac_f32 v85, v247, v236
    v_mfma_f32_16x16x32_bf16 v[72:75], v[144:147], v[168:171], v[72:75]
    s_nop 0
    ds_read_b128 v[120:123], v240 offset:6144
    v_fmac_f32 v86, v248, v236
    v_mfma_f32_16x16x32_bf16 v[96:99], v[144:147], v[172:175], v[96:99]
    s_waitcnt lgkmcnt(3)
    v_fmac_f32 v87, v249, v236
    v_fmac_f32 v108, v246, v238
    v_mfma_f32_16x16x32_bf16 v[76:79], v[148:151], v[168:171], v[76:79]
    s_nop 0
    ds_read_b128 v[124:127], v240 offset:7168
    v_fmac_f32 v109, v247, v238
    v_mfma_f32_16x16x32_bf16 v[100:103], v[148:151], v[172:175], v[100:103]
    v_fmac_f32 v110, v248, v238
    v_mfma_f32_16x16x32_bf16 v[80:83], v[152:155], v[168:171], v[80:83]
    s_nop 0
    ds_read_b128 v[128:131], v240 offset:12288
    v_fmac_f32_e64 v111, v249, v238
    v_mfma_f32_16x16x32_bf16 v[104:107], v[152:155], v[172:175], v[104:107]
    v_mfma_f32_16x16x32_bf16 v[84:87], v[156:159], v[168:171], v[84:87]
    ds_read_b128 v[132:135], v240 offset:13312
    v_mfma_f32_16x16x32_bf16 v[108:111], v[156:159], v[172:175], v[108:111]
    s_waitcnt vmcnt(10) lgkmcnt(3)
    v_mfma_f32_16x16x32_bf16 v[64:67], v[112:115], v[176:179], v[64:67]
    ds_read_b128 v[136:139], v240 offset:18432
    buffer_load_dwordx4 v[232:235], v3, s[36:39], s10 offen sc1
    v_mfma_f32_16x16x32_bf16 v[88:91], v[112:115], v[180:183], v[88:91]
    v_mfma_f32_16x16x32_bf16 v[68:71], v[116:119], v[176:179], v[68:71]
    ds_read_b128 v[140:143], v240 offset:19456
    v_mfma_f32_16x16x32_bf16 v[92:95], v[116:119], v[180:183], v[92:95]
    s_waitcnt vmcnt(9)
    v_mfma_f32_16x16x32_bf16 v[64:67], v[120:123], v[184:187], v[64:67]
    ds_read_b128 v[144:147], v241 offset:12288
    v_mfma_f32_16x16x32_bf16 v[88:91], v[120:123], v[188:191], v[88:91]
    s_waitcnt lgkmcnt(3)
    v_mfma_f32_16x16x32_bf16 v[68:71], v[124:127], v[184:187], v[68:71]
    ds_read_b128 v[148:151], v241 offset:13312
    s_getpc_b64 s[6:7]
    global_load_dword v7, v47, s[6:7]
    v_mfma_f32_16x16x32_bf16 v[92:95], v[124:127], v[188:191], v[92:95]
    s_waitcnt vmcnt(8)
    v_mfma_f32_16x16x32_bf16 v[64:67], v[128:131], v[192:195], v[64:67]
    ds_read_b128 v[152:155], v241 offset:18432
    v_mfma_f32_16x16x32_bf16 v[88:91], v[128:131], v[196:199], v[88:91]
    v_mfma_f32_16x16x32_bf16 v[68:71], v[132:135], v[192:195], v[68:71]
    ds_read_b128 v[156:159], v241 offset:19456
    v_mfma_f32_16x16x32_bf16 v[92:95], v[132:135], v[196:199], v[92:95]
    s_waitcnt vmcnt(6) lgkmcnt(3)
    v_mfma_f32_16x16x32_bf16 v[64:67], v[136:139], v[200:203], v[64:67]
    ds_read_b128 v[112:115], v240 offset:2048
    v_mfma_f32_16x16x32_bf16 v[88:91], v[136:139], v[204:207], v[88:91]
    v_mfma_f32_16x16x32_bf16 v[68:71], v[140:143], v[200:203], v[68:71]
    ds_read_b128 v[116:119], v240 offset:3072
    v_mfma_f32_16x16x32_bf16 v[92:95], v[140:143], v[204:207], v[92:95]
    s_waitcnt vmcnt(4)
    v_mfma_f32_16x16x32_bf16 v[64:67], v[144:147], v[208:211], v[64:67]
    s_nop 0
Lpg_9000:
    s_cbranch_execz Lret_7_1_f
    s_nop 0
    ds_read_b128 v[120:123], v240 offset:8192
    v_mfma_f32_16x16x32_bf16 v[88:91], v[144:147], v[212:215], v[88:91]
    s_waitcnt lgkmcnt(3)
    v_mfma_f32_16x16x32_bf16 v[68:71], v[148:151], v[208:211], v[68:71]
    ds_read_b128 v[124:127], v240 offset:9216
    v_mfma_f32_16x16x32_bf16 v[92:95], v[148:151], v[212:215], v[92:95]
    s_waitcnt vmcnt(2)
    v_mfma_f32_16x16x32_bf16 v[64:67], v[152:155], v[216:219], v[64:67]
    ds_read_b128 v[128:131], v240 offset:14336
    v_mfma_f32_16x16x32_bf16 v[88:91], v[152:155], v[220:223], v[88:91]
    v_mfma_f32_16x16x32_bf16 v[68:71], v[156:159], v[216:219], v[68:71]
    ds_read_b128 v[132:135], v240 offset:15360
    v_mfma_f32_16x16x32_bf16 v[92:95], v[156:159], v[220:223], v[92:95]
    s_waitcnt lgkmcnt(3)
    v_mfma_f32_16x16x32_bf16 v[72:75], v[112:115], v[176:179], v[72:75]
    ds_read_b128 v[136:139], v240 offset:20480
    v_mfma_f32_16x16x32_bf16 v[96:99], v[112:115], v[180:183], v[96:99]
    v_mfma_f32_16x16x32_bf16 v[76:79], v[116:119], v[176:179], v[76:79]
    ds_read_b128 v[140:143], v240 offset:21504
    v_mfma_f32_16x16x32_bf16 v[100:103], v[116:119], v[180:183], v[100:103]
    v_mfma_f32_16x16x32_bf16 v[72:75], v[120:123], v[184:187], v[72:75]
    s_nop 0
    ds_read_b128 v[144:147], v241 offset:14336
    v_cvt_pk_bf16_f32 v64, v64, v65
    v_mfma_f32_16x16x32_bf16 v[96:99], v[120:123], v[188:191], v[96:99]
    s_waitcnt lgkmcnt(3)
    v_cvt_pk_bf16_f32 v65, v66, v67
    v_cvt_pk_bf16_f32 v66, v68, v69
    v_mfma_f32_16x16x32_bf16 v[76:79], v[124:127], v[184:187], v[76:79]
    s_nop 0
    ds_read_b128 v[148:151], v241 offset:15360
    v_cvt_pk_bf16_f32 v67, v70, v71
    v_mfma_f32_16x16x32_bf16 v[100:103], v[124:127], v[188:191], v[100:103]
    v_pk_max_i16 v64, v64, 0
    v_pk_max_i16 v65, v65, 0
    v_mfma_f32_16x16x32_bf16 v[72:75], v[128:131], v[192:195], v[72:75]
    s_nop 0
    ds_read_b128 v[152:155], v241 offset:20480
    v_pk_max_i16 v66, v66, 0
    v_mfma_f32_16x16x32_bf16 v[96:99], v[128:131], v[196:199], v[96:99]
    v_pk_max_i16 v67, v67, 0
    v_mfma_f32_16x16x32_bf16 v[76:79], v[132:135], v[192:195], v[76:79]
    ds_read_b128 v[156:159], v241 offset:21504
    buffer_store_dwordx4 v[64:67], v3, s[36:39], s20 offen nt
    v_mfma_f32_16x16x32_bf16 v[100:103], v[132:135], v[196:199], v[100:103]
    s_waitcnt lgkmcnt(3)
    v_cvt_pk_bf16_f32 v88, v88, v89
    v_cvt_pk_bf16_f32 v89, v90, v91
    v_mfma_f32_16x16x32_bf16 v[72:75], v[136:139], v[200:203], v[72:75]
    s_nop 0
    ds_read_b128 v[112:115], v240 offset:4096
    v_cvt_pk_bf16_f32 v90, v92, v93
    v_mfma_f32_16x16x32_bf16 v[96:99], v[136:139], v[204:207], v[96:99]
    v_cvt_pk_bf16_f32 v91, v94, v95
    v_mfma_f32_16x16x32_bf16 v[76:79], v[140:143], v[200:203], v[76:79]
    s_nop 0
    ds_read_b128 v[116:119], v240 offset:5120
    v_pk_max_i16 v88, v88, 0
    v_mfma_f32_16x16x32_bf16 v[100:103], v[140:143], v[204:207], v[100:103]
    v_pk_max_i16 v89, v89, 0
    v_pk_max_i16 v90, v90, 0
    v_mfma_f32_16x16x32_bf16 v[72:75], v[144:147], v[208:211], v[72:75]
    s_nop 0
    ds_read_b128 v[120:123], v240 offset:10240
    v_pk_max_i16 v91, v91, 0
    v_mfma_f32_16x16x32_bf16 v[96:99], v[144:147], v[212:215], v[96:99]
    s_waitcnt lgkmcnt(3)
    buffer_store_dwordx4 v[88:91], v3, s[36:39], s21 offen nt
    v_mfma_f32_16x16x32_bf16 v[76:79], v[148:151], v[208:211], v[76:79]
    ds_read_b128 v[124:127], v240 offset:11264
    v_mfma_f32_16x16x32_bf16 v[100:103], v[148:151], v[212:215], v[100:103]
    v_mfma_f32_16x16x32_bf16 v[72:75], v[152:155], v[216:219], v[72:75]
    ds_read_b128 v[128:131], v240 offset:16384
    v_mfma_f32_16x16x32_bf16 v[96:99], v[152:155], v[220:223], v[96:99]
    v_mfma_f32_16x16x32_bf16 v[76:79], v[156:159], v[216:219], v[76:79]
    ds_read_b128 v[132:135], v240 offset:17408
    v_mfma_f32_16x16x32_bf16 v[100:103], v[156:159], v[220:223], v[100:103]
    s_waitcnt lgkmcnt(3)
    v_mfma_f32_16x16x32_bf16 v[80:83], v[112:115], v[176:179], v[80:83]
    ds_read_b128 v[136:139], v240 offset:22528
    v_mfma_f32_16x16x32_bf16 v[104:107], v[112:115], v[180:183], v[104:107]
    v_mfma_f32_16x16x32_bf16 v[84:87], v[116:119], v[176:179], v[84:87]
    ds_read_b128 v[140:143], v240 offset:23552
    v_mfma_f32_16x16x32_bf16 v[108:111], v[116:119], v[180:183], v[108:111]
    v_mfma_f32_16x16x32_bf16 v[80:83], v[120:123], v[184:187], v[80:83]
    s_nop 0
    ds_read_b128 v[144:147], v241 offset:16384
    v_cvt_pk_bf16_f32 v72, v72, v73
    v_mfma_f32_16x16x32_bf16 v[104:107], v[120:123], v[188:191], v[104:107]
    s_waitcnt lgkmcnt(3)
    v_cvt_pk_bf16_f32 v73, v74, v75
    v_cvt_pk_bf16_f32 v74, v76, v77
    v_mfma_f32_16x16x32_bf16 v[84:87], v[124:127], v[184:187], v[84:87]
    s_nop 0
    ds_read_b128 v[148:151], v241 offset:17408
    v_cvt_pk_bf16_f32 v75, v78, v79
    v_mfma_f32_16x16x32_bf16 v[108:111], v[124:127], v[188:191], v[108:111]
    s_nop 0
    v_pk_max_i16 v72, v72, 0
    v_pk_max_i16 v73, v73, 0
    v_mfma_f32_16x16x32_bf16 v[80:83], v[128:131], v[192:195], v[80:83]
    s_nop 0
    ds_read_b128 v[152:155], v241 offset:22528
    v_pk_max_i16 v74, v74, 0
    v_mfma_f32_16x16x32_bf16 v[104:107], v[128:131], v[196:199], v[104:107]
    v_pk_max_i16 v75, v75, 0
    v_mfma_f32_16x16x32_bf16 v[84:87], v[132:135], v[192:195], v[84:87]
    ds_read_b128 v[156:159], v241 offset:23552
    buffer_store_dwordx4 v[72:75], v3, s[36:39], s20 offen offset:1024 nt
    v_mfma_f32_16x16x32_bf16 v[108:111], v[132:135], v[196:199], v[108:111]
    s_waitcnt lgkmcnt(3)
    v_cvt_pk_bf16_f32 v96, v96, v97
    v_cvt_pk_bf16_f32 v97, v98, v99
    v_mfma_f32_16x16x32_bf16 v[80:83], v[136:139], v[200:203], v[80:83]
    v_cvt_pk_bf16_f32 v98, v100, v101
    v_mfma_f32_16x16x32_bf16 v[104:107], v[136:139], v[204:207], v[104:107]
    v_cvt_pk_bf16_f32 v99, v102, v103
    v_mfma_f32_16x16x32_bf16 v[84:87], v[140:143], v[200:203], v[84:87]
    v_pk_max_i16 v96, v96, 0
    v_pk_max_i16 v97, v97, 0
    v_mfma_f32_16x16x32_bf16 v[108:111], v[140:143], v[204:207], v[108:111]
    v_pk_max_i16 v98, v98, 0
    v_mfma_f32_16x16x32_bf16 v[80:83], v[144:147], v[208:211], v[80:83]
    v_pk_max_i16 v99, v99, 0
    v_mfma_f32_16x16x32_bf16 v[104:107], v[144:147], v[212:215], v[104:107]
    s_waitcnt lgkmcnt(0)
    buffer_store_dwordx4 v[96:99], v3, s[36:39], s21 offen offset:1024 nt
    v_mfma_f32_16x16x32_bf16 v[84:87], v[148:151], v[208:211], v[84:87]
    v_mfma_f32_16x16x32_bf16 v[108:111], v[148:151], v[212:215], v[108:111]
    v_mfma_f32_16x16x32_bf16 v[80:83], v[152:155], v[216:219], v[80:83]
    v_mfma_f32_16x16x32_bf16 v[104:107], v[152:155], v[220:223], v[104:107]
    v_mfma_f32_16x16x32_bf16 v[84:87], v[156:159], v[216:219], v[84:87]
    v_mfma_f32_16x16x32_bf16 v[108:111], v[156:159], v[220:223], v[108:111]
    s_nop 4
    v_cvt_pk_bf16_f32 v80, v80, v81
    s_nop 0
    v_cvt_pk_bf16_f32 v84, v84, v85
    v_cvt_pk_bf16_f32 v81, v82, v83
    v_cvt_pk_bf16_f32 v85, v86, v87
    v_pk_max_i16 v80, v80, 0
    v_pk_max_i16 v81, v81, 0
    v_pk_max_i16 v82, v84, 0
    v_pk_max_i16 v83, v85, 0
    v_cvt_pk_bf16_f32 v104, v104, v105
    v_cvt_pk_bf16_f32 v108, v108, v109
    v_cvt_pk_bf16_f32 v105, v106, v107
    v_cvt_pk_bf16_f32 v109, v110, v111
    v_pk_max_i16 v104, v104, 0
    v_pk_max_i16 v105, v105, 0
    v_pk_max_i16 v106, v108, 0
    v_pk_max_i16 v107, v109, 0
    buffer_store_dwordx4 v[80:83], v3, s[36:39], s22 offen offset:2048 nt
    buffer_store_dwordx4 v[104:107], v3, s[36:39], s23 offen offset:2048 nt
    v_mov_b32 v4, 7
    s_cmp_lg_u32 s48, 0
    s_mov_b64 exec, 1
    s_waitcnt vmcnt(0)
    s_barrier
    s_cbranch_scc1 Lq_f_36
    buffer_store_dword v4, off, s[36:39], s55
Lq_f_36:
    s_mov_b64 exec, -1
    v_add_f32 v232, v232, v234
    v_add_f32 v233, v233, v235
    s_nop 1
    v_permlane32_swap_b32 v232, v233
    v_add_f32 v232, v232, v233
    v_mov_b32 v233, v232
    s_nop 1
    v_permlane16_swap_b32 v232, v233
    v_add_f32 v232, v232, v233
    v_mov_b32 v233, v232
    s_nop 1
    v_permlane32_swap_b32 v232, v233
    v_mul_f32 v42, 0xbb000000, v232
    v_mul_f32 v233, 0x3b000000, v233
    v_fma_f32 v233, -v42, v42, v233
    v_max_f32 v233, 0, v233
    v_add_f32 v233, 0x3727c5ac, v233
    v_rsq_f32_e64 v43, v233
    s_mul_i32 s4, s48, 11264
    s_add_u32 s4, s4, 0x600000
    s_xor_b32 s5, s48, 0
    s_add_u32 s5, s5, s61
    s_mul_i32 s5, s5, 44032
    s_add_u32 s10, s5, s4
    s_xor_b32 s5, s48, 1
    s_add_u32 s5, s5, s61
    s_mul_i32 s5, s5, 44032
    s_add_u32 s11, s5, s4
    s_xor_b32 s5, s48, 2
    s_add_u32 s5, s5, s61
    s_mul_i32 s5, s5, 44032
    s_add_u32 s12, s5, s4
    s_xor_b32 s5, s48, 3
    s_add_u32 s5, s5, s61
    s_mul_i32 s5, s5, 44032
    s_add_u32 s13, s5, s4
    s_cmp_lg_u32 s48, 1
    s_cbranch_scc1 Lnw_8_1_f
    s_mov_b64 exec, 0
    s_branch Lpg_a000
Lret_8_1_f:
    s_mov_b64 exec, -1
Lnw_8_1_f:
    s_cmp_lg_u32 s48, 2
    s_cbranch_scc1 Lnw_8_2_f
    s_mov_b64 exec, 0
    s_branch Lret_8_2_f
Lret_8_2_f:
    s_mov_b64 exec, -1
Lnw_8_2_f:
    s_cmp_lg_u32 s48, 0
    s_cbranch_scc1 Ln_f_34
    buffer_load_dword v4, v17, s[36:39], s58 offen sc1
    s_nop 15
Lp_f_35:
    buffer_load_dword v5, v17, s[36:39], s58 offen sc1
    s_waitcnt vmcnt(1)
    v_cmp_gt_u32 vcc, 7, v4
    s_cbranch_vccz Ln_f_34
    buffer_load_dword v4, v17, s[36:39], s58 offen sc1
    s_waitcnt vmcnt(1)
    v_cmp_gt_u32 vcc, 7, v5
    s_cbranch_vccz Ln_f_34
    s_sub_u32 s14, s14, 1
    s_cbranch_scc1 L_end_f
    s_branch Lp_f_35
Ln_f_34:
    s_barrier
    buffer_load_dwordx4 v[64:67], v3, s[36:39], s13 offen sc1
    s_barrier
    buffer_load_dwordx4 v[68:71], v3, s[36:39], s13 offen offset:1024 sc1
    s_barrier
    buffer_load_dwordx4 v[72:75], v3, s[36:39], s13 offen offset:2048 sc1
    s_barrier
    buffer_load_dwordx4 v[76:79], v3, s[36:39], s13 offen offset:3072 sc1
    s_barrier
    s_nop 0
    s_add_u32 s17, s13, 0x1000
    buffer_load_dwordx4 v[80:83], v3, s[36:39], s17 offen sc1
    s_barrier
    buffer_load_dwordx4 v[84:87], v3, s[36:39], s17 offen offset:1024 sc1
    s_waitcnt vmcnt(5)
    v_mfma_f32_16x16x32_bf16 v[144:147], a[64:67], v[64:67], 0
    buffer_load_dwordx4 v[88:91], v3, s[36:39], s17 offen offset:2048 sc1
    v_mfma_f32_16x16x32_bf16 v[148:151], a[68:71], v[64:67], 0
    v_mfma_f32_16x16x32_bf16 v[152:155], a[72:75], v[64:67], 0
    buffer_load_dwordx4 v[92:95], v3, s[36:39], s17 offen offset:3072 sc1
    v_mfma_f32_16x16x32_bf16 v[156:159], a[76:79], v[64:67], 0
    s_waitcnt vmcnt(6)
    v_mfma_f32_16x16x32_bf16 v[144:147], a[80:83], v[68:71], v[144:147]
    s_add_u32 s18, s13, 0x2000
    buffer_load_dwordx4 v[96:99], v3, s[36:39], s18 offen sc1
    v_mfma_f32_16x16x32_bf16 v[148:151], a[84:87], v[68:71], v[148:151]
    v_mfma_f32_16x16x32_bf16 v[152:155], a[88:91], v[68:71], v[152:155]
    v_mfma_f32_16x16x32_bf16 v[156:159], a[92:95], v[68:71], v[156:159]
    s_waitcnt vmcnt(6)
    v_mfma_f32_16x16x32_bf16 v[144:147], a[96:99], v[72:75], v[144:147]
    buffer_load_dwordx4 v[100:103], v3, s[36:39], s18 offen offset:1024 sc1
    v_mfma_f32_16x16x32_bf16 v[148:151], a[100:103], v[72:75], v[148:151]
    s_add_u32 s4, s13, 10240
    v_mfma_f32_16x16x32_bf16 v[152:155], a[104:107], v[72:75], v[152:155]
    s_cmp_eq_u32 s48, 3
    v_mfma_f32_16x16x32_bf16 v[156:159], a[108:111], v[72:75], v[156:159]
    s_waitcnt vmcnt(6)
    v_mfma_f32_16x16x32_bf16 v[144:147], a[112:115], v[76:79], v[144:147]
    s_cselect_b32 s4, 0x80000000, s4
    buffer_load_dwordx4 v[104:107], v3, s[36:39], s4 offen sc1
    v_mfma_f32_16x16x32_bf16 v[148:151], a[116:119], v[76:79], v[148:151]
    v_mfma_f32_16x16x32_bf16 v[152:155], a[120:123], v[76:79], v[152:155]
    v_mfma_f32_16x16x32_bf16 v[156:159], a[124:127], v[76:79], v[156:159]
    s_waitcnt vmcnt(6)
    v_mfma_f32_16x16x32_bf16 v[144:147], a[128:131], v[80:83], v[144:147]
    s_nop 0
    buffer_load_dwordx4 v[108:111], v3, s[36:39], s12 offen sc1
    v_mfma_f32_16x16x32_bf16 v[148:151], a[132:135], v[80:83], v[148:151]
    v_mfma_f32_16x16x32_bf16 v[152:155], a[136:139], v[80:83], v[152:155]
    v_mfma_f32_16x16x32_bf16 v[156:159], a[140:143], v[80:83], v[156:159]
    s_waitcnt vmcnt(6)
    v_mfma_f32_16x16x32_bf16 v[144:147], a[144:147], v[84:87], v[144:147]
    buffer_load_dwordx4 v[112:115], v3, s[36:39], s12 offen offset:1024 sc1
    v_and_b32 v4, 7, v1
    v_mfma_f32_16x16x32_bf16 v[148:151], a[148:151], v[84:87], v[148:151]
    v_mfma_f32_16x16x32_bf16 v[152:155], a[152:155], v[84:87], v[152:155]
    v_xor_b32 v4, v4, v2
    v_mfma_f32_16x16x32_bf16 v[156:159], a[156:159], v[84:87], v[156:159]
    s_waitcnt vmcnt(6)
    v_mfma_f32_16x16x32_bf16 v[144:147], a[160:163], v[88:91], v[144:147]
    buffer_load_dwordx4 v[116:119], v3, s[36:39], s12 offen offset:2048 sc1
    v_lshlrev_b32 v4, 4, v4
    v_mfma_f32_16x16x32_bf16 v[148:151], a[164:167], v[88:91], v[148:151]
    v_mfma_f32_16x16x32_bf16 v[152:155], a[168:171], v[88:91], v[152:155]
    v_lshl_add_u32 v4, v1, 7, v4
    v_mfma_f32_16x16x32_bf16 v[156:159], a[172:175], v[88:91], v[156:159]
    s_waitcnt vmcnt(6)
    v_mfma_f32_16x16x32_bf16 v[144:147], a[176:179], v[92:95], v[144:147]
    s_lshl_b32 s6, s48, 11
    buffer_load_dwordx4 v[120:123], v3, s[36:39], s12 offen offset:3072 sc1
    v_add_u32 v4, s6, v4
    v_mfma_f32_16x16x32_bf16 v[148:151], a[180:183], v[92:95], v[148:151]
    v_mfma_f32_16x16x32_bf16 v[152:155], a[184:187], v[92:95], v[152:155]
    v_xor_b32 v5, 64, v4
    v_mfma_f32_16x16x32_bf16 v[156:159], a[188:191], v[92:95], v[156:159]
    s_waitcnt vmcnt(6)
    v_mfma_f32_16x16x32_bf16 v[144:147], a[192:195], v[96:99], v[144:147]
    s_add_u32 s16, s12, 0x1000
    buffer_load_dwordx4 v[124:127], v3, s[36:39], s16 offen sc1
    v_lshrrev_b32_e64 v6, 3, v3
    v_mfma_f32_16x16x32_bf16 v[148:151], a[196:199], v[96:99], v[148:151]
    v_mfma_f32_16x16x32_bf16 v[152:155], a[200:203], v[96:99], v[152:155]
    v_and_b32 v6, 0x70, v6
    v_mfma_f32_16x16x32_bf16 v[156:159], a[204:207], v[96:99], v[156:159]
    s_waitcnt vmcnt(6)
    v_mfma_f32_16x16x32_bf16 v[144:147], a[208:211], v[100:103], v[144:147]
    buffer_load_dwordx4 v[64:67], v3, s[36:39], s16 offen offset:1024 sc1
    v_xor_b32 v6, v6, v3
    v_mfma_f32_16x16x32_bf16 v[148:151], a[212:215], v[100:103], v[148:151]
    v_mfma_f32_16x16x32_bf16 v[152:155], a[216:219], v[100:103], v[152:155]
    v_add_u32 v6, s6, v6
    v_mfma_f32_16x16x32_bf16 v[156:159], a[220:223], v[100:103], v[156:159]
    s_waitcnt vmcnt(6)
    v_mfma_f32_16x16x32_bf16 v[144:147], a[224:227], v[104:107], v[144:147]
    buffer_load_dwordx4 v[68:71], v3, s[36:39], s16 offen offset:2048 sc1
    v_mfma_f32_16x16x32_bf16 v[148:151], a[228:231], v[104:107], v[148:151]
    v_mfma_f32_16x16x32_bf16 v[152:155], a[232:235], v[104:107], v[152:155]
    v_mfma_f32_16x16x32_bf16 v[156:159], a[236:239], v[104:107], v[156:159]
    s_waitcnt vmcnt(6)
    v_mfma_f32_16x16x32_bf16 v[128:131], a[64:67], v[108:111], 0
    buffer_load_dwordx4 v[72:75], v3, s[36:39], s16 offen offset:3072 sc1
    v_mfma_f32_16x16x32_bf16 v[132:135], a[68:71], v[108:111], 0
    ds_write_b128 v38, v[144:147] offset:0
    v_mfma_f32_16x16x32_bf16 v[136:139], a[72:75], v[108:111], 0
    v_mfma_f32_16x16x32_bf16 v[140:143], a[76:79], v[108:111], 0
    s_waitcnt vmcnt(6)
    v_mfma_f32_16x16x32_bf16 v[128:131], a[80:83], v[112:115], v[128:131]
    s_add_u32 s17, s12, 0x2000
    buffer_load_dwordx4 v[76:79], v3, s[36:39], s17 offen sc1
    v_mfma_f32_16x16x32_bf16 v[132:135], a[84:87], v[112:115], v[132:135]
    ds_write_b128 v38, v[148:151] offset:1024
    v_mfma_f32_16x16x32_bf16 v[136:139], a[88:91], v[112:115], v[136:139]
    v_mfma_f32_16x16x32_bf16 v[140:143], a[92:95], v[112:115], v[140:143]
    s_waitcnt vmcnt(6)
    v_mfma_f32_16x16x32_bf16 v[128:131], a[96:99], v[116:119], v[128:131]
    s_nop 0
    buffer_load_dwordx4 v[80:83], v3, s[36:39], s17 offen offset:1024 sc1
    v_mfma_f32_16x16x32_bf16 v[132:135], a[100:103], v[116:119], v[132:135]
    s_add_u32 s4, s12, 10240
    ds_write_b128 v38, v[152:155] offset:2048
    v_mfma_f32_16x16x32_bf16 v[136:139], a[104:107], v[116:119], v[136:139]
    s_cmp_eq_u32 s48, 3
    v_mfma_f32_16x16x32_bf16 v[140:143], a[108:111], v[116:119], v[140:143]
    s_waitcnt vmcnt(6)
    v_mfma_f32_16x16x32_bf16 v[128:131], a[112:115], v[120:123], v[128:131]
    s_cselect_b32 s4, 0x80000000, s4
    buffer_load_dwordx4 v[84:87], v3, s[36:39], s4 offen sc1
    v_mfma_f32_16x16x32_bf16 v[132:135], a[116:119], v[120:123], v[132:135]
    ds_write_b128 v38, v[156:159] offset:3072
    v_mfma_f32_16x16x32_bf16 v[136:139], a[120:123], v[120:123], v[136:139]
    v_mfma_f32_16x16x32_bf16 v[140:143], a[124:127], v[120:123], v[140:143]
    s_waitcnt vmcnt(6)
    v_mfma_f32_16x16x32_bf16 v[128:131], a[128:131], v[124:127], v[128:131]
    buffer_load_dwordx4 v[88:91], v3, s[36:39], s11 offen sc1
    v_mfma_f32_16x16x32_bf16 v[132:135], a[132:135], v[124:127], v[132:135]
    v_mfma_f32_16x16x32_bf16 v[136:139], a[136:139], v[124:127], v[136:139]
    v_mfma_f32_16x16x32_bf16 v[140:143], a[140:143], v[124:127], v[140:143]
    s_waitcnt lgkmcnt(0)
    s_barrier
    s_waitcnt vmcnt(6)
    ds_read_b128 v[192:195], v39 offset:0
    v_mfma_f32_16x16x32_bf16 v[128:131], a[144:147], v[64:67], v[128:131]
    buffer_load_dwordx4 v[92:95], v3, s[36:39], s11 offen offset:1024 sc1
    ds_read_b128 v[196:199], v39 offset:1024
    v_mfma_f32_16x16x32_bf16 v[132:135], a[148:151], v[64:67], v[132:135]
    ds_read_b128 v[200:203], v39 offset:2048
    v_mfma_f32_16x16x32_bf16 v[136:139], a[152:155], v[64:67], v[136:139]
    ds_read_b128 v[204:207], v39 offset:3072
    v_mfma_f32_16x16x32_bf16 v[140:143], a[156:159], v[64:67], v[140:143]
    s_waitcnt vmcnt(6)
    v_mfma_f32_16x16x32_bf16 v[128:131], a[160:163], v[68:71], v[128:131]
    buffer_load_dwordx4 v[96:99], v3, s[36:39], s11 offen offset:2048 sc1
    v_mfma_f32_16x16x32_bf16 v[132:135], a[164:167], v[68:71], v[132:135]
    v_mfma_f32_16x16x32_bf16 v[136:139], a[168:171], v[68:71], v[136:139]
    s_nop 0
    v_mfma_f32_16x16x32_bf16 v[140:143], a[172:175], v[68:71], v[140:143]
    s_waitcnt vmcnt(6)
    v_mfma_f32_16x16x32_bf16 v[128:131], a[176:179], v[72:75], v[128:131]
    buffer_load_dwordx4 v[100:103], v3, s[36:39], s11 offen offset:3072 sc1
    v_mfma_f32_16x16x32_bf16 v[132:135], a[180:183], v[72:75], v[132:135]
    v_mfma_f32_16x16x32_bf16 v[136:139], a[184:187], v[72:75], v[136:139]
    s_waitcnt lgkmcnt(0)
    v_fmac_f32 v48, v43, v192
    v_fmac_f32 v49, v43, v193
    v_mfma_f32_16x16x32_bf16 v[140:143], a[188:191], v[72:75], v[140:143]
    s_waitcnt vmcnt(6)
    v_fmac_f32 v50, v43, v194
    v_mfma_f32_16x16x32_bf16 v[128:131], a[192:195], v[76:79], v[128:131]
    s_add_u32 s18, s11, 0x1000
    buffer_load_dwordx4 v[104:107], v3, s[36:39], s18 offen sc1
    v_fmac_f32 v51, v43, v195
    v_mfma_f32_16x16x32_bf16 v[132:135], a[196:199], v[76:79], v[132:135]
    v_fmac_f32 v52, v43, v196
    v_mfma_f32_16x16x32_bf16 v[136:139], a[200:203], v[76:79], v[136:139]
    v_fmac_f32 v53, v43, v197
    v_mfma_f32_16x16x32_bf16 v[140:143], a[204:207], v[76:79], v[140:143]
    s_waitcnt vmcnt(6)
    v_fmac_f32 v54, v43, v198
    v_mfma_f32_16x16x32_bf16 v[128:131], a[208:211], v[80:83], v[128:131]
    buffer_load_dwordx4 v[108:111], v3, s[36:39], s18 offen offset:1024 sc1
    v_fmac_f32 v55, v43, v199
    v_mfma_f32_16x16x32_bf16 v[132:135], a[212:215], v[80:83], v[132:135]
    v_fmac_f32 v56, v43, v200
    v_fmac_f32 v57, v43, v201
    v_mfma_f32_16x16x32_bf16 v[136:139], a[216:219], v[80:83], v[136:139]
    v_fmac_f32 v58, v43, v202
    v_mfma_f32_16x16x32_bf16 v[140:143], a[220:223], v[80:83], v[140:143]
    s_waitcnt vmcnt(6)
    v_fmac_f32 v59, v43, v203
    v_mfma_f32_16x16x32_bf16 v[128:131], a[224:227], v[84:87], v[128:131]
    buffer_load_dwordx4 v[112:115], v3, s[36:39], s18 offen offset:2048 sc1
    v_fmac_f32 v60, v43, v204
    v_mfma_f32_16x16x32_bf16 v[132:135], a[228:231], v[84:87], v[132:135]
    v_fmac_f32 v61, v43, v205
    v_mfma_f32_16x16x32_bf16 v[136:139], a[232:235], v[84:87], v[136:139]
    v_fmac_f32 v62, v43, v206
    v_mfma_f32_16x16x32_bf16 v[140:143], a[236:239], v[84:87], v[140:143]
    s_waitcnt vmcnt(6)
    v_fmac_f32 v63, v43, v207
    v_mfma_f32_16x16x32_bf16 v[144:147], a[64:67], v[88:91], 0
    buffer_load_dwordx4 v[116:119], v3, s[36:39], s18 offen offset:3072 sc1
    v_mfma_f32_16x16x32_bf16 v[148:151], a[68:71], v[88:91], 0
    ds_write_b128 v37, v[128:131] offset:16384
    v_mfma_f32_16x16x32_bf16 v[152:155], a[72:75], v[88:91], 0
    v_mfma_f32_16x16x32_bf16 v[156:159], a[76:79], v[88:91], 0
    s_waitcnt vmcnt(6)
    v_mfma_f32_16x16x32_bf16 v[144:147], a[80:83], v[92:95], v[144:147]
    s_add_u32 s16, s11, 0x2000
    buffer_load_dwordx4 v[120:123], v3, s[36:39], s16 offen sc1
    v_mfma_f32_16x16x32_bf16 v[148:151], a[84:87], v[92:95], v[148:151]
    ds_write_b128 v37, v[132:135] offset:17408
    v_mfma_f32_16x16x32_bf16 v[152:155], a[88:91], v[92:95], v[152:155]
    v_mfma_f32_16x16x32_bf16 v[156:159], a[92:95], v[92:95], v[156:159]
    s_waitcnt vmcnt(6)
    v_mfma_f32_16x16x32_bf16 v[144:147], a[96:99], v[96:99], v[144:147]
    buffer_load_dwordx4 v[124:127], v3, s[36:39], s16 offen offset:1024 sc1
    v_mfma_f32_16x16x32_bf16 v[148:151], a[100:103], v[96:99], v[148:151]
    s_add_u32 s4, s11, 10240
    ds_write_b128 v37, v[136:139] offset:18432
    v_mfma_f32_16x16x32_bf16 v[152:155], a[104:107], v[96:99], v[152:155]
    s_cmp_eq_u32 s48, 3
    v_mfma_f32_16x16x32_bf16 v[156:159], a[108:111], v[96:99], v[156:159]
    s_waitcnt vmcnt(6)
    v_mfma_f32_16x16x32_bf16 v[144:147], a[112:115], v[100:103], v[144:147]
    s_cselect_b32 s4, 0x80000000, s4
    buffer_load_dwordx4 v[64:67], v3, s[36:39], s4 offen sc1
    v_mfma_f32_16x16x32_bf16 v[148:151], a[116:119], v[100:103], v[148:151]
    ds_write_b128 v37, v[140:143] offset:19456
    v_mfma_f32_16x16x32_bf16 v[152:155], a[120:123], v[100:103], v[152:155]
    v_mfma_f32_16x16x32_bf16 v[156:159], a[124:127], v[100:103], v[156:159]
    s_waitcnt vmcnt(6)
    v_mfma_f32_16x16x32_bf16 v[144:147], a[128:131], v[104:107], v[144:147]
    s_nop 0
    buffer_load_dwordx4 v[68:71], v3, s[36:39], s10 offen sc1
    v_mfma_f32_16x16x32_bf16 v[148:151], a[132:135], v[104:107], v[148:151]
    v_mfma_f32_16x16x32_bf16 v[152:155], a[136:139], v[104:107], v[152:155]
    v_mfma_f32_16x16x32_bf16 v[156:159], a[140:143], v[104:107], v[156:159]
    s_waitcnt lgkmcnt(0)
    s_barrier
    s_waitcnt vmcnt(6)
    ds_read_b128 v[160:163], v39 offset:16384
    v_mfma_f32_16x16x32_bf16 v[144:147], a[144:147], v[108:111], v[144:147]
    buffer_load_dwordx4 v[72:75], v3, s[36:39], s10 offen offset:1024 sc1
    ds_read_b128 v[164:167], v39 offset:17408
    v_mfma_f32_16x16x32_bf16 v[148:151], a[148:151], v[108:111], v[148:151]
    ds_read_b128 v[168:171], v39 offset:18432
    v_mfma_f32_16x16x32_bf16 v[152:155], a[152:155], v[108:111], v[152:155]
    ds_read_b128 v[172:175], v39 offset:19456
    v_mfma_f32_16x16x32_bf16 v[156:159], a[156:159], v[108:111], v[156:159]
    s_waitcnt vmcnt(6)
    v_mfma_f32_16x16x32_bf16 v[144:147], a[160:163], v[112:115], v[144:147]
    buffer_load_dwordx4 v[76:79], v3, s[36:39], s10 offen offset:2048 sc1
    v_mfma_f32_16x16x32_bf16 v[148:151], a[164:167], v[112:115], v[148:151]
    v_mfma_f32_16x16x32_bf16 v[152:155], a[168:171], v[112:115], v[152:155]
    v_mfma_f32_16x16x32_bf16 v[156:159], a[172:175], v[112:115], v[156:159]
    s_waitcnt vmcnt(6)
    v_mfma_f32_16x16x32_bf16 v[144:147], a[176:179], v[116:119], v[144:147]
    buffer_load_dwordx4 v[80:83], v3, s[36:39], s10 offen offset:3072 sc1
    v_mfma_f32_16x16x32_bf16 v[148:151], a[180:183], v[116:119], v[148:151]
    v_mfma_f32_16x16x32_bf16 v[152:155], a[184:187], v[116:119], v[152:155]
    s_waitcnt lgkmcnt(0)
    v_fmac_f32 v48, v43, v160
    v_fmac_f32 v49, v43, v161
    v_mfma_f32_16x16x32_bf16 v[156:159], a[188:191], v[116:119], v[156:159]
    s_waitcnt vmcnt(6)
    v_fmac_f32 v50, v43, v162
    v_mfma_f32_16x16x32_bf16 v[144:147], a[192:195], v[120:123], v[144:147]
    s_add_u32 s17, s10, 0x1000
    buffer_load_dwordx4 v[84:87], v3, s[36:39], s17 offen sc1
    v_fmac_f32_e64 v51, v43, v163
    v_mfma_f32_16x16x32_bf16 v[148:151], a[196:199], v[120:123], v[148:151]
    v_fmac_f32 v52, v43, v164
    v_mfma_f32_16x16x32_bf16 v[152:155], a[200:203], v[120:123], v[152:155]
    v_fmac_f32 v53, v43, v165
    v_mfma_f32_16x16x32_bf16 v[156:159], a[204:207], v[120:123], v[156:159]
    s_waitcnt vmcnt(6)
    v_fmac_f32 v54, v43, v166
    v_mfma_f32_16x16x32_bf16 v[144:147], a[208:211], v[124:127], v[144:147]
    buffer_load_dwordx4 v[88:91], v3, s[36:39], s17 offen offset:1024 sc1
    v_fmac_f32 v55, v43, v167
    v_mfma_f32_16x16x32_bf16 v[148:151], a[212:215], v[124:127], v[148:151]
    v_fmac_f32 v56, v43, v168
    v_fmac_f32 v57, v43, v169
    v_mfma_f32_16x16x32_bf16 v[152:155], a[216:219], v[124:127], v[152:155]
    v_fmac_f32 v58, v43, v170
    v_mfma_f32_16x16x32_bf16 v[156:159], a[220:223], v[124:127], v[156:159]
    s_waitcnt vmcnt(6)
    v_fmac_f32 v59, v43, v171
    v_mfma_f32_16x16x32_bf16 v[144:147], a[224:227], v[64:67], v[144:147]
    buffer_load_dwordx4 v[92:95], v3, s[36:39], s17 offen offset:2048 sc1
    v_fmac_f32 v60, v43, v172
    v_mfma_f32_16x16x32_bf16 v[148:151], a[228:231], v[64:67], v[148:151]
    v_fmac_f32 v61, v43, v173
    v_mfma_f32_16x16x32_bf16 v[152:155], a[232:235], v[64:67], v[152:155]
    v_fmac_f32 v62, v43, v174
    v_mfma_f32_16x16x32_bf16 v[156:159], a[236:239], v[64:67], v[156:159]
    s_waitcnt vmcnt(6)
    v_fmac_f32 v63, v43, v175
    v_mfma_f32_16x16x32_bf16 v[128:131], a[64:67], v[68:71], 0
    buffer_load_dwordx4 v[96:99], v3, s[36:39], s17 offen offset:3072 sc1
    v_mfma_f32_16x16x32_bf16 v[132:135], a[68:71], v[68:71], 0
    ds_write_b128 v36, v[144:147] offset:0
    v_mfma_f32_16x16x32_bf16 v[136:139], a[72:75], v[68:71], 0
    v_mfma_f32_16x16x32_bf16 v[140:143], a[76:79], v[68:71], 0
    s_waitcnt vmcnt(6)
    v_mfma_f32_16x16x32_bf16 v[128:131], a[80:83], v[72:75], v[128:131]
    s_add_u32 s18, s10, 0x2000
    buffer_load_dwordx4 v[100:103], v3, s[36:39], s18 offen sc1
    v_mfma_f32_16x16x32_bf16 v[132:135], a[84:87], v[72:75], v[132:135]
    ds_write_b128 v36, v[148:151] offset:1024
    v_mfma_f32_16x16x32_bf16 v[136:139], a[88:91], v[72:75], v[136:139]
    v_mfma_f32_16x16x32_bf16 v[140:143], a[92:95], v[72:75], v[140:143]
    s_waitcnt vmcnt(6)
    v_mfma_f32_16x16x32_bf16 v[128:131], a[96:99], v[76:79], v[128:131]
    buffer_load_dwordx4 v[104:107], v3, s[36:39], s18 offen offset:1024 sc1
    v_mfma_f32_16x16x32_bf16 v[132:135], a[100:103], v[76:79], v[132:135]
    s_add_u32 s4, s10, 10240
    ds_write_b128 v36, v[152:155] offset:2048
    v_mfma_f32_16x16x32_bf16 v[136:139], a[104:107], v[76:79], v[136:139]
    s_cmp_eq_u32 s48, 3
    v_mfma_f32_16x16x32_bf16 v[140:143], a[108:111], v[76:79], v[140:143]
    s_waitcnt vmcnt(6)
    v_mfma_f32_16x16x32_bf16 v[128:131], a[112:115], v[80:83], v[128:131]
    s_cselect_b32 s4, 0x80000000, s4
    buffer_load_dwordx4 v[108:111], v3, s[36:39], s4 offen sc1
    v_mfma_f32_16x16x32_bf16 v[132:135], a[116:119], v[80:83], v[132:135]
    ds_write_b128 v36, v[156:159] offset:3072
    v_mfma_f32_16x16x32_bf16 v[136:139], a[120:123], v[80:83], v[136:139]
    v_mfma_f32_16x16x32_bf16 v[140:143], a[124:127], v[80:83], v[140:143]
    s_waitcnt vmcnt(6)
    v_mfma_f32_16x16x32_bf16 v[128:131], a[128:131], v[84:87], v[128:131]
    v_mfma_f32_16x16x32_bf16 v[132:135], a[132:135], v[84:87], v[132:135]
    v_mfma_f32_16x16x32_bf16 v[136:139], a[136:139], v[84:87], v[136:139]
    v_mfma_f32_16x16x32_bf16 v[140:143], a[140:143], v[84:87], v[140:143]
    s_waitcnt lgkmcnt(0)
    s_barrier
    s_waitcnt vmcnt(5)
    ds_read_b128 v[176:179], v39 offset:0
    v_mfma_f32_16x16x32_bf16 v[128:131], a[144:147], v[88:91], v[128:131]
    ds_read_b128 v[180:183], v39 offset:1024
    v_mfma_f32_16x16x32_bf16 v[132:135], a[148:151], v[88:91], v[132:135]
    ds_read_b128 v[184:187], v39 offset:2048
    v_mfma_f32_16x16x32_bf16 v[136:139], a[152:155], v[88:91], v[136:139]
    ds_read_b128 v[188:191], v39 offset:3072
    v_mfma_f32_16x16x32_bf16 v[140:143], a[156:159], v[88:91], v[140:143]
    s_waitcnt vmcnt(4)
    v_mfma_f32_16x16x32_bf16 v[128:131], a[160:163], v[92:95], v[128:131]
    v_mfma_f32_16x16x32_bf16 v[132:135], a[164:167], v[92:95], v[132:135]
    v_mfma_f32_16x16x32_bf16 v[136:139], a[168:171], v[92:95], v[136:139]
    v_mfma_f32_16x16x32_bf16 v[140:143], a[172:175], v[92:95], v[140:143]
    s_waitcnt vmcnt(3)
    v_mfma_f32_16x16x32_bf16 v[128:131], a[176:179], v[96:99], v[128:131]
    v_mfma_f32_16x16x32_bf16 v[132:135], a[180:183], v[96:99], v[132:135]
    v_mfma_f32_16x16x32_bf16 v[136:139], a[184:187], v[96:99], v[136:139]
    s_waitcnt lgkmcnt(0)
    v_fmac_f32 v48, v43, v176
    v_fmac_f32 v49, v43, v177
    v_mfma_f32_16x16x32_bf16 v[140:143], a[188:191], v[96:99], v[140:143]
    s_waitcnt vmcnt(2)
    v_fmac_f32 v50, v43, v178
    v_mfma_f32_16x16x32_bf16 v[128:131], a[192:195], v[100:103], v[128:131]
    v_fmac_f32 v51, v43, v179
    v_mfma_f32_16x16x32_bf16 v[132:135], a[196:199], v[100:103], v[132:135]
    v_fmac_f32 v52, v43, v180
    v_mfma_f32_16x16x32_bf16 v[136:139], a[200:203], v[100:103], v[136:139]
    v_fmac_f32 v53, v43, v181
    v_mfma_f32_16x16x32_bf16 v[140:143], a[204:207], v[100:103], v[140:143]
    s_waitcnt vmcnt(1)
    v_fmac_f32 v54, v43, v182
    v_mfma_f32_16x16x32_bf16 v[128:131], a[208:211], v[104:107], v[128:131]
    v_fmac_f32 v55, v43, v183
    v_mfma_f32_16x16x32_bf16 v[132:135], a[212:215], v[104:107], v[132:135]
    s_add_u32 s4, s61, s48
    v_fmac_f32 v56, v43, v184
    v_fmac_f32 v57, v43, v185
    v_mfma_f32_16x16x32_bf16 v[136:139], a[216:219], v[104:107], v[136:139]
    s_lshl_b32 s4, s4, 14
    v_fmac_f32 v58, v43, v186
    v_mfma_f32_16x16x32_bf16 v[140:143], a[220:223], v[104:107], v[140:143]
    s_waitcnt vmcnt(0)
    v_fmac_f32 v59, v43, v187
    v_mfma_f32_16x16x32_bf16 v[128:131], a[224:227], v[108:111], v[128:131]
    s_lshl_b32 s5, s60, 7
    v_fmac_f32 v60, v43, v188
    v_mfma_f32_16x16x32_bf16 v[132:135], a[228:231], v[108:111], v[132:135]
    s_add_u32 s4, s4, s5
    v_fmac_f32 v61, v43, v189
    v_mfma_f32_16x16x32_bf16 v[136:139], a[232:235], v[108:111], v[136:139]
    s_add_u32 s5, s4, 8192
    v_fmac_f32 v62, v43, v190
Lpg_a000:
    s_cbranch_execz Lret_8_1_f
    s_nop 0
    v_mfma_f32_16x16x32_bf16 v[140:143], a[236:239], v[108:111], v[140:143]
    v_fmac_f32_e64 v63, v43, v191
    v_pk_fma_f32 v[48:49], v[128:129], v[42:43], v[48:49] op_sel:[0,1,0] op_sel_hi:[1,1,1]
    v_pk_fma_f32 v[50:51], v[130:131], v[42:43], v[50:51] op_sel:[0,1,0] op_sel_hi:[1,1,1]
    v_pk_fma_f32 v[52:53], v[132:133], v[42:43], v[52:53] op_sel:[0,1,0] op_sel_hi:[1,1,1]
    v_pk_fma_f32 v[54:55], v[134:135], v[42:43], v[54:55] op_sel:[0,1,0] op_sel_hi:[1,1,1]
    v_cvt_pk_bf16_f32 v208, v48, v49
    v_cvt_pk_bf16_f32 v209, v50, v51
    v_cvt_pk_bf16_f32 v210, v52, v53
    v_cvt_pk_bf16_f32 v211, v54, v55
    ds_write_b128 v4, v[208:211]
    v_pk_fma_f32 v[56:57], v[136:137], v[42:43], v[56:57] op_sel:[0,1,0] op_sel_hi:[1,1,1]
    v_pk_fma_f32 v[58:59], v[138:139], v[42:43], v[58:59] op_sel:[0,1,0] op_sel_hi:[1,1,1]
    v_pk_fma_f32 v[60:61], v[140:141], v[42:43], v[60:61] op_sel:[0,1,0] op_sel_hi:[1,1,1]
    v_pk_fma_f32 v[62:63], v[142:143], v[42:43], v[62:63] op_sel:[0,1,0] op_sel_hi:[1,1,1]
    v_cvt_pk_bf16_f32 v212, v56, v57
    v_cvt_pk_bf16_f32 v213, v58, v59
    v_cvt_pk_bf16_f32 v214, v60, v61
    v_cvt_pk_bf16_f32 v215, v62, v63
    ds_write_b128 v5, v[212:215]
    ds_read_b128 v[160:163], v6 offset:0
    ds_read_b128 v[164:167], v6 offset:1024
    s_waitcnt lgkmcnt(1)
    buffer_store_dwordx4 v[160:163], v8, s[40:43], s4 offen nt
    s_waitcnt lgkmcnt(0)
    buffer_store_dwordx4 v[164:167], v8, s[40:43], s5 offen nt
L_end_f:
L_exit:
    s_endpgm
L_fast_end:
L_fork_s:
    s_getpc_b64 s[6:7]
    s_nop 0
    global_load_dword v7, v47, s[6:7]
    v_pk_fma_f32 v[96:97], v[124:125], v[242:243], v[96:97] op_sel:[0,0,0] op_sel_hi:[1,0,1]
    v_pk_fma_f32 v[98:99], v[126:127], v[242:243], v[98:99] op_sel:[0,0,0] op_sel_hi:[1,0,1]
    v_pk_mul_f32 v[96:97], v[96:97], v[242:243] op_sel:[0,1] op_sel_hi:[1,1]
    v_pk_mul_f32 v[98:99], v[98:99], v[242:243] op_sel:[0,1] op_sel_hi:[1,1]
    v_cvt_pk_bf16_f32 v168, v96, v97
    v_cvt_pk_bf16_f32 v169, v98, v99
    v_pk_fma_f32 v[100:101], v[128:129], v[242:243], v[100:101] op_sel:[0,0,0] op_sel_hi:[1,0,1]
    v_pk_fma_f32 v[102:103], v[130:131], v[242:243], v[102:103] op_sel:[0,0,0] op_sel_hi:[1,0,1]
    ds_write_b64 v41, v[168:169] offset:1024
    v_pk_mul_f32 v[100:101], v[100:101], v[242:243] op_sel:[0,1] op_sel_hi:[1,1]
    v_pk_mul_f32 v[102:103], v[102:103], v[242:243] op_sel:[0,1] op_sel_hi:[1,1]
    v_cvt_pk_bf16_f32 v170, v100, v101
    v_cvt_pk_bf16_f32 v171, v102, v103
    v_pk_fma_f32 v[112:113], v[246:247], v[244:245], v[112:113] op_sel:[0,0,0] op_sel_hi:[1,0,1]
    v_pk_fma_f32 v[114:115], v[248:249], v[244:245], v[114:115] op_sel:[0,0,0] op_sel_hi:[1,0,1]
    ds_write_b64 v41, v[170:171] offset:1536
    v_pk_mul_f32 v[112:113], v[112:113], v[244:245] op_sel:[0,1] op_sel_hi:[1,1]
    v_pk_mul_f32 v[114:115], v[114:115], v[244:245] op_sel:[0,1] op_sel_hi:[1,1]
    v_cvt_pk_bf16_f32 v188, v112, v113
    v_cvt_pk_bf16_f32 v189, v114, v115
    v_pk_fma_f32 v[80:81], v[132:133], v[240:241], v[80:81] op_sel:[0,0,0] op_sel_hi:[1,0,1]
    s_add_u32 m0, s71, 0x18800
    s_add_u32 s75, s70, 0x0
    buffer_load_dwordx4 v3, s[36:39], s75 offen sc1 lds
    v_pk_fma_f32 v[82:83], v[134:135], v[240:241], v[82:83] op_sel:[0,0,0] op_sel_hi:[1,0,1]
    ds_write_b64 v32, v[188:189]
    v_pk_mul_f32 v[80:81], v[80:81], v[240:241] op_sel:[0,1] op_sel_hi:[1,1]
    v_pk_mul_f32 v[82:83], v[82:83], v[240:241] op_sel:[0,1] op_sel_hi:[1,1]
    v_cvt_pk_bf16_f32 v180, v80, v81
    v_cvt_pk_bf16_f32 v181, v82, v83
    v_pk_fma_f32 v[84:85], v[136:137], v[240:241], v[84:85] op_sel:[0,0,0] op_sel_hi:[1,0,1]
    v_pk_fma_f32 v[86:87], v[138:139], v[240:241], v[86:87] op_sel:[0,0,0] op_sel_hi:[1,0,1]
    ds_write_b64 v31, v[180:181] offset:0
    v_pk_mul_f32 v[84:85], v[84:85], v[240:241] op_sel:[0,1] op_sel_hi:[1,1]
    v_pk_mul_f32 v[86:87], v[86:87], v[240:241] op_sel:[0,1] op_sel_hi:[1,1]
    v_cvt_pk_bf16_f32 v182, v84, v85
    v_cvt_pk_bf16_f32 v183, v86, v87
    v_pk_fma_f32 v[104:105], v[132:133], v[242:243], v[104:105] op_sel:[0,0,0] op_sel_hi:[1,0,1]
    v_pk_fma_f32 v[106:107], v[134:135], v[242:243], v[106:107] op_sel:[0,0,0] op_sel_hi:[1,0,1]
    ds_write_b64 v31, v[182:183] offset:512
    v_pk_mul_f32 v[104:105], v[104:105], v[242:243] op_sel:[0,1] op_sel_hi:[1,1]
    v_pk_mul_f32 v[106:107], v[106:107], v[242:243] op_sel:[0,1] op_sel_hi:[1,1]
    v_cvt_pk_bf16_f32 v184, v104, v105
    v_cvt_pk_bf16_f32 v185, v106, v107
    v_pk_fma_f32 v[108:109], v[136:137], v[242:243], v[108:109] op_sel:[0,0,0] op_sel_hi:[1,0,1]
    s_add_u32 m0, s71, 0x19000
    s_add_u32 s75, s70, 0x8000
    buffer_load_dwordx4 v3, s[36:39], s75 offen sc1 lds
    v_pk_fma_f32 v[110:111], v[138:139], v[242:243], v[110:111] op_sel:[0,0,0] op_sel_hi:[1,0,1]
    ds_write_b64 v31, v[184:185] offset:1024
    v_pk_mul_f32 v[108:109], v[108:109], v[242:243] op_sel:[0,1] op_sel_hi:[1,1]
    v_pk_mul_f32 v[110:111], v[110:111], v[242:243] op_sel:[0,1] op_sel_hi:[1,1]
    v_cvt_pk_bf16_f32 v186, v108, v109
    v_cvt_pk_bf16_f32 v187, v110, v111
    v_pk_fma_f32 v[72:73], v[124:125], v[240:241], v[72:73] op_sel:[0,0,0] op_sel_hi:[1,0,1]
    v_pk_fma_f32 v[74:75], v[126:127], v[240:241], v[74:75] op_sel:[0,0,0] op_sel_hi:[1,0,1]
    ds_write_b64 v31, v[186:187] offset:1536
    v_pk_mul_f32 v[72:73], v[72:73], v[240:241] op_sel:[0,1] op_sel_hi:[1,1]
    v_pk_mul_f32 v[74:75], v[74:75], v[240:241] op_sel:[0,1] op_sel_hi:[1,1]
    v_cvt_pk_bf16_f32 v164, v72, v73
    v_cvt_pk_bf16_f32 v165, v74, v75
    v_pk_fma_f32 v[76:77], v[128:129], v[240:241], v[76:77] op_sel:[0,0,0] op_sel_hi:[1,0,1]
    v_pk_fma_f32 v[78:79], v[130:131], v[240:241], v[78:79] op_sel:[0,0,0] op_sel_hi:[1,0,1]
    v_pk_mul_f32 v[76:77], v[76:77], v[240:241] op_sel:[0,1] op_sel_hi:[1,1]
    v_pk_mul_f32 v[78:79], v[78:79], v[240:241] op_sel:[0,1] op_sel_hi:[1,1]
    v_cvt_pk_bf16_f32 v166, v76, v77
    v_cvt_pk_bf16_f32 v167, v78, v79
    v_pk_add_f32 v[116:117], v[116:117], v[196:197]
    v_pk_add_f32 v[118:119], v[118:119], v[198:199]
    s_add_u32 m0, s71, 0x19800
    s_add_u32 s75, s19, 0x10000
    buffer_load_dwordx4 v3, s[36:39], s75 offen sc1 lds
    v_pk_add_f32 v[120:121], v[120:121], v[200:201]
    v_pk_add_f32 v[122:123], v[122:123], v[202:203]
    v_pk_fma_f32 v[88:89], v[116:117], v[242:243], v[88:89] op_sel:[0,0,0] op_sel_hi:[1,0,1]
    v_pk_fma_f32 v[90:91], v[118:119], v[242:243], v[90:91] op_sel:[0,0,0] op_sel_hi:[1,0,1]
    v_cvt_pk_bf16_f32 v176, v88, v89
    v_cvt_pk_bf16_f32 v177, v90, v91
    v_pk_fma_f32 v[92:93], v[120:121], v[242:243], v[92:93] op_sel:[0,0,0] op_sel_hi:[1,0,1]
    v_pk_fma_f32 v[94:95], v[122:123], v[242:243], v[94:95] op_sel:[0,0,0] op_sel_hi:[1,0,1]
    v_cvt_pk_bf16_f32 v178, v92, v93
    v_cvt_pk_bf16_f32 v179, v94, v95
    v_pk_fma_f32 v[64:65], v[116:117], v[240:241], v[64:65] op_sel:[0,0,0] op_sel_hi:[1,0,1]
    v_pk_fma_f32 v[66:67], v[118:119], v[240:241], v[66:67] op_sel:[0,0,0] op_sel_hi:[1,0,1]
    v_cvt_pk_bf16_f32 v172, v64, v65
    v_cvt_pk_bf16_f32 v173, v66, v67
    v_pk_fma_f32 v[68:69], v[120:121], v[240:241], v[68:69] op_sel:[0,0,0] op_sel_hi:[1,0,1]
    v_pk_fma_f32 v[70:71], v[122:123], v[240:241], v[70:71] op_sel:[0,0,0] op_sel_hi:[1,0,1]
    v_cvt_pk_bf16_f32 v174, v68, v69
    v_cvt_pk_bf16_f32 v175, v70, v71
    s_waitcnt lgkmcnt(0)
    s_barrier
    ds_read_b64 v[224:225], v41 offset:0
    ds_read_b64 v[226:227], v41 offset:512
    s_add_u32 m0, s71, 0x1b800
    s_add_u32 s75, s70, 0x1000
    buffer_load_dwordx4 v3, s[36:39], s75 offen sc1 lds
    v_mfma_f32_16x16x16_bf16 v[64:67], v[164:165], v[176:177], 0
    s_mul_i32 s4, s59, 43
    ds_read_b64_tr_b16 v[212:213], v40 offset:0
    v_mfma_f32_16x16x16_bf16 v[68:71], v[168:169], v[176:177], 0
    s_add_u32 s4, s4, s50
    ds_read_b64_tr_b16 v[214:215], v40 offset:1024
    v_mfma_f32_16x16x16_bf16 v[72:75], v[166:167], v[178:179], 0
    s_lshl_b32 s4, s4, 10
    ds_read_b64_tr_b16 v[216:217], v40 offset:2048
    v_mfma_f32_16x16x16_bf16 v[76:79], v[170:171], v[178:179], 0
    s_add_u32 s4, s4, 0x600000
    ds_read_b64_tr_b16 v[218:219], v40 offset:512
    v_mfma_f32_16x16x16_bf16 v[84:87], v[164:165], v[172:173], 0
    s_add_u32 s5, s4, 44032
    ds_read_b64_tr_b16 v[220:221], v40 offset:1536
    v_mfma_f32_16x16x16_bf16 v[92:95], v[166:167], v[174:175], 0
    s_add_u32 m0, s71, 0x1c000
    s_add_u32 s75, s70, 0x9000
    buffer_load_dwordx4 v3, s[36:39], s75 offen sc1 lds
    ds_read_b64_tr_b16 v[222:223], v40 offset:2560
    s_waitcnt lgkmcnt(6)
    v_mfma_f32_16x16x16_bf16 v[80:83], v[224:225], v[172:173], v[26:29]
    v_mul_f32 v241, 0x3eb8aa3b, v241
    v_mfma_f32_16x16x16_bf16 v[88:91], v[226:227], v[174:175], v[26:29]
    v_mul_f32 v243, 0x3eb8aa3b, v243
    v_cndmask_b32 v142, v68, v69, s[64:65]
    v_cndmask_b32 v146, v76, v77, s[64:65]
    v_cndmask_b32 v150, v84, v85, s[64:65]
    v_cndmask_b32 v154, v92, v93, s[64:65]
    v_cndmask_b32 v143, v70, v71, s[64:65]
    v_cndmask_b32 v147, v78, v79, s[64:65]
    v_cndmask_b32 v151, v86, v87, s[64:65]
    v_cndmask_b32 v155, v94, v95, s[64:65]
    v_cndmask_b32 v140, v64, v65, s[64:65]
    v_cndmask_b32 v144, v72, v73, s[64:65]
    v_cndmask_b32 v148, v80, v81, s[64:65]
    s_add_u32 m0, s71, 0x1c800
    s_add_u32 s75, s19, 0x11000
    buffer_load_dwordx4 v3, s[36:39], s75 offen sc1 lds
    v_cndmask_b32 v152, v88, v89, s[64:65]
    v_cndmask_b32 v141, v66, v67, s[64:65]
    v_cndmask_b32 v145, v74, v75, s[64:65]
    v_cndmask_b32 v149, v82, v83, s[64:65]
    v_cndmask_b32 v153, v90, v91, s[64:65]
    v_cndmask_b32 v140, v140, v142, s[66:67]
    v_cndmask_b32 v144, v144, v146, s[66:67]
    v_cndmask_b32 v148, v148, v150, s[66:67]
    v_cndmask_b32 v152, v152, v154, s[66:67]
    v_cndmask_b32 v141, v141, v143, s[68:69]
    v_cndmask_b32 v145, v145, v147, s[68:69]
    v_cndmask_b32 v149, v149, v151, s[68:69]
    v_cndmask_b32 v153, v153, v155, s[68:69]
    v_pk_mul_f32 v[140:141], v[140:141], v[242:243] op_sel:[0,1] op_sel_hi:[1,1]
    v_pk_mul_f32 v[144:145], v[144:145], v[242:243] op_sel:[0,1] op_sel_hi:[1,1]
    v_pk_mul_f32 v[148:149], v[148:149], v[240:241] op_sel:[0,1] op_sel_hi:[1,1]
    v_pk_mul_f32 v[152:153], v[152:153], v[240:241] op_sel:[0,1] op_sel_hi:[1,1]
    v_max_f32 v158, v140, v141
    v_max_f32 v159, v144, v145
    v_max_f32 v156, v148, v149
    v_max_f32 v157, v152, v153
    buffer_load_dwordx4 a[64:67], v3, s[36:39], s73 offen sc1
    v_permlane32_swap_b32 v158, v159
    v_permlane32_swap_b32 v156, v157
    v_max_f32 v158, v158, v159
    v_max_f32 v156, v156, v157
    v_mov_b32 v159, v158
    v_mov_b32 v157, v156
    s_nop 0
    v_permlane16_swap_b32 v158, v159
    v_permlane16_swap_b32 v156, v157
    v_max_f32 v158, v158, v159
    v_max_f32 v156, v156, v157
    v_mov_b32 v159, v158
    v_mov_b32 v157, v156
    s_nop 0
    v_permlane32_swap_b32 v158, v159
    v_permlane32_swap_b32 v156, v157
    v_pk_add_f32 v[140:141], v[140:141], v[158:159] op_sel:[0,0] op_sel_hi:[1,0] neg_lo:[0,1] neg_hi:[0,1]
    v_pk_add_f32 v[144:145], v[144:145], v[158:159] op_sel:[0,1] op_sel_hi:[1,1] neg_lo:[0,1] neg_hi:[0,1]
    v_pk_add_f32 v[148:149], v[148:149], v[156:157] op_sel:[0,0] op_sel_hi:[1,0] neg_lo:[0,1] neg_hi:[0,1]
    v_pk_add_f32 v[152:153], v[152:153], v[156:157] op_sel:[0,1] op_sel_hi:[1,1] neg_lo:[0,1] neg_hi:[0,1]
    v_exp_f32 v140, v140
    v_exp_f32 v144, v144
    buffer_load_dwordx4 a[68:71], v3, s[36:39], s73 offen offset:1024 sc1
    v_exp_f32 v148, v148
    v_exp_f32 v152, v152
    v_exp_f32 v141, v141
    v_exp_f32 v145, v145
    v_exp_f32 v149, v149
    v_exp_f32 v153, v153
    v_cvt_pk_bf16_f32 v140, v140, v141
    v_cvt_pk_bf16_f32 v144, v144, v145
    v_cvt_pk_bf16_f32 v148, v148, v149
    v_cvt_pk_bf16_f32 v152, v152, v153
    s_waitcnt lgkmcnt(0)
    v_perm_b32 v96, v140, v140, v18
    v_perm_b32 v97, v140, v140, v19
    v_perm_b32 v98, v140, v140, v20
    v_perm_b32 v99, v140, v140, v21
    v_perm_b32 v100, v144, v144, v18
    v_perm_b32 v101, v144, v144, v19
    v_mfma_f32_16x16x32_bf16 v[68:71], v[22:25], v[96:99], 0
    v_perm_b32 v102, v144, v144, v20
    v_perm_b32 v103, v144, v144, v21
    v_mfma_f32_16x16x32_bf16 v[64:67], v[214:217], v[96:99], 0
    v_perm_b32 v104, v148, v148, v18
    v_perm_b32 v105, v148, v148, v19
    v_mfma_f32_16x16x32_bf16 v[76:79], v[22:25], v[100:103], 0
    v_perm_b32 v106, v148, v148, v20
    v_perm_b32 v107, v148, v148, v21
    v_mfma_f32_16x16x32_bf16 v[72:75], v[220:223], v[100:103], 0
    v_perm_b32 v108, v152, v152, v18
    v_perm_b32 v109, v152, v152, v19
    v_mfma_f32_16x16x32_bf16 v[84:87], v[22:25], v[104:107], 0
    v_perm_b32 v110, v152, v152, v20
    v_perm_b32 v111, v152, v152, v21
    v_mfma_f32_16x16x32_bf16 v[80:83], v[212:215], v[104:107], 0
    v_rcp_f32 v68, v68
    v_mfma_f32_16x16x32_bf16 v[92:95], v[22:25], v[108:111], 0
    v_rcp_f32 v76, v76
    v_mfma_f32_16x16x32_bf16 v[88:91], v[218:221], v[108:111], 0
    v_pk_mul_f32 v[64:65], v[64:65], v[68:69] op_sel:[0,0] op_sel_hi:[1,0]
    v_pk_mul_f32 v[66:67], v[66:67], v[68:69] op_sel:[0,0] op_sel_hi:[1,0]
    v_cvt_pk_bf16_f32 v168, v64, v65
    v_cvt_pk_bf16_f32 v169, v66, v67
    v_pk_mul_f32 v[72:73], v[72:73], v[76:77] op_sel:[0,0] op_sel_hi:[1,0]
    v_pk_mul_f32 v[74:75], v[74:75], v[76:77] op_sel:[0,0] op_sel_hi:[1,0]
    v_cvt_pk_bf16_f32 v170, v72, v73
    v_cvt_pk_bf16_f32 v171, v74, v75
    v_rcp_f32 v84, v84
    v_rcp_f32 v92, v92
    v_pk_mul_f32 v[80:81], v[80:81], v[84:85] op_sel:[0,0] op_sel_hi:[1,0]
    v_pk_mul_f32 v[82:83], v[82:83], v[84:85] op_sel:[0,0] op_sel_hi:[1,0]
    v_cvt_pk_bf16_f32 v164, v80, v81
    v_cvt_pk_bf16_f32 v165, v82, v83
    v_pk_mul_f32 v[88:89], v[88:89], v[92:93] op_sel:[0,0] op_sel_hi:[1,0]
    v_pk_mul_f32 v[90:91], v[90:91], v[92:93] op_sel:[0,0] op_sel_hi:[1,0]
    v_cvt_pk_bf16_f32 v166, v88, v89
    v_cvt_pk_bf16_f32 v167, v90, v91
    buffer_store_dwordx4 v[168:171], v3, s[36:39], s5 offen sc0 sc1
    buffer_store_dwordx4 v[164:167], v3, s[36:39], s4 offen sc0 sc1
    v_lshlrev_b32 v48, 16, v204
    v_and_b32 v49, 0xffff0000, v204
    v_lshlrev_b32 v50, 16, v205
    v_and_b32 v51, 0xffff0000, v205
    v_lshlrev_b32 v52, 16, v206
    v_and_b32 v53, 0xffff0000, v206
    v_lshlrev_b32 v54, 16, v207
    v_and_b32 v55, 0xffff0000, v207
    v_lshlrev_b32 v56, 16, v208
    v_and_b32 v57, 0xffff0000, v208
    v_lshlrev_b32 v58, 16, v209
    v_and_b32 v59, 0xffff0000, v209
    v_lshlrev_b32 v60, 16, v210
    v_and_b32 v61, 0xffff0000, v210
    v_lshlrev_b32 v62, 16, v211
    v_and_b32 v63, 0xffff0000, v211
    buffer_load_dwordx4 a[72:75], v3, s[36:39], s73 offen offset:2048 sc1
    buffer_load_dwordx4 a[76:79], v3, s[36:39], s73 offen offset:3072 sc1
    s_add_u32 s75, s73, 0x1000
    buffer_load_dwordx4 a[80:83], v3, s[36:39], s75 offen sc1
    buffer_load_dwordx4 a[84:87], v3, s[36:39], s75 offen offset:1024 sc1
    v_mov_b32 v4, 1
    s_cmp_lg_u32 s48, 0
    s_mov_b64 exec, 1
    s_waitcnt vmcnt(4)
    s_barrier
    s_cbranch_scc1 Lq_s_13
    buffer_store_dword v4, off, s[36:39], s55 sc0 sc1
Lq_s_13:
    s_mov_b64 exec, -1
    buffer_load_dwordx4 a[88:91], v3, s[36:39], s75 offen offset:2048 sc1
    buffer_load_dwordx4 a[92:95], v3, s[36:39], s75 offen offset:3072 sc1
    s_add_u32 s75, s73, 0x2000
    buffer_load_dwordx4 a[96:99], v3, s[36:39], s75 offen sc1
    buffer_load_dwordx4 a[100:103], v3, s[36:39], s75 offen offset:1024 sc1
    buffer_load_dwordx4 a[104:107], v3, s[36:39], s75 offen offset:2048 sc1
    buffer_load_dwordx4 a[108:111], v3, s[36:39], s75 offen offset:3072 sc1
    s_add_u32 s75, s73, 0x3000
    buffer_load_dwordx4 a[112:115], v3, s[36:39], s75 offen sc1
    buffer_load_dwordx4 a[116:119], v3, s[36:39], s75 offen offset:1024 sc1
    s_mov_b32 exec_lo, 0x00010001
    s_mov_b32 exec_hi, 0x00010001
    ds_write_b128 v35, v[116:119] offset:0
    ds_write_b128 v35, v[120:123] offset:64
    ds_write_b128 v35, v[124:127] offset:128
    ds_write_b128 v35, v[128:131] offset:192
    ds_write_b128 v35, v[132:135] offset:256
    ds_write_b128 v35, v[136:139] offset:320
    s_mov_b64 exec, -1
    s_mul_i32 s4, s48, 4096
    s_add_u32 s4, s4, 0x600000
    s_xor_b32 s5, s48, 0
    s_add_u32 s5, s5, s61
    s_mul_i32 s5, s5, 44032
    s_add_u32 s10, s5, s4
    s_xor_b32 s5, s48, 1
    s_add_u32 s5, s5, s61
    s_mul_i32 s5, s5, 44032
    s_add_u32 s11, s5, s4
    s_xor_b32 s5, s48, 2
    s_add_u32 s5, s5, s61
    s_mul_i32 s5, s5, 44032
    s_add_u32 s12, s5, s4
    s_xor_b32 s5, s48, 3
    s_add_u32 s5, s5, s61
    s_mul_i32 s5, s5, 44032
    s_add_u32 s13, s5, s4
    s_cmp_lg_u32 s48, 1
    s_cbranch_scc1 Lnw_2_1_s
    s_mov_b64 exec, 0
    s_branch Lret_2_1_s
Lret_2_1_s:
    s_mov_b64 exec, -1
Lnw_2_1_s:
    s_cmp_lg_u32 s48, 2
    s_cbranch_scc1 Lnw_2_2_s
    s_mov_b64 exec, 0
    s_branch Lret_2_2_s
Lret_2_2_s:
    s_mov_b64 exec, -1
Lnw_2_2_s:
    s_cmp_lg_u32 s48, 0
    s_cbranch_scc1 Ln_s_11
    buffer_load_dword v4, v17, s[36:39], s58 offen sc1
    s_nop 15
Lp_s_12:
    buffer_load_dword v5, v17, s[36:39], s58 offen sc1
    s_waitcnt vmcnt(1)
    v_cmp_gt_u32 vcc, 1, v4
    s_cbranch_vccz Ln_s_11
    buffer_load_dword v4, v17, s[36:39], s58 offen sc1
    s_waitcnt vmcnt(1)
    v_cmp_gt_u32 vcc, 1, v5
    s_cbranch_vccz Ln_s_11
    s_sub_u32 s14, s14, 1
    s_cbranch_scc1 L_end_s
    s_branch Lp_s_12
Ln_s_11:
    s_barrier
    buffer_load_dwordx4 v[64:67], v3, s[36:39], s13 offen sc1
    s_barrier
    buffer_load_dwordx4 v[68:71], v3, s[36:39], s13 offen offset:1024 sc1
    s_barrier
    buffer_load_dwordx4 v[72:75], v3, s[36:39], s13 offen offset:2048 sc1
    s_barrier
    buffer_load_dwordx4 v[76:79], v3, s[36:39], s13 offen offset:3072 sc1
    s_barrier
    buffer_load_dwordx4 v[80:83], v3, s[36:39], s12 offen sc1
    s_barrier
    buffer_load_dwordx4 v[84:87], v3, s[36:39], s12 offen offset:1024 sc1
    s_waitcnt vmcnt(5)
    v_mfma_f32_16x16x32_bf16 v[144:147], a[0:3], v[64:67], 0
    buffer_load_dwordx4 v[88:91], v3, s[36:39], s12 offen offset:2048 sc1
    v_mfma_f32_16x16x32_bf16 v[148:151], a[4:7], v[64:67], 0
    v_mfma_f32_16x16x32_bf16 v[152:155], a[8:11], v[64:67], 0
    buffer_load_dwordx4 v[92:95], v3, s[36:39], s12 offen offset:3072 sc1
    v_mfma_f32_16x16x32_bf16 v[156:159], a[12:15], v[64:67], 0
    s_waitcnt vmcnt(6)
    v_mfma_f32_16x16x32_bf16 v[144:147], a[16:19], v[68:71], v[144:147]
    buffer_load_dwordx4 v[96:99], v3, s[36:39], s11 offen sc1
    v_mfma_f32_16x16x32_bf16 v[148:151], a[20:23], v[68:71], v[148:151]
    v_mfma_f32_16x16x32_bf16 v[152:155], a[24:27], v[68:71], v[152:155]
    v_mfma_f32_16x16x32_bf16 v[156:159], a[28:31], v[68:71], v[156:159]
    s_waitcnt vmcnt(6)
    v_mfma_f32_16x16x32_bf16 v[144:147], a[32:35], v[72:75], v[144:147]
    buffer_load_dwordx4 v[100:103], v3, s[36:39], s11 offen offset:1024 sc1
    v_mfma_f32_16x16x32_bf16 v[148:151], a[36:39], v[72:75], v[148:151]
    v_mfma_f32_16x16x32_bf16 v[152:155], a[40:43], v[72:75], v[152:155]
    v_mfma_f32_16x16x32_bf16 v[156:159], a[44:47], v[72:75], v[156:159]
    s_waitcnt vmcnt(6)
    v_mfma_f32_16x16x32_bf16 v[144:147], a[48:51], v[76:79], v[144:147]
    buffer_load_dwordx4 v[104:107], v3, s[36:39], s11 offen offset:2048 sc1
    v_mfma_f32_16x16x32_bf16 v[148:151], a[52:55], v[76:79], v[148:151]
    v_mfma_f32_16x16x32_bf16 v[152:155], a[56:59], v[76:79], v[152:155]
    v_mfma_f32_16x16x32_bf16 v[156:159], a[60:63], v[76:79], v[156:159]
    s_waitcnt vmcnt(6)
    v_mfma_f32_16x16x32_bf16 v[128:131], a[0:3], v[80:83], 0
    buffer_load_dwordx4 v[108:111], v3, s[36:39], s11 offen offset:3072 sc1
    v_mfma_f32_16x16x32_bf16 v[132:135], a[4:7], v[80:83], 0
    ds_write_b128 v38, v[144:147] offset:0
    v_mfma_f32_16x16x32_bf16 v[136:139], a[8:11], v[80:83], 0
    v_mfma_f32_16x16x32_bf16 v[140:143], a[12:15], v[80:83], 0
    s_waitcnt vmcnt(6)
    v_mfma_f32_16x16x32_bf16 v[128:131], a[16:19], v[84:87], v[128:131]
    buffer_load_dwordx4 v[112:115], v3, s[36:39], s10 offen sc1
    ds_write_b128 v38, v[148:151] offset:1024
    v_mfma_f32_16x16x32_bf16 v[132:135], a[20:23], v[84:87], v[132:135]
    v_mfma_f32_16x16x32_bf16 v[136:139], a[24:27], v[84:87], v[136:139]
    v_mfma_f32_16x16x32_bf16 v[140:143], a[28:31], v[84:87], v[140:143]
    s_waitcnt vmcnt(6)
    ds_write_b128 v38, v[152:155] offset:2048
    v_mfma_f32_16x16x32_bf16 v[128:131], a[32:35], v[88:91], v[128:131]
    buffer_load_dwordx4 v[116:119], v3, s[36:39], s10 offen offset:1024 sc1
    v_mfma_f32_16x16x32_bf16 v[132:135], a[36:39], v[88:91], v[132:135]
    v_mfma_f32_16x16x32_bf16 v[136:139], a[40:43], v[88:91], v[136:139]
    ds_write_b128 v38, v[156:159] offset:3072
    v_mfma_f32_16x16x32_bf16 v[140:143], a[44:47], v[88:91], v[140:143]
    s_waitcnt vmcnt(6)
    v_mfma_f32_16x16x32_bf16 v[128:131], a[48:51], v[92:95], v[128:131]
    buffer_load_dwordx4 v[120:123], v3, s[36:39], s10 offen offset:2048 sc1
    v_mfma_f32_16x16x32_bf16 v[132:135], a[52:55], v[92:95], v[132:135]
    v_mfma_f32_16x16x32_bf16 v[136:139], a[56:59], v[92:95], v[136:139]
    v_mfma_f32_16x16x32_bf16 v[140:143], a[60:63], v[92:95], v[140:143]
    s_waitcnt lgkmcnt(0)
    s_barrier
    s_waitcnt vmcnt(6)
    ds_read_b128 v[192:195], v39 offset:0
    v_mfma_f32_16x16x32_bf16 v[144:147], a[0:3], v[96:99], 0
    buffer_load_dwordx4 v[124:127], v3, s[36:39], s10 offen offset:3072 sc1
    ds_read_b128 v[196:199], v39 offset:1024
    ds_read_b128 v[200:203], v39 offset:2048
    v_mfma_f32_16x16x32_bf16 v[148:151], a[4:7], v[96:99], 0
    s_nop 0
    ds_read_b128 v[204:207], v39 offset:3072
    ds_write_b128 v37, v[128:131] offset:16384
    v_mfma_f32_16x16x32_bf16 v[152:155], a[8:11], v[96:99], 0
    v_mfma_f32_16x16x32_bf16 v[156:159], a[12:15], v[96:99], 0
    s_waitcnt vmcnt(6)
    v_mfma_f32_16x16x32_bf16 v[144:147], a[16:19], v[100:103], v[144:147]
    ds_write_b128 v37, v[132:135] offset:17408
    s_mov_b32 exec_lo, 0x0
    s_mov_b32 exec_hi, 0x3fff
    buffer_load_dword v10, v9, s[36:39], 0 offen
    s_mov_b64 exec, -1
    v_mfma_f32_16x16x32_bf16 v[148:151], a[20:23], v[100:103], v[148:151]
    v_mfma_f32_16x16x32_bf16 v[152:155], a[24:27], v[100:103], v[152:155]
    v_mfma_f32_16x16x32_bf16 v[156:159], a[28:31], v[100:103], v[156:159]
    s_waitcnt vmcnt(6)
    ds_write_b128 v37, v[136:139] offset:18432
    v_mfma_f32_16x16x32_bf16 v[144:147], a[32:35], v[104:107], v[144:147]
    s_mov_b32 exec_lo, 0x0
    s_mov_b32 exec_hi, 0x7ffc000
    buffer_load_dword v10, v9, s[36:39], 0 offen
    s_mov_b64 exec, -1
    v_mfma_f32_16x16x32_bf16 v[148:151], a[36:39], v[104:107], v[148:151]
    v_mfma_f32_16x16x32_bf16 v[152:155], a[40:43], v[104:107], v[152:155]
    ds_write_b128 v37, v[140:143] offset:19456
    v_mfma_f32_16x16x32_bf16 v[156:159], a[44:47], v[104:107], v[156:159]
    s_waitcnt vmcnt(6)
    v_mfma_f32_16x16x32_bf16 v[144:147], a[48:51], v[108:111], v[144:147]
    v_mfma_f32_16x16x32_bf16 v[148:151], a[52:55], v[108:111], v[148:151]
    buffer_load_dwordx4 a[120:123], v3, s[36:39], s75 offen offset:2048 sc1
    v_mfma_f32_16x16x32_bf16 v[152:155], a[56:59], v[108:111], v[152:155]
    v_mfma_f32_16x16x32_bf16 v[156:159], a[60:63], v[108:111], v[156:159]
    s_waitcnt lgkmcnt(0)
    s_barrier
    s_waitcnt vmcnt(6)
    ds_read_b128 v[160:163], v39 offset:16384
    v_mfma_f32_16x16x32_bf16 v[128:131], a[0:3], v[112:115], 0
    s_nop 0
    ds_read_b128 v[164:167], v39 offset:17408
    ds_read_b128 v[168:171], v39 offset:18432
    v_mfma_f32_16x16x32_bf16 v[132:135], a[4:7], v[112:115], 0
    s_nop 0
    ds_read_b128 v[172:175], v39 offset:19456
    ds_write_b128 v36, v[144:147] offset:0
    v_mfma_f32_16x16x32_bf16 v[136:139], a[8:11], v[112:115], 0
    buffer_load_dwordx4 a[124:127], v3, s[36:39], s75 offen offset:3072 sc1
    v_mfma_f32_16x16x32_bf16 v[140:143], a[12:15], v[112:115], 0
    s_waitcnt vmcnt(6)
    ds_write_b128 v36, v[148:151] offset:1024
    v_mfma_f32_16x16x32_bf16 v[128:131], a[16:19], v[116:119], v[128:131]
    v_mfma_f32_16x16x32_bf16 v[132:135], a[20:23], v[116:119], v[132:135]
    ds_write_b128 v36, v[152:155] offset:2048
    v_mfma_f32_16x16x32_bf16 v[136:139], a[24:27], v[116:119], v[136:139]
    s_add_u32 s75, s73, 0x4000
    buffer_load_dwordx4 a[128:131], v3, s[36:39], s75 offen sc1
    v_mfma_f32_16x16x32_bf16 v[140:143], a[28:31], v[116:119], v[140:143]
    s_waitcnt vmcnt(6)
    ds_write_b128 v36, v[156:159] offset:3072
    v_mfma_f32_16x16x32_bf16 v[128:131], a[32:35], v[120:123], v[128:131]
    s_add_u32 s6, s61, s48
    s_lshl_b32 s4, s6, 14
    s_lshl_b32 s5, s60, 11
    v_mfma_f32_16x16x32_bf16 v[132:135], a[36:39], v[120:123], v[132:135]
    s_add_u32 s4, s4, s5
    v_mfma_f32_16x16x32_bf16 v[136:139], a[40:43], v[120:123], v[136:139]
    s_add_u32 s4, s4, 0x0
    v_mfma_f32_16x16x32_bf16 v[140:143], a[44:47], v[120:123], v[140:143]
    s_waitcnt vmcnt(5)
    buffer_load_dwordx4 a[132:135], v3, s[36:39], s75 offen offset:1024 sc1
    v_mfma_f32_16x16x32_bf16 v[128:131], a[48:51], v[124:127], v[128:131]
    s_waitcnt lgkmcnt(0)
    s_barrier
    ds_read_b128 v[176:179], v39 offset:0
    v_mfma_f32_16x16x32_bf16 v[132:135], a[52:55], v[124:127], v[132:135]
    s_lshl_b32 s6, s6, 10
    ds_read_b128 v[180:183], v39 offset:1024
    ds_read_b128 v[184:187], v39 offset:2048
    v_mfma_f32_16x16x32_bf16 v[136:139], a[56:59], v[124:127], v[136:139]
    s_add_u32 s6, s6, 0x380000
    ds_read_b128 v[188:191], v39 offset:3072
    v_mfma_f32_16x16x32_bf16 v[140:143], a[60:63], v[124:127], v[140:143]
    v_pk_add_f32 v[48:49], v[48:49], v[192:193]
    v_pk_add_f32 v[50:51], v[50:51], v[194:195]
    v_pk_add_f32 v[52:53], v[52:53], v[196:197]
    v_pk_add_f32 v[54:55], v[54:55], v[198:199]
    v_pk_add_f32 v[56:57], v[56:57], v[200:201]
    v_pk_add_f32 v[58:59], v[58:59], v[202:203]
    v_pk_add_f32 v[60:61], v[60:61], v[204:205]
    v_pk_add_f32 v[62:63], v[62:63], v[206:207]
    v_pk_add_f32 v[48:49], v[48:49], v[160:161]
    v_pk_add_f32 v[50:51], v[50:51], v[162:163]
    v_pk_add_f32 v[52:53], v[52:53], v[164:165]
    v_pk_add_f32 v[54:55], v[54:55], v[166:167]
    v_pk_add_f32 v[56:57], v[56:57], v[168:169]
    v_pk_add_f32 v[58:59], v[58:59], v[170:171]
    v_pk_add_f32 v[60:61], v[60:61], v[172:173]
    v_pk_add_f32 v[62:63], v[62:63], v[174:175]
    v_pk_add_f32 v[48:49], v[48:49], v[128:129]
    v_pk_add_f32 v[50:51], v[50:51], v[130:131]
    v_pk_add_f32 v[52:53], v[52:53], v[132:133]
    v_pk_add_f32 v[54:55], v[54:55], v[134:135]
    v_pk_add_f32 v[56:57], v[56:57], v[136:137]
    v_pk_add_f32 v[58:59], v[58:59], v[138:139]
    v_pk_add_f32 v[60:61], v[60:61], v[140:141]
    v_pk_add_f32 v[62:63], v[62:63], v[142:143]
    s_waitcnt lgkmcnt(0)
    v_pk_add_f32 v[48:49], v[48:49], v[176:177]
    v_pk_add_f32 v[50:51], v[50:51], v[178:179]
    v_pk_add_f32 v[52:53], v[52:53], v[180:181]
    v_pk_add_f32 v[54:55], v[54:55], v[182:183]
    v_cvt_pk_bf16_f32 v208, v48, v49
    v_cvt_pk_bf16_f32 v209, v50, v51
    v_cvt_pk_bf16_f32 v210, v52, v53
    v_cvt_pk_bf16_f32 v211, v54, v55
    buffer_store_dwordx4 v[208:211], v3, s[40:43], s4 offen sc0 sc1
    v_pk_add_f32 v[56:57], v[56:57], v[184:185]
    v_pk_add_f32 v[58:59], v[58:59], v[186:187]
    v_pk_add_f32 v[60:61], v[60:61], v[188:189]
    v_pk_add_f32 v[62:63], v[62:63], v[190:191]
    v_cvt_pk_bf16_f32 v212, v56, v57
    v_cvt_pk_bf16_f32 v213, v58, v59
    v_cvt_pk_bf16_f32 v214, v60, v61
    v_cvt_pk_bf16_f32 v215, v62, v63
    buffer_store_dwordx4 v[212:215], v3, s[40:43], s4 offen offset:1024 sc0 sc1
    v_pk_add_f32 v[216:217], v[48:49], v[50:51]
    v_pk_mul_f32 v[218:219], v[48:49], v[48:49]
    v_pk_fma_f32 v[218:219], v[50:51], v[50:51], v[218:219]
    v_pk_add_f32 v[216:217], v[216:217], v[52:53]
    v_pk_fma_f32 v[218:219], v[52:53], v[52:53], v[218:219]
    v_pk_add_f32 v[216:217], v[216:217], v[54:55]
    v_pk_fma_f32 v[218:219], v[54:55], v[54:55], v[218:219]
    v_pk_add_f32 v[216:217], v[216:217], v[56:57]
    v_pk_fma_f32 v[218:219], v[56:57], v[56:57], v[218:219]
    v_pk_add_f32 v[216:217], v[216:217], v[58:59]
    v_pk_fma_f32 v[218:219], v[58:59], v[58:59], v[218:219]
    v_pk_add_f32 v[216:217], v[216:217], v[60:61]
    v_pk_fma_f32 v[218:219], v[60:61], v[60:61], v[218:219]
    v_pk_add_f32 v[216:217], v[216:217], v[62:63]
    v_pk_fma_f32 v[218:219], v[62:63], v[62:63], v[218:219]
    v_add_f32 v216, v216, v217
    v_add_f32 v217, v218, v219
    s_nop 1
    v_permlane32_swap_b32 v216, v217
    v_add_f32 v216, v216, v217
    v_mov_b32 v217, v216
    s_nop 1
    v_permlane16_swap_b32 v216, v217
    v_add_f32 v216, v216, v217
    s_mov_b32 exec_lo, 0xffff
    s_mov_b32 exec_hi, 0xffff
    buffer_store_dword v216, v30, s[36:39], s6 offen sc0 sc1
    s_mov_b64 exec, -1
    v_mov_b32 v4, 2
    s_cmp_lg_u32 s48, 0
    s_mov_b64 exec, 1
    s_waitcnt vmcnt(0)
    s_barrier
    s_cbranch_scc1 Lq_s_16
    buffer_store_dword v4, off, s[36:39], s55 sc0 sc1
Lq_s_16:
    s_mov_b64 exec, -1
    s_add_u32 m0, s71, 0x1e800
    s_add_u32 s75, s70, 0x2000
    buffer_load_dwordx4 v3, s[36:39], s75 offen sc1 lds
    s_add_u32 m0, s71, 0x1f000
    s_add_u32 s75, s70, 0xa000
    buffer_load_dwordx4 v3, s[36:39], s75 offen sc1 lds
    s_add_u32 m0, s71, 0x1f800
    s_add_u32 s75, s19, 0x12000
    buffer_load_dwordx4 v3, s[36:39], s75 offen sc1 lds
    s_lshl_b32 s12, s59, 14
    s_add_u32 s12, s12, 0x0
    s_lshl_b32 s11, s59, 10
    s_add_u32 s11, s11, 0x380000
    s_add_u32 s10, s61, s48
    s_lshl_b32 s10, s10, 10
    s_add_u32 s10, s10, 0x380000
    s_add_u32 s16, s12, 0x4000
    s_mul_i32 s20, s59, 43
    s_add_u32 s20, s20, s62
    s_lshl_b32 s20, s20, 10
    s_add_u32 s20, s20, 0x600000
    s_add_u32 s21, s20, 44032
    s_cmp_lt_u32 s50, 11
    s_cselect_b32 s22, s20, 0x80000000
    s_cselect_b32 s23, s21, 0x80000000
    v_add_u32 v240, 0x18800, v3
    s_lshl_b32 s4, s48, 10
    s_add_u32 s4, s4, 2048
    v_add_u32 v250, s4, v240
    v_add_u32 v251, s71, v240
    ds_read_b128 v[112:115], v240 offset:0
    ds_read_b128 v[116:119], v240 offset:1024
    ds_read_b128 v[120:123], v240 offset:2048
    ds_read_b128 v[124:127], v240 offset:3072
    ds_read_b128 v[128:131], v240 offset:4096
    ds_read_b128 v[132:135], v240 offset:5120
    s_cmp_lg_u32 s48, 1
    s_cbranch_scc1 Lnw_3_1_s
    s_mov_b64 exec, 0
    s_branch Lret_3_1_s
Lret_3_1_s:
    s_mov_b64 exec, -1
Lnw_3_1_s:
    s_cmp_lg_u32 s48, 2
    s_cbranch_scc1 Lnw_3_2_s
    s_mov_b64 exec, 0
    s_branch Lret_3_2_s
Lret_3_2_s:
    s_mov_b64 exec, -1
Lnw_3_2_s:
    s_cmp_lg_u32 s48, 0
    s_cbranch_scc1 Ln_s_14
    buffer_load_dword v4, v17, s[36:39], s58 offen sc1
    s_nop 15
Lp_s_15:
    buffer_load_dword v5, v17, s[36:39], s58 offen sc1
    s_waitcnt vmcnt(1)
    v_cmp_gt_u32 vcc, 2, v4
    s_cbranch_vccz Ln_s_14
    buffer_load_dword v4, v17, s[36:39], s58 offen sc1
    s_waitcnt vmcnt(1)
    v_cmp_gt_u32 vcc, 2, v5
    s_cbranch_vccz Ln_s_14
    s_sub_u32 s14, s14, 1
    s_cbranch_scc1 L_end_s
    s_branch Lp_s_15
Ln_s_14:
    s_barrier
    buffer_load_dwordx4 v[160:163], v3, s[40:43], s12 offen sc1
    buffer_load_dwordx4 v[164:167], v3, s[40:43], s16 offen sc1
    buffer_load_dwordx4 v[168:171], v3, s[40:43], s12 offen offset:1024 sc1
    buffer_load_dwordx4 v[172:175], v3, s[40:43], s16 offen offset:1024 sc1
    buffer_load_dwordx4 v[176:179], v3, s[40:43], s12 offen offset:2048 sc1
    buffer_load_dwordx4 v[180:183], v3, s[40:43], s16 offen offset:2048 sc1
    s_waitcnt vmcnt(4) lgkmcnt(3)
    v_mfma_f32_16x16x32_bf16 v[64:67], v[112:115], v[160:163], 0
    s_add_u32 m0, s71, 0x21800
    s_add_u32 s75, s70, 0x3000
    ds_read_b128 v[136:139], v240 offset:6144
    buffer_load_dwordx4 v3, s[36:39], s75 offen sc1 lds
    v_mfma_f32_16x16x32_bf16 v[88:91], v[112:115], v[164:167], 0
    ds_read_b128 a[240:243], v250 offset:0
    v_mfma_f32_16x16x32_bf16 v[68:71], v[116:119], v[160:163], 0
    ds_read_b128 v[140:143], v240 offset:7168
    buffer_load_dwordx4 v[184:187], v3, s[40:43], s12 offen offset:3072 sc1
    v_mfma_f32_16x16x32_bf16 v[92:95], v[116:119], v[164:167], 0
    s_add_u32 m0, s71, 0x22000
    v_mfma_f32_16x16x32_bf16 v[72:75], v[120:123], v[160:163], 0
    s_add_u32 s75, s70, 0xb000
    ds_read_b128 v[144:147], v240 offset:8192
    buffer_load_dwordx4 v3, s[36:39], s75 offen sc1 lds
    v_mfma_f32_16x16x32_bf16 v[96:99], v[120:123], v[164:167], 0
    s_waitcnt lgkmcnt(4)
    v_mfma_f32_16x16x32_bf16 v[76:79], v[124:127], v[160:163], 0
    ds_read_b128 v[148:151], v240 offset:9216
    buffer_load_dwordx4 v[188:191], v3, s[40:43], s16 offen offset:3072 sc1
    v_mfma_f32_16x16x32_bf16 v[100:103], v[124:127], v[164:167], 0
    s_add_u32 m0, s71, 0x22800
    v_mfma_f32_16x16x32_bf16 v[80:83], v[128:131], v[160:163], 0
    s_add_u32 s75, s19, 0x13000
    ds_read_b128 v[152:155], v240 offset:10240
    buffer_load_dwordx4 v3, s[36:39], s75 offen sc1 lds
    v_mfma_f32_16x16x32_bf16 v[104:107], v[128:131], v[164:167], 0
    s_waitcnt lgkmcnt(4)
    v_mfma_f32_16x16x32_bf16 v[242:245], a[240:243], v[22:25], 0
    buffer_load_dwordx4 v[224:227], v3, s[36:39], s11 offen sc1
    v_mfma_f32_16x16x32_bf16 v[84:87], v[132:135], v[160:163], 0
    s_add_u32 m0, s71, 0x24800
    ds_read_b128 v[156:159], v240 offset:11264
    v_mfma_f32_16x16x32_bf16 v[108:111], v[132:135], v[164:167], 0
    s_waitcnt vmcnt(8) lgkmcnt(3)
    v_mfma_f32_16x16x32_bf16 v[64:67], v[136:139], v[168:171], v[64:67]
    s_add_u32 s75, s70, 0x4000
    ds_read_b128 v[112:115], v240 offset:12288
    buffer_load_dwordx4 v3, s[36:39], s75 offen sc1 lds
    v_mfma_f32_16x16x32_bf16 v[88:91], v[136:139], v[172:175], v[88:91]
    ds_read_b128 a[244:247], v250 offset:6144
    v_mfma_f32_16x16x32_bf16 v[68:71], v[140:143], v[168:171], v[68:71]
    s_nop 0
    ds_read_b128 v[116:119], v240 offset:13312
    ds_read_b128 a[248:251], v251 offset:0
    v_mfma_f32_16x16x32_bf16 v[92:95], v[140:143], v[172:175], v[92:95]
    s_add_u32 s17, s12, 0x1000
    buffer_load_dwordx4 v[192:195], v3, s[40:43], s17 offen sc1
    v_mfma_f32_16x16x32_bf16 v[72:75], v[144:147], v[168:171], v[72:75]
    s_add_u32 m0, s71, 0x25000
    s_add_u32 s75, s70, 0xc000
    ds_read_b128 v[120:123], v240 offset:14336
    v_mfma_f32_16x16x32_bf16 v[96:99], v[144:147], v[172:175], v[96:99]
    s_waitcnt lgkmcnt(5)
    buffer_load_dwordx4 v3, s[36:39], s75 offen sc1 lds
    v_mfma_f32_16x16x32_bf16 v[76:79], v[148:151], v[168:171], v[76:79]
    ds_read_b128 v[124:127], v240 offset:15360
    v_mfma_f32_16x16x32_bf16 v[100:103], v[148:151], v[172:175], v[100:103]
    v_mfma_f32_16x16x32_bf16 v[80:83], v[152:155], v[168:171], v[80:83]
    s_add_u32 s18, s12, 0x5000
    ds_read_b128 v[128:131], v240 offset:16384
    buffer_load_dwordx4 v[196:199], v3, s[40:43], s18 offen sc1
    v_mfma_f32_16x16x32_bf16 v[104:107], v[152:155], v[172:175], v[104:107]
    s_waitcnt lgkmcnt(5)
    v_mfma_f32_16x16x32_bf16 v[242:245], a[244:247], v[22:25], v[242:245]
    s_waitcnt lgkmcnt(3)
    v_mfma_f32_16x16x32_bf16 v[246:249], a[248:251], v[22:25], 0
    buffer_load_dwordx4 v[228:231], v3, s[36:39], s11 offen offset:1024 sc1
    v_mfma_f32_16x16x32_bf16 v[84:87], v[156:159], v[168:171], v[84:87]
    s_add_u32 m0, s71, 0x25800
    ds_read_b128 v[132:135], v240 offset:17408
    v_mfma_f32_16x16x32_bf16 v[108:111], v[156:159], v[172:175], v[108:111]
    s_waitcnt vmcnt(11) lgkmcnt(3)
    v_mfma_f32_16x16x32_bf16 v[64:67], v[112:115], v[176:179], v[64:67]
    s_add_u32 s75, s19, 0x14000
    ds_read_b128 v[136:139], v240 offset:18432
    buffer_load_dwordx4 v3, s[36:39], s75 offen sc1 lds
    v_mfma_f32_16x16x32_bf16 v[88:91], v[112:115], v[180:183], v[88:91]
    ds_read_b128 a[252:255], v250 offset:12288
    v_mfma_f32_16x16x32_bf16 v[68:71], v[116:119], v[176:179], v[68:71]
    ds_read_b128 v[140:143], v240 offset:19456
    v_mfma_f32_16x16x32_bf16 v[92:95], v[116:119], v[180:183], v[92:95]
    v_mfma_f32_16x16x32_bf16 v[72:75], v[120:123], v[176:179], v[72:75]
    ds_read_b128 v[144:147], v240 offset:20480
    buffer_load_dwordx4 v[200:203], v3, s[40:43], s17 offen offset:1024 sc1
    v_mfma_f32_16x16x32_bf16 v[96:99], v[120:123], v[180:183], v[96:99]
    s_waitcnt lgkmcnt(4)
    v_mfma_f32_16x16x32_bf16 v[76:79], v[124:127], v[176:179], v[76:79]
    ds_read_b128 v[148:151], v240 offset:21504
    v_mfma_f32_16x16x32_bf16 v[100:103], v[124:127], v[180:183], v[100:103]
    v_mfma_f32_16x16x32_bf16 v[80:83], v[128:131], v[176:179], v[80:83]
    ds_read_b128 v[152:155], v240 offset:22528
    buffer_load_dwordx4 v[204:207], v3, s[40:43], s18 offen offset:1024 sc1
    v_mfma_f32_16x16x32_bf16 v[104:107], v[128:131], v[180:183], v[104:107]
    s_waitcnt lgkmcnt(4)
    v_mfma_f32_16x16x32_bf16 v[242:245], a[252:255], v[22:25], v[242:245]
    s_add_u32 m0, s71, 0x18800
    v_mfma_f32_16x16x32_bf16 v[84:87], v[132:135], v[176:179], v[84:87]
    s_add_u32 s75, s70, 0x5000
    ds_read_b128 v[156:159], v240 offset:23552
    v_mfma_f32_16x16x32_bf16 v[108:111], v[132:135], v[180:183], v[108:111]
    s_waitcnt vmcnt(10) lgkmcnt(3)
    v_mfma_f32_16x16x32_bf16 v[64:67], v[136:139], v[184:187], v[64:67]
    s_barrier
    ds_read_b128 v[112:115], v240 offset:24576
    buffer_load_dwordx4 v3, s[36:39], s75 offen sc1 lds
    v_mfma_f32_16x16x32_bf16 v[88:91], v[136:139], v[188:191], v[88:91]
    ds_read_b128 a[240:243], v250 offset:18432
    v_mfma_f32_16x16x32_bf16 v[68:71], v[140:143], v[184:187], v[68:71]
    s_nop 0
    ds_read_b128 v[116:119], v240 offset:25600
    ds_read_b128 a[244:247], v251 offset:12288
    v_mfma_f32_16x16x32_bf16 v[92:95], v[140:143], v[188:191], v[92:95]
    buffer_load_dwordx4 v[208:211], v3, s[40:43], s17 offen offset:2048 sc1
    v_mfma_f32_16x16x32_bf16 v[72:75], v[144:147], v[184:187], v[72:75]
    ds_read_b128 v[120:123], v240 offset:26624
    v_mfma_f32_16x16x32_bf16 v[96:99], v[144:147], v[188:191], v[96:99]
    s_waitcnt lgkmcnt(5)
    v_mfma_f32_16x16x32_bf16 v[76:79], v[148:151], v[184:187], v[76:79]
    s_add_u32 m0, s71, 0x19000
    ds_read_b128 v[124:127], v240 offset:27648
    v_mfma_f32_16x16x32_bf16 v[100:103], v[148:151], v[188:191], v[100:103]
    s_add_u32 s75, s70, 0xd000
    buffer_load_dwordx4 v3, s[36:39], s75 offen sc1 lds
    v_mfma_f32_16x16x32_bf16 v[80:83], v[152:155], v[184:187], v[80:83]
    ds_read_b128 v[128:131], v240 offset:28672
    v_mfma_f32_16x16x32_bf16 v[104:107], v[152:155], v[188:191], v[104:107]
    s_waitcnt lgkmcnt(5)
    v_mfma_f32_16x16x32_bf16 v[242:245], a[240:243], v[22:25], v[242:245]
    s_waitcnt lgkmcnt(3)
    buffer_load_dwordx4 v[212:215], v3, s[40:43], s18 offen offset:2048 sc1
    v_mfma_f32_16x16x32_bf16 v[246:249], a[244:247], v[22:25], v[246:249]
    s_add_u32 m0, s71, 0x19800
    v_mfma_f32_16x16x32_bf16 v[84:87], v[156:159], v[184:187], v[84:87]
    s_add_u32 s75, s19, 0x15000
    ds_read_b128 v[132:135], v240 offset:29696
    v_mfma_f32_16x16x32_bf16 v[108:111], v[156:159], v[188:191], v[108:111]
    s_waitcnt vmcnt(8) lgkmcnt(3)
    v_mfma_f32_16x16x32_bf16 v[64:67], v[112:115], v[192:195], v[64:67]
    s_waitcnt vmcnt(7)
    ds_read_b128 v[136:139], v240 offset:30720
    buffer_load_dwordx4 v3, s[36:39], s75 offen sc1 lds
    v_mfma_f32_16x16x32_bf16 v[88:91], v[112:115], v[196:199], v[88:91]
    s_nop 0
    ds_read_b128 a[248:251], v250 offset:24576
    v_add_f32 v224, v224, v226
    v_mfma_f32_16x16x32_bf16 v[68:71], v[116:119], v[192:195], v[68:71]
    s_nop 0
    ds_read_b128 v[140:143], v240 offset:31744
    v_add_f32 v228, v228, v230
    v_mfma_f32_16x16x32_bf16 v[92:95], v[116:119], v[196:199], v[92:95]
    v_add_f32 v225, v225, v227
    v_mfma_f32_16x16x32_bf16 v[72:75], v[120:123], v[192:195], v[72:75]
    ds_read_b128 v[144:147], v240 offset:32768
    buffer_load_dwordx4 v[216:219], v3, s[40:43], s17 offen offset:3072 sc1
    v_mfma_f32_16x16x32_bf16 v[96:99], v[120:123], v[196:199], v[96:99]
    s_waitcnt lgkmcnt(4)
    v_add_f32 v229, v229, v231
    v_mfma_f32_16x16x32_bf16 v[76:79], v[124:127], v[192:195], v[76:79]
    ds_read_b128 v[148:151], v240 offset:33792
    v_mfma_f32_16x16x32_bf16 v[100:103], v[124:127], v[196:199], v[100:103]
    v_permlane32_swap_b32 v224, v225
    v_mfma_f32_16x16x32_bf16 v[80:83], v[128:131], v[192:195], v[80:83]
    ds_read_b128 v[152:155], v240 offset:34816
    buffer_load_dwordx4 v[220:223], v3, s[40:43], s18 offen offset:3072 sc1
    v_mfma_f32_16x16x32_bf16 v[104:107], v[128:131], v[196:199], v[104:107]
    s_waitcnt lgkmcnt(4)
    v_permlane32_swap_b32 v228, v229
    v_mfma_f32_16x16x32_bf16 v[242:245], a[248:251], v[22:25], v[242:245]
    s_add_u32 m0, s71, 0x1b800
    v_add_f32 v224, v224, v225
    v_add_f32 v228, v228, v229
    v_mfma_f32_16x16x32_bf16 v[84:87], v[132:135], v[192:195], v[84:87]
    s_add_u32 s75, s70, 0x6000
    ds_read_b128 v[156:159], v240 offset:35840
    v_mov_b32 v225, v224
    v_mfma_f32_16x16x32_bf16 v[108:111], v[132:135], v[196:199], v[108:111]
    s_waitcnt vmcnt(7) lgkmcnt(3)
    v_mov_b32 v229, v228
    v_mfma_f32_16x16x32_bf16 v[64:67], v[136:139], v[200:203], v[64:67]
    s_barrier
    ds_read_b128 v[112:115], v240 offset:36864
    buffer_load_dwordx4 v3, s[36:39], s75 offen sc1 lds
    v_mfma_f32_16x16x32_bf16 v[88:91], v[136:139], v[204:207], v[88:91]
    ds_read_b128 a[252:255], v250 offset:30720
    v_mfma_f32_16x16x32_bf16 v[68:71], v[140:143], v[200:203], v[68:71]
    s_nop 0
    ds_read_b128 v[116:119], v240 offset:37888
    ds_read_b128 a[240:243], v251 offset:24576
    v_mfma_f32_16x16x32_bf16 v[92:95], v[140:143], v[204:207], v[92:95]
    s_add_u32 s16, s12, 0x2000
    buffer_load_dwordx4 v[160:163], v3, s[40:43], s16 offen sc1
    v_mfma_f32_16x16x32_bf16 v[72:75], v[144:147], v[200:203], v[72:75]
    ds_read_b128 v[120:123], v240 offset:38912
    v_mfma_f32_16x16x32_bf16 v[96:99], v[144:147], v[204:207], v[96:99]
    s_waitcnt lgkmcnt(5)
    v_permlane16_swap_b32 v224, v225
    v_mfma_f32_16x16x32_bf16 v[76:79], v[148:151], v[200:203], v[76:79]
    s_add_u32 m0, s71, 0x1c000
    ds_read_b128 v[124:127], v240 offset:39936
    v_mfma_f32_16x16x32_bf16 v[100:103], v[148:151], v[204:207], v[100:103]
    s_add_u32 s75, s70, 0xe000
    buffer_load_dwordx4 v3, s[36:39], s75 offen sc1 lds
    v_mfma_f32_16x16x32_bf16 v[80:83], v[152:155], v[200:203], v[80:83]
    s_add_u32 s17, s12, 0x6000
    ds_read_b128 v[128:131], v240 offset:40960
    v_mfma_f32_16x16x32_bf16 v[104:107], v[152:155], v[204:207], v[104:107]
    s_waitcnt lgkmcnt(5)
    v_permlane16_swap_b32 v228, v229
    v_mfma_f32_16x16x32_bf16 v[242:245], a[252:255], v[22:25], v[242:245]
    s_waitcnt lgkmcnt(3)
    buffer_load_dwordx4 v[164:167], v3, s[40:43], s17 offen sc1
    v_add_f32 v224, v224, v225
    v_mfma_f32_16x16x32_bf16 v[246:249], a[240:243], v[22:25], v[246:249]
    v_add_f32 v228, v228, v229
    v_mov_b32 v225, v224
    v_mfma_f32_16x16x32_bf16 v[84:87], v[156:159], v[200:203], v[84:87]
    s_add_u32 m0, s71, 0x1c800
    ds_read_b128 v[132:135], v240 offset:41984
    v_mov_b32 v229, v228
    v_mfma_f32_16x16x32_bf16 v[108:111], v[156:159], v[204:207], v[108:111]
    s_waitcnt vmcnt(7) lgkmcnt(3)
    v_permlane32_swap_b32 v224, v225
    v_permlane32_swap_b32 v228, v229
    v_mul_f32 v236, 0xbb000000, v224
    v_mul_f32 v238, 0xbb000000, v228
    v_mfma_f32_16x16x32_bf16 v[64:67], v[112:115], v[208:211], v[64:67]
    s_add_u32 s75, s19, 0x16000
    ds_read_b128 v[136:139], v240 offset:43008
    buffer_load_dwordx4 v3, s[36:39], s75 offen sc1 lds
    v_mfma_f32_16x16x32_bf16 v[88:91], v[112:115], v[212:215], v[88:91]
    ds_read_b128 a[244:247], v250 offset:36864
    v_mfma_f32_16x16x32_bf16 v[68:71], v[116:119], v[208:211], v[68:71]
    ds_read_b128 v[140:143], v240 offset:44032
    v_mfma_f32_16x16x32_bf16 v[92:95], v[116:119], v[212:215], v[92:95]
    v_mfma_f32_16x16x32_bf16 v[72:75], v[120:123], v[208:211], v[72:75]
    ds_read_b128 v[144:147], v240 offset:45056
    buffer_load_dwordx4 v[168:171], v3, s[40:43], s16 offen offset:1024 sc1
    v_mfma_f32_16x16x32_bf16 v[96:99], v[120:123], v[212:215], v[96:99]
    s_waitcnt lgkmcnt(4)
    v_mfma_f32_16x16x32_bf16 v[76:79], v[124:127], v[208:211], v[76:79]
    ds_read_b128 v[148:151], v240 offset:46080
    v_mfma_f32_16x16x32_bf16 v[100:103], v[124:127], v[212:215], v[100:103]
    v_mfma_f32_16x16x32_bf16 v[80:83], v[128:131], v[208:211], v[80:83]
    ds_read_b128 v[152:155], v240 offset:47104
    buffer_load_dwordx4 v[172:175], v3, s[40:43], s17 offen offset:1024 sc1
    v_mfma_f32_16x16x32_bf16 v[104:107], v[128:131], v[212:215], v[104:107]
    s_waitcnt lgkmcnt(4)
    v_mfma_f32_16x16x32_bf16 v[242:245], a[244:247], v[22:25], v[242:245]
    s_add_u32 m0, s71, 0x1e800
    v_mfma_f32_16x16x32_bf16 v[84:87], v[132:135], v[208:211], v[84:87]
    s_add_u32 s75, s70, 0x7000
    ds_read_b128 v[156:159], v240 offset:48128
    v_mfma_f32_16x16x32_bf16 v[108:111], v[132:135], v[212:215], v[108:111]
    s_waitcnt vmcnt(7) lgkmcnt(3)
    v_mfma_f32_16x16x32_bf16 v[64:67], v[136:139], v[216:219], v[64:67]
    s_barrier
    ds_read_b128 v[112:115], v240 offset:49152
    buffer_load_dwordx4 v3, s[36:39], s75 offen sc1 lds
    v_mfma_f32_16x16x32_bf16 v[88:91], v[136:139], v[220:223], v[88:91]
    ds_read_b128 a[248:251], v250 offset:43008
    v_mfma_f32_16x16x32_bf16 v[68:71], v[140:143], v[216:219], v[68:71]
    s_nop 0
    ds_read_b128 v[116:119], v240 offset:50176
    ds_read_b128 a[252:255], v251 offset:36864
    v_mfma_f32_16x16x32_bf16 v[92:95], v[140:143], v[220:223], v[92:95]
    s_add_u32 m0, s71, 0x1f000
    buffer_load_dwordx4 v[176:179], v3, s[40:43], s16 offen offset:2048 sc1
    v_mfma_f32_16x16x32_bf16 v[72:75], v[144:147], v[216:219], v[72:75]
    s_add_u32 s75, s70, 0xf000
    ds_read_b128 v[120:123], v240 offset:51200
    v_mfma_f32_16x16x32_bf16 v[96:99], v[144:147], v[220:223], v[96:99]
    s_waitcnt lgkmcnt(5)
    buffer_load_dwordx4 v3, s[36:39], s75 offen sc1 lds
    v_mfma_f32_16x16x32_bf16 v[76:79], v[148:151], v[216:219], v[76:79]
    ds_read_b128 v[124:127], v240 offset:52224
    v_mfma_f32_16x16x32_bf16 v[100:103], v[148:151], v[220:223], v[100:103]
    v_mfma_f32_16x16x32_bf16 v[80:83], v[152:155], v[216:219], v[80:83]
    s_add_u32 m0, s71, 0x1f800
    ds_read_b128 v[128:131], v240 offset:53248
    buffer_load_dwordx4 v[180:183], v3, s[40:43], s17 offen offset:2048 sc1
    v_mfma_f32_16x16x32_bf16 v[104:107], v[152:155], v[220:223], v[104:107]
    s_waitcnt lgkmcnt(5)
    v_mfma_f32_16x16x32_bf16 v[242:245], a[248:251], v[22:25], v[242:245]
    s_waitcnt lgkmcnt(3)
    v_mfma_f32_16x16x32_bf16 v[246:249], a[252:255], v[22:25], v[246:249]
    s_add_u32 s75, s19, 0x17000
    buffer_load_dwordx4 v3, s[36:39], s75 offen sc1 lds
    v_mfma_f32_16x16x32_bf16 v[84:87], v[156:159], v[216:219], v[84:87]
    ds_read_b128 v[132:135], v240 offset:54272
    v_mfma_f32_16x16x32_bf16 v[108:111], v[156:159], v[220:223], v[108:111]
    s_waitcnt vmcnt(8) lgkmcnt(3)
    v_mfma_f32_16x16x32_bf16 v[64:67], v[112:115], v[160:163], v[64:67]
    ds_read_b128 v[136:139], v240 offset:55296
    buffer_load_dwordx4 v[184:187], v3, s[40:43], s16 offen offset:3072 sc1
    v_mfma_f32_16x16x32_bf16 v[88:91], v[112:115], v[164:167], v[88:91]
    ds_read_b128 a[240:243], v250 offset:49152
    v_mfma_f32_16x16x32_bf16 v[68:71], v[116:119], v[160:163], v[68:71]
    ds_read_b128 v[140:143], v240 offset:56320
    buffer_load_dwordx4 v[188:191], v3, s[40:43], s17 offen offset:3072 sc1
    v_mfma_f32_16x16x32_bf16 v[92:95], v[116:119], v[164:167], v[92:95]
    v_mfma_f32_16x16x32_bf16 v[72:75], v[120:123], v[160:163], v[72:75]
    s_add_u32 s18, s12, 0x3000
    ds_read_b128 v[144:147], v240 offset:57344
    v_mfma_f32_16x16x32_bf16 v[96:99], v[120:123], v[164:167], v[96:99]
    s_waitcnt lgkmcnt(4)
    buffer_load_dwordx4 v[192:195], v3, s[40:43], s18 offen sc1
    v_mfma_f32_16x16x32_bf16 v[76:79], v[124:127], v[160:163], v[76:79]
    ds_read_b128 v[148:151], v240 offset:58368
    v_mfma_f32_16x16x32_bf16 v[100:103], v[124:127], v[164:167], v[100:103]
    s_add_u32 s16, s12, 0x7000
    buffer_load_dwordx4 v[196:199], v3, s[40:43], s16 offen sc1
    v_mfma_f32_16x16x32_bf16 v[80:83], v[128:131], v[160:163], v[80:83]
    ds_read_b128 v[152:155], v240 offset:59392
    v_mfma_f32_16x16x32_bf16 v[104:107], v[128:131], v[164:167], v[104:107]
    s_waitcnt lgkmcnt(4)
    v_mfma_f32_16x16x32_bf16 v[242:245], a[240:243], v[22:25], v[242:245]
    buffer_load_dwordx4 v[200:203], v3, s[40:43], s18 offen offset:1024 sc1
    v_mfma_f32_16x16x32_bf16 v[84:87], v[132:135], v[160:163], v[84:87]
    ds_read_b128 v[156:159], v240 offset:60416
    v_mfma_f32_16x16x32_bf16 v[108:111], v[132:135], v[164:167], v[108:111]
    s_waitcnt vmcnt(10) lgkmcnt(3)
    v_mfma_f32_16x16x32_bf16 v[64:67], v[136:139], v[168:171], v[64:67]
    s_barrier
    ds_read_b128 v[112:115], v240 offset:2048
    buffer_load_dwordx4 v[204:207], v3, s[40:43], s16 offen offset:1024 sc1
    v_mfma_f32_16x16x32_bf16 v[88:91], v[136:139], v[172:175], v[88:91]
    ds_read_b128 a[244:247], v250 offset:55296
    v_mfma_f32_16x16x32_bf16 v[68:71], v[140:143], v[168:171], v[68:71]
    s_nop 0
    ds_read_b128 v[116:119], v240 offset:3072
    ds_read_b128 a[248:251], v251 offset:49152
    v_mfma_f32_16x16x32_bf16 v[92:95], v[140:143], v[172:175], v[92:95]
    buffer_load_dwordx4 v[208:211], v3, s[40:43], s18 offen offset:2048 sc1
    v_mfma_f32_16x16x32_bf16 v[72:75], v[144:147], v[168:171], v[72:75]
    ds_read_b128 v[120:123], v240 offset:8192
    v_mfma_f32_16x16x32_bf16 v[96:99], v[144:147], v[172:175], v[96:99]
    s_waitcnt lgkmcnt(5)
    buffer_load_dwordx4 v[212:215], v3, s[40:43], s16 offen offset:2048 sc1
    v_mfma_f32_16x16x32_bf16 v[76:79], v[148:151], v[168:171], v[76:79]
    ds_read_b128 v[124:127], v240 offset:9216
    v_mfma_f32_16x16x32_bf16 v[100:103], v[148:151], v[172:175], v[100:103]
    v_mfma_f32_16x16x32_bf16 v[80:83], v[152:155], v[168:171], v[80:83]
    ds_read_b128 v[128:131], v240 offset:14336
    buffer_load_dwordx4 v[216:219], v3, s[40:43], s18 offen offset:3072 sc1
    v_mfma_f32_16x16x32_bf16 v[104:107], v[152:155], v[172:175], v[104:107]
    s_waitcnt lgkmcnt(5)
    ds_read_b128 a[252:255], v250 offset:0
    v_mfma_f32_16x16x32_bf16 v[242:245], a[244:247], v[22:25], v[242:245]
    s_waitcnt lgkmcnt(4)
    v_mfma_f32_16x16x32_bf16 v[246:249], a[248:251], v[22:25], v[246:249]
    buffer_load_dwordx4 v[220:223], v3, s[40:43], s16 offen offset:3072 sc1
    v_mfma_f32_16x16x32_bf16 v[84:87], v[156:159], v[168:171], v[84:87]
    s_nop 0
    ds_read_b128 v[132:135], v240 offset:15360
    ds_read_b128 a[240:243], v250 offset:6144
    v_mfma_f32_16x16x32_bf16 v[108:111], v[156:159], v[172:175], v[108:111]
    s_waitcnt vmcnt(11) lgkmcnt(5)
    v_mfma_f32_16x16x32_bf16 v[72:75], v[112:115], v[176:179], v[72:75]
    s_waitcnt vmcnt(10)
    s_barrier
    ds_read_b128 v[136:139], v240 offset:20480
    buffer_load_dwordx4 v[232:235], v3, s[36:39], s10 offen sc1
    v_mfma_f32_16x16x32_bf16 v[96:99], v[112:115], v[180:183], v[96:99]
    ds_read_b128 a[244:247], v251 offset:0
    v_mfma_f32_16x16x32_bf16 v[76:79], v[116:119], v[176:179], v[76:79]
    ds_read_b128 v[140:143], v240 offset:21504
    v_mfma_f32_16x16x32_bf16 v[100:103], v[116:119], v[180:183], v[100:103]
    s_waitcnt lgkmcnt(5)
    s_getpc_b64 s[6:7]
    global_load_dword v7, v47, s[6:7]
    v_mfma_f32_16x16x32_bf16 v[242:245], a[252:255], v[22:25], v[242:245]
    s_waitcnt vmcnt(10)
    ds_read_b128 a[248:251], v250 offset:12288
    v_mfma_f32_16x16x32_bf16 v[72:75], v[120:123], v[184:187], v[72:75]
    s_add_u32 s75, s73, 0x4000
    ds_read_b128 v[144:147], v240 offset:26624
    v_mfma_f32_16x16x32_bf16 v[96:99], v[120:123], v[188:191], v[96:99]
    s_waitcnt lgkmcnt(5)
    buffer_load_dwordx4 a[136:139], v3, s[36:39], s75 offen offset:2048 sc1
    v_mfma_f32_16x16x32_bf16 v[242:245], a[240:243], v[22:25], v[242:245]
    ds_read_b128 a[252:255], v250 offset:18432
    v_mfma_f32_16x16x32_bf16 v[76:79], v[124:127], v[184:187], v[76:79]
    ds_read_b128 v[148:151], v240 offset:27648
    v_mfma_f32_16x16x32_bf16 v[100:103], v[124:127], v[188:191], v[100:103]
    s_waitcnt lgkmcnt(5)
    v_mfma_f32_16x16x32_bf16 v[246:249], a[244:247], v[22:25], v[246:249]
    s_waitcnt vmcnt(9)
    ds_read_b128 a[240:243], v251 offset:12288
    buffer_load_dwordx4 a[140:143], v3, s[36:39], s75 offen offset:3072 sc1
    v_mfma_f32_16x16x32_bf16 v[72:75], v[128:131], v[192:195], v[72:75]
    ds_read_b128 v[152:155], v240 offset:32768
    v_mfma_f32_16x16x32_bf16 v[96:99], v[128:131], v[196:199], v[96:99]
    s_waitcnt lgkmcnt(5)
    v_mfma_f32_16x16x32_bf16 v[242:245], a[248:251], v[22:25], v[242:245]
    s_add_u32 s75, s73, 0x5000
    ds_read_b128 a[244:247], v250 offset:24576
    buffer_load_dwordx4 a[144:147], v3, s[36:39], s75 offen sc1
    v_mfma_f32_16x16x32_bf16 v[76:79], v[132:135], v[192:195], v[76:79]
    ds_read_b128 v[156:159], v240 offset:33792
    v_mfma_f32_16x16x32_bf16 v[100:103], v[132:135], v[196:199], v[100:103]
    s_waitcnt lgkmcnt(5)
    v_mfma_f32_16x16x32_bf16 v[242:245], a[252:255], v[22:25], v[242:245]
    s_waitcnt vmcnt(9)
    ds_read_b128 a[248:251], v250 offset:30720
    v_mfma_f32_16x16x32_bf16 v[72:75], v[136:139], v[200:203], v[72:75]
    ds_read_b128 v[112:115], v240 offset:4096
    buffer_load_dwordx4 a[148:151], v3, s[36:39], s75 offen offset:1024 sc1
    v_mfma_f32_16x16x32_bf16 v[96:99], v[136:139], v[204:207], v[96:99]
    s_waitcnt lgkmcnt(5)
    v_mfma_f32_16x16x32_bf16 v[246:249], a[240:243], v[22:25], v[246:249]
    ds_read_b128 a[252:255], v251 offset:24576
    v_mfma_f32_16x16x32_bf16 v[76:79], v[140:143], v[200:203], v[76:79]
    ds_read_b128 v[116:119], v240 offset:5120
    v_mfma_f32_16x16x32_bf16 v[100:103], v[140:143], v[204:207], v[100:103]
    s_waitcnt lgkmcnt(5)
    v_mfma_f32_16x16x32_bf16 v[242:245], a[244:247], v[22:25], v[242:245]
    s_waitcnt vmcnt(8)
    buffer_load_dwordx4 a[152:155], v3, s[36:39], s75 offen offset:2048 sc1
    v_mfma_f32_16x16x32_bf16 v[72:75], v[144:147], v[208:211], v[72:75]
    ds_read_b128 v[120:123], v240 offset:10240
    v_mfma_f32_16x16x32_bf16 v[96:99], v[144:147], v[212:215], v[96:99]
    s_waitcnt lgkmcnt(4)
    v_mfma_f32_16x16x32_bf16 v[242:245], a[248:251], v[22:25], v[242:245]
    v_mfma_f32_16x16x32_bf16 v[76:79], v[148:151], v[208:211], v[76:79]
    ds_read_b128 v[124:127], v240 offset:11264
    v_mfma_f32_16x16x32_bf16 v[100:103], v[148:151], v[212:215], v[100:103]
    s_waitcnt lgkmcnt(3)
    buffer_load_dwordx4 a[156:159], v3, s[36:39], s75 offen offset:3072 sc1
    v_mfma_f32_16x16x32_bf16 v[246:249], a[252:255], v[22:25], v[246:249]
    s_waitcnt vmcnt(8)
    v_mfma_f32_16x16x32_bf16 v[72:75], v[152:155], v[216:219], v[72:75]
    ds_read_b128 v[128:131], v240 offset:16384
    v_mfma_f32_16x16x32_bf16 v[96:99], v[152:155], v[220:223], v[96:99]
    v_mfma_f32_16x16x32_bf16 v[76:79], v[156:159], v[216:219], v[76:79]
    ds_read_b128 v[132:135], v240 offset:17408
    v_mfma_f32_16x16x32_bf16 v[100:103], v[156:159], v[220:223], v[100:103]
    s_waitcnt lgkmcnt(3)
    s_mov_b32 exec_lo, 0x00010001
    s_mov_b32 exec_hi, 0x00010001
    ds_write_b128 v45, v[242:245] offset:512
    ds_write_b128 v46, v[246:249] offset:512
    s_mov_b64 exec, -1
    v_mfma_f32_16x16x32_bf16 v[80:83], v[112:115], v[176:179], v[80:83]
    s_add_u32 s75, s73, 0x6000
    ds_read_b128 v[136:139], v240 offset:22528
    buffer_load_dwordx4 a[160:163], v3, s[36:39], s75 offen sc1
    v_mfma_f32_16x16x32_bf16 v[104:107], v[112:115], v[180:183], v[104:107]
    v_mfma_f32_16x16x32_bf16 v[84:87], v[116:119], v[176:179], v[84:87]
    s_waitcnt lgkmcnt(1)
    s_barrier
    ds_read_b128 v[140:143], v240 offset:23552
    ds_read_b128 v[160:163], v35 offset:640
    v_mfma_f32_16x16x32_bf16 v[108:111], v[116:119], v[180:183], v[108:111]
    ds_read_b128 v[164:167], v35 offset:704
    v_mfma_f32_16x16x32_bf16 v[80:83], v[120:123], v[184:187], v[80:83]
    ds_read_b128 v[144:147], v240 offset:28672
    buffer_load_dwordx4 a[164:167], v3, s[36:39], s75 offen offset:1024 sc1
    v_mfma_f32_16x16x32_bf16 v[104:107], v[120:123], v[188:191], v[104:107]
    ds_read_b128 v[168:171], v35 offset:768
    ds_read_b128 v[172:175], v35 offset:832
    v_mfma_f32_16x16x32_bf16 v[84:87], v[124:127], v[184:187], v[84:87]
    ds_read_b128 v[148:151], v240 offset:29696
    v_mfma_f32_16x16x32_bf16 v[108:111], v[124:127], v[188:191], v[108:111]
    v_mfma_f32_16x16x32_bf16 v[80:83], v[128:131], v[192:195], v[80:83]
    ds_read_b128 v[152:155], v240 offset:34816
    buffer_load_dwordx4 a[168:171], v3, s[36:39], s75 offen offset:2048 sc1
    v_mfma_f32_16x16x32_bf16 v[104:107], v[128:131], v[196:199], v[104:107]
    s_waitcnt lgkmcnt(2)
    v_fmac_f32 v72, v160, v236
    v_fmac_f32 v73, v161, v236
    v_mfma_f32_16x16x32_bf16 v[84:87], v[132:135], v[192:195], v[84:87]
    s_nop 0
    ds_read_b128 v[156:159], v240 offset:35840
    v_fmac_f32 v74, v162, v236
    v_mfma_f32_16x16x32_bf16 v[108:111], v[132:135], v[196:199], v[108:111]
    v_fmac_f32 v75, v163, v236
    v_fmac_f32 v76, v164, v236
    v_mfma_f32_16x16x32_bf16 v[80:83], v[136:139], v[200:203], v[80:83]
    ds_read_b128 v[112:115], v240 offset:0
    buffer_load_dwordx4 a[172:175], v3, s[36:39], s75 offen offset:3072 sc1
    v_mfma_f32_16x16x32_bf16 v[104:107], v[136:139], v[204:207], v[104:107]
    v_fmac_f32 v77, v165, v236
    v_fmac_f32 v78, v166, v236
    v_mfma_f32_16x16x32_bf16 v[84:87], v[140:143], v[200:203], v[84:87]
    s_nop 0
    ds_read_b128 v[116:119], v240 offset:1024
    v_fmac_f32 v79, v167, v236
    v_mfma_f32_16x16x32_bf16 v[108:111], v[140:143], v[204:207], v[108:111]
    v_cvt_pk_bf16_f32 v72, v72, v73
    v_cvt_pk_bf16_f32 v73, v74, v75
    v_mfma_f32_16x16x32_bf16 v[80:83], v[144:147], v[208:211], v[80:83]
    s_add_u32 s75, s73, 0x7000
    ds_read_b128 v[120:123], v240 offset:6144
    buffer_load_dwordx4 a[176:179], v3, s[36:39], s75 offen sc1
    v_mfma_f32_16x16x32_bf16 v[104:107], v[144:147], v[212:215], v[104:107]
    s_waitcnt lgkmcnt(3)
    v_cvt_pk_bf16_f32 v74, v76, v77
    v_cvt_pk_bf16_f32 v75, v78, v79
    v_mfma_f32_16x16x32_bf16 v[84:87], v[148:151], v[208:211], v[84:87]
    s_nop 0
    ds_read_b128 v[124:127], v240 offset:7168
    v_pk_max_i16 v72, v72, 0
    v_mfma_f32_16x16x32_bf16 v[108:111], v[148:151], v[212:215], v[108:111]
    v_pk_max_i16 v73, v73, 0
    v_pk_max_i16 v74, v74, 0
    v_mfma_f32_16x16x32_bf16 v[80:83], v[152:155], v[216:219], v[80:83]
    ds_read_b128 v[128:131], v240 offset:12288
    buffer_load_dwordx4 a[180:183], v3, s[36:39], s75 offen offset:1024 sc1
    v_mfma_f32_16x16x32_bf16 v[104:107], v[152:155], v[220:223], v[104:107]
    v_pk_max_i16 v75, v75, 0
    buffer_store_dwordx4 v[72:75], v3, s[36:39], s20 offen offset:1024 sc0 sc1
    v_mfma_f32_16x16x32_bf16 v[84:87], v[156:159], v[216:219], v[84:87]
    s_nop 0
    ds_read_b128 v[132:135], v240 offset:13312
    v_fmac_f32 v96, v160, v238
    v_mfma_f32_16x16x32_bf16 v[108:111], v[156:159], v[220:223], v[108:111]
    s_waitcnt lgkmcnt(3)
    v_fmac_f32 v97, v161, v238
    v_fmac_f32 v98, v162, v238
    v_mfma_f32_16x16x32_bf16 v[64:67], v[112:115], v[176:179], v[64:67]
    ds_read_b128 v[136:139], v240 offset:18432
    buffer_load_dwordx4 a[184:187], v3, s[36:39], s75 offen offset:2048 sc1
    v_mfma_f32_16x16x32_bf16 v[88:91], v[112:115], v[180:183], v[88:91]
    v_fmac_f32 v99, v163, v238
    v_fmac_f32 v100, v164, v238
    v_mfma_f32_16x16x32_bf16 v[68:71], v[116:119], v[176:179], v[68:71]
    ds_read_b128 v[140:143], v240 offset:19456
    v_fmac_f32 v101, v165, v238
    v_fmac_f32 v102, v166, v238
    v_fmac_f32 v103, v167, v238
    v_cvt_pk_bf16_f32 v96, v96, v97
    v_cvt_pk_bf16_f32 v97, v98, v99
    v_cvt_pk_bf16_f32 v98, v100, v101
    v_cvt_pk_bf16_f32 v99, v102, v103
    v_pk_max_i16 v96, v96, 0
    v_pk_max_i16 v97, v97, 0
    v_pk_max_i16 v98, v98, 0
    v_pk_max_i16 v99, v99, 0
    buffer_store_dwordx4 v[96:99], v3, s[36:39], s21 offen offset:1024 sc0 sc1
    v_mfma_f32_16x16x32_bf16 v[92:95], v[116:119], v[180:183], v[92:95]
    v_mfma_f32_16x16x32_bf16 v[64:67], v[120:123], v[184:187], v[64:67]
    ds_read_b128 v[144:147], v240 offset:24576
    buffer_load_dwordx4 a[188:191], v3, s[36:39], s75 offen offset:3072 sc1
    v_mfma_f32_16x16x32_bf16 v[88:91], v[120:123], v[188:191], v[88:91]
    s_waitcnt lgkmcnt(3)
    v_fmac_f32 v80, v168, v236
    v_fmac_f32 v81, v169, v236
    v_mfma_f32_16x16x32_bf16 v[68:71], v[124:127], v[184:187], v[68:71]
    s_nop 0
    ds_read_b128 v[148:151], v240 offset:25600
    v_fmac_f32 v82, v170, v236
    v_mfma_f32_16x16x32_bf16 v[92:95], v[124:127], v[188:191], v[92:95]
    v_fmac_f32 v83, v171, v236
    v_fmac_f32 v84, v172, v236
    v_mfma_f32_16x16x32_bf16 v[64:67], v[128:131], v[192:195], v[64:67]
    s_add_u32 s75, s73, 0x8000
    ds_read_b128 v[152:155], v240 offset:30720
    buffer_load_dwordx4 a[192:195], v3, s[36:39], s75 offen sc1
    v_mfma_f32_16x16x32_bf16 v[88:91], v[128:131], v[196:199], v[88:91]
    v_fmac_f32 v85, v173, v236
    v_fmac_f32 v86, v174, v236
    v_mfma_f32_16x16x32_bf16 v[68:71], v[132:135], v[192:195], v[68:71]
    s_nop 0
    ds_read_b128 v[156:159], v240 offset:31744
    v_fmac_f32 v87, v175, v236
    v_mfma_f32_16x16x32_bf16 v[92:95], v[132:135], v[196:199], v[92:95]
    s_waitcnt lgkmcnt(3)
    v_cvt_pk_bf16_f32 v80, v80, v81
    v_cvt_pk_bf16_f32 v81, v82, v83
    v_mfma_f32_16x16x32_bf16 v[64:67], v[136:139], v[200:203], v[64:67]
    ds_read_b128 v[160:163], v35 offset:512
    v_cvt_pk_bf16_f32 v82, v84, v85
    v_cvt_pk_bf16_f32 v83, v86, v87
    v_mfma_f32_16x16x32_bf16 v[88:91], v[136:139], v[204:207], v[88:91]
    ds_read_b128 v[164:167], v35 offset:576
    v_pk_max_i16 v80, v80, 0
    v_pk_max_i16 v81, v81, 0
    v_mfma_f32_16x16x32_bf16 v[68:71], v[140:143], v[200:203], v[68:71]
    ds_read_b128 v[242:245], v35 offset:896
    v_pk_max_i16 v82, v82, 0
    v_pk_max_i16 v83, v83, 0
    v_mfma_f32_16x16x32_bf16 v[92:95], v[140:143], v[204:207], v[92:95]
    ds_read_b128 v[246:249], v35 offset:960
    buffer_store_dwordx4 v[80:83], v3, s[36:39], s22 offen offset:2048 sc0 sc1
    v_fmac_f32 v104, v168, v238
    v_mfma_f32_16x16x32_bf16 v[64:67], v[144:147], v[208:211], v[64:67]
    v_fmac_f32 v105, v169, v238
    v_fmac_f32 v106, v170, v238
    v_mfma_f32_16x16x32_bf16 v[88:91], v[144:147], v[212:215], v[88:91]
    s_waitcnt lgkmcnt(4)
    v_fmac_f32 v107, v171, v238
    v_fmac_f32 v108, v172, v238
    v_mfma_f32_16x16x32_bf16 v[68:71], v[148:151], v[208:211], v[68:71]
    v_fmac_f32 v109, v173, v238
    v_fmac_f32 v110, v174, v238
    v_mfma_f32_16x16x32_bf16 v[92:95], v[148:151], v[212:215], v[92:95]
    v_fmac_f32 v111, v175, v238
    v_cvt_pk_bf16_f32 v104, v104, v105
    v_mfma_f32_16x16x32_bf16 v[64:67], v[152:155], v[216:219], v[64:67]
    v_cvt_pk_bf16_f32 v105, v106, v107
    v_cvt_pk_bf16_f32 v106, v108, v109
    v_mfma_f32_16x16x32_bf16 v[88:91], v[152:155], v[220:223], v[88:91]
    v_cvt_pk_bf16_f32 v107, v110, v111
    v_pk_max_i16 v104, v104, 0
    v_mfma_f32_16x16x32_bf16 v[68:71], v[156:159], v[216:219], v[68:71]
    v_pk_max_i16 v105, v105, 0
    v_pk_max_i16 v106, v106, 0
    v_mfma_f32_16x16x32_bf16 v[92:95], v[156:159], v[220:223], v[92:95]
    v_pk_max_i16 v107, v107, 0
    buffer_store_dwordx4 v[104:107], v3, s[36:39], s23 offen offset:2048 sc0 sc1
    s_waitcnt lgkmcnt(0)
    v_pk_add_f32 v[160:161], v[160:161], v[242:243]
    v_pk_add_f32 v[162:163], v[162:163], v[244:245]
    v_pk_add_f32 v[164:165], v[164:165], v[246:247]
    v_pk_add_f32 v[166:167], v[166:167], v[248:249]
    v_pk_fma_f32 v[64:65], v[160:161], v[236:237], v[64:65] op_sel:[0,0,0] op_sel_hi:[1,0,1]
    v_pk_fma_f32 v[68:69], v[164:165], v[236:237], v[68:69] op_sel:[0,0,0] op_sel_hi:[1,0,1]
    v_pk_fma_f32 v[66:67], v[162:163], v[236:237], v[66:67] op_sel:[0,0,0] op_sel_hi:[1,0,1]
    v_pk_fma_f32 v[70:71], v[166:167], v[236:237], v[70:71] op_sel:[0,0,0] op_sel_hi:[1,0,1]
    v_cvt_pk_bf16_f32 v64, v64, v65
    v_cvt_pk_bf16_f32 v68, v68, v69
    v_cvt_pk_bf16_f32 v65, v66, v67
    v_cvt_pk_bf16_f32 v69, v70, v71
    v_pk_max_i16 v64, v64, 0
    v_pk_max_i16 v65, v65, 0
    v_pk_max_i16 v66, v68, 0
    v_pk_max_i16 v67, v69, 0
    v_pk_fma_f32 v[88:89], v[160:161], v[238:239], v[88:89] op_sel:[0,0,0] op_sel_hi:[1,0,1]
    v_pk_fma_f32 v[92:93], v[164:165], v[238:239], v[92:93] op_sel:[0,0,0] op_sel_hi:[1,0,1]
    v_pk_fma_f32 v[90:91], v[162:163], v[238:239], v[90:91] op_sel:[0,0,0] op_sel_hi:[1,0,1]
    v_pk_fma_f32 v[94:95], v[166:167], v[238:239], v[94:95] op_sel:[0,0,0] op_sel_hi:[1,0,1]
    v_cvt_pk_bf16_f32 v88, v88, v89
    v_cvt_pk_bf16_f32 v92, v92, v93
    v_cvt_pk_bf16_f32 v89, v90, v91
    v_cvt_pk_bf16_f32 v93, v94, v95
    v_pk_max_i16 v88, v88, 0
    v_pk_max_i16 v89, v89, 0
    v_pk_max_i16 v90, v92, 0
    v_pk_max_i16 v91, v93, 0
    buffer_store_dwordx4 v[64:67], v3, s[36:39], s20 offen sc0 sc1
    buffer_store_dwordx4 v[88:91], v3, s[36:39], s21 offen sc0 sc1
    buffer_load_dwordx4 a[196:199], v3, s[36:39], s75 offen offset:1024 sc1
    buffer_load_dwordx4 a[200:203], v3, s[36:39], s75 offen offset:2048 sc1
    buffer_load_dwordx4 a[204:207], v3, s[36:39], s75 offen offset:3072 sc1
    s_add_u32 s75, s73, 0x9000
    buffer_load_dwordx4 a[208:211], v3, s[36:39], s75 offen sc1
    buffer_load_dwordx4 a[212:215], v3, s[36:39], s75 offen offset:1024 sc1
    buffer_load_dwordx4 a[216:219], v3, s[36:39], s75 offen offset:2048 sc1
    buffer_load_dwordx4 a[220:223], v3, s[36:39], s75 offen offset:3072 sc1
    buffer_load_dwordx4 a[224:227], v3, s[36:39], s74 offen sc1
    v_mov_b32 v4, 3
    s_cmp_lg_u32 s48, 0
    s_mov_b64 exec, 1
    s_waitcnt vmcnt(8)
    s_barrier
    s_cbranch_scc1 Lq_s_19
    buffer_store_dword v4, off, s[36:39], s55 sc0 sc1
Lq_s_19:
    s_mov_b64 exec, -1
    buffer_load_dwordx4 a[228:231], v3, s[36:39], s74 offen offset:1024 sc1
    buffer_load_dwordx4 a[232:235], v3, s[36:39], s74 offen offset:2048 sc1
    buffer_load_dwordx4 a[236:239], v3, s[36:39], s74 offen offset:3072 sc1
    s_mov_b32 exec_lo, 0x00010001
    s_mov_b32 exec_hi, 0x00010001
    ds_write_b128 v35, v[160:163] offset:512
    ds_write_b128 v35, v[164:167] offset:576
    s_mov_b64 exec, -1
    v_add_f32 v232, v232, v234
    v_add_f32 v233, v233, v235
    s_nop 1
    v_permlane32_swap_b32 v232, v233
    v_add_f32 v232, v232, v233
    v_mov_b32 v233, v232
    s_nop 1
    v_permlane16_swap_b32 v232, v233
    v_add_f32 v232, v232, v233
    v_mov_b32 v233, v232
    s_nop 1
    v_permlane32_swap_b32 v232, v233
    v_mul_f32 v42, 0xbb000000, v232
    v_mul_f32 v233, 0x3b000000, v233
    v_fma_f32 v233, -v42, v42, v233
    v_max_f32 v233, 0, v233
    v_add_f32 v233, 0x3727c5ac, v233
    v_rsq_f32 v43, v233
    s_mul_i32 s4, s48, 11264
    s_add_u32 s4, s4, 0x600000
    s_xor_b32 s5, s48, 0
    s_add_u32 s5, s5, s61
    s_mul_i32 s5, s5, 44032
    s_add_u32 s10, s5, s4
    s_xor_b32 s5, s48, 1
    s_add_u32 s5, s5, s61
    s_mul_i32 s5, s5, 44032
    s_add_u32 s11, s5, s4
    s_xor_b32 s5, s48, 2
    s_add_u32 s5, s5, s61
    s_mul_i32 s5, s5, 44032
    s_add_u32 s12, s5, s4
    s_xor_b32 s5, s48, 3
    s_add_u32 s5, s5, s61
    s_mul_i32 s5, s5, 44032
    s_add_u32 s13, s5, s4
    s_cmp_lg_u32 s48, 1
    s_cbranch_scc1 Lnw_4_1_s
    s_mov_b64 exec, 0
    s_branch Lret_4_1_s
Lret_4_1_s:
    s_mov_b64 exec, -1
Lnw_4_1_s:
    s_cmp_lg_u32 s48, 2
    s_cbranch_scc1 Lnw_4_2_s
    s_mov_b64 exec, 0
    s_branch Lret_4_2_s
Lret_4_2_s:
    s_mov_b64 exec, -1
Lnw_4_2_s:
    s_cmp_lg_u32 s48, 0
    s_cbranch_scc1 Ln_s_17
    buffer_load_dword v4, v17, s[36:39], s58 offen sc1
    s_nop 15
Lp_s_18:
    buffer_load_dword v5, v17, s[36:39], s58 offen sc1
    s_waitcnt vmcnt(1)
    v_cmp_gt_u32 vcc, 3, v4
    s_cbranch_vccz Ln_s_17
    buffer_load_dword v4, v17, s[36:39], s58 offen sc1
    s_waitcnt vmcnt(1)
    v_cmp_gt_u32 vcc, 3, v5
    s_cbranch_vccz Ln_s_17
    s_sub_u32 s14, s14, 1
    s_cbranch_scc1 L_end_s
    s_branch Lp_s_18
Ln_s_17:
    s_barrier
    buffer_load_dwordx4 v[64:67], v3, s[36:39], s13 offen sc1
    s_barrier
    buffer_load_dwordx4 v[68:71], v3, s[36:39], s13 offen offset:1024 sc1
    s_barrier
    buffer_load_dwordx4 v[72:75], v3, s[36:39], s13 offen offset:2048 sc1
    s_barrier
    buffer_load_dwordx4 v[76:79], v3, s[36:39], s13 offen offset:3072 sc1
    s_barrier
    s_add_u32 s17, s13, 0x1000
    buffer_load_dwordx4 v[80:83], v3, s[36:39], s17 offen sc1
    s_barrier
    buffer_load_dwordx4 v[84:87], v3, s[36:39], s17 offen offset:1024 sc1
    s_waitcnt vmcnt(5)
    v_mfma_f32_16x16x32_bf16 v[144:147], a[64:67], v[64:67], 0
    buffer_load_dwordx4 v[88:91], v3, s[36:39], s17 offen offset:2048 sc1
    v_mfma_f32_16x16x32_bf16 v[148:151], a[68:71], v[64:67], 0
    v_mfma_f32_16x16x32_bf16 v[152:155], a[72:75], v[64:67], 0
    buffer_load_dwordx4 v[92:95], v3, s[36:39], s17 offen offset:3072 sc1
    v_mfma_f32_16x16x32_bf16 v[156:159], a[76:79], v[64:67], 0
    s_waitcnt vmcnt(6)
    v_mfma_f32_16x16x32_bf16 v[144:147], a[80:83], v[68:71], v[144:147]
    s_add_u32 s18, s13, 0x2000
    buffer_load_dwordx4 v[96:99], v3, s[36:39], s18 offen sc1
    v_mfma_f32_16x16x32_bf16 v[148:151], a[84:87], v[68:71], v[148:151]
    v_mfma_f32_16x16x32_bf16 v[152:155], a[88:91], v[68:71], v[152:155]
    v_mfma_f32_16x16x32_bf16 v[156:159], a[92:95], v[68:71], v[156:159]
    s_waitcnt vmcnt(6)
    v_mfma_f32_16x16x32_bf16 v[144:147], a[96:99], v[72:75], v[144:147]
    buffer_load_dwordx4 v[100:103], v3, s[36:39], s18 offen offset:1024 sc1
    v_mfma_f32_16x16x32_bf16 v[148:151], a[100:103], v[72:75], v[148:151]
    s_add_u32 s4, s13, 10240
    v_mfma_f32_16x16x32_bf16 v[152:155], a[104:107], v[72:75], v[152:155]
    s_cmp_eq_u32 s48, 3
    v_mfma_f32_16x16x32_bf16 v[156:159], a[108:111], v[72:75], v[156:159]
    s_waitcnt vmcnt(6)
    v_mfma_f32_16x16x32_bf16 v[144:147], a[112:115], v[76:79], v[144:147]
    s_cselect_b32 s4, 0x80000000, s4
    buffer_load_dwordx4 v[104:107], v3, s[36:39], s4 offen sc1
    v_mfma_f32_16x16x32_bf16 v[148:151], a[116:119], v[76:79], v[148:151]
    v_mfma_f32_16x16x32_bf16 v[152:155], a[120:123], v[76:79], v[152:155]
    v_mfma_f32_16x16x32_bf16 v[156:159], a[124:127], v[76:79], v[156:159]
    s_waitcnt vmcnt(6)
    v_mfma_f32_16x16x32_bf16 v[144:147], a[128:131], v[80:83], v[144:147]
    buffer_load_dwordx4 v[108:111], v3, s[36:39], s12 offen sc1
    v_mfma_f32_16x16x32_bf16 v[148:151], a[132:135], v[80:83], v[148:151]
    v_mfma_f32_16x16x32_bf16 v[152:155], a[136:139], v[80:83], v[152:155]
    v_mfma_f32_16x16x32_bf16 v[156:159], a[140:143], v[80:83], v[156:159]
    s_waitcnt vmcnt(6)
    v_mfma_f32_16x16x32_bf16 v[144:147], a[144:147], v[84:87], v[144:147]
    buffer_load_dwordx4 v[112:115], v3, s[36:39], s12 offen offset:1024 sc1
    v_mfma_f32_16x16x32_bf16 v[148:151], a[148:151], v[84:87], v[148:151]
    v_mfma_f32_16x16x32_bf16 v[152:155], a[152:155], v[84:87], v[152:155]
    v_mfma_f32_16x16x32_bf16 v[156:159], a[156:159], v[84:87], v[156:159]
    s_waitcnt vmcnt(6)
    v_mfma_f32_16x16x32_bf16 v[144:147], a[160:163], v[88:91], v[144:147]
    buffer_load_dwordx4 v[116:119], v3, s[36:39], s12 offen offset:2048 sc1
    v_mfma_f32_16x16x32_bf16 v[148:151], a[164:167], v[88:91], v[148:151]
    v_mfma_f32_16x16x32_bf16 v[152:155], a[168:171], v[88:91], v[152:155]
    v_mfma_f32_16x16x32_bf16 v[156:159], a[172:175], v[88:91], v[156:159]
    s_waitcnt vmcnt(6)
    v_mfma_f32_16x16x32_bf16 v[144:147], a[176:179], v[92:95], v[144:147]
    buffer_load_dwordx4 v[120:123], v3, s[36:39], s12 offen offset:3072 sc1
    v_mfma_f32_16x16x32_bf16 v[148:151], a[180:183], v[92:95], v[148:151]
    v_mfma_f32_16x16x32_bf16 v[152:155], a[184:187], v[92:95], v[152:155]
    v_mfma_f32_16x16x32_bf16 v[156:159], a[188:191], v[92:95], v[156:159]
    s_waitcnt vmcnt(6)
    v_mfma_f32_16x16x32_bf16 v[144:147], a[192:195], v[96:99], v[144:147]
    s_add_u32 s16, s12, 0x1000
    buffer_load_dwordx4 v[124:127], v3, s[36:39], s16 offen sc1
    v_mfma_f32_16x16x32_bf16 v[148:151], a[196:199], v[96:99], v[148:151]
    v_mfma_f32_16x16x32_bf16 v[152:155], a[200:203], v[96:99], v[152:155]
    v_mfma_f32_16x16x32_bf16 v[156:159], a[204:207], v[96:99], v[156:159]
    s_waitcnt vmcnt(6)
    v_mfma_f32_16x16x32_bf16 v[144:147], a[208:211], v[100:103], v[144:147]
    buffer_load_dwordx4 v[64:67], v3, s[36:39], s16 offen offset:1024 sc1
    v_mfma_f32_16x16x32_bf16 v[148:151], a[212:215], v[100:103], v[148:151]
    v_mfma_f32_16x16x32_bf16 v[152:155], a[216:219], v[100:103], v[152:155]
    v_mfma_f32_16x16x32_bf16 v[156:159], a[220:223], v[100:103], v[156:159]
    s_waitcnt vmcnt(6)
    v_mfma_f32_16x16x32_bf16 v[144:147], a[224:227], v[104:107], v[144:147]
    buffer_load_dwordx4 v[68:71], v3, s[36:39], s16 offen offset:2048 sc1
    v_mfma_f32_16x16x32_bf16 v[148:151], a[228:231], v[104:107], v[148:151]
    v_mfma_f32_16x16x32_bf16 v[152:155], a[232:235], v[104:107], v[152:155]
    v_mfma_f32_16x16x32_bf16 v[156:159], a[236:239], v[104:107], v[156:159]
    s_waitcnt vmcnt(6)
    v_mfma_f32_16x16x32_bf16 v[128:131], a[64:67], v[108:111], 0
    buffer_load_dwordx4 v[72:75], v3, s[36:39], s16 offen offset:3072 sc1
    v_mfma_f32_16x16x32_bf16 v[132:135], a[68:71], v[108:111], 0
    ds_write_b128 v38, v[144:147] offset:0
    v_mfma_f32_16x16x32_bf16 v[136:139], a[72:75], v[108:111], 0
    v_mfma_f32_16x16x32_bf16 v[140:143], a[76:79], v[108:111], 0
    s_waitcnt vmcnt(6)
    v_mfma_f32_16x16x32_bf16 v[128:131], a[80:83], v[112:115], v[128:131]
    s_add_u32 s17, s12, 0x2000
    buffer_load_dwordx4 v[76:79], v3, s[36:39], s17 offen sc1
    v_mfma_f32_16x16x32_bf16 v[132:135], a[84:87], v[112:115], v[132:135]
    ds_write_b128 v38, v[148:151] offset:1024
    v_mfma_f32_16x16x32_bf16 v[136:139], a[88:91], v[112:115], v[136:139]
    v_mfma_f32_16x16x32_bf16 v[140:143], a[92:95], v[112:115], v[140:143]
    s_waitcnt vmcnt(6)
    v_mfma_f32_16x16x32_bf16 v[128:131], a[96:99], v[116:119], v[128:131]
    buffer_load_dwordx4 v[80:83], v3, s[36:39], s17 offen offset:1024 sc1
    v_mfma_f32_16x16x32_bf16 v[132:135], a[100:103], v[116:119], v[132:135]
    s_add_u32 s4, s12, 10240
    ds_write_b128 v38, v[152:155] offset:2048
    v_mfma_f32_16x16x32_bf16 v[136:139], a[104:107], v[116:119], v[136:139]
    s_cmp_eq_u32 s48, 3
    v_mfma_f32_16x16x32_bf16 v[140:143], a[108:111], v[116:119], v[140:143]
    s_waitcnt vmcnt(6)
    v_mfma_f32_16x16x32_bf16 v[128:131], a[112:115], v[120:123], v[128:131]
    s_cselect_b32 s4, 0x80000000, s4
    buffer_load_dwordx4 v[84:87], v3, s[36:39], s4 offen sc1
    v_mfma_f32_16x16x32_bf16 v[132:135], a[116:119], v[120:123], v[132:135]
    ds_write_b128 v38, v[156:159] offset:3072
    v_mfma_f32_16x16x32_bf16 v[136:139], a[120:123], v[120:123], v[136:139]
    v_mfma_f32_16x16x32_bf16 v[140:143], a[124:127], v[120:123], v[140:143]
    s_waitcnt vmcnt(6)
    v_mfma_f32_16x16x32_bf16 v[128:131], a[128:131], v[124:127], v[128:131]
    buffer_load_dwordx4 v[88:91], v3, s[36:39], s11 offen sc1
    v_mfma_f32_16x16x32_bf16 v[132:135], a[132:135], v[124:127], v[132:135]
    v_mfma_f32_16x16x32_bf16 v[136:139], a[136:139], v[124:127], v[136:139]
    v_mfma_f32_16x16x32_bf16 v[140:143], a[140:143], v[124:127], v[140:143]
    s_waitcnt lgkmcnt(0)
    s_barrier
    s_waitcnt vmcnt(6)
    ds_read_b128 v[192:195], v39 offset:0
    v_mfma_f32_16x16x32_bf16 v[128:131], a[144:147], v[64:67], v[128:131]
    buffer_load_dwordx4 v[92:95], v3, s[36:39], s11 offen offset:1024 sc1
    ds_read_b128 v[196:199], v39 offset:1024
    v_mfma_f32_16x16x32_bf16 v[132:135], a[148:151], v[64:67], v[132:135]
    ds_read_b128 v[200:203], v39 offset:2048
    v_mfma_f32_16x16x32_bf16 v[136:139], a[152:155], v[64:67], v[136:139]
    ds_read_b128 v[204:207], v39 offset:3072
    v_mfma_f32_16x16x32_bf16 v[140:143], a[156:159], v[64:67], v[140:143]
    s_waitcnt vmcnt(6)
    v_mfma_f32_16x16x32_bf16 v[128:131], a[160:163], v[68:71], v[128:131]
    buffer_load_dwordx4 v[96:99], v3, s[36:39], s11 offen offset:2048 sc1
    v_mfma_f32_16x16x32_bf16 v[132:135], a[164:167], v[68:71], v[132:135]
    v_mfma_f32_16x16x32_bf16 v[136:139], a[168:171], v[68:71], v[136:139]
    v_mfma_f32_16x16x32_bf16 v[140:143], a[172:175], v[68:71], v[140:143]
    s_waitcnt vmcnt(6)
    v_mfma_f32_16x16x32_bf16 v[128:131], a[176:179], v[72:75], v[128:131]
    buffer_load_dwordx4 v[100:103], v3, s[36:39], s11 offen offset:3072 sc1
    v_mfma_f32_16x16x32_bf16 v[132:135], a[180:183], v[72:75], v[132:135]
    v_mfma_f32_16x16x32_bf16 v[136:139], a[184:187], v[72:75], v[136:139]
    s_waitcnt lgkmcnt(0)
    v_fmac_f32 v48, v43, v192
    v_fmac_f32 v49, v43, v193
    v_mfma_f32_16x16x32_bf16 v[140:143], a[188:191], v[72:75], v[140:143]
    s_waitcnt vmcnt(6)
    v_fmac_f32 v50, v43, v194
    v_mfma_f32_16x16x32_bf16 v[128:131], a[192:195], v[76:79], v[128:131]
    s_add_u32 s18, s11, 0x1000
    buffer_load_dwordx4 v[104:107], v3, s[36:39], s18 offen sc1
    v_fmac_f32 v51, v43, v195
    v_mfma_f32_16x16x32_bf16 v[132:135], a[196:199], v[76:79], v[132:135]
    v_fmac_f32 v52, v43, v196
    v_mfma_f32_16x16x32_bf16 v[136:139], a[200:203], v[76:79], v[136:139]
    v_fmac_f32 v53, v43, v197
    v_mfma_f32_16x16x32_bf16 v[140:143], a[204:207], v[76:79], v[140:143]
    s_waitcnt vmcnt(6)
    v_fmac_f32 v54, v43, v198
    v_mfma_f32_16x16x32_bf16 v[128:131], a[208:211], v[80:83], v[128:131]
    buffer_load_dwordx4 v[108:111], v3, s[36:39], s18 offen offset:1024 sc1
    v_fmac_f32 v55, v43, v199
    v_mfma_f32_16x16x32_bf16 v[132:135], a[212:215], v[80:83], v[132:135]
    v_fmac_f32 v56, v43, v200
    v_fmac_f32 v57, v43, v201
    v_mfma_f32_16x16x32_bf16 v[136:139], a[216:219], v[80:83], v[136:139]
    v_fmac_f32 v58, v43, v202
    v_mfma_f32_16x16x32_bf16 v[140:143], a[220:223], v[80:83], v[140:143]
    s_waitcnt vmcnt(6)
    v_fmac_f32 v59, v43, v203
    v_mfma_f32_16x16x32_bf16 v[128:131], a[224:227], v[84:87], v[128:131]
    buffer_load_dwordx4 v[112:115], v3, s[36:39], s18 offen offset:2048 sc1
    v_fmac_f32 v60, v43, v204
    v_mfma_f32_16x16x32_bf16 v[132:135], a[228:231], v[84:87], v[132:135]
    v_fmac_f32 v61, v43, v205
    v_mfma_f32_16x16x32_bf16 v[136:139], a[232:235], v[84:87], v[136:139]
    v_fmac_f32 v62, v43, v206
    v_mfma_f32_16x16x32_bf16 v[140:143], a[236:239], v[84:87], v[140:143]
    s_waitcnt vmcnt(6)
    v_fmac_f32 v63, v43, v207
    v_mfma_f32_16x16x32_bf16 v[144:147], a[64:67], v[88:91], 0
    buffer_load_dwordx4 v[116:119], v3, s[36:39], s18 offen offset:3072 sc1
    v_mfma_f32_16x16x32_bf16 v[148:151], a[68:71], v[88:91], 0
    ds_write_b128 v37, v[128:131] offset:16384
    v_mfma_f32_16x16x32_bf16 v[152:155], a[72:75], v[88:91], 0
    v_mfma_f32_16x16x32_bf16 v[156:159], a[76:79], v[88:91], 0
    s_waitcnt vmcnt(6)
    v_mfma_f32_16x16x32_bf16 v[144:147], a[80:83], v[92:95], v[144:147]
    s_add_u32 s16, s11, 0x2000
    buffer_load_dwordx4 v[120:123], v3, s[36:39], s16 offen sc1
    v_mfma_f32_16x16x32_bf16 v[148:151], a[84:87], v[92:95], v[148:151]
    ds_write_b128 v37, v[132:135] offset:17408
    v_mfma_f32_16x16x32_bf16 v[152:155], a[88:91], v[92:95], v[152:155]
    v_mfma_f32_16x16x32_bf16 v[156:159], a[92:95], v[92:95], v[156:159]
    s_waitcnt vmcnt(6)
    v_mfma_f32_16x16x32_bf16 v[144:147], a[96:99], v[96:99], v[144:147]
    buffer_load_dwordx4 v[124:127], v3, s[36:39], s16 offen offset:1024 sc1
    v_mfma_f32_16x16x32_bf16 v[148:151], a[100:103], v[96:99], v[148:151]
    s_add_u32 s4, s11, 10240
    ds_write_b128 v37, v[136:139] offset:18432
    v_mfma_f32_16x16x32_bf16 v[152:155], a[104:107], v[96:99], v[152:155]
    s_cmp_eq_u32 s48, 3
    v_mfma_f32_16x16x32_bf16 v[156:159], a[108:111], v[96:99], v[156:159]
    s_waitcnt vmcnt(6)
    v_mfma_f32_16x16x32_bf16 v[144:147], a[112:115], v[100:103], v[144:147]
    s_cselect_b32 s4, 0x80000000, s4
    buffer_load_dwordx4 v[64:67], v3, s[36:39], s4 offen sc1
    v_mfma_f32_16x16x32_bf16 v[148:151], a[116:119], v[100:103], v[148:151]
    ds_write_b128 v37, v[140:143] offset:19456
    v_mfma_f32_16x16x32_bf16 v[152:155], a[120:123], v[100:103], v[152:155]
    v_mfma_f32_16x16x32_bf16 v[156:159], a[124:127], v[100:103], v[156:159]
    s_waitcnt vmcnt(6)
    v_mfma_f32_16x16x32_bf16 v[144:147], a[128:131], v[104:107], v[144:147]
    buffer_load_dwordx4 v[68:71], v3, s[36:39], s10 offen sc1
    v_mfma_f32_16x16x32_bf16 v[148:151], a[132:135], v[104:107], v[148:151]
    v_mfma_f32_16x16x32_bf16 v[152:155], a[136:139], v[104:107], v[152:155]
    v_mfma_f32_16x16x32_bf16 v[156:159], a[140:143], v[104:107], v[156:159]
    s_waitcnt lgkmcnt(0)
    s_barrier
    s_waitcnt vmcnt(6)
    ds_read_b128 v[160:163], v39 offset:16384
    v_mfma_f32_16x16x32_bf16 v[144:147], a[144:147], v[108:111], v[144:147]
    buffer_load_dwordx4 v[72:75], v3, s[36:39], s10 offen offset:1024 sc1
    ds_read_b128 v[164:167], v39 offset:17408
    v_mfma_f32_16x16x32_bf16 v[148:151], a[148:151], v[108:111], v[148:151]
    ds_read_b128 v[168:171], v39 offset:18432
    v_mfma_f32_16x16x32_bf16 v[152:155], a[152:155], v[108:111], v[152:155]
    ds_read_b128 v[172:175], v39 offset:19456
    v_mfma_f32_16x16x32_bf16 v[156:159], a[156:159], v[108:111], v[156:159]
    s_waitcnt vmcnt(6)
    v_mfma_f32_16x16x32_bf16 v[144:147], a[160:163], v[112:115], v[144:147]
    buffer_load_dwordx4 v[76:79], v3, s[36:39], s10 offen offset:2048 sc1
    v_mfma_f32_16x16x32_bf16 v[148:151], a[164:167], v[112:115], v[148:151]
    v_mfma_f32_16x16x32_bf16 v[152:155], a[168:171], v[112:115], v[152:155]
    v_mfma_f32_16x16x32_bf16 v[156:159], a[172:175], v[112:115], v[156:159]
    s_waitcnt vmcnt(6)
    v_mfma_f32_16x16x32_bf16 v[144:147], a[176:179], v[116:119], v[144:147]
    buffer_load_dwordx4 v[80:83], v3, s[36:39], s10 offen offset:3072 sc1
    v_mfma_f32_16x16x32_bf16 v[148:151], a[180:183], v[116:119], v[148:151]
    v_mfma_f32_16x16x32_bf16 v[152:155], a[184:187], v[116:119], v[152:155]
    s_waitcnt lgkmcnt(0)
    v_fmac_f32 v48, v43, v160
    v_fmac_f32 v49, v43, v161
    v_mfma_f32_16x16x32_bf16 v[156:159], a[188:191], v[116:119], v[156:159]
    s_waitcnt vmcnt(6)
    v_fmac_f32 v50, v43, v162
    v_mfma_f32_16x16x32_bf16 v[144:147], a[192:195], v[120:123], v[144:147]
    s_add_u32 s17, s10, 0x1000
    buffer_load_dwordx4 v[84:87], v3, s[36:39], s17 offen sc1
    v_fmac_f32 v51, v43, v163
    v_mfma_f32_16x16x32_bf16 v[148:151], a[196:199], v[120:123], v[148:151]
    v_fmac_f32 v52, v43, v164
    v_mfma_f32_16x16x32_bf16 v[152:155], a[200:203], v[120:123], v[152:155]
    v_fmac_f32 v53, v43, v165
    v_mfma_f32_16x16x32_bf16 v[156:159], a[204:207], v[120:123], v[156:159]
    s_waitcnt vmcnt(6)
    v_fmac_f32 v54, v43, v166
    v_mfma_f32_16x16x32_bf16 v[144:147], a[208:211], v[124:127], v[144:147]
    buffer_load_dwordx4 v[88:91], v3, s[36:39], s17 offen offset:1024 sc1
    v_fmac_f32 v55, v43, v167
    v_mfma_f32_16x16x32_bf16 v[148:151], a[212:215], v[124:127], v[148:151]
    v_fmac_f32 v56, v43, v168
    v_fmac_f32 v57, v43, v169
    v_mfma_f32_16x16x32_bf16 v[152:155], a[216:219], v[124:127], v[152:155]
    v_fmac_f32 v58, v43, v170
    v_mfma_f32_16x16x32_bf16 v[156:159], a[220:223], v[124:127], v[156:159]
    s_waitcnt vmcnt(6)
    v_fmac_f32 v59, v43, v171
    v_mfma_f32_16x16x32_bf16 v[144:147], a[224:227], v[64:67], v[144:147]
    buffer_load_dwordx4 v[92:95], v3, s[36:39], s17 offen offset:2048 sc1
    v_fmac_f32 v60, v43, v172
    v_mfma_f32_16x16x32_bf16 v[148:151], a[228:231], v[64:67], v[148:151]
    v_fmac_f32 v61, v43, v173
    v_mfma_f32_16x16x32_bf16 v[152:155], a[232:235], v[64:67], v[152:155]
    v_fmac_f32 v62, v43, v174
    v_mfma_f32_16x16x32_bf16 v[156:159], a[236:239], v[64:67], v[156:159]
    s_waitcnt vmcnt(6)
    v_fmac_f32 v63, v43, v175
    v_mfma_f32_16x16x32_bf16 v[128:131], a[64:67], v[68:71], 0
    buffer_load_dwordx4 v[96:99], v3, s[36:39], s17 offen offset:3072 sc1
    v_mfma_f32_16x16x32_bf16 v[132:135], a[68:71], v[68:71], 0
    ds_write_b128 v36, v[144:147] offset:0
    v_mfma_f32_16x16x32_bf16 v[136:139], a[72:75], v[68:71], 0
    v_mfma_f32_16x16x32_bf16 v[140:143], a[76:79], v[68:71], 0
    s_waitcnt vmcnt(6)
    v_mfma_f32_16x16x32_bf16 v[128:131], a[80:83], v[72:75], v[128:131]
    s_add_u32 s18, s10, 0x2000
    buffer_load_dwordx4 v[100:103], v3, s[36:39], s18 offen sc1
    v_mfma_f32_16x16x32_bf16 v[132:135], a[84:87], v[72:75], v[132:135]
    ds_write_b128 v36, v[148:151] offset:1024
    v_mfma_f32_16x16x32_bf16 v[136:139], a[88:91], v[72:75], v[136:139]
    v_mfma_f32_16x16x32_bf16 v[140:143], a[92:95], v[72:75], v[140:143]
    s_waitcnt vmcnt(6)
    v_mfma_f32_16x16x32_bf16 v[128:131], a[96:99], v[76:79], v[128:131]
    buffer_load_dwordx4 v[104:107], v3, s[36:39], s18 offen offset:1024 sc1
    v_mfma_f32_16x16x32_bf16 v[132:135], a[100:103], v[76:79], v[132:135]
    s_add_u32 s4, s10, 10240
    ds_write_b128 v36, v[152:155] offset:2048
    v_mfma_f32_16x16x32_bf16 v[136:139], a[104:107], v[76:79], v[136:139]
    s_cmp_eq_u32 s48, 3
    v_mfma_f32_16x16x32_bf16 v[140:143], a[108:111], v[76:79], v[140:143]
    s_waitcnt vmcnt(6)
    v_mfma_f32_16x16x32_bf16 v[128:131], a[112:115], v[80:83], v[128:131]
    s_cselect_b32 s4, 0x80000000, s4
    buffer_load_dwordx4 v[108:111], v3, s[36:39], s4 offen sc1
    v_mfma_f32_16x16x32_bf16 v[132:135], a[116:119], v[80:83], v[132:135]
    ds_write_b128 v36, v[156:159] offset:3072
    v_mfma_f32_16x16x32_bf16 v[136:139], a[120:123], v[80:83], v[136:139]
    v_mfma_f32_16x16x32_bf16 v[140:143], a[124:127], v[80:83], v[140:143]
    s_waitcnt vmcnt(6)
    v_mfma_f32_16x16x32_bf16 v[128:131], a[128:131], v[84:87], v[128:131]
    v_mfma_f32_16x16x32_bf16 v[132:135], a[132:135], v[84:87], v[132:135]
    v_mfma_f32_16x16x32_bf16 v[136:139], a[136:139], v[84:87], v[136:139]
    v_mfma_f32_16x16x32_bf16 v[140:143], a[140:143], v[84:87], v[140:143]
    s_waitcnt lgkmcnt(0)
    s_barrier
    s_waitcnt vmcnt(5)
    ds_read_b128 v[176:179], v39 offset:0
    v_mfma_f32_16x16x32_bf16 v[128:131], a[144:147], v[88:91], v[128:131]
    ds_read_b128 v[180:183], v39 offset:1024
    v_mfma_f32_16x16x32_bf16 v[132:135], a[148:151], v[88:91], v[132:135]
    ds_read_b128 v[184:187], v39 offset:2048
    v_mfma_f32_16x16x32_bf16 v[136:139], a[152:155], v[88:91], v[136:139]
    ds_read_b128 v[188:191], v39 offset:3072
    v_mfma_f32_16x16x32_bf16 v[140:143], a[156:159], v[88:91], v[140:143]
    s_waitcnt vmcnt(4)
    v_mfma_f32_16x16x32_bf16 v[128:131], a[160:163], v[92:95], v[128:131]
    v_mfma_f32_16x16x32_bf16 v[132:135], a[164:167], v[92:95], v[132:135]
    v_mfma_f32_16x16x32_bf16 v[136:139], a[168:171], v[92:95], v[136:139]
    v_mfma_f32_16x16x32_bf16 v[140:143], a[172:175], v[92:95], v[140:143]
    s_waitcnt vmcnt(3)
    v_mfma_f32_16x16x32_bf16 v[128:131], a[176:179], v[96:99], v[128:131]
    v_mfma_f32_16x16x32_bf16 v[132:135], a[180:183], v[96:99], v[132:135]
    v_mfma_f32_16x16x32_bf16 v[136:139], a[184:187], v[96:99], v[136:139]
    s_waitcnt lgkmcnt(0)
    v_fmac_f32 v48, v43, v176
    v_fmac_f32 v49, v43, v177
    v_mfma_f32_16x16x32_bf16 v[140:143], a[188:191], v[96:99], v[140:143]
    s_waitcnt vmcnt(2)
    v_fmac_f32 v50, v43, v178
    v_mfma_f32_16x16x32_bf16 v[128:131], a[192:195], v[100:103], v[128:131]
    v_fmac_f32 v51, v43, v179
    v_mfma_f32_16x16x32_bf16 v[132:135], a[196:199], v[100:103], v[132:135]
    v_fmac_f32 v52, v43, v180
    v_mfma_f32_16x16x32_bf16 v[136:139], a[200:203], v[100:103], v[136:139]
    s_add_u32 s6, s61, s48
    v_fmac_f32 v53, v43, v181
    v_mfma_f32_16x16x32_bf16 v[140:143], a[204:207], v[100:103], v[140:143]
    s_waitcnt vmcnt(1)
    v_fmac_f32 v54, v43, v182
    v_mfma_f32_16x16x32_bf16 v[128:131], a[208:211], v[104:107], v[128:131]
    s_lshl_b32 s4, s6, 14
    v_fmac_f32 v55, v43, v183
    v_mfma_f32_16x16x32_bf16 v[132:135], a[212:215], v[104:107], v[132:135]
    s_lshl_b32 s5, s60, 11
    v_fmac_f32 v56, v43, v184
    v_fmac_f32 v57, v43, v185
    v_mfma_f32_16x16x32_bf16 v[136:139], a[216:219], v[104:107], v[136:139]
    s_add_u32 s4, s4, s5
    v_fmac_f32 v58, v43, v186
    v_mfma_f32_16x16x32_bf16 v[140:143], a[220:223], v[104:107], v[140:143]
    s_waitcnt vmcnt(0)
    v_fmac_f32 v59, v43, v187
    v_mfma_f32_16x16x32_bf16 v[128:131], a[224:227], v[108:111], v[128:131]
    s_add_u32 s4, s4, 0x0
    v_fmac_f32 v60, v43, v188
    v_mfma_f32_16x16x32_bf16 v[132:135], a[228:231], v[108:111], v[132:135]
    s_lshl_b32 s6, s6, 10
    v_fmac_f32 v61, v43, v189
    v_mfma_f32_16x16x32_bf16 v[136:139], a[232:235], v[108:111], v[136:139]
    s_add_u32 s6, s6, 0x380000
    v_fmac_f32 v62, v43, v190
    v_mfma_f32_16x16x32_bf16 v[140:143], a[236:239], v[108:111], v[140:143]
    v_fmac_f32 v63, v43, v191
    v_pk_fma_f32 v[48:49], v[128:129], v[42:43], v[48:49] op_sel:[0,1,0] op_sel_hi:[1,1,1]
    v_pk_fma_f32 v[50:51], v[130:131], v[42:43], v[50:51] op_sel:[0,1,0] op_sel_hi:[1,1,1]
    v_pk_fma_f32 v[52:53], v[132:133], v[42:43], v[52:53] op_sel:[0,1,0] op_sel_hi:[1,1,1]
    v_pk_fma_f32 v[54:55], v[134:135], v[42:43], v[54:55] op_sel:[0,1,0] op_sel_hi:[1,1,1]
    v_cvt_pk_bf16_f32 v208, v48, v49
    v_cvt_pk_bf16_f32 v209, v50, v51
    v_cvt_pk_bf16_f32 v210, v52, v53
    v_cvt_pk_bf16_f32 v211, v54, v55
    buffer_store_dwordx4 v[208:211], v3, s[40:43], s4 offen sc0 sc1
    v_pk_fma_f32 v[56:57], v[136:137], v[42:43], v[56:57] op_sel:[0,1,0] op_sel_hi:[1,1,1]
    v_pk_fma_f32 v[58:59], v[138:139], v[42:43], v[58:59] op_sel:[0,1,0] op_sel_hi:[1,1,1]
    v_pk_fma_f32 v[60:61], v[140:141], v[42:43], v[60:61] op_sel:[0,1,0] op_sel_hi:[1,1,1]
    v_pk_fma_f32 v[62:63], v[142:143], v[42:43], v[62:63] op_sel:[0,1,0] op_sel_hi:[1,1,1]
    v_cvt_pk_bf16_f32 v212, v56, v57
    v_cvt_pk_bf16_f32 v213, v58, v59
    v_cvt_pk_bf16_f32 v214, v60, v61
    v_cvt_pk_bf16_f32 v215, v62, v63
    buffer_store_dwordx4 v[212:215], v3, s[40:43], s4 offen offset:1024 sc0 sc1
    v_pk_add_f32 v[216:217], v[48:49], v[50:51]
    v_pk_mul_f32 v[218:219], v[48:49], v[48:49]
    v_pk_fma_f32 v[218:219], v[50:51], v[50:51], v[218:219]
    v_pk_add_f32 v[216:217], v[216:217], v[52:53]
    v_pk_fma_f32 v[218:219], v[52:53], v[52:53], v[218:219]
    v_pk_add_f32 v[216:217], v[216:217], v[54:55]
    v_pk_fma_f32 v[218:219], v[54:55], v[54:55], v[218:219]
    v_pk_add_f32 v[216:217], v[216:217], v[56:57]
    v_pk_fma_f32 v[218:219], v[56:57], v[56:57], v[218:219]
    v_pk_add_f32 v[216:217], v[216:217], v[58:59]
    v_pk_fma_f32 v[218:219], v[58:59], v[58:59], v[218:219]
    v_pk_add_f32 v[216:217], v[216:217], v[60:61]
    v_pk_fma_f32 v[218:219], v[60:61], v[60:61], v[218:219]
    v_pk_add_f32 v[216:217], v[216:217], v[62:63]
    v_pk_fma_f32 v[218:219], v[62:63], v[62:63], v[218:219]
    v_add_f32 v216, v216, v217
    v_add_f32 v217, v218, v219
    s_nop 1
    v_permlane32_swap_b32 v216, v217
    v_add_f32 v216, v216, v217
    v_mov_b32 v217, v216
    s_nop 1
    v_permlane16_swap_b32 v216, v217
    v_add_f32 v216, v216, v217
    s_mov_b32 exec_lo, 0xffff
    s_mov_b32 exec_hi, 0xffff
    buffer_store_dword v216, v30, s[36:39], s6 offen sc0 sc1
    s_lshr_b32 s7, s50, 3
    s_add_u32 s7, s7, s48
    s_cmp_lg_u32 s7, 4
    s_cbranch_scc1 Lhl_s_20
    s_add_u32 s6, s49, 1
    s_lshl_b32 s6, s6, 15
    s_add_u32 s6, s6, 0xb60000
    s_add_u32 s4, s6, s5
    s_add_u32 s6, s6, 16384
    buffer_store_dword v216, v30, s[36:39], s6 offen sc0 sc1
    s_mov_b64 exec, -1
    buffer_store_dwordx4 v[208:211], v3, s[36:39], s4 offen sc0 sc1
    buffer_store_dwordx4 v[212:215], v3, s[36:39], s4 offen offset:1024 sc0 sc1
    s_waitcnt vmcnt(3)
    s_branch Lhj_s_21
Lhl_s_20:
    s_waitcnt vmcnt(0)
Lhj_s_21:
    s_mov_b64 exec, -1
    v_mov_b32 v4, 4
    s_cmp_lg_u32 s48, 0
    s_mov_b64 exec, 1
    s_barrier
    s_cbranch_scc1 Lq_s_24
    buffer_store_dword v4, off, s[36:39], s55 sc0 sc1
Lq_s_24:
    s_mov_b64 exec, -1
    s_lshl_b32 s12, s59, 14
    s_add_u32 s12, s12, 0x0
    s_lshl_b32 s8, s51, 12
    s_add_u32 s8, s8, s12
    s_add_u32 s9, s8, 16384
    ds_read_b64_tr_b16 v[116:117], v11 offset:0
    ds_read_b64_tr_b16 v[118:119], v11 offset:256
    ds_read_b64_tr_b16 v[120:121], v12 offset:0
    ds_read_b64_tr_b16 v[122:123], v12 offset:256
    ds_read_b64_tr_b16 v[124:125], v11 offset:1024
    ds_read_b64_tr_b16 v[126:127], v11 offset:1280
    ds_read_b64_tr_b16 v[128:129], v12 offset:1024
    ds_read_b64_tr_b16 v[130:131], v12 offset:1280
    ds_read_b64_tr_b16 v[132:133], v11 offset:2048
    ds_read_b64_tr_b16 v[134:135], v11 offset:2304
    ds_read_b64_tr_b16 v[136:137], v12 offset:2048
    ds_read_b64_tr_b16 v[138:139], v12 offset:2304
    s_lshl_b32 s11, s59, 10
    s_add_u32 s11, s11, 0x380000
    s_lshl_b32 s4, s49, 15
    s_add_u32 s4, s4, 0xb60000
    s_add_u32 s10, s4, 16384
    s_add_u32 s5, s48, s51
    s_and_b32 s5, s5, 3
    s_lshl_b32 s5, s5, 12
    s_add_u32 s4, s4, s5
    s_cmp_eq_u32 s49, 0
    s_cselect_b32 s13, 0x80000000, s4
    s_cselect_b32 s10, 0x80000000, s10
    s_lshl_b32 s5, s48, 12
    s_add_u32 s63, s5, 0x23000
    v_add_u32 v16, 0x24000, v3
    v_and_b32 v6, 28, v17
    s_cmp_lg_u32 s48, 3
    s_cbranch_scc1 Lhf_s_25
    s_cmp_lt_u32 s50, 8
    s_cbranch_scc1 Lhf_s_25
    v_mov_b32 v4, 1
    s_add_u32 s4, s55, 352
    s_mov_b64 exec, 1
    s_waitcnt vmcnt(0)
    buffer_store_dword v4, off, s[36:39], s4 sc0 sc1
    s_mov_b64 exec, -1
Lhf_s_25:
    s_cmp_lg_u32 s48, 1
    s_cbranch_scc1 Lnw_5_1_s
    s_mov_b64 exec, 0
    s_branch Lret_5_1_s
Lret_5_1_s:
    s_mov_b64 exec, -1
Lnw_5_1_s:
    s_cmp_lg_u32 s48, 2
    s_cbranch_scc1 Lnw_5_2_s
    s_mov_b64 exec, 0
    s_branch Lret_5_2_s
Lret_5_2_s:
    s_mov_b64 exec, -1
Lnw_5_2_s:
    s_cmp_lg_u32 s48, 0
    s_cbranch_scc1 Ln_s_22
    buffer_load_dword v4, v17, s[36:39], s58 offen sc1
    s_nop 15
Lp_s_23:
    buffer_load_dword v5, v17, s[36:39], s58 offen sc1
    s_waitcnt vmcnt(1)
    v_cmp_gt_u32 vcc, 4, v4
    s_cbranch_vccz Ln_s_22
    buffer_load_dword v4, v17, s[36:39], s58 offen sc1
    s_waitcnt vmcnt(1)
    v_cmp_gt_u32 vcc, 4, v5
    s_cbranch_vccz Ln_s_22
    s_sub_u32 s14, s14, 1
    s_cbranch_scc1 L_end_s
    s_branch Lp_s_23
Ln_s_22:
    s_barrier
    buffer_load_dwordx4 v[164:167], v3, s[40:43], s8 offen sc1
    s_barrier
    buffer_load_dwordx4 v[168:171], v3, s[40:43], s9 offen sc1
    s_barrier
    buffer_load_dwordx4 v[172:175], v3, s[40:43], s8 offen offset:1024 sc1
    buffer_load_dwordx4 v[176:179], v3, s[40:43], s9 offen offset:1024 sc1
    buffer_load_dwordx4 v[180:183], v3, s[40:43], s8 offen offset:2048 sc1
    buffer_load_dwordx4 v[184:187], v3, s[40:43], s9 offen offset:2048 sc1
    s_waitcnt vmcnt(4) lgkmcnt(6)
    v_mfma_f32_16x16x32_bf16 v[64:67], v[116:119], v[164:167], 0
    ds_read_b64_tr_b16 v[140:141], v11 offset:6144
    buffer_load_dwordx4 v[188:191], v3, s[40:43], s8 offen offset:3072 sc1
    v_mfma_f32_16x16x32_bf16 v[88:91], v[116:119], v[168:171], 0
    ds_read_b64_tr_b16 v[142:143], v11 offset:6400
    v_mfma_f32_16x16x32_bf16 v[68:71], v[120:123], v[164:167], 0
    ds_read_b64_tr_b16 v[144:145], v12 offset:6144
    v_mfma_f32_16x16x32_bf16 v[92:95], v[120:123], v[168:171], 0
    ds_read_b64_tr_b16 v[146:147], v12 offset:6400
    v_mfma_f32_16x16x32_bf16 v[72:75], v[124:127], v[164:167], 0
    ds_read_b64_tr_b16 v[148:149], v11 offset:7168
    buffer_load_dwordx4 v[192:195], v3, s[40:43], s9 offen offset:3072 sc1
    v_mfma_f32_16x16x32_bf16 v[96:99], v[124:127], v[168:171], 0
    s_waitcnt lgkmcnt(5)
    ds_read_b64_tr_b16 v[150:151], v11 offset:7424
    v_mfma_f32_16x16x32_bf16 v[76:79], v[128:131], v[164:167], 0
    ds_read_b64_tr_b16 v[152:153], v12 offset:7168
    v_mfma_f32_16x16x32_bf16 v[100:103], v[128:131], v[168:171], 0
    ds_read_b64_tr_b16 v[154:155], v12 offset:7424
    v_mfma_f32_16x16x32_bf16 v[80:83], v[132:135], v[164:167], 0
    ds_read_b64_tr_b16 v[156:157], v11 offset:8192
    buffer_load_dwordx4 v[228:231], v3, s[36:39], s11 offen sc1
    v_mfma_f32_16x16x32_bf16 v[104:107], v[132:135], v[168:171], 0
    s_lshl_b32 s8, s52, 12
    ds_read_b64_tr_b16 v[158:159], v11 offset:8448
    v_mfma_f32_16x16x32_bf16 v[84:87], v[136:139], v[164:167], 0
    s_add_u32 s8, s8, s12
    ds_read_b64_tr_b16 v[160:161], v12 offset:8192
    v_mfma_f32_16x16x32_bf16 v[108:111], v[136:139], v[168:171], 0
    s_waitcnt vmcnt(5) lgkmcnt(5)
    ds_read_b64_tr_b16 v[162:163], v12 offset:8448
    v_mfma_f32_16x16x32_bf16 v[64:67], v[140:143], v[172:175], v[64:67]
    s_add_u32 s9, s8, 16384
    ds_read_b64_tr_b16 v[116:117], v11 offset:12288
    buffer_load_dwordx4 v[196:199], v3, s[40:43], s8 offen sc1
    v_mfma_f32_16x16x32_bf16 v[88:91], v[140:143], v[176:179], v[88:91]
    ds_read_b64_tr_b16 v[118:119], v11 offset:12544
    v_mfma_f32_16x16x32_bf16 v[68:71], v[144:147], v[172:175], v[68:71]
    ds_read_b64_tr_b16 v[120:121], v12 offset:12288
    v_mfma_f32_16x16x32_bf16 v[92:95], v[144:147], v[176:179], v[92:95]
    ds_read_b64_tr_b16 v[122:123], v12 offset:12544
    v_mfma_f32_16x16x32_bf16 v[72:75], v[148:151], v[172:175], v[72:75]
    ds_read_b64_tr_b16 v[124:125], v11 offset:13312
    buffer_load_dwordx4 v[200:203], v3, s[40:43], s9 offen sc1
    v_mfma_f32_16x16x32_bf16 v[96:99], v[148:151], v[176:179], v[96:99]
    s_waitcnt lgkmcnt(5)
    ds_read_b64_tr_b16 v[126:127], v11 offset:13568
    v_mfma_f32_16x16x32_bf16 v[76:79], v[152:155], v[172:175], v[76:79]
    ds_read_b64_tr_b16 v[128:129], v12 offset:13312
    v_mfma_f32_16x16x32_bf16 v[100:103], v[152:155], v[176:179], v[100:103]
    ds_read_b64_tr_b16 v[130:131], v12 offset:13568
    v_mfma_f32_16x16x32_bf16 v[80:83], v[156:159], v[172:175], v[80:83]
    ds_read_b64_tr_b16 v[132:133], v11 offset:14336
    buffer_load_dwordx4 v[232:235], v3, s[36:39], s11 offen offset:1024 sc1
    v_mfma_f32_16x16x32_bf16 v[104:107], v[156:159], v[176:179], v[104:107]
    ds_read_b64_tr_b16 v[134:135], v11 offset:14592
    v_mfma_f32_16x16x32_bf16 v[84:87], v[160:163], v[172:175], v[84:87]
    ds_read_b64_tr_b16 v[136:137], v12 offset:14336
    v_mfma_f32_16x16x32_bf16 v[108:111], v[160:163], v[176:179], v[108:111]
    s_waitcnt vmcnt(6) lgkmcnt(5)
    ds_read_b64_tr_b16 v[138:139], v12 offset:14592
    v_mfma_f32_16x16x32_bf16 v[64:67], v[116:119], v[180:183], v[64:67]
    ds_read_b64_tr_b16 v[140:141], v11 offset:18432
    buffer_load_dwordx4 v[204:207], v3, s[40:43], s8 offen offset:1024 sc1
    v_mfma_f32_16x16x32_bf16 v[88:91], v[116:119], v[184:187], v[88:91]
    ds_read_b64_tr_b16 v[142:143], v11 offset:18688
    v_mfma_f32_16x16x32_bf16 v[68:71], v[120:123], v[180:183], v[68:71]
    ds_read_b64_tr_b16 v[144:145], v12 offset:18432
    v_mfma_f32_16x16x32_bf16 v[92:95], v[120:123], v[184:187], v[92:95]
    ds_read_b64_tr_b16 v[146:147], v12 offset:18688
    v_mfma_f32_16x16x32_bf16 v[72:75], v[124:127], v[180:183], v[72:75]
    ds_read_b64_tr_b16 v[148:149], v11 offset:19456
    buffer_load_dwordx4 v[208:211], v3, s[40:43], s9 offen offset:1024 sc1
    v_mfma_f32_16x16x32_bf16 v[96:99], v[124:127], v[184:187], v[96:99]
    s_waitcnt lgkmcnt(5)
    ds_read_b64_tr_b16 v[150:151], v11 offset:19712
    v_mfma_f32_16x16x32_bf16 v[76:79], v[128:131], v[180:183], v[76:79]
    ds_read_b64_tr_b16 v[152:153], v12 offset:19456
    v_mfma_f32_16x16x32_bf16 v[100:103], v[128:131], v[184:187], v[100:103]
    ds_read_b64_tr_b16 v[154:155], v12 offset:19712
    v_mfma_f32_16x16x32_bf16 v[80:83], v[132:135], v[180:183], v[80:83]
    ds_read_b64_tr_b16 v[156:157], v11 offset:20480
    buffer_load_dwordx4 v[164:167], v3, s[40:43], s8 offen offset:2048 sc1
    v_mfma_f32_16x16x32_bf16 v[104:107], v[132:135], v[184:187], v[104:107]
    ds_read_b64_tr_b16 v[158:159], v11 offset:20736
    v_mfma_f32_16x16x32_bf16 v[84:87], v[136:139], v[180:183], v[84:87]
    ds_read_b64_tr_b16 v[160:161], v12 offset:20480
    v_mfma_f32_16x16x32_bf16 v[108:111], v[136:139], v[184:187], v[108:111]
    s_waitcnt vmcnt(7) lgkmcnt(5)
    ds_read_b64_tr_b16 v[162:163], v12 offset:20736
    v_mfma_f32_16x16x32_bf16 v[64:67], v[140:143], v[188:191], v[64:67]
    ds_read_b64_tr_b16 v[116:117], v11 offset:24576
    buffer_load_dword v5, v6, s[36:39], s58 offen offset:128 sc1
    v_mfma_f32_16x16x32_bf16 v[88:91], v[140:143], v[192:195], v[88:91]
    ds_read_b64_tr_b16 v[118:119], v11 offset:24832
    v_mfma_f32_16x16x32_bf16 v[68:71], v[144:147], v[188:191], v[68:71]
    ds_read_b64_tr_b16 v[120:121], v12 offset:24576
    v_mfma_f32_16x16x32_bf16 v[92:95], v[144:147], v[192:195], v[92:95]
    ds_read_b64_tr_b16 v[122:123], v12 offset:24832
    buffer_load_dwordx4 v[168:171], v3, s[40:43], s9 offen offset:2048 sc1
    v_mfma_f32_16x16x32_bf16 v[72:75], v[148:151], v[188:191], v[72:75]
    ds_read_b64_tr_b16 v[124:125], v11 offset:25600
    v_mfma_f32_16x16x32_bf16 v[96:99], v[148:151], v[192:195], v[96:99]
    s_waitcnt lgkmcnt(5)
    ds_read_b64_tr_b16 v[126:127], v11 offset:25856
    v_mfma_f32_16x16x32_bf16 v[76:79], v[152:155], v[188:191], v[76:79]
    ds_read_b64_tr_b16 v[128:129], v12 offset:25600
    buffer_load_dwordx4 v[172:175], v3, s[40:43], s8 offen offset:3072 sc1
    v_mfma_f32_16x16x32_bf16 v[100:103], v[152:155], v[192:195], v[100:103]
    ds_read_b64_tr_b16 v[130:131], v12 offset:25856
    v_mfma_f32_16x16x32_bf16 v[80:83], v[156:159], v[188:191], v[80:83]
    s_lshl_b32 s8, s53, 12
    ds_read_b64_tr_b16 v[132:133], v11 offset:26624
    v_mfma_f32_16x16x32_bf16 v[104:107], v[156:159], v[192:195], v[104:107]
    s_add_u32 s8, s8, s12
    ds_read_b64_tr_b16 v[134:135], v11 offset:26880
    buffer_load_dwordx4 v[176:179], v3, s[40:43], s9 offen offset:3072 sc1
    v_mfma_f32_16x16x32_bf16 v[84:87], v[160:163], v[188:191], v[84:87]
    s_add_u32 s9, s8, 16384
    ds_read_b64_tr_b16 v[136:137], v12 offset:26624
    v_mfma_f32_16x16x32_bf16 v[108:111], v[160:163], v[192:195], v[108:111]
    s_waitcnt vmcnt(8) lgkmcnt(5)
    ds_read_b64_tr_b16 v[138:139], v12 offset:26880
    v_mfma_f32_16x16x32_bf16 v[64:67], v[116:119], v[196:199], v[64:67]
    s_waitcnt vmcnt(7)
    ds_read_b64_tr_b16 v[140:141], v11 offset:30720
    buffer_load_dwordx4 v[180:183], v3, s[40:43], s8 offen sc1
    v_mfma_f32_16x16x32_bf16 v[88:91], v[116:119], v[200:203], v[88:91]
    s_nop 0
    ds_read_b64_tr_b16 v[142:143], v11 offset:30976
    v_add_f32 v228, v228, v230
    v_mfma_f32_16x16x32_bf16 v[68:71], v[120:123], v[196:199], v[68:71]
    s_nop 0
    ds_read_b64_tr_b16 v[144:145], v12 offset:30720
    v_add_f32 v232, v232, v234
    v_mfma_f32_16x16x32_bf16 v[92:95], v[120:123], v[200:203], v[92:95]
    s_nop 0
    ds_read_b64_tr_b16 v[146:147], v12 offset:30976
    v_add_f32 v229, v229, v231
    v_mfma_f32_16x16x32_bf16 v[72:75], v[124:127], v[196:199], v[72:75]
    ds_read_b64_tr_b16 v[148:149], v11 offset:31744
    buffer_load_dwordx4 v[184:187], v3, s[40:43], s9 offen sc1
    v_mfma_f32_16x16x32_bf16 v[96:99], v[124:127], v[200:203], v[96:99]
    s_waitcnt lgkmcnt(5)
    ds_read_b64_tr_b16 v[150:151], v11 offset:32000
    v_add_f32 v233, v233, v235
    v_mfma_f32_16x16x32_bf16 v[76:79], v[128:131], v[196:199], v[76:79]
    ds_read_b64_tr_b16 v[152:153], v12 offset:31744
    v_mfma_f32_16x16x32_bf16 v[100:103], v[128:131], v[200:203], v[100:103]
    s_nop 0
    ds_read_b64_tr_b16 v[154:155], v12 offset:32000
    v_permlane32_swap_b32 v228, v229
    v_mfma_f32_16x16x32_bf16 v[80:83], v[132:135], v[196:199], v[80:83]
    ds_read_b64_tr_b16 v[156:157], v11 offset:32768
    buffer_load_dwordx4 v[188:191], v3, s[40:43], s8 offen offset:1024 sc1
    v_mfma_f32_16x16x32_bf16 v[104:107], v[132:135], v[200:203], v[104:107]
    s_nop 0
    ds_read_b64_tr_b16 v[158:159], v11 offset:33024
    v_permlane32_swap_b32 v232, v233
    v_mfma_f32_16x16x32_bf16 v[84:87], v[136:139], v[196:199], v[84:87]
    s_nop 0
    ds_read_b64_tr_b16 v[160:161], v12 offset:32768
    v_add_f32 v228, v228, v229
    v_mfma_f32_16x16x32_bf16 v[108:111], v[136:139], v[200:203], v[108:111]
    s_waitcnt vmcnt(8) lgkmcnt(5)
    ds_read_b64_tr_b16 v[162:163], v12 offset:33024
    v_mfma_f32_16x16x32_bf16 v[64:67], v[140:143], v[204:207], v[64:67]
    ds_read_b64_tr_b16 v[116:117], v11 offset:36864
    buffer_load_dwordx4 v[192:195], v3, s[40:43], s9 offen offset:1024 sc1
    v_mfma_f32_16x16x32_bf16 v[88:91], v[140:143], v[208:211], v[88:91]
    s_nop 0
    ds_read_b64_tr_b16 v[118:119], v11 offset:37120
    v_add_f32 v232, v232, v233
    v_mfma_f32_16x16x32_bf16 v[68:71], v[144:147], v[204:207], v[68:71]
    s_nop 0
    ds_read_b64_tr_b16 v[120:121], v12 offset:36864
    v_mov_b32 v229, v228
    v_mfma_f32_16x16x32_bf16 v[92:95], v[144:147], v[208:211], v[92:95]
    ds_read_b64_tr_b16 v[122:123], v12 offset:37120
    v_mfma_f32_16x16x32_bf16 v[72:75], v[148:151], v[204:207], v[72:75]
    ds_read_b64_tr_b16 v[124:125], v11 offset:37888
    buffer_load_dwordx4 v[196:199], v3, s[40:43], s8 offen offset:2048 sc1
    v_mfma_f32_16x16x32_bf16 v[96:99], v[148:151], v[208:211], v[96:99]
    s_waitcnt lgkmcnt(5)
    ds_read_b64_tr_b16 v[126:127], v11 offset:38144
    v_mov_b32 v233, v232
    v_mfma_f32_16x16x32_bf16 v[76:79], v[152:155], v[204:207], v[76:79]
    s_nop 0
    ds_read_b64_tr_b16 v[128:129], v12 offset:37888
    v_permlane16_swap_b32 v228, v229
    v_mfma_f32_16x16x32_bf16 v[100:103], v[152:155], v[208:211], v[100:103]
    s_nop 0
    ds_read_b64_tr_b16 v[130:131], v12 offset:38144
    v_permlane16_swap_b32 v232, v233
    v_mfma_f32_16x16x32_bf16 v[80:83], v[156:159], v[204:207], v[80:83]
    ds_read_b64_tr_b16 v[132:133], v11 offset:38912
    buffer_load_dwordx4 v[200:203], v3, s[40:43], s9 offen offset:2048 sc1
    v_mfma_f32_16x16x32_bf16 v[104:107], v[156:159], v[208:211], v[104:107]
    s_nop 0
    ds_read_b64_tr_b16 v[134:135], v11 offset:39168
    v_add_f32 v228, v228, v229
    v_mfma_f32_16x16x32_bf16 v[84:87], v[160:163], v[204:207], v[84:87]
    ds_read_b64_tr_b16 v[136:137], v12 offset:38912
    v_mfma_f32_16x16x32_bf16 v[108:111], v[160:163], v[208:211], v[108:111]
    s_waitcnt vmcnt(8) lgkmcnt(5)
    ds_read_b64_tr_b16 v[138:139], v12 offset:39168
    v_add_f32 v232, v232, v233
    v_mfma_f32_16x16x32_bf16 v[64:67], v[116:119], v[164:167], v[64:67]
    s_cmp_eq_u32 s49, 0
    s_cbranch_scc1 Lh_s_27
Lg_s_26:
    v_cmp_ne_u32 vcc, 1, v5
    s_cbranch_vccz Lh_s_27
    buffer_load_dword v5, v6, s[36:39], s58 offen offset:128 sc1
    s_waitcnt vmcnt(0)
    s_sub_u32 s14, s14, 1
    s_cbranch_scc1 L_end_s
    s_branch Lg_s_26
Lh_s_27:
    ds_read_b64_tr_b16 v[140:141], v11 offset:43008
    s_add_u32 m0, s63, 0x1000
    s_nop 0
    buffer_load_dwordx4 v3, s[36:39], s13 offen sc1 lds
    v_mfma_f32_16x16x32_bf16 v[88:91], v[116:119], v[168:171], v[88:91]
    s_nop 0
    ds_read_b64_tr_b16 v[142:143], v11 offset:43264
    v_mov_b32 v229, v228
    v_mfma_f32_16x16x32_bf16 v[68:71], v[120:123], v[164:167], v[68:71]
    ds_read_b64_tr_b16 v[144:145], v12 offset:43008
    v_mfma_f32_16x16x32_bf16 v[92:95], v[120:123], v[168:171], v[92:95]
    s_nop 0
    ds_read_b64_tr_b16 v[146:147], v12 offset:43264
    v_mov_b32 v233, v232
    v_mfma_f32_16x16x32_bf16 v[72:75], v[124:127], v[164:167], v[72:75]
    ds_read_b64_tr_b16 v[148:149], v11 offset:44032
    buffer_load_dwordx4 v3, s[36:39], s13 offen offset:1024 sc1 lds
    v_mfma_f32_16x16x32_bf16 v[96:99], v[124:127], v[168:171], v[96:99]
    s_waitcnt lgkmcnt(5)
    ds_read_b64_tr_b16 v[150:151], v11 offset:44288
    v_permlane32_swap_b32 v228, v229
    v_mfma_f32_16x16x32_bf16 v[76:79], v[128:131], v[164:167], v[76:79]
    s_nop 0
    ds_read_b64_tr_b16 v[152:153], v12 offset:44032
    v_permlane32_swap_b32 v232, v233
    v_mfma_f32_16x16x32_bf16 v[100:103], v[128:131], v[168:171], v[100:103]
    ds_read_b64_tr_b16 v[154:155], v12 offset:44288
    v_mfma_f32_16x16x32_bf16 v[80:83], v[132:135], v[164:167], v[80:83]
    ds_read_b64_tr_b16 v[156:157], v11 offset:45056
    buffer_load_dwordx4 v3, s[36:39], s13 offen offset:2048 sc1 lds
    v_mfma_f32_16x16x32_bf16 v[104:107], v[132:135], v[168:171], v[104:107]
    s_nop 0
    ds_read_b64_tr_b16 v[158:159], v11 offset:45312
    v_mul_f32 v240, 0xbb000000, v228
    v_mfma_f32_16x16x32_bf16 v[84:87], v[136:139], v[164:167], v[84:87]
    s_nop 0
    ds_read_b64_tr_b16 v[160:161], v12 offset:45056
    v_mul_f32 v242, 0xbb000000, v232
    v_mfma_f32_16x16x32_bf16 v[108:111], v[136:139], v[168:171], v[108:111]
    s_waitcnt vmcnt(9) lgkmcnt(5)
    ds_read_b64_tr_b16 v[162:163], v12 offset:45312
    ds_read_b128 v[246:249], v35 offset:0
    v_mfma_f32_16x16x32_bf16 v[64:67], v[140:143], v[172:175], v[64:67]
    ds_read_b64_tr_b16 v[116:117], v13 offset:0
    buffer_load_dwordx4 v3, s[36:39], s13 offen offset:3072 sc1 lds
    v_mfma_f32_16x16x32_bf16 v[88:91], v[140:143], v[176:179], v[88:91]
    ds_read_b64_tr_b16 v[118:119], v13 offset:256
    v_mfma_f32_16x16x32_bf16 v[68:71], v[144:147], v[172:175], v[68:71]
    ds_read_b64_tr_b16 v[120:121], v14 offset:0
    v_mfma_f32_16x16x32_bf16 v[92:95], v[144:147], v[176:179], v[92:95]
    ds_read_b64_tr_b16 v[122:123], v14 offset:256
    v_mfma_f32_16x16x32_bf16 v[72:75], v[148:151], v[172:175], v[72:75]
    s_waitcnt lgkmcnt(4)
    ds_read_b64_tr_b16 v[124:125], v13 offset:1024
    buffer_load_dwordx4 v[236:239], v3, s[36:39], s10 offen sc1
    v_mfma_f32_16x16x32_bf16 v[96:99], v[148:151], v[176:179], v[96:99]
    ds_read_b64_tr_b16 v[126:127], v13 offset:1280
    v_fmac_f32 v64, v246, v240
    v_mfma_f32_16x16x32_bf16 v[76:79], v[152:155], v[172:175], v[76:79]
    s_nop 0
    ds_read_b64_tr_b16 v[128:129], v14 offset:1024
    v_fmac_f32 v65, v247, v240
    v_mfma_f32_16x16x32_bf16 v[100:103], v[152:155], v[176:179], v[100:103]
    s_nop 0
    ds_read_b64_tr_b16 v[130:131], v14 offset:1280
    v_fmac_f32 v66, v248, v240
    v_mfma_f32_16x16x32_bf16 v[80:83], v[156:159], v[172:175], v[80:83]
    ds_read_b64_tr_b16 v[132:133], v13 offset:2048
    buffer_load_dwordx4 v[204:207], v3, s[40:43], s8 offen offset:3072 sc1
    v_mfma_f32_16x16x32_bf16 v[104:107], v[156:159], v[176:179], v[104:107]
    s_nop 0
    ds_read_b64_tr_b16 v[134:135], v13 offset:2304
    v_fmac_f32 v67, v249, v240
    v_mfma_f32_16x16x32_bf16 v[84:87], v[160:163], v[172:175], v[84:87]
    ds_read_b64_tr_b16 v[136:137], v14 offset:2048
    v_fmac_f32 v88, v246, v242
    v_fmac_f32 v89, v247, v242
    v_fmac_f32 v90, v248, v242
    v_fmac_f32 v91, v249, v242
    v_mfma_f32_16x16x32_bf16 v[108:111], v[160:163], v[176:179], v[108:111]
    s_waitcnt vmcnt(10) lgkmcnt(5)
    ds_read_b64_tr_b16 v[138:139], v14 offset:2304
    ds_read_b128 v[250:253], v35 offset:64
    v_mfma_f32_16x16x32_bf16 v[64:67], v[116:119], v[180:183], v[64:67]
    ds_read_b64_tr_b16 v[140:141], v13 offset:6144
    buffer_load_dwordx4 v[208:211], v3, s[40:43], s9 offen offset:3072 sc1
    v_mfma_f32_16x16x32_bf16 v[88:91], v[116:119], v[184:187], v[88:91]
    ds_read_b64_tr_b16 v[142:143], v13 offset:6400
    v_mfma_f32_16x16x32_bf16 v[68:71], v[120:123], v[180:183], v[68:71]
    s_lshl_b32 s8, s54, 12
    ds_read_b64_tr_b16 v[144:145], v14 offset:6144
    v_mfma_f32_16x16x32_bf16 v[92:95], v[120:123], v[184:187], v[92:95]
    s_add_u32 s8, s8, s12
    ds_read_b64_tr_b16 v[146:147], v14 offset:6400
    v_mfma_f32_16x16x32_bf16 v[72:75], v[124:127], v[180:183], v[72:75]
    s_add_u32 s9, s8, 16384
    ds_read_b64_tr_b16 v[148:149], v13 offset:7168
    buffer_load_dwordx4 v[164:167], v3, s[40:43], s8 offen sc1
    v_mfma_f32_16x16x32_bf16 v[96:99], v[124:127], v[184:187], v[96:99]
    s_waitcnt lgkmcnt(6)
    ds_read_b64_tr_b16 v[150:151], v13 offset:7424
    v_mfma_f32_16x16x32_bf16 v[76:79], v[128:131], v[180:183], v[76:79]
    s_waitcnt lgkmcnt(6)
    ds_read_b64_tr_b16 v[152:153], v14 offset:7168
    v_fmac_f32 v68, v250, v240
    v_mfma_f32_16x16x32_bf16 v[100:103], v[128:131], v[184:187], v[100:103]
    s_nop 0
    ds_read_b64_tr_b16 v[154:155], v14 offset:7424
    v_fmac_f32 v69, v251, v240
    v_mfma_f32_16x16x32_bf16 v[80:83], v[132:135], v[180:183], v[80:83]
    ds_read_b64_tr_b16 v[156:157], v13 offset:8192
    buffer_load_dwordx4 v[168:171], v3, s[40:43], s9 offen sc1
    v_mfma_f32_16x16x32_bf16 v[104:107], v[132:135], v[184:187], v[104:107]
    s_nop 0
    ds_read_b64_tr_b16 v[158:159], v13 offset:8448
    v_fmac_f32 v70, v252, v240
    v_mfma_f32_16x16x32_bf16 v[84:87], v[136:139], v[180:183], v[84:87]
    s_nop 0
    ds_read_b64_tr_b16 v[160:161], v14 offset:8192
    v_fmac_f32 v71, v253, v240
    v_mfma_f32_16x16x32_bf16 v[108:111], v[136:139], v[184:187], v[108:111]
    s_waitcnt vmcnt(11) lgkmcnt(5)
    ds_read_b64_tr_b16 v[162:163], v14 offset:8448
    v_fmac_f32 v92, v250, v242
    v_fmac_f32 v93, v251, v242
    v_mfma_f32_16x16x32_bf16 v[64:67], v[140:143], v[188:191], v[64:67]
    ds_read_b64_tr_b16 v[116:117], v13 offset:12288
    buffer_load_dwordx4 v[172:175], v3, s[40:43], s8 offen offset:1024 sc1
    v_fmac_f32 v94, v252, v242
    v_fmac_f32 v95, v253, v242
    v_mfma_f32_16x16x32_bf16 v[88:91], v[140:143], v[192:195], v[88:91]
    s_nop 0
    ds_read_b64_tr_b16 v[118:119], v13 offset:12544
    ds_read_b128 v[246:249], v35 offset:128
    v_mfma_f32_16x16x32_bf16 v[68:71], v[144:147], v[188:191], v[68:71]
    ds_read_b64_tr_b16 v[120:121], v14 offset:12288
    v_mfma_f32_16x16x32_bf16 v[92:95], v[144:147], v[192:195], v[92:95]
    ds_read_b64_tr_b16 v[122:123], v14 offset:12544
    v_mfma_f32_16x16x32_bf16 v[72:75], v[148:151], v[188:191], v[72:75]
    ds_read_b64_tr_b16 v[124:125], v13 offset:13312
    buffer_load_dwordx4 v[176:179], v3, s[40:43], s9 offen offset:1024 sc1
    v_mfma_f32_16x16x32_bf16 v[96:99], v[148:151], v[192:195], v[96:99]
    s_waitcnt lgkmcnt(6)
    ds_read_b64_tr_b16 v[126:127], v13 offset:13568
    v_mfma_f32_16x16x32_bf16 v[76:79], v[152:155], v[188:191], v[76:79]
    ds_read_b64_tr_b16 v[128:129], v14 offset:13312
    v_mfma_f32_16x16x32_bf16 v[100:103], v[152:155], v[192:195], v[100:103]
    ds_read_b64_tr_b16 v[130:131], v14 offset:13568
    v_mfma_f32_16x16x32_bf16 v[80:83], v[156:159], v[188:191], v[80:83]
    s_waitcnt lgkmcnt(6)
    ds_read_b64_tr_b16 v[132:133], v13 offset:14336
    buffer_load_dwordx4 v[180:183], v3, s[40:43], s8 offen offset:2048 sc1
    v_mfma_f32_16x16x32_bf16 v[104:107], v[156:159], v[192:195], v[104:107]
    s_nop 0
    ds_read_b64_tr_b16 v[134:135], v13 offset:14592
    v_fmac_f32 v72, v246, v240
    v_mfma_f32_16x16x32_bf16 v[84:87], v[160:163], v[188:191], v[84:87]
    s_nop 0
    ds_read_b64_tr_b16 v[136:137], v14 offset:14336
    v_fmac_f32 v73, v247, v240
    v_mfma_f32_16x16x32_bf16 v[108:111], v[160:163], v[192:195], v[108:111]
    s_waitcnt vmcnt(12) lgkmcnt(5)
    ds_read_b64_tr_b16 v[138:139], v14 offset:14592
    v_fmac_f32 v74, v248, v240
    v_mfma_f32_16x16x32_bf16 v[64:67], v[116:119], v[196:199], v[64:67]
    ds_read_b64_tr_b16 v[140:141], v13 offset:18432
    buffer_load_dwordx4 v[184:187], v3, s[40:43], s9 offen offset:2048 sc1
    v_mfma_f32_16x16x32_bf16 v[88:91], v[116:119], v[200:203], v[88:91]
    ds_read_b64_tr_b16 v[142:143], v13 offset:18688
    v_fmac_f32 v75, v249, v240
    v_fmac_f32 v96, v246, v242
    v_mfma_f32_16x16x32_bf16 v[68:71], v[120:123], v[196:199], v[68:71]
    s_waitcnt vmcnt(9)
    s_barrier
    ds_read_b64_tr_b16 v[144:145], v14 offset:18432
    ds_read_b64_tr_b16 a[240:241], v33 offset:0
    v_fmac_f32 v97, v247, v242
    v_fmac_f32 v98, v248, v242
    v_fmac_f32 v99, v249, v242
    v_mfma_f32_16x16x32_bf16 v[92:95], v[120:123], v[200:203], v[92:95]
    ds_read_b64_tr_b16 v[146:147], v14 offset:18688
    ds_read_b64_tr_b16 a[242:243], v33 offset:256
    ds_read_b128 v[250:253], v35 offset:192
    v_mfma_f32_16x16x32_bf16 v[72:75], v[124:127], v[196:199], v[72:75]
    s_nop 0
    ds_read_b64_tr_b16 v[148:149], v13 offset:19456
    ds_read_b128 a[244:247], v16 offset:0
    v_mfma_f32_16x16x32_bf16 v[96:99], v[124:127], v[200:203], v[96:99]
    s_waitcnt lgkmcnt(9)
    ds_read_b64_tr_b16 v[150:151], v13 offset:19712
    buffer_load_dwordx4 v[188:191], v3, s[40:43], s8 offen offset:3072 sc1
    v_mfma_f32_16x16x32_bf16 v[76:79], v[128:131], v[196:199], v[76:79]
    s_nop 0
    ds_read_b64_tr_b16 v[152:153], v14 offset:19456
    ds_read_b64_tr_b16 a[248:249], v33 offset:6144
    v_mfma_f32_16x16x32_bf16 v[100:103], v[128:131], v[200:203], v[100:103]
    s_nop 0
    ds_read_b64_tr_b16 v[154:155], v14 offset:19712
    ds_read_b64_tr_b16 a[250:251], v33 offset:6400
    v_mfma_f32_16x16x32_bf16 v[80:83], v[132:135], v[196:199], v[80:83]
    s_nop 0
    ds_read_b64_tr_b16 v[156:157], v13 offset:20480
    ds_read_b128 a[252:255], v16 offset:1024
    v_mfma_f32_16x16x32_bf16 v[104:107], v[132:135], v[200:203], v[104:107]
    ds_read_b64_tr_b16 v[158:159], v13 offset:20736
    buffer_load_dwordx4 v[192:195], v3, s[40:43], s9 offen offset:3072 sc1
    v_mfma_f32_16x16x32_bf16 v[84:87], v[136:139], v[196:199], v[84:87]
    s_waitcnt lgkmcnt(10)
    ds_read_b64_tr_b16 v[160:161], v14 offset:20480
    v_fmac_f32 v76, v250, v240
    v_mfma_f32_16x16x32_bf16 v[108:111], v[136:139], v[200:203], v[108:111]
    s_waitcnt lgkmcnt(9)
    ds_read_b64_tr_b16 v[162:163], v14 offset:20736
    ds_read_b64_tr_b16 v[212:213], v33 offset:12288
    v_mfma_f32_16x16x32_bf16 v[112:115], a[240:243], a[244:247], 0
    s_waitcnt vmcnt(8) lgkmcnt(10)
    ds_read_b64_tr_b16 v[214:215], v33 offset:12544
    v_fmac_f32 v77, v251, v240
    v_mfma_f32_16x16x32_bf16 v[64:67], v[140:143], v[204:207], v[64:67]
    s_nop 0
    ds_read_b64_tr_b16 v[116:117], v13 offset:24576
    ds_read_b128 v[216:219], v16 offset:2048
    v_mfma_f32_16x16x32_bf16 v[88:91], v[140:143], v[208:211], v[88:91]
    s_nop 0
    ds_read_b64_tr_b16 v[118:119], v13 offset:24832
    v_fmac_f32 v78, v252, v240
    v_mfma_f32_16x16x32_bf16 v[68:71], v[144:147], v[204:207], v[68:71]
    s_waitcnt lgkmcnt(8)
    ds_read_b64_tr_b16 v[120:121], v14 offset:24576
    v_fmac_f32 v79, v253, v240
    v_mfma_f32_16x16x32_bf16 v[112:115], a[248:251], a[252:255], v[112:115]
    s_nop 0
    ds_read_b64_tr_b16 v[122:123], v14 offset:24832
    ds_read_b64_tr_b16 v[220:221], v33 offset:18432
    v_mfma_f32_16x16x32_bf16 v[92:95], v[144:147], v[208:211], v[92:95]
    ds_read_b64_tr_b16 v[222:223], v33 offset:18688
    v_fmac_f32 v100, v250, v242
    v_fmac_f32 v101, v251, v242
    v_mfma_f32_16x16x32_bf16 v[72:75], v[148:151], v[204:207], v[72:75]
    ds_read_b64_tr_b16 v[124:125], v13 offset:25600
    ds_read_b128 v[224:227], v16 offset:3072
    v_fmac_f32 v102, v252, v242
    v_fmac_f32 v103, v253, v242
    v_mfma_f32_16x16x32_bf16 v[96:99], v[148:151], v[208:211], v[96:99]
    s_waitcnt lgkmcnt(11)
    ds_read_b64_tr_b16 v[126:127], v13 offset:25856
    s_getpc_b64 s[6:7]
    global_load_dword v7, v47, s[6:7]
    v_mfma_f32_16x16x32_bf16 v[76:79], v[152:155], v[204:207], v[76:79]
    s_waitcnt lgkmcnt(8)
    ds_read_b64_tr_b16 v[128:129], v14 offset:25600
    ds_read_b128 v[246:249], v35 offset:256
    v_mfma_f32_16x16x32_bf16 v[112:115], v[212:215], v[216:219], v[112:115]
    s_nop 0
    ds_read_b64_tr_b16 v[130:131], v14 offset:25856
    ds_read_b64_tr_b16 a[240:241], v33 offset:24576
    v_mfma_f32_16x16x32_bf16 v[100:103], v[152:155], v[208:211], v[100:103]
    ds_read_b64_tr_b16 a[242:243], v33 offset:24832
    v_mfma_f32_16x16x32_bf16 v[80:83], v[156:159], v[204:207], v[80:83]
    s_nop 0
    ds_read_b64_tr_b16 v[132:133], v13 offset:26624
    ds_read_b128 a[244:247], v16 offset:4096
    v_mfma_f32_16x16x32_bf16 v[104:107], v[156:159], v[208:211], v[104:107]
    ds_read_b64_tr_b16 v[134:135], v13 offset:26880
    v_mfma_f32_16x16x32_bf16 v[84:87], v[160:163], v[204:207], v[84:87]
    s_waitcnt lgkmcnt(9)
    ds_read_b64_tr_b16 v[136:137], v14 offset:26624
    v_mfma_f32_16x16x32_bf16 v[112:115], v[220:223], v[224:227], v[112:115]
    s_nop 0
    ds_read_b64_tr_b16 v[138:139], v14 offset:26880
    ds_read_b64_tr_b16 a[248:249], v33 offset:30720
    v_mfma_f32_16x16x32_bf16 v[108:111], v[160:163], v[208:211], v[108:111]
    s_waitcnt lgkmcnt(9)
    s_waitcnt vmcnt(7)
    ds_read_b64_tr_b16 a[250:251], v33 offset:30976
    v_fmac_f32 v80, v246, v240
    v_mfma_f32_16x16x32_bf16 v[64:67], v[116:119], v[164:167], v[64:67]
    s_nop 0
    ds_read_b64_tr_b16 v[140:141], v13 offset:30720
    ds_read_b128 a[252:255], v16 offset:5120
    v_mfma_f32_16x16x32_bf16 v[88:91], v[116:119], v[168:171], v[88:91]
    s_nop 0
    ds_read_b64_tr_b16 v[142:143], v13 offset:30976
    v_fmac_f32 v81, v247, v240
    v_mfma_f32_16x16x32_bf16 v[68:71], v[120:123], v[164:167], v[68:71]
    s_waitcnt lgkmcnt(8)
    ds_read_b64_tr_b16 v[144:145], v14 offset:30720
    v_fmac_f32 v82, v248, v240
    v_mfma_f32_16x16x32_bf16 v[112:115], a[240:243], a[244:247], v[112:115]
    s_nop 0
    ds_read_b64_tr_b16 v[146:147], v14 offset:30976
    ds_read_b64_tr_b16 v[212:213], v33 offset:36864
    v_mfma_f32_16x16x32_bf16 v[92:95], v[120:123], v[168:171], v[92:95]
    s_nop 0
    ds_read_b64_tr_b16 v[214:215], v33 offset:37120
    v_fmac_f32 v83, v249, v240
    v_mfma_f32_16x16x32_bf16 v[72:75], v[124:127], v[164:167], v[72:75]
    s_nop 0
    ds_read_b64_tr_b16 v[148:149], v13 offset:31744
    ds_read_b128 v[216:219], v16 offset:6144
    v_mfma_f32_16x16x32_bf16 v[96:99], v[124:127], v[168:171], v[96:99]
    s_waitcnt lgkmcnt(11)
    ds_read_b64_tr_b16 v[150:151], v13 offset:32000
    v_fmac_f32 v104, v246, v242
    v_mfma_f32_16x16x32_bf16 v[76:79], v[128:131], v[164:167], v[76:79]
    s_waitcnt lgkmcnt(8)
    ds_read_b64_tr_b16 v[152:153], v14 offset:31744
    v_fmac_f32 v105, v247, v242
    v_fmac_f32 v106, v248, v242
    v_mfma_f32_16x16x32_bf16 v[112:115], a[248:251], a[252:255], v[112:115]
    ds_read_b64_tr_b16 v[154:155], v14 offset:32000
    ds_read_b64_tr_b16 v[220:221], v33 offset:43008
    v_fmac_f32 v107, v249, v242
    v_mfma_f32_16x16x32_bf16 v[100:103], v[128:131], v[168:171], v[100:103]
    s_nop 0
    ds_read_b64_tr_b16 v[222:223], v33 offset:43264
    ds_read_b128 v[250:253], v35 offset:320
    v_mfma_f32_16x16x32_bf16 v[80:83], v[132:135], v[164:167], v[80:83]
    s_nop 0
    ds_read_b64_tr_b16 v[156:157], v13 offset:32768
    ds_read_b128 v[224:227], v16 offset:7168
    v_mfma_f32_16x16x32_bf16 v[104:107], v[132:135], v[168:171], v[104:107]
    ds_read_b64_tr_b16 v[158:159], v13 offset:33024
    v_mfma_f32_16x16x32_bf16 v[84:87], v[136:139], v[164:167], v[84:87]
    s_waitcnt lgkmcnt(9)
    ds_read_b64_tr_b16 v[160:161], v14 offset:32768
    v_mfma_f32_16x16x32_bf16 v[112:115], v[212:215], v[216:219], v[112:115]
    s_nop 0
    ds_read_b64_tr_b16 v[162:163], v14 offset:33024
    ds_read_b64_tr_b16 a[240:241], v34 offset:0
    v_mfma_f32_16x16x32_bf16 v[108:111], v[136:139], v[168:171], v[108:111]
    s_waitcnt vmcnt(5) lgkmcnt(11)
    ds_read_b64_tr_b16 a[242:243], v34 offset:256
    v_mfma_f32_16x16x32_bf16 v[64:67], v[140:143], v[172:175], v[64:67]
    ds_read_b64_tr_b16 v[116:117], v13 offset:36864
    ds_read_b128 a[244:247], v16 offset:8192
    v_mfma_f32_16x16x32_bf16 v[88:91], v[140:143], v[176:179], v[88:91]
    s_waitcnt lgkmcnt(9)
    ds_read_b64_tr_b16 v[118:119], v13 offset:37120
    v_fmac_f32 v84, v250, v240
    v_mfma_f32_16x16x32_bf16 v[68:71], v[144:147], v[172:175], v[68:71]
    s_waitcnt lgkmcnt(8)
    ds_read_b64_tr_b16 v[120:121], v14 offset:36864
    v_fmac_f32 v85, v251, v240
    v_mfma_f32_16x16x32_bf16 v[112:115], v[220:223], v[224:227], v[112:115]
    s_nop 0
    ds_read_b64_tr_b16 v[122:123], v14 offset:37120
    ds_read_b64_tr_b16 a[248:249], v34 offset:6144
    v_mfma_f32_16x16x32_bf16 v[92:95], v[144:147], v[176:179], v[92:95]
    s_nop 0
    ds_read_b64_tr_b16 a[250:251], v34 offset:6400
    v_fmac_f32 v86, v252, v240
    v_mfma_f32_16x16x32_bf16 v[72:75], v[148:151], v[172:175], v[72:75]
    s_nop 0
    ds_read_b64_tr_b16 v[124:125], v13 offset:37888
    ds_read_b128 a[252:255], v16 offset:9216
    v_mfma_f32_16x16x32_bf16 v[96:99], v[148:151], v[176:179], v[96:99]
    s_waitcnt lgkmcnt(11)
    ds_read_b64_tr_b16 v[126:127], v13 offset:38144
    v_fmac_f32 v87, v253, v240
    v_mfma_f32_16x16x32_bf16 v[76:79], v[152:155], v[172:175], v[76:79]
    s_waitcnt lgkmcnt(8)
    ds_read_b64_tr_b16 v[128:129], v14 offset:37888
    v_fmac_f32 v108, v250, v242
    v_mfma_f32_16x16x32_bf16 v[112:115], a[240:243], a[244:247], v[112:115]
    s_nop 0
    ds_read_b64_tr_b16 v[130:131], v14 offset:38144
    ds_read_b64_tr_b16 v[212:213], v34 offset:12288
    v_mfma_f32_16x16x32_bf16 v[100:103], v[152:155], v[176:179], v[100:103]
    ds_read_b64_tr_b16 v[214:215], v34 offset:12544
    v_fmac_f32 v109, v251, v242
    v_fmac_f32 v110, v252, v242
    v_mfma_f32_16x16x32_bf16 v[80:83], v[156:159], v[172:175], v[80:83]
    ds_read_b64_tr_b16 v[132:133], v13 offset:38912
    ds_read_b128 v[216:219], v16 offset:10240
    v_fmac_f32 v111, v253, v242
    v_mfma_f32_16x16x32_bf16 v[104:107], v[156:159], v[176:179], v[104:107]
    s_nop 0
    ds_read_b64_tr_b16 v[134:135], v13 offset:39168
    v_mul_f32 v229, 0x3b000000, v229
    v_mfma_f32_16x16x32_bf16 v[84:87], v[160:163], v[172:175], v[84:87]
    s_waitcnt lgkmcnt(8)
    ds_read_b64_tr_b16 v[136:137], v14 offset:38912
    v_mul_f32 v233, 0x3b000000, v233
    v_mfma_f32_16x16x32_bf16 v[112:115], a[248:251], a[252:255], v[112:115]
    s_nop 0
    ds_read_b64_tr_b16 v[138:139], v14 offset:39168
    ds_read_b64_tr_b16 v[220:221], v34 offset:18432
    v_mfma_f32_16x16x32_bf16 v[108:111], v[160:163], v[176:179], v[108:111]
    s_waitcnt vmcnt(3) lgkmcnt(10)
    ds_read_b64_tr_b16 v[222:223], v34 offset:18688
    v_fma_f32 v229, -v240, v240, v229
    v_mfma_f32_16x16x32_bf16 v[64:67], v[116:119], v[180:183], v[64:67]
    s_nop 0
    ds_read_b64_tr_b16 v[140:141], v13 offset:43008
    ds_read_b128 v[224:227], v16 offset:11264
    v_mfma_f32_16x16x32_bf16 v[88:91], v[116:119], v[184:187], v[88:91]
    s_nop 0
    ds_read_b64_tr_b16 v[142:143], v13 offset:43264
    v_fma_f32 v233, -v242, v242, v233
    v_mfma_f32_16x16x32_bf16 v[68:71], v[120:123], v[180:183], v[68:71]
    s_waitcnt lgkmcnt(8)
    ds_read_b64_tr_b16 v[144:145], v14 offset:43008
    v_max_f32 v229, 0, v229
    v_mfma_f32_16x16x32_bf16 v[112:115], v[212:215], v[216:219], v[112:115]
    s_nop 0
    ds_read_b64_tr_b16 v[146:147], v14 offset:43264
    ds_read_b64_tr_b16 a[240:241], v34 offset:24576
    v_mfma_f32_16x16x32_bf16 v[92:95], v[120:123], v[184:187], v[92:95]
    s_nop 0
    ds_read_b64_tr_b16 a[242:243], v34 offset:24832
    v_max_f32 v233, 0, v233
    v_mfma_f32_16x16x32_bf16 v[72:75], v[124:127], v[180:183], v[72:75]
    s_nop 0
    ds_read_b64_tr_b16 v[148:149], v13 offset:44032
    ds_read_b128 a[244:247], v16 offset:12288
    v_mfma_f32_16x16x32_bf16 v[96:99], v[124:127], v[184:187], v[96:99]
    s_waitcnt lgkmcnt(11)
    ds_read_b64_tr_b16 v[150:151], v13 offset:44288
    ds_read_b64_tr_b16 a[248:249], v34 offset:30720
    v_mfma_f32_16x16x32_bf16 v[76:79], v[128:131], v[180:183], v[76:79]
    s_waitcnt lgkmcnt(9)
    ds_read_b64_tr_b16 v[152:153], v14 offset:44032
    ds_read_b64_tr_b16 a[250:251], v34 offset:30976
    v_mfma_f32_16x16x32_bf16 v[112:115], v[220:223], v[224:227], v[112:115]
    s_nop 0
    ds_read_b64_tr_b16 v[154:155], v14 offset:44288
    ds_read_b128 a[252:255], v16 offset:13312
    v_mfma_f32_16x16x32_bf16 v[100:103], v[128:131], v[184:187], v[100:103]
    s_nop 0
    ds_read_b64_tr_b16 v[212:213], v34 offset:36864
    v_add_f32 v229, 0x3727c5ac, v229
    v_mfma_f32_16x16x32_bf16 v[80:83], v[132:135], v[180:183], v[80:83]
    s_nop 0
    ds_read_b64_tr_b16 v[156:157], v13 offset:45056
    ds_read_b64_tr_b16 v[214:215], v34 offset:37120
    v_mfma_f32_16x16x32_bf16 v[104:107], v[132:135], v[184:187], v[104:107]
    s_nop 0
    ds_read_b64_tr_b16 v[158:159], v13 offset:45312
    ds_read_b128 v[216:219], v16 offset:14336
    v_mfma_f32_16x16x32_bf16 v[84:87], v[136:139], v[180:183], v[84:87]
    s_waitcnt lgkmcnt(11)
    ds_read_b64_tr_b16 v[160:161], v14 offset:45056
    ds_read_b64_tr_b16 v[220:221], v34 offset:43008
    v_mfma_f32_16x16x32_bf16 v[112:115], a[240:243], a[244:247], v[112:115]
    s_nop 0
    ds_read_b64_tr_b16 v[162:163], v14 offset:45312
    ds_read_b64_tr_b16 v[222:223], v34 offset:43264
    v_mfma_f32_16x16x32_bf16 v[108:111], v[136:139], v[184:187], v[108:111]
    s_waitcnt vmcnt(1) lgkmcnt(14)
    ds_read_b128 v[224:227], v16 offset:15360
    v_add_f32 v233, 0x3727c5ac, v233
    v_mfma_f32_16x16x32_bf16 v[64:67], v[140:143], v[188:191], v[64:67]
    s_waitcnt lgkmcnt(10)
    ds_read_b128 v[246:249], v45
    v_rsq_f32 v241, v229
    v_rsq_f32 v243, v233
    v_mfma_f32_16x16x32_bf16 v[112:115], a[248:251], a[252:255], v[112:115]
    v_add_f32 v236, v236, v238
    v_add_f32 v237, v237, v239
    v_mfma_f32_16x16x32_bf16 v[88:91], v[140:143], v[192:195], v[88:91]
    s_nop 0
    v_permlane32_swap_b32 v236, v237
    v_add_f32 v236, v236, v237
    v_mfma_f32_16x16x32_bf16 v[68:71], v[144:147], v[188:191], v[68:71]
    s_waitcnt lgkmcnt(6)
    v_mov_b32 v237, v236
    s_nop 1
    v_permlane16_swap_b32 v236, v237
    v_mfma_f32_16x16x32_bf16 v[112:115], v[212:215], v[216:219], v[112:115]
    v_add_f32 v236, v236, v237
    v_mov_b32 v237, v236
    v_mfma_f32_16x16x32_bf16 v[92:95], v[144:147], v[192:195], v[92:95]
    s_nop 0
    v_permlane32_swap_b32 v236, v237
    v_mul_f32 v244, 0xbb000000, v236
    v_mul_f32 v237, 0x3b000000, v237
    v_fma_f32 v237, -v244, v244, v237
    v_max_f32 v237, 0, v237
    v_add_f32 v237, 0x3727c5ac, v237
    v_rsq_f32 v245, v237
    v_mfma_f32_16x16x32_bf16 v[72:75], v[148:151], v[188:191], v[72:75]
    s_waitcnt lgkmcnt(1)
    s_barrier
    v_mfma_f32_16x16x32_bf16 v[112:115], v[220:223], v[224:227], v[112:115]
    v_mfma_f32_16x16x32_bf16 v[96:99], v[148:151], v[192:195], v[96:99]
    v_mfma_f32_16x16x32_bf16 v[76:79], v[152:155], v[188:191], v[76:79]
    v_mfma_f32_16x16x32_bf16 v[100:103], v[152:155], v[192:195], v[100:103]
    v_mfma_f32_16x16x32_bf16 v[80:83], v[156:159], v[188:191], v[80:83]
    v_mfma_f32_16x16x32_bf16 v[104:107], v[156:159], v[192:195], v[104:107]
    v_mfma_f32_16x16x32_bf16 v[84:87], v[160:163], v[188:191], v[84:87]
    v_mfma_f32_16x16x32_bf16 v[108:111], v[160:163], v[192:195], v[108:111]
    s_waitcnt lgkmcnt(0)
    s_add_u32 m0, s71, 0x0
    s_add_u32 s75, s70, 0x0
    buffer_load_dwordx4 v3, s[36:39], s75 offen sc1 lds
    v_pk_mul_f32 v[96:97], v[96:97], v[242:243] op_sel:[0,1] op_sel_hi:[1,1]
    v_pk_mul_f32 v[98:99], v[98:99], v[242:243] op_sel:[0,1] op_sel_hi:[1,1]
    v_cvt_pk_bf16_f32 v168, v96, v97
    v_cvt_pk_bf16_f32 v169, v98, v99
    v_pk_mul_f32 v[100:101], v[100:101], v[242:243] op_sel:[0,1] op_sel_hi:[1,1]
    v_pk_mul_f32 v[102:103], v[102:103], v[242:243] op_sel:[0,1] op_sel_hi:[1,1]
    ds_write_b64 v41, v[168:169] offset:1024
    v_cvt_pk_bf16_f32 v170, v100, v101
    v_cvt_pk_bf16_f32 v171, v102, v103
    v_pk_fma_f32 v[112:113], v[246:247], v[244:245], v[112:113] op_sel:[0,0,0] op_sel_hi:[1,0,1]
    s_add_u32 m0, s71, 0x800
    s_add_u32 s75, s70, 0x8000
    buffer_load_dwordx4 v3, s[36:39], s75 offen sc1 lds
    v_pk_fma_f32 v[114:115], v[248:249], v[244:245], v[114:115] op_sel:[0,0,0] op_sel_hi:[1,0,1]
    ds_write_b64 v41, v[170:171] offset:1536
    v_pk_mul_f32 v[112:113], v[112:113], v[244:245] op_sel:[0,1] op_sel_hi:[1,1]
    v_pk_mul_f32 v[114:115], v[114:115], v[244:245] op_sel:[0,1] op_sel_hi:[1,1]
    v_cvt_pk_bf16_f32 v188, v112, v113
    v_cvt_pk_bf16_f32 v189, v114, v115
    v_pk_mul_f32 v[80:81], v[80:81], v[240:241] op_sel:[0,1] op_sel_hi:[1,1]
    v_pk_mul_f32 v[82:83], v[82:83], v[240:241] op_sel:[0,1] op_sel_hi:[1,1]
    ds_write_b64 v32, v[188:189]
    v_cvt_pk_bf16_f32 v180, v80, v81
    s_add_u32 m0, s71, 0x1000
    s_add_u32 s75, s19, 0x10000
    buffer_load_dwordx4 v3, s[36:39], s75 offen sc1 lds
    v_cvt_pk_bf16_f32 v181, v82, v83
    v_pk_mul_f32 v[84:85], v[84:85], v[240:241] op_sel:[0,1] op_sel_hi:[1,1]
    v_pk_mul_f32 v[86:87], v[86:87], v[240:241] op_sel:[0,1] op_sel_hi:[1,1]
    ds_write_b64 v31, v[180:181] offset:0
    v_cvt_pk_bf16_f32 v182, v84, v85
    v_cvt_pk_bf16_f32 v183, v86, v87
    v_pk_mul_f32 v[104:105], v[104:105], v[242:243] op_sel:[0,1] op_sel_hi:[1,1]
    v_pk_mul_f32 v[106:107], v[106:107], v[242:243] op_sel:[0,1] op_sel_hi:[1,1]
    ds_write_b64 v31, v[182:183] offset:512
    v_cvt_pk_bf16_f32 v184, v104, v105
    s_add_u32 m0, s71, 0x3000
    s_add_u32 s75, s70, 0x1000
    buffer_load_dwordx4 v3, s[36:39], s75 offen sc1 lds
    v_cvt_pk_bf16_f32 v185, v106, v107
    v_pk_mul_f32 v[108:109], v[108:109], v[242:243] op_sel:[0,1] op_sel_hi:[1,1]
    v_pk_mul_f32 v[110:111], v[110:111], v[242:243] op_sel:[0,1] op_sel_hi:[1,1]
    ds_write_b64 v31, v[184:185] offset:1024
    v_cvt_pk_bf16_f32 v186, v108, v109
    v_cvt_pk_bf16_f32 v187, v110, v111
    v_pk_mul_f32 v[72:73], v[72:73], v[240:241] op_sel:[0,1] op_sel_hi:[1,1]
    v_pk_mul_f32 v[74:75], v[74:75], v[240:241] op_sel:[0,1] op_sel_hi:[1,1]
    ds_write_b64 v31, v[186:187] offset:1536
    v_cvt_pk_bf16_f32 v164, v72, v73
    s_add_u32 m0, s71, 0x3800
    s_add_u32 s75, s70, 0x9000
    buffer_load_dwordx4 v3, s[36:39], s75 offen sc1 lds
    v_cvt_pk_bf16_f32 v165, v74, v75
    v_pk_mul_f32 v[76:77], v[76:77], v[240:241] op_sel:[0,1] op_sel_hi:[1,1]
    v_pk_mul_f32 v[78:79], v[78:79], v[240:241] op_sel:[0,1] op_sel_hi:[1,1]
    v_cvt_pk_bf16_f32 v166, v76, v77
    v_cvt_pk_bf16_f32 v167, v78, v79
    v_cvt_pk_bf16_f32 v176, v88, v89
    v_cvt_pk_bf16_f32 v177, v90, v91
    v_cvt_pk_bf16_f32 v178, v92, v93
    v_cvt_pk_bf16_f32 v179, v94, v95
    v_cvt_pk_bf16_f32 v172, v64, v65
    s_add_u32 m0, s71, 0x4000
    s_add_u32 s75, s19, 0x11000
    buffer_load_dwordx4 v3, s[36:39], s75 offen sc1 lds
    v_cvt_pk_bf16_f32 v173, v66, v67
    v_cvt_pk_bf16_f32 v174, v68, v69
    v_cvt_pk_bf16_f32 v175, v70, v71
    s_waitcnt lgkmcnt(0)
    s_barrier
    ds_read_b64 v[224:225], v41 offset:0
    ds_read_b64 v[226:227], v41 offset:512
    v_mfma_f32_16x16x16_bf16 v[64:67], v[164:165], v[176:177], 0
    s_mul_i32 s4, s59, 43
    ds_read_b64_tr_b16 v[212:213], v40 offset:0
    s_add_u32 m0, s71, 0x6000
    s_add_u32 s75, s70, 0x2000
    buffer_load_dwordx4 v3, s[36:39], s75 offen sc1 lds
    v_mfma_f32_16x16x16_bf16 v[68:71], v[168:169], v[176:177], 0
    s_add_u32 s4, s4, s50
    ds_read_b64_tr_b16 v[214:215], v40 offset:1024
    v_mfma_f32_16x16x16_bf16 v[72:75], v[166:167], v[178:179], 0
    s_lshl_b32 s4, s4, 10
    ds_read_b64_tr_b16 v[216:217], v40 offset:2048
    v_mfma_f32_16x16x16_bf16 v[76:79], v[170:171], v[178:179], 0
    s_add_u32 s4, s4, 0x600000
    s_add_u32 m0, s71, 0x6800
    s_add_u32 s75, s70, 0xa000
    buffer_load_dwordx4 v3, s[36:39], s75 offen sc1 lds
    ds_read_b64_tr_b16 v[218:219], v40 offset:512
    v_mfma_f32_16x16x16_bf16 v[84:87], v[164:165], v[172:173], 0
    s_add_u32 s5, s4, 44032
    ds_read_b64_tr_b16 v[220:221], v40 offset:1536
    v_mfma_f32_16x16x16_bf16 v[92:95], v[166:167], v[174:175], 0
    ds_read_b64_tr_b16 v[222:223], v40 offset:2560
    s_waitcnt lgkmcnt(6)
    s_add_u32 m0, s71, 0x7000
    s_add_u32 s75, s19, 0x12000
    buffer_load_dwordx4 v3, s[36:39], s75 offen sc1 lds
    v_mfma_f32_16x16x16_bf16 v[80:83], v[224:225], v[172:173], v[26:29]
    v_mul_f32 v241, 0x3eb8aa3b, v241
    v_mfma_f32_16x16x16_bf16 v[88:91], v[226:227], v[174:175], v[26:29]
    v_mul_f32 v243, 0x3eb8aa3b, v243
    v_cndmask_b32 v142, v68, v69, s[64:65]
    v_cndmask_b32 v146, v76, v77, s[64:65]
    v_cndmask_b32 v150, v84, v85, s[64:65]
    s_add_u32 m0, s71, 0x9000
    s_add_u32 s75, s70, 0x3000
    buffer_load_dwordx4 v3, s[36:39], s75 offen sc1 lds
    v_cndmask_b32 v154, v92, v93, s[64:65]
    v_cndmask_b32 v143, v70, v71, s[64:65]
    v_cndmask_b32 v147, v78, v79, s[64:65]
    v_cndmask_b32 v151, v86, v87, s[64:65]
    v_cndmask_b32 v155, v94, v95, s[64:65]
    v_cndmask_b32 v140, v64, v65, s[64:65]
    v_cndmask_b32 v144, v72, v73, s[64:65]
    v_cndmask_b32 v148, v80, v81, s[64:65]
    v_cndmask_b32 v152, v88, v89, s[64:65]
    v_cndmask_b32 v141, v66, v67, s[64:65]
    s_add_u32 m0, s71, 0x9800
    s_add_u32 s75, s70, 0xb000
    buffer_load_dwordx4 v3, s[36:39], s75 offen sc1 lds
    v_cndmask_b32 v145, v74, v75, s[64:65]
    v_cndmask_b32 v149, v82, v83, s[64:65]
    v_cndmask_b32 v153, v90, v91, s[64:65]
    v_cndmask_b32 v140, v140, v142, s[66:67]
    v_cndmask_b32 v144, v144, v146, s[66:67]
    v_cndmask_b32 v148, v148, v150, s[66:67]
    v_cndmask_b32 v152, v152, v154, s[66:67]
    v_cndmask_b32 v141, v141, v143, s[68:69]
    v_cndmask_b32 v145, v145, v147, s[68:69]
    v_cndmask_b32 v149, v149, v151, s[68:69]
    s_add_u32 m0, s71, 0xa000
    s_add_u32 s75, s19, 0x13000
    buffer_load_dwordx4 v3, s[36:39], s75 offen sc1 lds
    v_cndmask_b32 v153, v153, v155, s[68:69]
    v_pk_mul_f32 v[140:141], v[140:141], v[242:243] op_sel:[0,1] op_sel_hi:[1,1]
    v_pk_mul_f32 v[144:145], v[144:145], v[242:243] op_sel:[0,1] op_sel_hi:[1,1]
    v_pk_mul_f32 v[148:149], v[148:149], v[240:241] op_sel:[0,1] op_sel_hi:[1,1]
    v_pk_mul_f32 v[152:153], v[152:153], v[240:241] op_sel:[0,1] op_sel_hi:[1,1]
    v_max_f32 v158, v140, v141
    v_max_f32 v159, v144, v145
    v_max_f32 v156, v148, v149
    v_max_f32 v157, v152, v153
    v_permlane32_swap_b32 v158, v159
    s_add_u32 m0, s71, 0xc000
    s_add_u32 s75, s70, 0x4000
    buffer_load_dwordx4 v3, s[36:39], s75 offen sc1 lds
    v_permlane32_swap_b32 v156, v157
    v_max_f32 v158, v158, v159
    v_max_f32 v156, v156, v157
    v_mov_b32 v159, v158
    v_mov_b32 v157, v156
    s_nop 0
    v_permlane16_swap_b32 v158, v159
    v_permlane16_swap_b32 v156, v157
    v_max_f32 v158, v158, v159
    v_max_f32 v156, v156, v157
    v_mov_b32 v159, v158
    s_add_u32 m0, s71, 0xc800
    s_add_u32 s75, s70, 0xc000
    buffer_load_dwordx4 v3, s[36:39], s75 offen sc1 lds
    v_mov_b32 v157, v156
    v_permlane32_swap_b32 v158, v159
    s_nop 0
    v_permlane32_swap_b32 v156, v157
    v_pk_add_f32 v[140:141], v[140:141], v[158:159] op_sel:[0,0] op_sel_hi:[1,0] neg_lo:[0,1] neg_hi:[0,1]
    v_pk_add_f32 v[144:145], v[144:145], v[158:159] op_sel:[0,1] op_sel_hi:[1,1] neg_lo:[0,1] neg_hi:[0,1]
    v_pk_add_f32 v[148:149], v[148:149], v[156:157] op_sel:[0,0] op_sel_hi:[1,0] neg_lo:[0,1] neg_hi:[0,1]
    v_pk_add_f32 v[152:153], v[152:153], v[156:157] op_sel:[0,1] op_sel_hi:[1,1] neg_lo:[0,1] neg_hi:[0,1]
    v_exp_f32 v140, v140
    v_exp_f32 v144, v144
    s_add_u32 m0, s71, 0xd000
    s_add_u32 s75, s19, 0x14000
    buffer_load_dwordx4 v3, s[36:39], s75 offen sc1 lds
    v_exp_f32 v148, v148
    v_exp_f32 v152, v152
    v_exp_f32 v141, v141
    v_exp_f32 v145, v145
    v_exp_f32 v149, v149
    v_exp_f32 v153, v153
    v_cvt_pk_bf16_f32 v140, v140, v141
    v_cvt_pk_bf16_f32 v144, v144, v145
    v_cvt_pk_bf16_f32 v148, v148, v149
    v_cvt_pk_bf16_f32 v152, v152, v153
    s_waitcnt lgkmcnt(0)
    v_perm_b32 v96, v140, v140, v18
    v_perm_b32 v97, v140, v140, v19
    v_perm_b32 v98, v140, v140, v20
    v_perm_b32 v99, v140, v140, v21
    v_perm_b32 v100, v144, v144, v18
    v_perm_b32 v101, v144, v144, v19
    v_mfma_f32_16x16x32_bf16 v[68:71], v[22:25], v[96:99], 0
    v_perm_b32 v102, v144, v144, v20
    v_perm_b32 v103, v144, v144, v21
    v_mfma_f32_16x16x32_bf16 v[64:67], v[214:217], v[96:99], 0
    v_perm_b32 v104, v148, v148, v18
    v_perm_b32 v105, v148, v148, v19
    v_mfma_f32_16x16x32_bf16 v[76:79], v[22:25], v[100:103], 0
    v_perm_b32 v106, v148, v148, v20
    v_perm_b32 v107, v148, v148, v21
    v_mfma_f32_16x16x32_bf16 v[72:75], v[220:223], v[100:103], 0
    v_perm_b32 v108, v152, v152, v18
    v_perm_b32 v109, v152, v152, v19
    v_mfma_f32_16x16x32_bf16 v[84:87], v[22:25], v[104:107], 0
    v_perm_b32 v110, v152, v152, v20
    v_perm_b32 v111, v152, v152, v21
    v_mfma_f32_16x16x32_bf16 v[80:83], v[212:215], v[104:107], 0
    v_rcp_f32 v68, v68
    v_mfma_f32_16x16x32_bf16 v[92:95], v[22:25], v[108:111], 0
    v_rcp_f32 v76, v76
    v_mfma_f32_16x16x32_bf16 v[88:91], v[218:221], v[108:111], 0
    v_pk_mul_f32 v[64:65], v[64:65], v[68:69] op_sel:[0,0] op_sel_hi:[1,0]
    v_pk_mul_f32 v[66:67], v[66:67], v[68:69] op_sel:[0,0] op_sel_hi:[1,0]
    v_cvt_pk_bf16_f32 v168, v64, v65
    v_cvt_pk_bf16_f32 v169, v66, v67
    v_pk_mul_f32 v[72:73], v[72:73], v[76:77] op_sel:[0,0] op_sel_hi:[1,0]
    v_pk_mul_f32 v[74:75], v[74:75], v[76:77] op_sel:[0,0] op_sel_hi:[1,0]
    v_cvt_pk_bf16_f32 v170, v72, v73
    v_cvt_pk_bf16_f32 v171, v74, v75
    v_rcp_f32 v84, v84
    v_rcp_f32 v92, v92
    v_pk_mul_f32 v[80:81], v[80:81], v[84:85] op_sel:[0,0] op_sel_hi:[1,0]
    v_pk_mul_f32 v[82:83], v[82:83], v[84:85] op_sel:[0,0] op_sel_hi:[1,0]
    v_cvt_pk_bf16_f32 v164, v80, v81
    v_cvt_pk_bf16_f32 v165, v82, v83
    v_pk_mul_f32 v[88:89], v[88:89], v[92:93] op_sel:[0,0] op_sel_hi:[1,0]
    v_pk_mul_f32 v[90:91], v[90:91], v[92:93] op_sel:[0,0] op_sel_hi:[1,0]
    v_cvt_pk_bf16_f32 v166, v88, v89
    v_cvt_pk_bf16_f32 v167, v90, v91
    buffer_store_dwordx4 v[168:171], v3, s[36:39], s5 offen sc0 sc1
    buffer_store_dwordx4 v[164:167], v3, s[36:39], s4 offen sc0 sc1
    s_add_u32 m0, s71, 0xf000
    s_add_u32 s75, s70, 0x7000
    buffer_load_dwordx4 v3, s[36:39], s75 offen sc1 lds
    s_add_u32 m0, s71, 0xf800
    s_add_u32 s75, s70, 0xf000
    buffer_load_dwordx4 v3, s[36:39], s75 offen sc1 lds
    s_add_u32 m0, s71, 0x10000
    s_add_u32 s75, s19, 0x17000
    buffer_load_dwordx4 v3, s[36:39], s75 offen sc1 lds
    v_mov_b32 v4, 5
    s_cmp_lg_u32 s48, 0
    s_mov_b64 exec, 1
    s_waitcnt vmcnt(3)
    s_barrier
    s_cbranch_scc1 Lq_s_30
    buffer_store_dword v4, off, s[36:39], s55 sc0 sc1
Lq_s_30:
    s_mov_b64 exec, -1
    s_mul_i32 s4, s48, 4096
    s_add_u32 s4, s4, 0x600000
    s_xor_b32 s5, s48, 0
    s_add_u32 s5, s5, s61
    s_mul_i32 s5, s5, 44032
    s_add_u32 s10, s5, s4
    s_xor_b32 s5, s48, 1
    s_add_u32 s5, s5, s61
    s_mul_i32 s5, s5, 44032
    s_add_u32 s11, s5, s4
    s_xor_b32 s5, s48, 2
    s_add_u32 s5, s5, s61
    s_mul_i32 s5, s5, 44032
    s_add_u32 s12, s5, s4
    s_xor_b32 s5, s48, 3
    s_add_u32 s5, s5, s61
    s_mul_i32 s5, s5, 44032
    s_add_u32 s13, s5, s4
    s_cmp_lg_u32 s48, 1
    s_cbranch_scc1 Lnw_6_1_s
    s_mov_b64 exec, 0
    s_branch Lret_6_1_s
Lret_6_1_s:
    s_mov_b64 exec, -1
Lnw_6_1_s:
    s_cmp_lg_u32 s48, 2
    s_cbranch_scc1 Lnw_6_2_s
    s_mov_b64 exec, 0
    s_branch Lret_6_2_s
Lret_6_2_s:
    s_mov_b64 exec, -1
Lnw_6_2_s:
    s_cmp_lg_u32 s48, 0
    s_cbranch_scc1 Ln_s_28
    buffer_load_dword v4, v17, s[36:39], s58 offen sc1
    s_nop 15
Lp_s_29:
    buffer_load_dword v5, v17, s[36:39], s58 offen sc1
    s_waitcnt vmcnt(1)
    v_cmp_gt_u32 vcc, 5, v4
    s_cbranch_vccz Ln_s_28
    buffer_load_dword v4, v17, s[36:39], s58 offen sc1
    s_waitcnt vmcnt(1)
    v_cmp_gt_u32 vcc, 5, v5
    s_cbranch_vccz Ln_s_28
    s_sub_u32 s14, s14, 1
    s_cbranch_scc1 L_end_s
    s_branch Lp_s_29
Ln_s_28:
    s_barrier
    buffer_load_dwordx4 v[64:67], v3, s[36:39], s13 offen sc1
    s_barrier
    buffer_load_dwordx4 v[68:71], v3, s[36:39], s13 offen offset:1024 sc1
    s_barrier
    buffer_load_dwordx4 v[72:75], v3, s[36:39], s13 offen offset:2048 sc1
    s_barrier
    buffer_load_dwordx4 v[76:79], v3, s[36:39], s13 offen offset:3072 sc1
    s_barrier
    buffer_load_dwordx4 v[80:83], v3, s[36:39], s12 offen sc1
    s_barrier
    buffer_load_dwordx4 v[84:87], v3, s[36:39], s12 offen offset:1024 sc1
    s_waitcnt vmcnt(5)
    v_mfma_f32_16x16x32_bf16 v[144:147], a[0:3], v[64:67], 0
    buffer_load_dwordx4 v[88:91], v3, s[36:39], s12 offen offset:2048 sc1
    v_mfma_f32_16x16x32_bf16 v[148:151], a[4:7], v[64:67], 0
    v_mfma_f32_16x16x32_bf16 v[152:155], a[8:11], v[64:67], 0
    buffer_load_dwordx4 v[92:95], v3, s[36:39], s12 offen offset:3072 sc1
    v_mfma_f32_16x16x32_bf16 v[156:159], a[12:15], v[64:67], 0
    s_waitcnt vmcnt(6)
    v_mfma_f32_16x16x32_bf16 v[144:147], a[16:19], v[68:71], v[144:147]
    buffer_load_dwordx4 v[96:99], v3, s[36:39], s11 offen sc1
    v_mfma_f32_16x16x32_bf16 v[148:151], a[20:23], v[68:71], v[148:151]
    v_mfma_f32_16x16x32_bf16 v[152:155], a[24:27], v[68:71], v[152:155]
    v_mfma_f32_16x16x32_bf16 v[156:159], a[28:31], v[68:71], v[156:159]
    s_waitcnt vmcnt(6)
    v_mfma_f32_16x16x32_bf16 v[144:147], a[32:35], v[72:75], v[144:147]
    buffer_load_dwordx4 v[100:103], v3, s[36:39], s11 offen offset:1024 sc1
    v_mfma_f32_16x16x32_bf16 v[148:151], a[36:39], v[72:75], v[148:151]
    v_mfma_f32_16x16x32_bf16 v[152:155], a[40:43], v[72:75], v[152:155]
    v_mfma_f32_16x16x32_bf16 v[156:159], a[44:47], v[72:75], v[156:159]
    s_waitcnt vmcnt(6)
    v_mfma_f32_16x16x32_bf16 v[144:147], a[48:51], v[76:79], v[144:147]
    buffer_load_dwordx4 v[104:107], v3, s[36:39], s11 offen offset:2048 sc1
    v_mfma_f32_16x16x32_bf16 v[148:151], a[52:55], v[76:79], v[148:151]
    v_mfma_f32_16x16x32_bf16 v[152:155], a[56:59], v[76:79], v[152:155]
    v_mfma_f32_16x16x32_bf16 v[156:159], a[60:63], v[76:79], v[156:159]
    s_waitcnt vmcnt(6)
    v_mfma_f32_16x16x32_bf16 v[128:131], a[0:3], v[80:83], 0
    buffer_load_dwordx4 v[108:111], v3, s[36:39], s11 offen offset:3072 sc1
    v_mfma_f32_16x16x32_bf16 v[132:135], a[4:7], v[80:83], 0
    ds_write_b128 v38, v[144:147] offset:0
    v_mfma_f32_16x16x32_bf16 v[136:139], a[8:11], v[80:83], 0
    v_mfma_f32_16x16x32_bf16 v[140:143], a[12:15], v[80:83], 0
    s_waitcnt vmcnt(6)
    v_mfma_f32_16x16x32_bf16 v[128:131], a[16:19], v[84:87], v[128:131]
    buffer_load_dwordx4 v[112:115], v3, s[36:39], s10 offen sc1
    ds_write_b128 v38, v[148:151] offset:1024
    v_mfma_f32_16x16x32_bf16 v[132:135], a[20:23], v[84:87], v[132:135]
    v_mfma_f32_16x16x32_bf16 v[136:139], a[24:27], v[84:87], v[136:139]
    v_mfma_f32_16x16x32_bf16 v[140:143], a[28:31], v[84:87], v[140:143]
    s_waitcnt vmcnt(6)
    ds_write_b128 v38, v[152:155] offset:2048
    v_mfma_f32_16x16x32_bf16 v[128:131], a[32:35], v[88:91], v[128:131]
    buffer_load_dwordx4 v[116:119], v3, s[36:39], s10 offen offset:1024 sc1
    v_mfma_f32_16x16x32_bf16 v[132:135], a[36:39], v[88:91], v[132:135]
    v_mfma_f32_16x16x32_bf16 v[136:139], a[40:43], v[88:91], v[136:139]
    ds_write_b128 v38, v[156:159] offset:3072
    v_mfma_f32_16x16x32_bf16 v[140:143], a[44:47], v[88:91], v[140:143]
    s_waitcnt vmcnt(6)
    v_mfma_f32_16x16x32_bf16 v[128:131], a[48:51], v[92:95], v[128:131]
    buffer_load_dwordx4 v[120:123], v3, s[36:39], s10 offen offset:2048 sc1
    v_mfma_f32_16x16x32_bf16 v[132:135], a[52:55], v[92:95], v[132:135]
    v_mfma_f32_16x16x32_bf16 v[136:139], a[56:59], v[92:95], v[136:139]
    v_mfma_f32_16x16x32_bf16 v[140:143], a[60:63], v[92:95], v[140:143]
    s_waitcnt lgkmcnt(0)
    s_barrier
    s_waitcnt vmcnt(6)
    ds_read_b128 v[192:195], v39 offset:0
    v_mfma_f32_16x16x32_bf16 v[144:147], a[0:3], v[96:99], 0
    buffer_load_dwordx4 v[124:127], v3, s[36:39], s10 offen offset:3072 sc1
    ds_read_b128 v[196:199], v39 offset:1024
    ds_read_b128 v[200:203], v39 offset:2048
    v_mfma_f32_16x16x32_bf16 v[148:151], a[4:7], v[96:99], 0
    s_nop 0
    ds_read_b128 v[204:207], v39 offset:3072
    ds_write_b128 v37, v[128:131] offset:16384
    v_mfma_f32_16x16x32_bf16 v[152:155], a[8:11], v[96:99], 0
    v_mfma_f32_16x16x32_bf16 v[156:159], a[12:15], v[96:99], 0
    s_waitcnt vmcnt(6)
    v_mfma_f32_16x16x32_bf16 v[144:147], a[16:19], v[100:103], v[144:147]
    ds_write_b128 v37, v[132:135] offset:17408
    v_mfma_f32_16x16x32_bf16 v[148:151], a[20:23], v[100:103], v[148:151]
    v_mfma_f32_16x16x32_bf16 v[152:155], a[24:27], v[100:103], v[152:155]
    v_mfma_f32_16x16x32_bf16 v[156:159], a[28:31], v[100:103], v[156:159]
    s_waitcnt vmcnt(5)
    ds_write_b128 v37, v[136:139] offset:18432
    v_mfma_f32_16x16x32_bf16 v[144:147], a[32:35], v[104:107], v[144:147]
    v_mfma_f32_16x16x32_bf16 v[148:151], a[36:39], v[104:107], v[148:151]
    v_mfma_f32_16x16x32_bf16 v[152:155], a[40:43], v[104:107], v[152:155]
    ds_write_b128 v37, v[140:143] offset:19456
    v_mfma_f32_16x16x32_bf16 v[156:159], a[44:47], v[104:107], v[156:159]
    s_waitcnt vmcnt(4)
    v_mfma_f32_16x16x32_bf16 v[144:147], a[48:51], v[108:111], v[144:147]
    v_mfma_f32_16x16x32_bf16 v[148:151], a[52:55], v[108:111], v[148:151]
    v_mfma_f32_16x16x32_bf16 v[152:155], a[56:59], v[108:111], v[152:155]
    v_mfma_f32_16x16x32_bf16 v[156:159], a[60:63], v[108:111], v[156:159]
    s_waitcnt lgkmcnt(0)
    s_barrier
    s_waitcnt vmcnt(3)
    ds_read_b128 v[160:163], v39 offset:16384
    v_mfma_f32_16x16x32_bf16 v[128:131], a[0:3], v[112:115], 0
    s_nop 0
    ds_read_b128 v[164:167], v39 offset:17408
    ds_read_b128 v[168:171], v39 offset:18432
    v_mfma_f32_16x16x32_bf16 v[132:135], a[4:7], v[112:115], 0
    s_nop 0
    ds_read_b128 v[172:175], v39 offset:19456
    ds_write_b128 v36, v[144:147] offset:0
    v_mfma_f32_16x16x32_bf16 v[136:139], a[8:11], v[112:115], 0
    v_mfma_f32_16x16x32_bf16 v[140:143], a[12:15], v[112:115], 0
    s_waitcnt vmcnt(2)
    ds_write_b128 v36, v[148:151] offset:1024
    v_mfma_f32_16x16x32_bf16 v[128:131], a[16:19], v[116:119], v[128:131]
    v_mfma_f32_16x16x32_bf16 v[132:135], a[20:23], v[116:119], v[132:135]
    ds_write_b128 v36, v[152:155] offset:2048
    v_mfma_f32_16x16x32_bf16 v[136:139], a[24:27], v[116:119], v[136:139]
    s_add_u32 s6, s61, s48
    s_lshl_b32 s4, s6, 14
    v_mfma_f32_16x16x32_bf16 v[140:143], a[28:31], v[116:119], v[140:143]
    s_waitcnt vmcnt(1)
    ds_write_b128 v36, v[156:159] offset:3072
    v_mfma_f32_16x16x32_bf16 v[128:131], a[32:35], v[120:123], v[128:131]
    s_lshl_b32 s5, s60, 11
    v_mfma_f32_16x16x32_bf16 v[132:135], a[36:39], v[120:123], v[132:135]
    s_add_u32 s4, s4, s5
    v_mfma_f32_16x16x32_bf16 v[136:139], a[40:43], v[120:123], v[136:139]
    s_add_u32 s4, s4, 0x0
    v_mfma_f32_16x16x32_bf16 v[140:143], a[44:47], v[120:123], v[140:143]
    s_waitcnt vmcnt(0)
    v_mfma_f32_16x16x32_bf16 v[128:131], a[48:51], v[124:127], v[128:131]
    s_waitcnt lgkmcnt(0)
    s_barrier
    ds_read_b128 v[176:179], v39 offset:0
    v_mfma_f32_16x16x32_bf16 v[132:135], a[52:55], v[124:127], v[132:135]
    s_lshl_b32 s6, s6, 10
    ds_read_b128 v[180:183], v39 offset:1024
    ds_read_b128 v[184:187], v39 offset:2048
    v_mfma_f32_16x16x32_bf16 v[136:139], a[56:59], v[124:127], v[136:139]
    s_add_u32 s6, s6, 0x380000
    ds_read_b128 v[188:191], v39 offset:3072
    v_mfma_f32_16x16x32_bf16 v[140:143], a[60:63], v[124:127], v[140:143]
    v_pk_add_f32 v[48:49], v[48:49], v[192:193]
    v_pk_add_f32 v[50:51], v[50:51], v[194:195]
    v_pk_add_f32 v[52:53], v[52:53], v[196:197]
    v_pk_add_f32 v[54:55], v[54:55], v[198:199]
    v_pk_add_f32 v[56:57], v[56:57], v[200:201]
    v_pk_add_f32 v[58:59], v[58:59], v[202:203]
    v_pk_add_f32 v[60:61], v[60:61], v[204:205]
    v_pk_add_f32 v[62:63], v[62:63], v[206:207]
    v_pk_add_f32 v[48:49], v[48:49], v[160:161]
    v_pk_add_f32 v[50:51], v[50:51], v[162:163]
    v_pk_add_f32 v[52:53], v[52:53], v[164:165]
    v_pk_add_f32 v[54:55], v[54:55], v[166:167]
    v_pk_add_f32 v[56:57], v[56:57], v[168:169]
    v_pk_add_f32 v[58:59], v[58:59], v[170:171]
    v_pk_add_f32 v[60:61], v[60:61], v[172:173]
    v_pk_add_f32 v[62:63], v[62:63], v[174:175]
    v_pk_add_f32 v[48:49], v[48:49], v[128:129]
    v_pk_add_f32 v[50:51], v[50:51], v[130:131]
    v_pk_add_f32 v[52:53], v[52:53], v[132:133]
    v_pk_add_f32 v[54:55], v[54:55], v[134:135]
    v_pk_add_f32 v[56:57], v[56:57], v[136:137]
    v_pk_add_f32 v[58:59], v[58:59], v[138:139]
    v_pk_add_f32 v[60:61], v[60:61], v[140:141]
    v_pk_add_f32 v[62:63], v[62:63], v[142:143]
    s_waitcnt lgkmcnt(0)
    v_pk_add_f32 v[48:49], v[48:49], v[176:177]
    v_pk_add_f32 v[50:51], v[50:51], v[178:179]
    v_pk_add_f32 v[52:53], v[52:53], v[180:181]
    v_pk_add_f32 v[54:55], v[54:55], v[182:183]
    v_cvt_pk_bf16_f32 v208, v48, v49
    v_cvt_pk_bf16_f32 v209, v50, v51
    v_cvt_pk_bf16_f32 v210, v52, v53
    v_cvt_pk_bf16_f32 v211, v54, v55
    buffer_store_dwordx4 v[208:211], v3, s[40:43], s4 offen sc0 sc1
    v_pk_add_f32 v[56:57], v[56:57], v[184:185]
    v_pk_add_f32 v[58:59], v[58:59], v[186:187]
    v_pk_add_f32 v[60:61], v[60:61], v[188:189]
    v_pk_add_f32 v[62:63], v[62:63], v[190:191]
    v_cvt_pk_bf16_f32 v212, v56, v57
    v_cvt_pk_bf16_f32 v213, v58, v59
    v_cvt_pk_bf16_f32 v214, v60, v61
    v_cvt_pk_bf16_f32 v215, v62, v63
    buffer_store_dwordx4 v[212:215], v3, s[40:43], s4 offen offset:1024 sc0 sc1
    v_pk_add_f32 v[216:217], v[48:49], v[50:51]
    v_pk_mul_f32 v[218:219], v[48:49], v[48:49]
    v_pk_fma_f32 v[218:219], v[50:51], v[50:51], v[218:219]
    v_pk_add_f32 v[216:217], v[216:217], v[52:53]
    v_pk_fma_f32 v[218:219], v[52:53], v[52:53], v[218:219]
    v_pk_add_f32 v[216:217], v[216:217], v[54:55]
    v_pk_fma_f32 v[218:219], v[54:55], v[54:55], v[218:219]
    v_pk_add_f32 v[216:217], v[216:217], v[56:57]
    v_pk_fma_f32 v[218:219], v[56:57], v[56:57], v[218:219]
    v_pk_add_f32 v[216:217], v[216:217], v[58:59]
    v_pk_fma_f32 v[218:219], v[58:59], v[58:59], v[218:219]
    v_pk_add_f32 v[216:217], v[216:217], v[60:61]
    v_pk_fma_f32 v[218:219], v[60:61], v[60:61], v[218:219]
    v_pk_add_f32 v[216:217], v[216:217], v[62:63]
    v_pk_fma_f32 v[218:219], v[62:63], v[62:63], v[218:219]
    v_add_f32 v216, v216, v217
    v_add_f32 v217, v218, v219
    s_nop 1
    v_permlane32_swap_b32 v216, v217
    v_add_f32 v216, v216, v217
    v_mov_b32 v217, v216
    s_nop 1
    v_permlane16_swap_b32 v216, v217
    v_add_f32 v216, v216, v217
    s_mov_b32 exec_lo, 0xffff
    s_mov_b32 exec_hi, 0xffff
    buffer_store_dword v216, v30, s[36:39], s6 offen sc0 sc1
    s_mov_b64 exec, -1
    v_mov_b32 v4, 6
    s_cmp_lg_u32 s48, 0
    s_mov_b64 exec, 1
    s_waitcnt vmcnt(0)
    s_barrier
    s_cbranch_scc1 Lq_s_33
    buffer_store_dword v4, off, s[36:39], s55 sc0 sc1
Lq_s_33:
    s_mov_b64 exec, -1
    s_lshl_b32 s12, s59, 14
    s_add_u32 s12, s12, 0x0
    s_lshl_b32 s11, s59, 10
    s_add_u32 s11, s11, 0x380000
    s_add_u32 s10, s61, s48
    s_lshl_b32 s10, s10, 10
    s_add_u32 s10, s10, 0x380000
    s_add_u32 s16, s12, 0x4000
    s_mul_i32 s20, s59, 43
    s_add_u32 s20, s20, s62
    s_lshl_b32 s20, s20, 10
    s_add_u32 s20, s20, 0x600000
    s_add_u32 s21, s20, 44032
    s_cmp_lt_u32 s50, 11
    s_cselect_b32 s22, s20, 0x80000000
    s_cselect_b32 s23, s21, 0x80000000
    v_add_u32 v240, 0x18800, v3
    v_add_u32 v241, 49152, v3
    ds_read_b128 v[112:115], v3 offset:0
    ds_read_b128 v[116:119], v3 offset:1024
    ds_read_b128 v[120:123], v3 offset:2048
    ds_read_b128 v[124:127], v3 offset:3072
    ds_read_b128 v[128:131], v3 offset:4096
    ds_read_b128 v[132:135], v3 offset:5120
    s_cmp_lg_u32 s48, 1
    s_cbranch_scc1 Lnw_7_1_s
    s_mov_b64 exec, 0
    s_branch Lret_7_1_s
Lret_7_1_s:
    s_mov_b64 exec, -1
Lnw_7_1_s:
    s_cmp_lg_u32 s48, 2
    s_cbranch_scc1 Lnw_7_2_s
    s_mov_b64 exec, 0
    s_branch Lret_7_2_s
Lret_7_2_s:
    s_mov_b64 exec, -1
Lnw_7_2_s:
    s_cmp_lg_u32 s48, 0
    s_cbranch_scc1 Ln_s_31
    buffer_load_dword v4, v17, s[36:39], s58 offen sc1
    s_nop 15
Lp_s_32:
    buffer_load_dword v5, v17, s[36:39], s58 offen sc1
    s_waitcnt vmcnt(1)
    v_cmp_gt_u32 vcc, 6, v4
    s_cbranch_vccz Ln_s_31
    buffer_load_dword v4, v17, s[36:39], s58 offen sc1
    s_waitcnt vmcnt(1)
    v_cmp_gt_u32 vcc, 6, v5
    s_cbranch_vccz Ln_s_31
    s_sub_u32 s14, s14, 1
    s_cbranch_scc1 L_end_s
    s_branch Lp_s_32
Ln_s_31:
    s_barrier
    buffer_load_dwordx4 v[160:163], v3, s[40:43], s12 offen sc1
    buffer_load_dwordx4 v[164:167], v3, s[40:43], s16 offen sc1
    buffer_load_dwordx4 v[168:171], v3, s[40:43], s12 offen offset:1024 sc1
    buffer_load_dwordx4 v[172:175], v3, s[40:43], s16 offen offset:1024 sc1
    buffer_load_dwordx4 v[176:179], v3, s[40:43], s12 offen offset:2048 sc1
    buffer_load_dwordx4 v[180:183], v3, s[40:43], s16 offen offset:2048 sc1
    s_waitcnt vmcnt(4) lgkmcnt(3)
    v_mfma_f32_16x16x32_bf16 v[64:67], v[112:115], v[160:163], 0
    ds_read_b128 v[136:139], v3 offset:6144
    buffer_load_dwordx4 v[184:187], v3, s[40:43], s12 offen offset:3072 sc1
    v_mfma_f32_16x16x32_bf16 v[88:91], v[112:115], v[164:167], 0
    v_mfma_f32_16x16x32_bf16 v[68:71], v[116:119], v[160:163], 0
    ds_read_b128 v[140:143], v3 offset:7168
    v_mfma_f32_16x16x32_bf16 v[92:95], v[116:119], v[164:167], 0
    v_mfma_f32_16x16x32_bf16 v[72:75], v[120:123], v[160:163], 0
    ds_read_b128 v[144:147], v3 offset:8192
    buffer_load_dwordx4 v[188:191], v3, s[40:43], s16 offen offset:3072 sc1
    v_mfma_f32_16x16x32_bf16 v[96:99], v[120:123], v[164:167], 0
    s_waitcnt lgkmcnt(3)
    v_mfma_f32_16x16x32_bf16 v[76:79], v[124:127], v[160:163], 0
    ds_read_b128 v[148:151], v3 offset:9216
    v_mfma_f32_16x16x32_bf16 v[100:103], v[124:127], v[164:167], 0
    v_mfma_f32_16x16x32_bf16 v[80:83], v[128:131], v[160:163], 0
    ds_read_b128 v[152:155], v3 offset:10240
    buffer_load_dwordx4 v[224:227], v3, s[36:39], s11 offen sc1
    v_mfma_f32_16x16x32_bf16 v[104:107], v[128:131], v[164:167], 0
    v_mfma_f32_16x16x32_bf16 v[84:87], v[132:135], v[160:163], 0
    ds_read_b128 v[156:159], v3 offset:11264
    v_mfma_f32_16x16x32_bf16 v[108:111], v[132:135], v[164:167], 0
    s_waitcnt vmcnt(5) lgkmcnt(3)
    v_mfma_f32_16x16x32_bf16 v[64:67], v[136:139], v[168:171], v[64:67]
    s_add_u32 s17, s12, 0x1000
    ds_read_b128 v[112:115], v3 offset:12288
    buffer_load_dwordx4 v[192:195], v3, s[40:43], s17 offen sc1
    v_mfma_f32_16x16x32_bf16 v[88:91], v[136:139], v[172:175], v[88:91]
    v_mfma_f32_16x16x32_bf16 v[68:71], v[140:143], v[168:171], v[68:71]
    ds_read_b128 v[116:119], v3 offset:13312
    v_mfma_f32_16x16x32_bf16 v[92:95], v[140:143], v[172:175], v[92:95]
    v_mfma_f32_16x16x32_bf16 v[72:75], v[144:147], v[168:171], v[72:75]
    s_add_u32 s18, s12, 0x5000
    ds_read_b128 v[120:123], v3 offset:14336
    buffer_load_dwordx4 v[196:199], v3, s[40:43], s18 offen sc1
    v_mfma_f32_16x16x32_bf16 v[96:99], v[144:147], v[172:175], v[96:99]
    s_waitcnt lgkmcnt(3)
    v_mfma_f32_16x16x32_bf16 v[76:79], v[148:151], v[168:171], v[76:79]
    ds_read_b128 v[124:127], v3 offset:15360
    v_mfma_f32_16x16x32_bf16 v[100:103], v[148:151], v[172:175], v[100:103]
    v_mfma_f32_16x16x32_bf16 v[80:83], v[152:155], v[168:171], v[80:83]
    ds_read_b128 v[128:131], v3 offset:16384
    buffer_load_dwordx4 v[228:231], v3, s[36:39], s11 offen offset:1024 sc1
    v_mfma_f32_16x16x32_bf16 v[104:107], v[152:155], v[172:175], v[104:107]
    v_mfma_f32_16x16x32_bf16 v[84:87], v[156:159], v[168:171], v[84:87]
    ds_read_b128 v[132:135], v3 offset:17408
    v_mfma_f32_16x16x32_bf16 v[108:111], v[156:159], v[172:175], v[108:111]
    s_waitcnt vmcnt(6) lgkmcnt(3)
    v_mfma_f32_16x16x32_bf16 v[64:67], v[112:115], v[176:179], v[64:67]
    ds_read_b128 v[136:139], v3 offset:18432
    buffer_load_dwordx4 v[200:203], v3, s[40:43], s17 offen offset:1024 sc1
    v_mfma_f32_16x16x32_bf16 v[88:91], v[112:115], v[180:183], v[88:91]
    v_mfma_f32_16x16x32_bf16 v[68:71], v[116:119], v[176:179], v[68:71]
    ds_read_b128 v[140:143], v3 offset:19456
    v_mfma_f32_16x16x32_bf16 v[92:95], v[116:119], v[180:183], v[92:95]
    v_mfma_f32_16x16x32_bf16 v[72:75], v[120:123], v[176:179], v[72:75]
    ds_read_b128 v[144:147], v3 offset:20480
    buffer_load_dwordx4 v[204:207], v3, s[40:43], s18 offen offset:1024 sc1
    v_mfma_f32_16x16x32_bf16 v[96:99], v[120:123], v[180:183], v[96:99]
    s_waitcnt lgkmcnt(3)
    v_mfma_f32_16x16x32_bf16 v[76:79], v[124:127], v[176:179], v[76:79]
    ds_read_b128 v[148:151], v3 offset:21504
    v_mfma_f32_16x16x32_bf16 v[100:103], v[124:127], v[180:183], v[100:103]
    v_mfma_f32_16x16x32_bf16 v[80:83], v[128:131], v[176:179], v[80:83]
    ds_read_b128 v[152:155], v3 offset:22528
    buffer_load_dwordx4 v[208:211], v3, s[40:43], s17 offen offset:2048 sc1
    v_mfma_f32_16x16x32_bf16 v[104:107], v[128:131], v[180:183], v[104:107]
    v_mfma_f32_16x16x32_bf16 v[84:87], v[132:135], v[176:179], v[84:87]
    ds_read_b128 v[156:159], v3 offset:23552
    v_mfma_f32_16x16x32_bf16 v[108:111], v[132:135], v[180:183], v[108:111]
    s_waitcnt vmcnt(7) lgkmcnt(3)
    v_mfma_f32_16x16x32_bf16 v[64:67], v[136:139], v[184:187], v[64:67]
    ds_read_b128 v[112:115], v3 offset:24576
    buffer_load_dwordx4 v[212:215], v3, s[40:43], s18 offen offset:2048 sc1
    v_mfma_f32_16x16x32_bf16 v[88:91], v[136:139], v[188:191], v[88:91]
    v_mfma_f32_16x16x32_bf16 v[68:71], v[140:143], v[184:187], v[68:71]
    ds_read_b128 v[116:119], v3 offset:25600
    v_mfma_f32_16x16x32_bf16 v[92:95], v[140:143], v[188:191], v[92:95]
    v_mfma_f32_16x16x32_bf16 v[72:75], v[144:147], v[184:187], v[72:75]
    ds_read_b128 v[120:123], v3 offset:26624
    buffer_load_dwordx4 v[216:219], v3, s[40:43], s17 offen offset:3072 sc1
    v_mfma_f32_16x16x32_bf16 v[96:99], v[144:147], v[188:191], v[96:99]
    s_waitcnt lgkmcnt(3)
    v_mfma_f32_16x16x32_bf16 v[76:79], v[148:151], v[184:187], v[76:79]
    ds_read_b128 v[124:127], v3 offset:27648
    v_mfma_f32_16x16x32_bf16 v[100:103], v[148:151], v[188:191], v[100:103]
    v_mfma_f32_16x16x32_bf16 v[80:83], v[152:155], v[184:187], v[80:83]
    ds_read_b128 v[128:131], v3 offset:28672
    buffer_load_dwordx4 v[220:223], v3, s[40:43], s18 offen offset:3072 sc1
    v_mfma_f32_16x16x32_bf16 v[104:107], v[152:155], v[188:191], v[104:107]
    v_mfma_f32_16x16x32_bf16 v[84:87], v[156:159], v[184:187], v[84:87]
    s_add_u32 s16, s12, 0x2000
    ds_read_b128 v[132:135], v3 offset:29696
    v_mfma_f32_16x16x32_bf16 v[108:111], v[156:159], v[188:191], v[108:111]
    s_waitcnt vmcnt(7) lgkmcnt(3)
    v_mfma_f32_16x16x32_bf16 v[64:67], v[112:115], v[192:195], v[64:67]
    s_waitcnt vmcnt(6)
    ds_read_b128 v[136:139], v3 offset:30720
    buffer_load_dwordx4 v[160:163], v3, s[40:43], s16 offen sc1
    v_mfma_f32_16x16x32_bf16 v[88:91], v[112:115], v[196:199], v[88:91]
    v_add_f32 v224, v224, v226
    v_add_f32 v228, v228, v230
    v_mfma_f32_16x16x32_bf16 v[68:71], v[116:119], v[192:195], v[68:71]
    s_nop 0
    ds_read_b128 v[140:143], v3 offset:31744
    v_add_f32 v225, v225, v227
    v_mfma_f32_16x16x32_bf16 v[92:95], v[116:119], v[196:199], v[92:95]
    v_add_f32 v229, v229, v231
    v_mfma_f32_16x16x32_bf16 v[72:75], v[120:123], v[192:195], v[72:75]
    s_add_u32 s17, s12, 0x6000
    ds_read_b128 v[144:147], v3 offset:32768
    buffer_load_dwordx4 v[164:167], v3, s[40:43], s17 offen sc1
    v_mfma_f32_16x16x32_bf16 v[96:99], v[120:123], v[196:199], v[96:99]
    s_waitcnt lgkmcnt(3)
    v_permlane32_swap_b32 v224, v225
    v_mfma_f32_16x16x32_bf16 v[76:79], v[124:127], v[192:195], v[76:79]
    ds_read_b128 v[148:151], v3 offset:33792
    v_mfma_f32_16x16x32_bf16 v[100:103], v[124:127], v[196:199], v[100:103]
    v_permlane32_swap_b32 v228, v229
    v_mfma_f32_16x16x32_bf16 v[80:83], v[128:131], v[192:195], v[80:83]
    ds_read_b128 v[152:155], v3 offset:34816
    buffer_load_dwordx4 v[168:171], v3, s[40:43], s16 offen offset:1024 sc1
    v_mfma_f32_16x16x32_bf16 v[104:107], v[128:131], v[196:199], v[104:107]
    v_add_f32 v224, v224, v225
    v_add_f32 v228, v228, v229
    v_mfma_f32_16x16x32_bf16 v[84:87], v[132:135], v[192:195], v[84:87]
    s_nop 0
    ds_read_b128 v[156:159], v3 offset:35840
    v_mov_b32 v225, v224
    v_mfma_f32_16x16x32_bf16 v[108:111], v[132:135], v[196:199], v[108:111]
    s_waitcnt vmcnt(7) lgkmcnt(3)
    v_mov_b32 v229, v228
    v_mfma_f32_16x16x32_bf16 v[64:67], v[136:139], v[200:203], v[64:67]
    ds_read_b128 v[112:115], v3 offset:36864
    buffer_load_dwordx4 v[172:175], v3, s[40:43], s17 offen offset:1024 sc1
    v_mfma_f32_16x16x32_bf16 v[88:91], v[136:139], v[204:207], v[88:91]
    v_permlane16_swap_b32 v224, v225
    v_mfma_f32_16x16x32_bf16 v[68:71], v[140:143], v[200:203], v[68:71]
    ds_read_b128 v[116:119], v3 offset:37888
    v_mfma_f32_16x16x32_bf16 v[92:95], v[140:143], v[204:207], v[92:95]
    v_permlane16_swap_b32 v228, v229
    v_mfma_f32_16x16x32_bf16 v[72:75], v[144:147], v[200:203], v[72:75]
    ds_read_b128 v[120:123], v3 offset:38912
    buffer_load_dwordx4 v[176:179], v3, s[40:43], s16 offen offset:2048 sc1
    v_mfma_f32_16x16x32_bf16 v[96:99], v[144:147], v[204:207], v[96:99]
    s_waitcnt lgkmcnt(3)
    v_add_f32 v224, v224, v225
    v_add_f32 v228, v228, v229
    v_mfma_f32_16x16x32_bf16 v[76:79], v[148:151], v[200:203], v[76:79]
    s_nop 0
    ds_read_b128 v[124:127], v3 offset:39936
    v_mov_b32 v225, v224
    v_mfma_f32_16x16x32_bf16 v[100:103], v[148:151], v[204:207], v[100:103]
    v_mov_b32 v229, v228
    v_mfma_f32_16x16x32_bf16 v[80:83], v[152:155], v[200:203], v[80:83]
    ds_read_b128 v[128:131], v3 offset:40960
    buffer_load_dwordx4 v[180:183], v3, s[40:43], s17 offen offset:2048 sc1
    v_mfma_f32_16x16x32_bf16 v[104:107], v[152:155], v[204:207], v[104:107]
    v_permlane32_swap_b32 v224, v225
    v_mfma_f32_16x16x32_bf16 v[84:87], v[156:159], v[200:203], v[84:87]
    s_nop 0
    ds_read_b128 v[132:135], v3 offset:41984
    ds_read_b128 v[242:245], v35 offset:512
    v_mfma_f32_16x16x32_bf16 v[108:111], v[156:159], v[204:207], v[108:111]
    s_waitcnt vmcnt(8) lgkmcnt(4)
    v_permlane32_swap_b32 v228, v229
    v_mul_f32 v236, 0xbb000000, v224
    v_mul_f32 v238, 0xbb000000, v228
    v_mfma_f32_16x16x32_bf16 v[64:67], v[112:115], v[208:211], v[64:67]
    ds_read_b128 v[136:139], v3 offset:43008
    buffer_load_dwordx4 v[184:187], v3, s[40:43], s16 offen offset:3072 sc1
    v_mfma_f32_16x16x32_bf16 v[88:91], v[112:115], v[212:215], v[88:91]
    v_mfma_f32_16x16x32_bf16 v[68:71], v[116:119], v[208:211], v[68:71]
    ds_read_b128 v[140:143], v3 offset:44032
    v_mfma_f32_16x16x32_bf16 v[92:95], v[116:119], v[212:215], v[92:95]
    ds_read_b128 v[246:249], v35 offset:704
    v_mfma_f32_16x16x32_bf16 v[72:75], v[120:123], v[208:211], v[72:75]
    s_waitcnt lgkmcnt(3)
    ds_read_b128 v[144:147], v3 offset:45056
    buffer_load_dwordx4 v[188:191], v3, s[40:43], s17 offen offset:3072 sc1
    v_mfma_f32_16x16x32_bf16 v[96:99], v[120:123], v[212:215], v[96:99]
    v_fmac_f32 v64, v242, v236
    v_fmac_f32 v65, v243, v236
    v_mfma_f32_16x16x32_bf16 v[76:79], v[124:127], v[208:211], v[76:79]
    s_nop 0
    ds_read_b128 v[148:151], v3 offset:46080
    v_fmac_f32 v66, v244, v236
    v_mfma_f32_16x16x32_bf16 v[100:103], v[124:127], v[212:215], v[100:103]
    v_fmac_f32 v67, v245, v236
    v_fmac_f32 v88, v242, v238
    v_mfma_f32_16x16x32_bf16 v[80:83], v[128:131], v[208:211], v[80:83]
    s_add_u32 s18, s12, 0x3000
    ds_read_b128 v[152:155], v3 offset:47104
    buffer_load_dwordx4 v[192:195], v3, s[40:43], s18 offen sc1
    v_mfma_f32_16x16x32_bf16 v[104:107], v[128:131], v[212:215], v[104:107]
    v_fmac_f32 v89, v243, v238
    v_fmac_f32 v90, v244, v238
    v_mfma_f32_16x16x32_bf16 v[84:87], v[132:135], v[208:211], v[84:87]
    s_waitcnt lgkmcnt(3)
    ds_read_b128 v[156:159], v3 offset:48128
    v_fmac_f32 v91, v245, v238
    v_mfma_f32_16x16x32_bf16 v[108:111], v[132:135], v[212:215], v[108:111]
    s_waitcnt vmcnt(9) lgkmcnt(3)
    ds_read_b128 v[242:245], v35 offset:576
    v_fmac_f32 v76, v246, v236
    v_mfma_f32_16x16x32_bf16 v[64:67], v[136:139], v[216:219], v[64:67]
    s_add_u32 s16, s12, 0x7000
    ds_read_b128 v[112:115], v241 offset:0
    buffer_load_dwordx4 v[196:199], v3, s[40:43], s16 offen sc1
    v_mfma_f32_16x16x32_bf16 v[88:91], v[136:139], v[220:223], v[88:91]
    v_fmac_f32 v77, v247, v236
    v_fmac_f32 v78, v248, v236
    v_mfma_f32_16x16x32_bf16 v[68:71], v[140:143], v[216:219], v[68:71]
    s_nop 0
    ds_read_b128 v[116:119], v241 offset:1024
    v_fmac_f32 v79, v249, v236
    v_mfma_f32_16x16x32_bf16 v[92:95], v[140:143], v[220:223], v[92:95]
    v_fmac_f32 v100, v246, v238
    v_fmac_f32 v101, v247, v238
    v_fmac_f32 v102, v248, v238
    v_mfma_f32_16x16x32_bf16 v[72:75], v[144:147], v[216:219], v[72:75]
    ds_read_b128 v[120:123], v241 offset:2048
    buffer_load_dwordx4 v[200:203], v3, s[40:43], s18 offen offset:1024 sc1
    v_fmac_f32 v103, v249, v238
    v_mfma_f32_16x16x32_bf16 v[96:99], v[144:147], v[220:223], v[96:99]
    s_waitcnt lgkmcnt(4)
    ds_read_b128 v[246:249], v35 offset:768
    v_mfma_f32_16x16x32_bf16 v[76:79], v[148:151], v[216:219], v[76:79]
    s_waitcnt lgkmcnt(4)
    ds_read_b128 v[124:127], v241 offset:3072
    v_fmac_f32 v68, v242, v236
    v_mfma_f32_16x16x32_bf16 v[100:103], v[148:151], v[220:223], v[100:103]
    v_fmac_f32 v69, v243, v236
    v_fmac_f32 v70, v244, v236
    v_mfma_f32_16x16x32_bf16 v[80:83], v[152:155], v[216:219], v[80:83]
    ds_read_b128 v[128:131], v241 offset:4096
    buffer_load_dwordx4 v[204:207], v3, s[40:43], s16 offen offset:1024 sc1
    v_mfma_f32_16x16x32_bf16 v[104:107], v[152:155], v[220:223], v[104:107]
    v_fmac_f32 v71, v245, v236
    v_fmac_f32 v92, v242, v238
    v_mfma_f32_16x16x32_bf16 v[84:87], v[156:159], v[216:219], v[84:87]
    s_nop 0
    ds_read_b128 v[132:135], v241 offset:5120
    v_fmac_f32 v93, v243, v238
    v_mfma_f32_16x16x32_bf16 v[108:111], v[156:159], v[220:223], v[108:111]
    s_waitcnt vmcnt(10) lgkmcnt(4)
    v_fmac_f32 v94, v244, v238
    v_fmac_f32 v95, v245, v238
    v_mfma_f32_16x16x32_bf16 v[64:67], v[112:115], v[160:163], v[64:67]
    s_waitcnt lgkmcnt(3)
    ds_read_b128 v[136:139], v241 offset:6144
    buffer_load_dwordx4 v[208:211], v3, s[40:43], s18 offen offset:2048 sc1
    v_mfma_f32_16x16x32_bf16 v[88:91], v[112:115], v[164:167], v[88:91]
    s_nop 0
    ds_read_b128 v[242:245], v35 offset:640
    v_fmac_f32 v80, v246, v236
    v_mfma_f32_16x16x32_bf16 v[68:71], v[116:119], v[160:163], v[68:71]
    s_nop 0
    ds_read_b128 v[140:143], v241 offset:7168
    v_fmac_f32 v81, v247, v236
    v_mfma_f32_16x16x32_bf16 v[92:95], v[116:119], v[164:167], v[92:95]
    v_fmac_f32 v82, v248, v236
    v_fmac_f32 v83, v249, v236
    v_mfma_f32_16x16x32_bf16 v[72:75], v[120:123], v[160:163], v[72:75]
    ds_read_b128 v[144:147], v241 offset:8192
    buffer_load_dwordx4 v[212:215], v3, s[40:43], s16 offen offset:2048 sc1
    v_mfma_f32_16x16x32_bf16 v[96:99], v[120:123], v[164:167], v[96:99]
    s_waitcnt lgkmcnt(4)
    v_fmac_f32 v104, v246, v238
    v_fmac_f32 v105, v247, v238
    v_mfma_f32_16x16x32_bf16 v[76:79], v[124:127], v[160:163], v[76:79]
    ds_read_b128 v[148:151], v241 offset:9216
    v_fmac_f32 v106, v248, v238
    v_fmac_f32 v107, v249, v238
    v_mfma_f32_16x16x32_bf16 v[100:103], v[124:127], v[164:167], v[100:103]
    ds_read_b128 v[246:249], v35 offset:832
    v_mfma_f32_16x16x32_bf16 v[80:83], v[128:131], v[160:163], v[80:83]
    s_waitcnt lgkmcnt(4)
    ds_read_b128 v[152:155], v241 offset:10240
    buffer_load_dwordx4 v[216:219], v3, s[40:43], s18 offen offset:3072 sc1
    v_mfma_f32_16x16x32_bf16 v[104:107], v[128:131], v[164:167], v[104:107]
    v_fmac_f32 v72, v242, v236
    v_fmac_f32 v73, v243, v236
    v_mfma_f32_16x16x32_bf16 v[84:87], v[132:135], v[160:163], v[84:87]
    s_nop 0
    ds_read_b128 v[156:159], v241 offset:11264
    v_fmac_f32 v74, v244, v236
    v_mfma_f32_16x16x32_bf16 v[108:111], v[132:135], v[164:167], v[108:111]
    s_waitcnt vmcnt(11) lgkmcnt(4)
    v_fmac_f32 v75, v245, v236
    v_fmac_f32 v96, v242, v238
    v_mfma_f32_16x16x32_bf16 v[64:67], v[136:139], v[168:171], v[64:67]
    ds_read_b128 v[112:115], v240 offset:0
    buffer_load_dwordx4 v[220:223], v3, s[40:43], s16 offen offset:3072 sc1
    v_mfma_f32_16x16x32_bf16 v[88:91], v[136:139], v[172:175], v[88:91]
    v_fmac_f32 v97, v243, v238
    v_fmac_f32 v98, v244, v238
    v_mfma_f32_16x16x32_bf16 v[68:71], v[140:143], v[168:171], v[68:71]
    s_waitcnt lgkmcnt(3)
    ds_read_b128 v[116:119], v240 offset:1024
    v_fmac_f32 v99, v245, v238
    v_mfma_f32_16x16x32_bf16 v[92:95], v[140:143], v[172:175], v[92:95]
    v_fmac_f32 v84, v246, v236
    v_fmac_f32 v85, v247, v236
    v_mfma_f32_16x16x32_bf16 v[72:75], v[144:147], v[168:171], v[72:75]
    s_nop 0
    ds_read_b128 v[120:123], v240 offset:6144
    v_fmac_f32 v86, v248, v236
    v_mfma_f32_16x16x32_bf16 v[96:99], v[144:147], v[172:175], v[96:99]
    s_waitcnt lgkmcnt(3)
    v_fmac_f32 v87, v249, v236
    v_fmac_f32 v108, v246, v238
    v_mfma_f32_16x16x32_bf16 v[76:79], v[148:151], v[168:171], v[76:79]
    s_nop 0
    ds_read_b128 v[124:127], v240 offset:7168
    v_fmac_f32 v109, v247, v238
    v_mfma_f32_16x16x32_bf16 v[100:103], v[148:151], v[172:175], v[100:103]
    v_fmac_f32 v110, v248, v238
    v_mfma_f32_16x16x32_bf16 v[80:83], v[152:155], v[168:171], v[80:83]
    s_nop 0
    ds_read_b128 v[128:131], v240 offset:12288
    v_fmac_f32 v111, v249, v238
    v_mfma_f32_16x16x32_bf16 v[104:107], v[152:155], v[172:175], v[104:107]
    v_mfma_f32_16x16x32_bf16 v[84:87], v[156:159], v[168:171], v[84:87]
    ds_read_b128 v[132:135], v240 offset:13312
    v_mfma_f32_16x16x32_bf16 v[108:111], v[156:159], v[172:175], v[108:111]
    s_waitcnt vmcnt(10) lgkmcnt(3)
    v_mfma_f32_16x16x32_bf16 v[64:67], v[112:115], v[176:179], v[64:67]
    ds_read_b128 v[136:139], v240 offset:18432
    buffer_load_dwordx4 v[232:235], v3, s[36:39], s10 offen sc1
    v_mfma_f32_16x16x32_bf16 v[88:91], v[112:115], v[180:183], v[88:91]
    v_mfma_f32_16x16x32_bf16 v[68:71], v[116:119], v[176:179], v[68:71]
    ds_read_b128 v[140:143], v240 offset:19456
    v_mfma_f32_16x16x32_bf16 v[92:95], v[116:119], v[180:183], v[92:95]
    s_waitcnt vmcnt(9)
    v_mfma_f32_16x16x32_bf16 v[64:67], v[120:123], v[184:187], v[64:67]
    ds_read_b128 v[144:147], v241 offset:12288
    v_mfma_f32_16x16x32_bf16 v[88:91], v[120:123], v[188:191], v[88:91]
    s_waitcnt lgkmcnt(3)
    v_mfma_f32_16x16x32_bf16 v[68:71], v[124:127], v[184:187], v[68:71]
    ds_read_b128 v[148:151], v241 offset:13312
    s_getpc_b64 s[6:7]
    global_load_dword v7, v47, s[6:7]
    v_mfma_f32_16x16x32_bf16 v[92:95], v[124:127], v[188:191], v[92:95]
    s_waitcnt vmcnt(8)
    v_mfma_f32_16x16x32_bf16 v[64:67], v[128:131], v[192:195], v[64:67]
    ds_read_b128 v[152:155], v241 offset:18432
    v_mfma_f32_16x16x32_bf16 v[88:91], v[128:131], v[196:199], v[88:91]
    v_mfma_f32_16x16x32_bf16 v[68:71], v[132:135], v[192:195], v[68:71]
    ds_read_b128 v[156:159], v241 offset:19456
    v_mfma_f32_16x16x32_bf16 v[92:95], v[132:135], v[196:199], v[92:95]
    s_waitcnt vmcnt(6) lgkmcnt(3)
    v_mfma_f32_16x16x32_bf16 v[64:67], v[136:139], v[200:203], v[64:67]
    ds_read_b128 v[112:115], v240 offset:2048
    v_mfma_f32_16x16x32_bf16 v[88:91], v[136:139], v[204:207], v[88:91]
    v_mfma_f32_16x16x32_bf16 v[68:71], v[140:143], v[200:203], v[68:71]
    ds_read_b128 v[116:119], v240 offset:3072
    v_mfma_f32_16x16x32_bf16 v[92:95], v[140:143], v[204:207], v[92:95]
    s_waitcnt vmcnt(4)
    v_mfma_f32_16x16x32_bf16 v[64:67], v[144:147], v[208:211], v[64:67]
    ds_read_b128 v[120:123], v240 offset:8192
    v_mfma_f32_16x16x32_bf16 v[88:91], v[144:147], v[212:215], v[88:91]
    s_waitcnt lgkmcnt(3)
    v_mfma_f32_16x16x32_bf16 v[68:71], v[148:151], v[208:211], v[68:71]
    ds_read_b128 v[124:127], v240 offset:9216
    v_mfma_f32_16x16x32_bf16 v[92:95], v[148:151], v[212:215], v[92:95]
    s_waitcnt vmcnt(2)
    v_mfma_f32_16x16x32_bf16 v[64:67], v[152:155], v[216:219], v[64:67]
    ds_read_b128 v[128:131], v240 offset:14336
    v_mfma_f32_16x16x32_bf16 v[88:91], v[152:155], v[220:223], v[88:91]
    v_mfma_f32_16x16x32_bf16 v[68:71], v[156:159], v[216:219], v[68:71]
    ds_read_b128 v[132:135], v240 offset:15360
    v_mfma_f32_16x16x32_bf16 v[92:95], v[156:159], v[220:223], v[92:95]
    s_waitcnt lgkmcnt(3)
    v_mfma_f32_16x16x32_bf16 v[72:75], v[112:115], v[176:179], v[72:75]
    ds_read_b128 v[136:139], v240 offset:20480
    v_mfma_f32_16x16x32_bf16 v[96:99], v[112:115], v[180:183], v[96:99]
    v_mfma_f32_16x16x32_bf16 v[76:79], v[116:119], v[176:179], v[76:79]
    ds_read_b128 v[140:143], v240 offset:21504
    v_mfma_f32_16x16x32_bf16 v[100:103], v[116:119], v[180:183], v[100:103]
    v_mfma_f32_16x16x32_bf16 v[72:75], v[120:123], v[184:187], v[72:75]
    s_nop 0
    ds_read_b128 v[144:147], v241 offset:14336
    v_cvt_pk_bf16_f32 v64, v64, v65
    v_mfma_f32_16x16x32_bf16 v[96:99], v[120:123], v[188:191], v[96:99]
    s_waitcnt lgkmcnt(3)
    v_cvt_pk_bf16_f32 v65, v66, v67
    v_cvt_pk_bf16_f32 v66, v68, v69
    v_mfma_f32_16x16x32_bf16 v[76:79], v[124:127], v[184:187], v[76:79]
    s_nop 0
    ds_read_b128 v[148:151], v241 offset:15360
    v_cvt_pk_bf16_f32 v67, v70, v71
    v_mfma_f32_16x16x32_bf16 v[100:103], v[124:127], v[188:191], v[100:103]
    v_pk_max_i16 v64, v64, 0
    v_pk_max_i16 v65, v65, 0
    v_mfma_f32_16x16x32_bf16 v[72:75], v[128:131], v[192:195], v[72:75]
    s_nop 0
    ds_read_b128 v[152:155], v241 offset:20480
    v_pk_max_i16 v66, v66, 0
    v_mfma_f32_16x16x32_bf16 v[96:99], v[128:131], v[196:199], v[96:99]
    v_pk_max_i16 v67, v67, 0
    v_mfma_f32_16x16x32_bf16 v[76:79], v[132:135], v[192:195], v[76:79]
    ds_read_b128 v[156:159], v241 offset:21504
    buffer_store_dwordx4 v[64:67], v3, s[36:39], s20 offen sc0 sc1
    v_mfma_f32_16x16x32_bf16 v[100:103], v[132:135], v[196:199], v[100:103]
    s_waitcnt lgkmcnt(3)
    v_cvt_pk_bf16_f32 v88, v88, v89
    v_cvt_pk_bf16_f32 v89, v90, v91
    v_mfma_f32_16x16x32_bf16 v[72:75], v[136:139], v[200:203], v[72:75]
    s_nop 0
    ds_read_b128 v[112:115], v240 offset:4096
    v_cvt_pk_bf16_f32 v90, v92, v93
    v_mfma_f32_16x16x32_bf16 v[96:99], v[136:139], v[204:207], v[96:99]
    v_cvt_pk_bf16_f32 v91, v94, v95
    v_mfma_f32_16x16x32_bf16 v[76:79], v[140:143], v[200:203], v[76:79]
    s_nop 0
    ds_read_b128 v[116:119], v240 offset:5120
    v_pk_max_i16 v88, v88, 0
    v_mfma_f32_16x16x32_bf16 v[100:103], v[140:143], v[204:207], v[100:103]
    v_pk_max_i16 v89, v89, 0
    v_pk_max_i16 v90, v90, 0
    v_mfma_f32_16x16x32_bf16 v[72:75], v[144:147], v[208:211], v[72:75]
    s_nop 0
    ds_read_b128 v[120:123], v240 offset:10240
    v_pk_max_i16 v91, v91, 0
    v_mfma_f32_16x16x32_bf16 v[96:99], v[144:147], v[212:215], v[96:99]
    s_waitcnt lgkmcnt(3)
    buffer_store_dwordx4 v[88:91], v3, s[36:39], s21 offen sc0 sc1
    v_mfma_f32_16x16x32_bf16 v[76:79], v[148:151], v[208:211], v[76:79]
    ds_read_b128 v[124:127], v240 offset:11264
    v_mfma_f32_16x16x32_bf16 v[100:103], v[148:151], v[212:215], v[100:103]
    v_mfma_f32_16x16x32_bf16 v[72:75], v[152:155], v[216:219], v[72:75]
    ds_read_b128 v[128:131], v240 offset:16384
    v_mfma_f32_16x16x32_bf16 v[96:99], v[152:155], v[220:223], v[96:99]
    v_mfma_f32_16x16x32_bf16 v[76:79], v[156:159], v[216:219], v[76:79]
    ds_read_b128 v[132:135], v240 offset:17408
    v_mfma_f32_16x16x32_bf16 v[100:103], v[156:159], v[220:223], v[100:103]
    s_waitcnt lgkmcnt(3)
    v_mfma_f32_16x16x32_bf16 v[80:83], v[112:115], v[176:179], v[80:83]
    ds_read_b128 v[136:139], v240 offset:22528
    v_mfma_f32_16x16x32_bf16 v[104:107], v[112:115], v[180:183], v[104:107]
    v_mfma_f32_16x16x32_bf16 v[84:87], v[116:119], v[176:179], v[84:87]
    ds_read_b128 v[140:143], v240 offset:23552
    v_mfma_f32_16x16x32_bf16 v[108:111], v[116:119], v[180:183], v[108:111]
    v_mfma_f32_16x16x32_bf16 v[80:83], v[120:123], v[184:187], v[80:83]
    s_nop 0
    ds_read_b128 v[144:147], v241 offset:16384
    v_cvt_pk_bf16_f32 v72, v72, v73
    v_mfma_f32_16x16x32_bf16 v[104:107], v[120:123], v[188:191], v[104:107]
    s_waitcnt lgkmcnt(3)
    v_cvt_pk_bf16_f32 v73, v74, v75
    v_cvt_pk_bf16_f32 v74, v76, v77
    v_mfma_f32_16x16x32_bf16 v[84:87], v[124:127], v[184:187], v[84:87]
    s_nop 0
    ds_read_b128 v[148:151], v241 offset:17408
    v_cvt_pk_bf16_f32 v75, v78, v79
    v_mfma_f32_16x16x32_bf16 v[108:111], v[124:127], v[188:191], v[108:111]
    v_pk_max_i16 v72, v72, 0
    v_pk_max_i16 v73, v73, 0
    v_mfma_f32_16x16x32_bf16 v[80:83], v[128:131], v[192:195], v[80:83]
    s_nop 0
    ds_read_b128 v[152:155], v241 offset:22528
    v_pk_max_i16 v74, v74, 0
    v_mfma_f32_16x16x32_bf16 v[104:107], v[128:131], v[196:199], v[104:107]
    v_pk_max_i16 v75, v75, 0
    v_mfma_f32_16x16x32_bf16 v[84:87], v[132:135], v[192:195], v[84:87]
    ds_read_b128 v[156:159], v241 offset:23552
    buffer_store_dwordx4 v[72:75], v3, s[36:39], s20 offen offset:1024 sc0 sc1
    v_mfma_f32_16x16x32_bf16 v[108:111], v[132:135], v[196:199], v[108:111]
    s_waitcnt lgkmcnt(3)
    v_cvt_pk_bf16_f32 v96, v96, v97
    v_cvt_pk_bf16_f32 v97, v98, v99
    v_mfma_f32_16x16x32_bf16 v[80:83], v[136:139], v[200:203], v[80:83]
    v_cvt_pk_bf16_f32 v98, v100, v101
    v_mfma_f32_16x16x32_bf16 v[104:107], v[136:139], v[204:207], v[104:107]
    v_cvt_pk_bf16_f32 v99, v102, v103
    v_mfma_f32_16x16x32_bf16 v[84:87], v[140:143], v[200:203], v[84:87]
    v_pk_max_i16 v96, v96, 0
    v_pk_max_i16 v97, v97, 0
    v_mfma_f32_16x16x32_bf16 v[108:111], v[140:143], v[204:207], v[108:111]
    v_pk_max_i16 v98, v98, 0
    v_mfma_f32_16x16x32_bf16 v[80:83], v[144:147], v[208:211], v[80:83]
    v_pk_max_i16 v99, v99, 0
    v_mfma_f32_16x16x32_bf16 v[104:107], v[144:147], v[212:215], v[104:107]
    s_waitcnt lgkmcnt(0)
    buffer_store_dwordx4 v[96:99], v3, s[36:39], s21 offen offset:1024 sc0 sc1
    v_mfma_f32_16x16x32_bf16 v[84:87], v[148:151], v[208:211], v[84:87]
    v_mfma_f32_16x16x32_bf16 v[108:111], v[148:151], v[212:215], v[108:111]
    v_mfma_f32_16x16x32_bf16 v[80:83], v[152:155], v[216:219], v[80:83]
    v_mfma_f32_16x16x32_bf16 v[104:107], v[152:155], v[220:223], v[104:107]
    v_mfma_f32_16x16x32_bf16 v[84:87], v[156:159], v[216:219], v[84:87]
    v_mfma_f32_16x16x32_bf16 v[108:111], v[156:159], v[220:223], v[108:111]
    s_nop 4
    v_cvt_pk_bf16_f32 v80, v80, v81
    s_nop 0
    v_cvt_pk_bf16_f32 v84, v84, v85
    v_cvt_pk_bf16_f32 v81, v82, v83
    v_cvt_pk_bf16_f32 v85, v86, v87
    v_pk_max_i16 v80, v80, 0
    v_pk_max_i16 v81, v81, 0
    v_pk_max_i16 v82, v84, 0
    v_pk_max_i16 v83, v85, 0
    v_cvt_pk_bf16_f32 v104, v104, v105
    v_cvt_pk_bf16_f32 v108, v108, v109
    v_cvt_pk_bf16_f32 v105, v106, v107
    v_cvt_pk_bf16_f32 v109, v110, v111
    v_pk_max_i16 v104, v104, 0
    v_pk_max_i16 v105, v105, 0
    v_pk_max_i16 v106, v108, 0
    v_pk_max_i16 v107, v109, 0
    buffer_store_dwordx4 v[80:83], v3, s[36:39], s22 offen offset:2048 sc0 sc1
    buffer_store_dwordx4 v[104:107], v3, s[36:39], s23 offen offset:2048 sc0 sc1
    v_mov_b32 v4, 7
    s_cmp_lg_u32 s48, 0
    s_mov_b64 exec, 1
    s_waitcnt vmcnt(0)
    s_barrier
    s_cbranch_scc1 Lq_s_36
    buffer_store_dword v4, off, s[36:39], s55 sc0 sc1
Lq_s_36:
    s_mov_b64 exec, -1
    v_add_f32 v232, v232, v234
    v_add_f32 v233, v233, v235
    s_nop 1
    v_permlane32_swap_b32 v232, v233
    v_add_f32 v232, v232, v233
    v_mov_b32 v233, v232
    s_nop 1
    v_permlane16_swap_b32 v232, v233
    v_add_f32 v232, v232, v233
    v_mov_b32 v233, v232
    s_nop 1
    v_permlane32_swap_b32 v232, v233
    v_mul_f32 v42, 0xbb000000, v232
    v_mul_f32 v233, 0x3b000000, v233
    v_fma_f32 v233, -v42, v42, v233
    v_max_f32 v233, 0, v233
    v_add_f32 v233, 0x3727c5ac, v233
    v_rsq_f32 v43, v233
    s_mul_i32 s4, s48, 11264
    s_add_u32 s4, s4, 0x600000
    s_xor_b32 s5, s48, 0
    s_add_u32 s5, s5, s61
    s_mul_i32 s5, s5, 44032
    s_add_u32 s10, s5, s4
    s_xor_b32 s5, s48, 1
    s_add_u32 s5, s5, s61
    s_mul_i32 s5, s5, 44032
    s_add_u32 s11, s5, s4
    s_xor_b32 s5, s48, 2
    s_add_u32 s5, s5, s61
    s_mul_i32 s5, s5, 44032
    s_add_u32 s12, s5, s4
    s_xor_b32 s5, s48, 3
    s_add_u32 s5, s5, s61
    s_mul_i32 s5, s5, 44032
    s_add_u32 s13, s5, s4
    s_cmp_lg_u32 s48, 1
    s_cbranch_scc1 Lnw_8_1_s
    s_mov_b64 exec, 0
    s_branch Lret_8_1_s
Lret_8_1_s:
    s_mov_b64 exec, -1
Lnw_8_1_s:
    s_cmp_lg_u32 s48, 2
    s_cbranch_scc1 Lnw_8_2_s
    s_mov_b64 exec, 0
    s_branch Lret_8_2_s
Lret_8_2_s:
    s_mov_b64 exec, -1
Lnw_8_2_s:
    s_cmp_lg_u32 s48, 0
    s_cbranch_scc1 Ln_s_34
    buffer_load_dword v4, v17, s[36:39], s58 offen sc1
    s_nop 15
Lp_s_35:
    buffer_load_dword v5, v17, s[36:39], s58 offen sc1
    s_waitcnt vmcnt(1)
    v_cmp_gt_u32 vcc, 7, v4
    s_cbranch_vccz Ln_s_34
    buffer_load_dword v4, v17, s[36:39], s58 offen sc1
    s_waitcnt vmcnt(1)
    v_cmp_gt_u32 vcc, 7, v5
    s_cbranch_vccz Ln_s_34
    s_sub_u32 s14, s14, 1
    s_cbranch_scc1 L_end_s
    s_branch Lp_s_35
Ln_s_34:
    s_barrier
    buffer_load_dwordx4 v[64:67], v3, s[36:39], s13 offen sc1
    s_barrier
    buffer_load_dwordx4 v[68:71], v3, s[36:39], s13 offen offset:1024 sc1
    s_barrier
    buffer_load_dwordx4 v[72:75], v3, s[36:39], s13 offen offset:2048 sc1
    s_barrier
    buffer_load_dwordx4 v[76:79], v3, s[36:39], s13 offen offset:3072 sc1
    s_barrier
    s_add_u32 s17, s13, 0x1000
    buffer_load_dwordx4 v[80:83], v3, s[36:39], s17 offen sc1
    s_barrier
    buffer_load_dwordx4 v[84:87], v3, s[36:39], s17 offen offset:1024 sc1
    s_waitcnt vmcnt(5)
    v_mfma_f32_16x16x32_bf16 v[144:147], a[64:67], v[64:67], 0
    buffer_load_dwordx4 v[88:91], v3, s[36:39], s17 offen offset:2048 sc1
    v_mfma_f32_16x16x32_bf16 v[148:151], a[68:71], v[64:67], 0
    v_mfma_f32_16x16x32_bf16 v[152:155], a[72:75], v[64:67], 0
    buffer_load_dwordx4 v[92:95], v3, s[36:39], s17 offen offset:3072 sc1
    v_mfma_f32_16x16x32_bf16 v[156:159], a[76:79], v[64:67], 0
    s_waitcnt vmcnt(6)
    v_mfma_f32_16x16x32_bf16 v[144:147], a[80:83], v[68:71], v[144:147]
    s_add_u32 s18, s13, 0x2000
    buffer_load_dwordx4 v[96:99], v3, s[36:39], s18 offen sc1
    v_mfma_f32_16x16x32_bf16 v[148:151], a[84:87], v[68:71], v[148:151]
    v_mfma_f32_16x16x32_bf16 v[152:155], a[88:91], v[68:71], v[152:155]
    v_mfma_f32_16x16x32_bf16 v[156:159], a[92:95], v[68:71], v[156:159]
    s_waitcnt vmcnt(6)
    v_mfma_f32_16x16x32_bf16 v[144:147], a[96:99], v[72:75], v[144:147]
    buffer_load_dwordx4 v[100:103], v3, s[36:39], s18 offen offset:1024 sc1
    v_mfma_f32_16x16x32_bf16 v[148:151], a[100:103], v[72:75], v[148:151]
    s_add_u32 s4, s13, 10240
    v_mfma_f32_16x16x32_bf16 v[152:155], a[104:107], v[72:75], v[152:155]
    s_cmp_eq_u32 s48, 3
    v_mfma_f32_16x16x32_bf16 v[156:159], a[108:111], v[72:75], v[156:159]
    s_waitcnt vmcnt(6)
    v_mfma_f32_16x16x32_bf16 v[144:147], a[112:115], v[76:79], v[144:147]
    s_cselect_b32 s4, 0x80000000, s4
    buffer_load_dwordx4 v[104:107], v3, s[36:39], s4 offen sc1
    v_mfma_f32_16x16x32_bf16 v[148:151], a[116:119], v[76:79], v[148:151]
    v_mfma_f32_16x16x32_bf16 v[152:155], a[120:123], v[76:79], v[152:155]
    v_mfma_f32_16x16x32_bf16 v[156:159], a[124:127], v[76:79], v[156:159]
    s_waitcnt vmcnt(6)
    v_mfma_f32_16x16x32_bf16 v[144:147], a[128:131], v[80:83], v[144:147]
    buffer_load_dwordx4 v[108:111], v3, s[36:39], s12 offen sc1
    v_mfma_f32_16x16x32_bf16 v[148:151], a[132:135], v[80:83], v[148:151]
    v_mfma_f32_16x16x32_bf16 v[152:155], a[136:139], v[80:83], v[152:155]
    v_mfma_f32_16x16x32_bf16 v[156:159], a[140:143], v[80:83], v[156:159]
    s_waitcnt vmcnt(6)
    v_mfma_f32_16x16x32_bf16 v[144:147], a[144:147], v[84:87], v[144:147]
    buffer_load_dwordx4 v[112:115], v3, s[36:39], s12 offen offset:1024 sc1
    v_and_b32 v4, 7, v1
    v_mfma_f32_16x16x32_bf16 v[148:151], a[148:151], v[84:87], v[148:151]
    v_mfma_f32_16x16x32_bf16 v[152:155], a[152:155], v[84:87], v[152:155]
    v_xor_b32 v4, v4, v2
    v_mfma_f32_16x16x32_bf16 v[156:159], a[156:159], v[84:87], v[156:159]
    s_waitcnt vmcnt(6)
    v_mfma_f32_16x16x32_bf16 v[144:147], a[160:163], v[88:91], v[144:147]
    buffer_load_dwordx4 v[116:119], v3, s[36:39], s12 offen offset:2048 sc1
    v_lshlrev_b32 v4, 4, v4
    v_mfma_f32_16x16x32_bf16 v[148:151], a[164:167], v[88:91], v[148:151]
    v_mfma_f32_16x16x32_bf16 v[152:155], a[168:171], v[88:91], v[152:155]
    v_lshl_add_u32 v4, v1, 7, v4
    v_mfma_f32_16x16x32_bf16 v[156:159], a[172:175], v[88:91], v[156:159]
    s_waitcnt vmcnt(6)
    v_mfma_f32_16x16x32_bf16 v[144:147], a[176:179], v[92:95], v[144:147]
    s_lshl_b32 s6, s48, 11
    buffer_load_dwordx4 v[120:123], v3, s[36:39], s12 offen offset:3072 sc1
    v_add_u32 v4, s6, v4
    v_mfma_f32_16x16x32_bf16 v[148:151], a[180:183], v[92:95], v[148:151]
    v_mfma_f32_16x16x32_bf16 v[152:155], a[184:187], v[92:95], v[152:155]
    v_xor_b32 v5, 64, v4
    v_mfma_f32_16x16x32_bf16 v[156:159], a[188:191], v[92:95], v[156:159]
    s_waitcnt vmcnt(6)
    v_mfma_f32_16x16x32_bf16 v[144:147], a[192:195], v[96:99], v[144:147]
    s_add_u32 s16, s12, 0x1000
    buffer_load_dwordx4 v[124:127], v3, s[36:39], s16 offen sc1
    v_lshrrev_b32 v6, 3, v3
    v_mfma_f32_16x16x32_bf16 v[148:151], a[196:199], v[96:99], v[148:151]
    v_mfma_f32_16x16x32_bf16 v[152:155], a[200:203], v[96:99], v[152:155]
    v_and_b32 v6, 0x70, v6
    v_mfma_f32_16x16x32_bf16 v[156:159], a[204:207], v[96:99], v[156:159]
    s_waitcnt vmcnt(6)
    v_mfma_f32_16x16x32_bf16 v[144:147], a[208:211], v[100:103], v[144:147]
    buffer_load_dwordx4 v[64:67], v3, s[36:39], s16 offen offset:1024 sc1
    v_xor_b32 v6, v6, v3
    v_mfma_f32_16x16x32_bf16 v[148:151], a[212:215], v[100:103], v[148:151]
    v_mfma_f32_16x16x32_bf16 v[152:155], a[216:219], v[100:103], v[152:155]
    v_add_u32 v6, s6, v6
    v_mfma_f32_16x16x32_bf16 v[156:159], a[220:223], v[100:103], v[156:159]
    s_waitcnt vmcnt(6)
    v_mfma_f32_16x16x32_bf16 v[144:147], a[224:227], v[104:107], v[144:147]
    buffer_load_dwordx4 v[68:71], v3, s[36:39], s16 offen offset:2048 sc1
    v_mfma_f32_16x16x32_bf16 v[148:151], a[228:231], v[104:107], v[148:151]
    v_mfma_f32_16x16x32_bf16 v[152:155], a[232:235], v[104:107], v[152:155]
    v_mfma_f32_16x16x32_bf16 v[156:159], a[236:239], v[104:107], v[156:159]
    s_waitcnt vmcnt(6)
    v_mfma_f32_16x16x32_bf16 v[128:131], a[64:67], v[108:111], 0
    buffer_load_dwordx4 v[72:75], v3, s[36:39], s16 offen offset:3072 sc1
    v_mfma_f32_16x16x32_bf16 v[132:135], a[68:71], v[108:111], 0
    ds_write_b128 v38, v[144:147] offset:0
    v_mfma_f32_16x16x32_bf16 v[136:139], a[72:75], v[108:111], 0
    v_mfma_f32_16x16x32_bf16 v[140:143], a[76:79], v[108:111], 0
    s_waitcnt vmcnt(6)
    v_mfma_f32_16x16x32_bf16 v[128:131], a[80:83], v[112:115], v[128:131]
    s_add_u32 s17, s12, 0x2000
    buffer_load_dwordx4 v[76:79], v3, s[36:39], s17 offen sc1
    v_mfma_f32_16x16x32_bf16 v[132:135], a[84:87], v[112:115], v[132:135]
    ds_write_b128 v38, v[148:151] offset:1024
    v_mfma_f32_16x16x32_bf16 v[136:139], a[88:91], v[112:115], v[136:139]
    v_mfma_f32_16x16x32_bf16 v[140:143], a[92:95], v[112:115], v[140:143]
    s_waitcnt vmcnt(6)
    v_mfma_f32_16x16x32_bf16 v[128:131], a[96:99], v[116:119], v[128:131]
    buffer_load_dwordx4 v[80:83], v3, s[36:39], s17 offen offset:1024 sc1
    v_mfma_f32_16x16x32_bf16 v[132:135], a[100:103], v[116:119], v[132:135]
    s_add_u32 s4, s12, 10240
    ds_write_b128 v38, v[152:155] offset:2048
    v_mfma_f32_16x16x32_bf16 v[136:139], a[104:107], v[116:119], v[136:139]
    s_cmp_eq_u32 s48, 3
    v_mfma_f32_16x16x32_bf16 v[140:143], a[108:111], v[116:119], v[140:143]
    s_waitcnt vmcnt(6)
    v_mfma_f32_16x16x32_bf16 v[128:131], a[112:115], v[120:123], v[128:131]
    s_cselect_b32 s4, 0x80000000, s4
    buffer_load_dwordx4 v[84:87], v3, s[36:39], s4 offen sc1
    v_mfma_f32_16x16x32_bf16 v[132:135], a[116:119], v[120:123], v[132:135]
    ds_write_b128 v38, v[156:159] offset:3072
    v_mfma_f32_16x16x32_bf16 v[136:139], a[120:123], v[120:123], v[136:139]
    v_mfma_f32_16x16x32_bf16 v[140:143], a[124:127], v[120:123], v[140:143]
    s_waitcnt vmcnt(6)
    v_mfma_f32_16x16x32_bf16 v[128:131], a[128:131], v[124:127], v[128:131]
    buffer_load_dwordx4 v[88:91], v3, s[36:39], s11 offen sc1
    v_mfma_f32_16x16x32_bf16 v[132:135], a[132:135], v[124:127], v[132:135]
    v_mfma_f32_16x16x32_bf16 v[136:139], a[136:139], v[124:127], v[136:139]
    v_mfma_f32_16x16x32_bf16 v[140:143], a[140:143], v[124:127], v[140:143]
    s_waitcnt lgkmcnt(0)
    s_barrier
    s_waitcnt vmcnt(6)
    ds_read_b128 v[192:195], v39 offset:0
    v_mfma_f32_16x16x32_bf16 v[128:131], a[144:147], v[64:67], v[128:131]
    buffer_load_dwordx4 v[92:95], v3, s[36:39], s11 offen offset:1024 sc1
    ds_read_b128 v[196:199], v39 offset:1024
    v_mfma_f32_16x16x32_bf16 v[132:135], a[148:151], v[64:67], v[132:135]
    ds_read_b128 v[200:203], v39 offset:2048
    v_mfma_f32_16x16x32_bf16 v[136:139], a[152:155], v[64:67], v[136:139]
    ds_read_b128 v[204:207], v39 offset:3072
    v_mfma_f32_16x16x32_bf16 v[140:143], a[156:159], v[64:67], v[140:143]
    s_waitcnt vmcnt(6)
    v_mfma_f32_16x16x32_bf16 v[128:131], a[160:163], v[68:71], v[128:131]
    buffer_load_dwordx4 v[96:99], v3, s[36:39], s11 offen offset:2048 sc1
    v_mfma_f32_16x16x32_bf16 v[132:135], a[164:167], v[68:71], v[132:135]
    v_mfma_f32_16x16x32_bf16 v[136:139], a[168:171], v[68:71], v[136:139]
    v_mfma_f32_16x16x32_bf16 v[140:143], a[172:175], v[68:71], v[140:143]
    s_waitcnt vmcnt(6)
    v_mfma_f32_16x16x32_bf16 v[128:131], a[176:179], v[72:75], v[128:131]
    buffer_load_dwordx4 v[100:103], v3, s[36:39], s11 offen offset:3072 sc1
    v_mfma_f32_16x16x32_bf16 v[132:135], a[180:183], v[72:75], v[132:135]
    v_mfma_f32_16x16x32_bf16 v[136:139], a[184:187], v[72:75], v[136:139]
    s_waitcnt lgkmcnt(0)
    v_fmac_f32 v48, v43, v192
    v_fmac_f32 v49, v43, v193
    v_mfma_f32_16x16x32_bf16 v[140:143], a[188:191], v[72:75], v[140:143]
    s_waitcnt vmcnt(6)
    v_fmac_f32 v50, v43, v194
    v_mfma_f32_16x16x32_bf16 v[128:131], a[192:195], v[76:79], v[128:131]
    s_add_u32 s18, s11, 0x1000
    buffer_load_dwordx4 v[104:107], v3, s[36:39], s18 offen sc1
    v_fmac_f32 v51, v43, v195
    v_mfma_f32_16x16x32_bf16 v[132:135], a[196:199], v[76:79], v[132:135]
    v_fmac_f32 v52, v43, v196
    v_mfma_f32_16x16x32_bf16 v[136:139], a[200:203], v[76:79], v[136:139]
    v_fmac_f32 v53, v43, v197
    v_mfma_f32_16x16x32_bf16 v[140:143], a[204:207], v[76:79], v[140:143]
    s_waitcnt vmcnt(6)
    v_fmac_f32 v54, v43, v198
    v_mfma_f32_16x16x32_bf16 v[128:131], a[208:211], v[80:83], v[128:131]
    buffer_load_dwordx4 v[108:111], v3, s[36:39], s18 offen offset:1024 sc1
    v_fmac_f32 v55, v43, v199
    v_mfma_f32_16x16x32_bf16 v[132:135], a[212:215], v[80:83], v[132:135]
    v_fmac_f32 v56, v43, v200
    v_fmac_f32 v57, v43, v201
    v_mfma_f32_16x16x32_bf16 v[136:139], a[216:219], v[80:83], v[136:139]
    v_fmac_f32 v58, v43, v202
    v_mfma_f32_16x16x32_bf16 v[140:143], a[220:223], v[80:83], v[140:143]
    s_waitcnt vmcnt(6)
    v_fmac_f32 v59, v43, v203
    v_mfma_f32_16x16x32_bf16 v[128:131], a[224:227], v[84:87], v[128:131]
    buffer_load_dwordx4 v[112:115], v3, s[36:39], s18 offen offset:2048 sc1
    v_fmac_f32 v60, v43, v204
    v_mfma_f32_16x16x32_bf16 v[132:135], a[228:231], v[84:87], v[132:135]
    v_fmac_f32 v61, v43, v205
    v_mfma_f32_16x16x32_bf16 v[136:139], a[232:235], v[84:87], v[136:139]
    v_fmac_f32 v62, v43, v206
    v_mfma_f32_16x16x32_bf16 v[140:143], a[236:239], v[84:87], v[140:143]
    s_waitcnt vmcnt(6)
    v_fmac_f32 v63, v43, v207
    v_mfma_f32_16x16x32_bf16 v[144:147], a[64:67], v[88:91], 0
    buffer_load_dwordx4 v[116:119], v3, s[36:39], s18 offen offset:3072 sc1
    v_mfma_f32_16x16x32_bf16 v[148:151], a[68:71], v[88:91], 0
    ds_write_b128 v37, v[128:131] offset:16384
    v_mfma_f32_16x16x32_bf16 v[152:155], a[72:75], v[88:91], 0
    v_mfma_f32_16x16x32_bf16 v[156:159], a[76:79], v[88:91], 0
    s_waitcnt vmcnt(6)
    v_mfma_f32_16x16x32_bf16 v[144:147], a[80:83], v[92:95], v[144:147]
    s_add_u32 s16, s11, 0x2000
    buffer_load_dwordx4 v[120:123], v3, s[36:39], s16 offen sc1
    v_mfma_f32_16x16x32_bf16 v[148:151], a[84:87], v[92:95], v[148:151]
    ds_write_b128 v37, v[132:135] offset:17408
    v_mfma_f32_16x16x32_bf16 v[152:155], a[88:91], v[92:95], v[152:155]
    v_mfma_f32_16x16x32_bf16 v[156:159], a[92:95], v[92:95], v[156:159]
    s_waitcnt vmcnt(6)
    v_mfma_f32_16x16x32_bf16 v[144:147], a[96:99], v[96:99], v[144:147]
    buffer_load_dwordx4 v[124:127], v3, s[36:39], s16 offen offset:1024 sc1
    v_mfma_f32_16x16x32_bf16 v[148:151], a[100:103], v[96:99], v[148:151]
    s_add_u32 s4, s11, 10240
    ds_write_b128 v37, v[136:139] offset:18432
    v_mfma_f32_16x16x32_bf16 v[152:155], a[104:107], v[96:99], v[152:155]
    s_cmp_eq_u32 s48, 3
    v_mfma_f32_16x16x32_bf16 v[156:159], a[108:111], v[96:99], v[156:159]
    s_waitcnt vmcnt(6)
    v_mfma_f32_16x16x32_bf16 v[144:147], a[112:115], v[100:103], v[144:147]
    s_cselect_b32 s4, 0x80000000, s4
    buffer_load_dwordx4 v[64:67], v3, s[36:39], s4 offen sc1
    v_mfma_f32_16x16x32_bf16 v[148:151], a[116:119], v[100:103], v[148:151]
    ds_write_b128 v37, v[140:143] offset:19456
    v_mfma_f32_16x16x32_bf16 v[152:155], a[120:123], v[100:103], v[152:155]
    v_mfma_f32_16x16x32_bf16 v[156:159], a[124:127], v[100:103], v[156:159]
    s_waitcnt vmcnt(6)
    v_mfma_f32_16x16x32_bf16 v[144:147], a[128:131], v[104:107], v[144:147]
    buffer_load_dwordx4 v[68:71], v3, s[36:39], s10 offen sc1
    v_mfma_f32_16x16x32_bf16 v[148:151], a[132:135], v[104:107], v[148:151]
    v_mfma_f32_16x16x32_bf16 v[152:155], a[136:139], v[104:107], v[152:155]
    v_mfma_f32_16x16x32_bf16 v[156:159], a[140:143], v[104:107], v[156:159]
    s_waitcnt lgkmcnt(0)
    s_barrier
    s_waitcnt vmcnt(6)
    ds_read_b128 v[160:163], v39 offset:16384
    v_mfma_f32_16x16x32_bf16 v[144:147], a[144:147], v[108:111], v[144:147]
    buffer_load_dwordx4 v[72:75], v3, s[36:39], s10 offen offset:1024 sc1
    ds_read_b128 v[164:167], v39 offset:17408
    v_mfma_f32_16x16x32_bf16 v[148:151], a[148:151], v[108:111], v[148:151]
    ds_read_b128 v[168:171], v39 offset:18432
    v_mfma_f32_16x16x32_bf16 v[152:155], a[152:155], v[108:111], v[152:155]
    ds_read_b128 v[172:175], v39 offset:19456
    v_mfma_f32_16x16x32_bf16 v[156:159], a[156:159], v[108:111], v[156:159]
    s_waitcnt vmcnt(6)
    v_mfma_f32_16x16x32_bf16 v[144:147], a[160:163], v[112:115], v[144:147]
    buffer_load_dwordx4 v[76:79], v3, s[36:39], s10 offen offset:2048 sc1
    v_mfma_f32_16x16x32_bf16 v[148:151], a[164:167], v[112:115], v[148:151]
    v_mfma_f32_16x16x32_bf16 v[152:155], a[168:171], v[112:115], v[152:155]
    v_mfma_f32_16x16x32_bf16 v[156:159], a[172:175], v[112:115], v[156:159]
    s_waitcnt vmcnt(6)
    v_mfma_f32_16x16x32_bf16 v[144:147], a[176:179], v[116:119], v[144:147]
    buffer_load_dwordx4 v[80:83], v3, s[36:39], s10 offen offset:3072 sc1
    v_mfma_f32_16x16x32_bf16 v[148:151], a[180:183], v[116:119], v[148:151]
    v_mfma_f32_16x16x32_bf16 v[152:155], a[184:187], v[116:119], v[152:155]
    s_waitcnt lgkmcnt(0)
    v_fmac_f32 v48, v43, v160
    v_fmac_f32 v49, v43, v161
    v_mfma_f32_16x16x32_bf16 v[156:159], a[188:191], v[116:119], v[156:159]
    s_waitcnt vmcnt(6)
    v_fmac_f32 v50, v43, v162
    v_mfma_f32_16x16x32_bf16 v[144:147], a[192:195], v[120:123], v[144:147]
    s_add_u32 s17, s10, 0x1000
    buffer_load_dwordx4 v[84:87], v3, s[36:39], s17 offen sc1
    v_fmac_f32 v51, v43, v163
    v_mfma_f32_16x16x32_bf16 v[148:151], a[196:199], v[120:123], v[148:151]
    v_fmac_f32 v52, v43, v164
    v_mfma_f32_16x16x32_bf16 v[152:155], a[200:203], v[120:123], v[152:155]
    v_fmac_f32 v53, v43, v165
    v_mfma_f32_16x16x32_bf16 v[156:159], a[204:207], v[120:123], v[156:159]
    s_waitcnt vmcnt(6)
    v_fmac_f32 v54, v43, v166
    v_mfma_f32_16x16x32_bf16 v[144:147], a[208:211], v[124:127], v[144:147]
    buffer_load_dwordx4 v[88:91], v3, s[36:39], s17 offen offset:1024 sc1
    v_fmac_f32 v55, v43, v167
    v_mfma_f32_16x16x32_bf16 v[148:151], a[212:215], v[124:127], v[148:151]
    v_fmac_f32 v56, v43, v168
    v_fmac_f32 v57, v43, v169
    v_mfma_f32_16x16x32_bf16 v[152:155], a[216:219], v[124:127], v[152:155]
    v_fmac_f32 v58, v43, v170
    v_mfma_f32_16x16x32_bf16 v[156:159], a[220:223], v[124:127], v[156:159]
    s_waitcnt vmcnt(6)
    v_fmac_f32 v59, v43, v171
    v_mfma_f32_16x16x32_bf16 v[144:147], a[224:227], v[64:67], v[144:147]
    buffer_load_dwordx4 v[92:95], v3, s[36:39], s17 offen offset:2048 sc1
    v_fmac_f32 v60, v43, v172
    v_mfma_f32_16x16x32_bf16 v[148:151], a[228:231], v[64:67], v[148:151]
    v_fmac_f32 v61, v43, v173
    v_mfma_f32_16x16x32_bf16 v[152:155], a[232:235], v[64:67], v[152:155]
    v_fmac_f32 v62, v43, v174
    v_mfma_f32_16x16x32_bf16 v[156:159], a[236:239], v[64:67], v[156:159]
    s_waitcnt vmcnt(6)
    v_fmac_f32 v63, v43, v175
    v_mfma_f32_16x16x32_bf16 v[128:131], a[64:67], v[68:71], 0
    buffer_load_dwordx4 v[96:99], v3, s[36:39], s17 offen offset:3072 sc1
    v_mfma_f32_16x16x32_bf16 v[132:135], a[68:71], v[68:71], 0
    ds_write_b128 v36, v[144:147] offset:0
    v_mfma_f32_16x16x32_bf16 v[136:139], a[72:75], v[68:71], 0
    v_mfma_f32_16x16x32_bf16 v[140:143], a[76:79], v[68:71], 0
    s_waitcnt vmcnt(6)
    v_mfma_f32_16x16x32_bf16 v[128:131], a[80:83], v[72:75], v[128:131]
    s_add_u32 s18, s10, 0x2000
    buffer_load_dwordx4 v[100:103], v3, s[36:39], s18 offen sc1
    v_mfma_f32_16x16x32_bf16 v[132:135], a[84:87], v[72:75], v[132:135]
    ds_write_b128 v36, v[148:151] offset:1024
    v_mfma_f32_16x16x32_bf16 v[136:139], a[88:91], v[72:75], v[136:139]
    v_mfma_f32_16x16x32_bf16 v[140:143], a[92:95], v[72:75], v[140:143]
    s_waitcnt vmcnt(6)
    v_mfma_f32_16x16x32_bf16 v[128:131], a[96:99], v[76:79], v[128:131]
    buffer_load_dwordx4 v[104:107], v3, s[36:39], s18 offen offset:1024 sc1
    v_mfma_f32_16x16x32_bf16 v[132:135], a[100:103], v[76:79], v[132:135]
    s_add_u32 s4, s10, 10240
    ds_write_b128 v36, v[152:155] offset:2048
    v_mfma_f32_16x16x32_bf16 v[136:139], a[104:107], v[76:79], v[136:139]
    s_cmp_eq_u32 s48, 3
    v_mfma_f32_16x16x32_bf16 v[140:143], a[108:111], v[76:79], v[140:143]
    s_waitcnt vmcnt(6)
    v_mfma_f32_16x16x32_bf16 v[128:131], a[112:115], v[80:83], v[128:131]
    s_cselect_b32 s4, 0x80000000, s4
    buffer_load_dwordx4 v[108:111], v3, s[36:39], s4 offen sc1
    v_mfma_f32_16x16x32_bf16 v[132:135], a[116:119], v[80:83], v[132:135]
    ds_write_b128 v36, v[156:159] offset:3072
    v_mfma_f32_16x16x32_bf16 v[136:139], a[120:123], v[80:83], v[136:139]
    v_mfma_f32_16x16x32_bf16 v[140:143], a[124:127], v[80:83], v[140:143]
    s_waitcnt vmcnt(6)
    v_mfma_f32_16x16x32_bf16 v[128:131], a[128:131], v[84:87], v[128:131]
    v_mfma_f32_16x16x32_bf16 v[132:135], a[132:135], v[84:87], v[132:135]
    v_mfma_f32_16x16x32_bf16 v[136:139], a[136:139], v[84:87], v[136:139]
    v_mfma_f32_16x16x32_bf16 v[140:143], a[140:143], v[84:87], v[140:143]
    s_waitcnt lgkmcnt(0)
    s_barrier
    s_waitcnt vmcnt(5)
    ds_read_b128 v[176:179], v39 offset:0
    v_mfma_f32_16x16x32_bf16 v[128:131], a[144:147], v[88:91], v[128:131]
    ds_read_b128 v[180:183], v39 offset:1024
    v_mfma_f32_16x16x32_bf16 v[132:135], a[148:151], v[88:91], v[132:135]
    ds_read_b128 v[184:187], v39 offset:2048
    v_mfma_f32_16x16x32_bf16 v[136:139], a[152:155], v[88:91], v[136:139]
    ds_read_b128 v[188:191], v39 offset:3072
    v_mfma_f32_16x16x32_bf16 v[140:143], a[156:159], v[88:91], v[140:143]
    s_waitcnt vmcnt(4)
    v_mfma_f32_16x16x32_bf16 v[128:131], a[160:163], v[92:95], v[128:131]
    v_mfma_f32_16x16x32_bf16 v[132:135], a[164:167], v[92:95], v[132:135]
    v_mfma_f32_16x16x32_bf16 v[136:139], a[168:171], v[92:95], v[136:139]
    v_mfma_f32_16x16x32_bf16 v[140:143], a[172:175], v[92:95], v[140:143]
    s_waitcnt vmcnt(3)
    v_mfma_f32_16x16x32_bf16 v[128:131], a[176:179], v[96:99], v[128:131]
    v_mfma_f32_16x16x32_bf16 v[132:135], a[180:183], v[96:99], v[132:135]
    v_mfma_f32_16x16x32_bf16 v[136:139], a[184:187], v[96:99], v[136:139]
    s_waitcnt lgkmcnt(0)
    v_fmac_f32 v48, v43, v176
    v_fmac_f32 v49, v43, v177
    v_mfma_f32_16x16x32_bf16 v[140:143], a[188:191], v[96:99], v[140:143]
    s_waitcnt vmcnt(2)
    v_fmac_f32 v50, v43, v178
    v_mfma_f32_16x16x32_bf16 v[128:131], a[192:195], v[100:103], v[128:131]
    v_fmac_f32 v51, v43, v179
    v_mfma_f32_16x16x32_bf16 v[132:135], a[196:199], v[100:103], v[132:135]
    v_fmac_f32 v52, v43, v180
    v_mfma_f32_16x16x32_bf16 v[136:139], a[200:203], v[100:103], v[136:139]
    v_fmac_f32 v53, v43, v181
    v_mfma_f32_16x16x32_bf16 v[140:143], a[204:207], v[100:103], v[140:143]
    s_waitcnt vmcnt(1)
    v_fmac_f32 v54, v43, v182
    v_mfma_f32_16x16x32_bf16 v[128:131], a[208:211], v[104:107], v[128:131]
    v_fmac_f32 v55, v43, v183
    v_mfma_f32_16x16x32_bf16 v[132:135], a[212:215], v[104:107], v[132:135]
    s_add_u32 s4, s61, s48
    v_fmac_f32 v56, v43, v184
    v_fmac_f32 v57, v43, v185
    v_mfma_f32_16x16x32_bf16 v[136:139], a[216:219], v[104:107], v[136:139]
    s_lshl_b32 s4, s4, 14
    v_fmac_f32 v58, v43, v186
    v_mfma_f32_16x16x32_bf16 v[140:143], a[220:223], v[104:107], v[140:143]
    s_waitcnt vmcnt(0)
    v_fmac_f32 v59, v43, v187
    v_mfma_f32_16x16x32_bf16 v[128:131], a[224:227], v[108:111], v[128:131]
    s_lshl_b32 s5, s60, 7
    v_fmac_f32 v60, v43, v188
    v_mfma_f32_16x16x32_bf16 v[132:135], a[228:231], v[108:111], v[132:135]
    s_add_u32 s4, s4, s5
    v_fmac_f32 v61, v43, v189
    v_mfma_f32_16x16x32_bf16 v[136:139], a[232:235], v[108:111], v[136:139]
    s_add_u32 s5, s4, 8192
    v_fmac_f32 v62, v43, v190
    v_mfma_f32_16x16x32_bf16 v[140:143], a[236:239], v[108:111], v[140:143]
    v_fmac_f32 v63, v43, v191
    v_pk_fma_f32 v[48:49], v[128:129], v[42:43], v[48:49] op_sel:[0,1,0] op_sel_hi:[1,1,1]
    v_pk_fma_f32 v[50:51], v[130:131], v[42:43], v[50:51] op_sel:[0,1,0] op_sel_hi:[1,1,1]
    v_pk_fma_f32 v[52:53], v[132:133], v[42:43], v[52:53] op_sel:[0,1,0] op_sel_hi:[1,1,1]
    v_pk_fma_f32 v[54:55], v[134:135], v[42:43], v[54:55] op_sel:[0,1,0] op_sel_hi:[1,1,1]
    v_cvt_pk_bf16_f32 v208, v48, v49
    v_cvt_pk_bf16_f32 v209, v50, v51
    v_cvt_pk_bf16_f32 v210, v52, v53
    v_cvt_pk_bf16_f32 v211, v54, v55
    ds_write_b128 v4, v[208:211]
    v_pk_fma_f32 v[56:57], v[136:137], v[42:43], v[56:57] op_sel:[0,1,0] op_sel_hi:[1,1,1]
    v_pk_fma_f32 v[58:59], v[138:139], v[42:43], v[58:59] op_sel:[0,1,0] op_sel_hi:[1,1,1]
    v_pk_fma_f32 v[60:61], v[140:141], v[42:43], v[60:61] op_sel:[0,1,0] op_sel_hi:[1,1,1]
    v_pk_fma_f32 v[62:63], v[142:143], v[42:43], v[62:63] op_sel:[0,1,0] op_sel_hi:[1,1,1]
    v_cvt_pk_bf16_f32 v212, v56, v57
    v_cvt_pk_bf16_f32 v213, v58, v59
    v_cvt_pk_bf16_f32 v214, v60, v61
    v_cvt_pk_bf16_f32 v215, v62, v63
    ds_write_b128 v5, v[212:215]
    ds_read_b128 v[160:163], v6 offset:0
    ds_read_b128 v[164:167], v6 offset:1024
    s_waitcnt lgkmcnt(1)
    buffer_store_dwordx4 v[160:163], v8, s[40:43], s4 offen nt
    s_waitcnt lgkmcnt(0)
    buffer_store_dwordx4 v[164:167], v8, s[40:43], s5 offen nt
L_end_s:
    s_endpgm
    .fill 4500, 4, 0xbf810000
.section .rodata,"a"
.p2align 6
.amdhsa_kernel interleave_layers__sliding_local_dilated__dense_activation_relu__prompt_kernel
  .amdhsa_next_free_vgpr 512
  .amdhsa_next_free_sgpr 102
  .amdhsa_accum_offset 256
  .amdhsa_group_segment_fixed_size 0
  .amdhsa_kernarg_size 72
  .amdhsa_user_sgpr_count 2
  .amdhsa_user_sgpr_kernarg_segment_ptr 1
  .amdhsa_system_sgpr_workgroup_id_x 1
  .amdhsa_float_denorm_mode_32 3
.end_amdhsa_kernel
```
